```python
import torch

def _softmax(x, axis=-1):
    return torch.softmax(x, dim=axis)

def _gelu(x):
    return torch.nn.functional.gelu(x, approximate='tanh')

def _silu(x):
    return torch.nn.functional.silu(x)

def _sigmoid(x):
    return torch.sigmoid(x)

def _layernorm(x, axis=-1, eps=1e-05):
    m = x.mean(dim=axis, keepdim=True)
    v = x.var(dim=axis, keepdim=True, unbiased=False)
    return (x - m) / torch.sqrt(v + eps)

def _scatter_add(tgt, idx, src, axis=0):
    return tgt.clone().index_add_(axis, idx, src)

def _segment_sum(src, seg, n):
    out = torch.zeros((n,) + src.shape[1:], dtype=src.dtype)
    return out.index_add_(0, seg, src)

def _pad(x, pw):
    flat = tuple((v for pair in reversed(pw) for v in pair))
    return torch.nn.functional.pad(x, flat)
kernel_name = 'gated_mix__mha_block__memory_aug_recurrent_mem_tr__prompt'

def setup_inputs():

    _w = lambda a: (lambda t: t.to(torch.bfloat16) if t.is_floating_point() else t)(torch.as_tensor(a))

    def _A_setup():
        B, S, D, H = (1, 2048, 640, 32)
        return {'x': _w((lambda *s: torch.randn(*s, dtype=torch.bfloat16) * 0.05)(B, S, D)), 'wqkv': _w((lambda *s: torch.randn(*s, dtype=torch.bfloat16) * 0.8)(D, 3 * D)), 'wo': _w((lambda *s: torch.randn(*s, dtype=torch.bfloat16) * 0.05)(D, D))}
    _A_in = _A_setup()

    def _B_setup():
        B, S, Dm = (1, 2048, 640)
        H, Dh = (32, 128)
        M, seg = (8, 32)
        seg = min(seg, S)
        S = S // seg * seg
        return {'x': _w((lambda *s: torch.randn(*s, dtype=torch.bfloat16) * 0.05)(B, S, Dm)), 'mem0': _w((lambda *s: torch.randn(*s, dtype=torch.bfloat16) * 0.8)(B, M, Dm)), 'Wq': _w((lambda *s: torch.randn(*s, dtype=torch.bfloat16) * 3.2)(Dm, H, Dh) * Dm ** (-0.5)), 'Wk': _w((lambda *s: torch.randn(*s, dtype=torch.bfloat16) * 3.2)(Dm, H, Dh) * Dm ** (-0.5)), 'Wv': _w((lambda *s: torch.randn(*s, dtype=torch.bfloat16) * 0.8)(Dm, H, Dh) * Dm ** (-0.5)), 'Wo': _w((lambda *s: torch.randn(*s, dtype=torch.bfloat16) * 0.8)(H, Dh, Dm) * (H * Dh) ** (-0.5)), 'seg_len': seg}
    _B_in = _B_setup()
    return {'A_x': _A_in['x'], 'A_wqkv': _A_in['wqkv'], 'A_wo': _A_in['wo'], 'B_x': _B_in['x'], 'B_mem0': _B_in['mem0'], 'B_Wq': _B_in['Wq'], 'B_Wk': _B_in['Wk'], 'B_Wv': _B_in['Wv'], 'B_Wo': _B_in['Wo'], 'B_seg_len': _B_in['seg_len'], 'gate_w': _w((lambda *s: torch.randn(*s, dtype=torch.bfloat16) * 0.05)(640) * 16.0)}

def reference(A_x, A_wqkv, A_wo, B_x, B_mem0, B_Wq, B_Wk, B_Wv, B_Wo, B_seg_len, gate_w):

    def _A_ref(x, wqkv, wo):
        B, S, D = x.shape
        H = 32
        Dh = D // H
        qkv = (lambda x, *d: x.permute(*d))((x @ wqkv).reshape(B, S, 3, H, Dh), 2, 0, 3, 1, 4)
        q, k, v = (qkv[0], qkv[1], qkv[2])
        scores = torch.einsum('bhqd,bhkd->bhqk', q, k) * Dh ** (-0.5)
        p = _softmax(scores, axis=-1)
        o = torch.einsum('bhqk,bhkd->bhqd', p, v)
        return (lambda x, *d: x.permute(*d))(o, 0, 2, 1, 3).reshape(B, S, D) @ wo

    def _B_ref(x, mem0, Wq, Wk, Wv, Wo, seg_len):
        B, S, Dm = x.shape
        H, Dh = (Wq.shape[1], Wq.shape[2])
        M = mem0.shape[1]
        scale = Dh ** (-0.5)
        n_seg = S // seg_len
        L = M + seg_len
        idx = torch.arange(L)
        mask = (idx[:, None] < M) | (idx[:, None] >= idx[None, :])
        mem = mem0
        outs = []
        for s in range(n_seg):
            xs = x[:, s * seg_len:(s + 1) * seg_len, :].clone()
            h = torch.concatenate([mem, xs], axis=1)
            q = torch.einsum('btd,dhe->bhte', h, Wq)
            k = torch.einsum('btd,dhe->bhte', h, Wk)
            v = torch.einsum('btd,dhe->bhte', h, Wv)
            scores = torch.einsum('bhqe,bhke->bhqk', q, k) * scale
            scores = torch.where(mask[None, None], scores, -1000000000.0)
            p = _softmax(scores, axis=-1)
            o = torch.einsum('bhqk,bhke->bhqe', p, v)
            o = torch.einsum('bhte,hed->btd', o, Wo)
            mem = o[:, :M, :].clone()
            outs.append(o[:, M:, :])
        return torch.concatenate(outs, axis=1)
    x = A_x
    g = _sigmoid((x * gate_w).sum(-1, keepdims=True))
    a = _A_ref(x, A_wqkv, A_wo)
    b = _B_ref(x, B_mem0, B_Wq, B_Wk, B_Wv, B_Wo, B_seg_len)
    return g * a + (1 - g) * b
```

```asm
; @launch grid=(256,1,1) block=(256,1,1) lds=163840
.amdgcn_target "amdgcn-amd-amdhsa--gfx950"
.text
.globl gated_mix__mha_block__memory_aug_recurrent_mem_tr__prompt_kernel
.p2align 8
.type gated_mix__mha_block__memory_aug_recurrent_mem_tr__prompt_kernel,@function
gated_mix__mha_block__memory_aug_recurrent_mem_tr__prompt_kernel:
    s_cmp_ge_u32 s2, 256
    s_cbranch_scc1 f_end
    s_load_dwordx4 s[76:79], s[0:1], 0
    s_load_dwordx2 s[80:81], s[0:1], 16
    s_load_dwordx2 s[82:83], s[0:1], 32
    s_load_dwordx4 s[84:87], s[0:1], 40
    s_load_dwordx4 s[88:91], s[0:1], 56
    s_load_dwordx4 s[92:95], s[0:1], 80
    s_load_dwordx4 s[96:99], s[0:1], 96
    v_and_b32 v1, 63, v0
    v_and_b32 v2, 15, v0
    v_bfe_u32 v3, v0, 4, 2
    v_lshrrev_b32 v4, 6, v0
    s_nop 0
    v_readfirstlane_b32 s32, v4
    s_getreg_b32 s28, hwreg(HW_REG_XCC_ID)
    s_and_b32 s28, s28, 7
    s_waitcnt lgkmcnt(0)
    s_mov_b32 s8, s98
    s_and_b32 s9, s99, 0xffff
    s_mov_b32 s10, 0x10000000
    s_mov_b32 s11, 0x00020000
    s_mov_b32 s20, s96
    s_and_b32 s21, s97, 0xffff
    s_mov_b32 s22, 0x100
    s_mov_b32 s23, 0x00020000
    s_cmp_eq_u32 s32, 0
    s_cbranch_scc0 Ftk_1
    s_lshl_b32 s54, s28, 2
    v_mov_b32 v4, 1
    v_mov_b32 v5, s54
    v_mov_b32 v6, 0
    s_mov_b64 exec, 1
    buffer_atomic_add v4, v5, s[20:23], 0 offen sc0
    s_waitcnt vmcnt(0)
    ds_write_b32 v6, v4
    s_waitcnt lgkmcnt(0)
    s_mov_b64 exec, -1
Ftk_1:
    s_barrier
    v_mov_b32 v6, 0
    ds_read_b32 v4, v6
    s_waitcnt lgkmcnt(0)
    v_readfirstlane_b32 s29, v4
    s_barrier
    s_cmp_ge_u32 s28, 2
    s_cbranch_scc1 f_work
    s_cmp_ge_u32 s29, 32
    s_cbranch_scc1 f_work
f_chain:
    s_mov_b32 s24, s82
    s_and_b32 s25, s83, 0xffff
    s_mov_b32 s26, 0x2800
    s_mov_b32 s27, 0x00020000
    s_lshr_b32 s31, s29, 1
    s_lshl_b32 s30, s28, 4
    s_add_u32 s30, s30, s31
    s_and_b32 s54, s29, 1
    s_cmp_eq_u32 s54, 1
    s_cbranch_scc1 f_cB
    s_mov_b32 s12, s84
    s_and_b32 s13, s85, 0xffff
    s_mov_b32 s14, 0x500000
    s_mov_b32 s15, 0x00020000
    s_mov_b32 s16, s86
    s_and_b32 s17, s87, 0xffff
    s_mov_b32 s18, 0x500000
    s_mov_b32 s19, 0x00020000
    v_lshlrev_b32 v6, 4, v1
    v_cmp_gt_u32 s[44:45], 8, v2
    v_cmp_gt_u32 s[52:53], 2, v3
    v_and_b32 v168, 7, v2
    v_lshrrev_b32 v174, 3, v2
    s_mul_i32 s54, s28, 174080
    s_mul_i32 s55, s28, 10240
    s_sub_u32 s56, 30720, s55
    s_cmp_ge_u32 s32, 2
    s_cselect_b32 s55, s55, s56
    s_and_b32 s56, s32, 1
    s_mul_i32 s56, s56, 5120
    s_add_u32 s55, s55, s56
    s_add_u32 s55, s55, 348160
    v_lshl_add_u32 v169, v174, 9, s55
    v_lshl_add_u32 v169, v3, 7, v169
    v_lshl_add_u32 v4, v168, 4, v169
    s_and_b32 s56, s32, 1
    s_mul_i32 s56, s56, 10240
    s_lshr_b32 s55, s32, 1
    s_lshl_b32 s55, s55, 7
    s_add_u32 s56, s56, s55
    v_lshl_add_u32 v169, v174, 10, s56
    v_lshl_add_u32 v169, v3, 8, v169
    v_lshl_add_u32 v5, v168, 4, v169
    s_mul_i32 s41, s28, 768
    s_add_u32 s41, s41, 0x8d7c000
    s_lshl_b32 s56, s31, 2
    s_add_u32 s56, s56, s32
    s_lshl_b32 s56, s56, 2
    v_mov_b32 v13, s56
    s_lshl_b32 s56, s32, 4
    v_add_u32 v14, s56, v2
    v_lshlrev_b32 v14, 2, v14
    s_mul_i32 s56, s32, 5
    s_add_u32 s56, s56, s29
    s_mul_i32 s55, s56, 6554
    s_lshr_b32 s55, s55, 16
    s_mul_i32 s55, s55, 10
    s_sub_u32 s56, s56, s55
    s_lshl_b32 s56, s56, 10
    s_mul_i32 s55, s28, 10240
    s_add_u32 s56, s56, s55
    s_add_u32 s56, s56, 348160
    v_add_u32 v11, s56, v6
    v_mov_b32 v22, -1
    v_mov_b32 v23, -1
    v_mov_b32 v24, -1
    v_mov_b32 v25, -1
    s_mul_i32 s56, s32, 3456
    s_add_u32 s56, s56, 20480
    v_mul_u32_u24 v177, 18, v3
    v_add_u32 v177, v177, v2
    v_lshl_add_u32 v15, v177, 4, s56
    v_mov_b32 v27, 0xff61b1e6
    s_mov_b32 s57, 0x3e0293ee
    s_lshl_b32 s56, s30, 13
    s_lshl_b32 s60, s32, 11
    s_add_u32 s56, s56, s60
    v_add_u32 v12, s56, v6
    s_lshl_b32 s56, s30, 12
    s_lshl_b32 s60, s32, 10
    s_add_u32 s56, s56, s60
    v_add_u32 v28, s56, v6
    v_lshrrev_b32 v169, 2, v2
    v_and_b32 v170, 3, v2
    v_and_b32 v171, 1, v3
    s_lshl_b32 s56, s32, 1
    v_add_u32 v171, s56, v171
    v_min_u32 v172, 2, v169
    v_mul_u32_u24 v172, 72, v172
    v_mul_u32_u24 v173, 18, v170
    v_add_u32 v173, v173, v171
    v_add_u32 v172, v172, v173
    v_lshlrev_b32 v172, 4, v172
    v_add_u32 v16, 20480, v172
    v_cmp_gt_u32 s[46:47], 2, v2
    v_subrev_u32 v172, 4, v2
    v_cmp_gt_u32 vcc, 8, v172
    s_or_b64 s[46:47], s[46:47], vcc
    s_and_b64 s[48:49], s[46:47], s[52:53]
    s_lshl_b32 s56, s31, 7
    s_add_u32 s56, s56, 8192
    v_lshl_add_u32 v172, v171, 4, s56
    v_lshl_add_u32 v172, v170, 3, v172
    s_lshl_b32 s56, s31, 9
    s_sub_u32 s56, s56, 8
    v_lshl_add_u32 v173, v171, 6, s56
    v_lshl_add_u32 v173, v170, 4, v173
    v_lshl_add_u32 v173, v169, 3, v173
    v_cmp_eq_u32 vcc, 0, v169
    s_nop 1
    v_cndmask_b32 v17, v173, v172, vcc
    v_add_u32 v17, s54, v17
    v_lshlrev_b32 v168, 2, v2
    v_and_b32 v168, 28, v168
    s_mov_b32 s43, 0x40000
dc_3:
    buffer_load_dword v169, v168, s[20:23], 0 offen sc1
    s_waitcnt vmcnt(0)
    v_mov_b32 v170, v169
    s_nop 1
    v_add_u32_dpp v170, v170, v170 row_ror:1 row_mask:0xf bank_mask:0xf
    s_nop 1
    v_add_u32_dpp v170, v170, v170 row_ror:2 row_mask:0xf bank_mask:0xf
    s_nop 1
    v_add_u32_dpp v170, v170, v170 row_ror:4 row_mask:0xf bank_mask:0xf
    s_nop 1
    v_readfirstlane_b32 s54, v170
    v_readlane_b32 s55, v169, 0
    v_readlane_b32 s56, v169, 1
    s_nop 3
    s_cmp_ge_u32 s54, 256
    s_cbranch_scc1 dd_4
    s_sleep 1
    s_sub_u32 s43, s43, 1
    s_cbranch_scc0 dc_3
dd_4:
    s_min_u32 s55, s55, s56
    s_cmp_lt_u32 s55, 32
    s_cbranch_scc1 HslowA_2
    s_mov_b32 s55, 0x8c00000
    s_mov_b64 exec, s[48:49]
    buffer_store_dwordx2 v[22:23], v17, s[8:11], s55 offen
    s_mov_b64 exec, -1
    s_mov_b32 s55, 0x8c5f000
    s_mov_b64 exec, s[48:49]
    buffer_store_dwordx2 v[22:23], v17, s[8:11], s55 offen
    s_mov_b64 exec, -1
    s_mov_b32 s55, 0x8cbe000
    s_mov_b64 exec, s[48:49]
    buffer_store_dwordx2 v[22:23], v17, s[8:11], s55 offen
    s_mov_b64 exec, -1
    s_mov_b32 s55, 0x8d1d000
    s_mov_b64 exec, s[48:49]
    buffer_store_dwordx2 v[22:23], v17, s[8:11], s55 offen
    s_mov_b64 exec, -1
    v_mov_b32 v168, 0
    s_mov_b64 exec, 1
    s_add_u32 s55, s41, 0
    buffer_store_dword v168, v13, s[8:11], s55 offen
    s_mov_b64 exec, -1
    s_waitcnt vmcnt(0)
    s_barrier
    s_cmp_eq_u32 s32, 0
    s_cbranch_scc0 HAfsb_5
    v_mov_b32 v168, 1
    v_mov_b32 v169, 36
    s_mov_b64 exec, 1
    buffer_atomic_add v168, v169, s[20:23], 0 offen
    s_mov_b64 exec, -1
    s_waitcnt vmcnt(0)
HAfsb_5:
    s_lshr_b32 s56, s32, 1
    s_lshl_b32 s56, s56, 3
    v_lshlrev_b32 v172, 1, v3
    v_add_u32 v172, s56, v172
    v_xor_b32 v172, v172, v2
    v_lshlrev_b32 v172, 4, v172
    s_lshl_b32 s56, s32, 2
    v_add_u32 v173, s56, v3
    v_lshlrev_b32 v168, 13, v173
    v_add_u32 v168, v168, v172
    s_lshl_b32 s56, s32, 1
    s_lshl_b32 s56, s56, 1
    v_bfe_u32 v172, v1, 1, 1
    v_add_u32 v172, s56, v172
    v_lshrrev_b32 v173, 2, v2
    v_lshlrev_b32 v173, 1, v173
    v_and_b32 v170, 1, v3
    v_lshl_add_u32 v173, v170, 3, v173
    v_xor_b32 v172, v172, v173
    v_lshlrev_b32 v172, 4, v172
    v_and_b32 v173, 1, v1
    v_lshl_add_u32 v172, v173, 3, v172
    v_lshrrev_b32 v173, 2, v2
    v_mad_u32_u24 v173, v3, 8, v173
    v_lshl_add_u32 v170, v173, 8, v172
    s_lshl_b32 s56, s32, 1
    s_add_u32 s56, s56, 1
    s_lshl_b32 s56, s56, 1
    v_bfe_u32 v172, v1, 1, 1
    v_add_u32 v172, s56, v172
    v_lshrrev_b32 v173, 2, v2
    v_lshlrev_b32 v173, 1, v173
    v_and_b32 v171, 1, v3
    v_lshl_add_u32 v173, v171, 3, v173
    v_xor_b32 v172, v172, v173
    v_lshlrev_b32 v172, 4, v172
    v_and_b32 v173, 1, v1
    v_lshl_add_u32 v172, v173, 3, v172
    v_lshrrev_b32 v173, 2, v2
    v_mad_u32_u24 v173, v3, 8, v173
    v_lshl_add_u32 v171, v173, 8, v172
    s_lshl_b32 s54, s30, 8
    s_add_u32 s55, s54, 0x0
    s_lshl_b32 s56, s32, 10
    s_add_u32 m0, s56, 0x0
    s_nop 0
    buffer_load_dwordx4 v168, s[12:15], s55 offen lds
    s_add_u32 s55, s54, 0x20000
    s_lshl_b32 s56, s32, 10
    s_add_u32 m0, s56, 0x1000
    s_nop 0
    buffer_load_dwordx4 v168, s[12:15], s55 offen lds
    s_add_u32 s55, s54, 0x40000
    s_lshl_b32 s56, s32, 10
    s_add_u32 m0, s56, 0x2000
    s_nop 0
    buffer_load_dwordx4 v168, s[12:15], s55 offen lds
    s_add_u32 s55, s54, 0x60000
    s_lshl_b32 s56, s32, 10
    s_add_u32 m0, s56, 0x3000
    s_nop 0
    buffer_load_dwordx4 v168, s[12:15], s55 offen lds
    s_add_u32 s55, s54, 0x80000
    s_lshl_b32 s56, s32, 10
    s_add_u32 m0, s56, 0x4000
    s_nop 0
    buffer_load_dwordx4 v168, s[12:15], s55 offen lds
    s_add_u32 s55, s54, 0xa0000
    s_lshl_b32 s56, s32, 10
    s_add_u32 m0, s56, 0x5000
    s_nop 0
    buffer_load_dwordx4 v168, s[12:15], s55 offen lds
    s_add_u32 s55, s54, 0xc0000
    s_lshl_b32 s56, s32, 10
    s_add_u32 m0, s56, 0x6000
    s_nop 0
    buffer_load_dwordx4 v168, s[12:15], s55 offen lds
    s_add_u32 s55, s54, 0xe0000
    s_lshl_b32 s56, s32, 10
    s_add_u32 m0, s56, 0x7000
    s_nop 0
    buffer_load_dwordx4 v168, s[12:15], s55 offen lds
    s_add_u32 s55, s54, 0x100000
    s_lshl_b32 s56, s32, 10
    s_add_u32 m0, s56, 0x8000
    s_nop 0
    buffer_load_dwordx4 v168, s[12:15], s55 offen lds
    s_add_u32 s55, s54, 0x120000
    s_lshl_b32 s56, s32, 10
    s_add_u32 m0, s56, 0x9000
    s_nop 0
    buffer_load_dwordx4 v168, s[12:15], s55 offen lds
    s_add_u32 s55, s54, 0x140000
    s_lshl_b32 s56, s32, 10
    s_add_u32 m0, s56, 0xa000
    s_nop 0
    buffer_load_dwordx4 v168, s[12:15], s55 offen lds
    s_add_u32 s55, s54, 0x160000
    s_lshl_b32 s56, s32, 10
    s_add_u32 m0, s56, 0xb000
    s_nop 0
    buffer_load_dwordx4 v168, s[12:15], s55 offen lds
    s_add_u32 s55, s54, 0x180000
    s_lshl_b32 s56, s32, 10
    s_add_u32 m0, s56, 0xc000
    s_nop 0
    buffer_load_dwordx4 v168, s[12:15], s55 offen lds
    s_add_u32 s55, s54, 0x1a0000
    s_lshl_b32 s56, s32, 10
    s_add_u32 m0, s56, 0xd000
    s_nop 0
    buffer_load_dwordx4 v168, s[12:15], s55 offen lds
    s_add_u32 s55, s54, 0x1c0000
    s_lshl_b32 s56, s32, 10
    s_add_u32 m0, s56, 0xe000
    s_nop 0
    buffer_load_dwordx4 v168, s[12:15], s55 offen lds
    s_add_u32 s55, s54, 0x1e0000
    s_lshl_b32 s56, s32, 10
    s_add_u32 m0, s56, 0xf000
    s_nop 0
    buffer_load_dwordx4 v168, s[12:15], s55 offen lds
    s_add_u32 s55, s54, 0x200000
    s_lshl_b32 s56, s32, 10
    s_add_u32 m0, s56, 0x10000
    s_nop 0
    buffer_load_dwordx4 v168, s[12:15], s55 offen lds
    s_add_u32 s55, s54, 0x220000
    s_lshl_b32 s56, s32, 10
    s_add_u32 m0, s56, 0x11000
    s_nop 0
    buffer_load_dwordx4 v168, s[12:15], s55 offen lds
    s_add_u32 s55, s54, 0x240000
    s_lshl_b32 s56, s32, 10
    s_add_u32 m0, s56, 0x12000
    s_nop 0
    buffer_load_dwordx4 v168, s[12:15], s55 offen lds
    s_add_u32 s55, s54, 0x260000
    s_lshl_b32 s56, s32, 10
    s_add_u32 m0, s56, 0x13000
    s_nop 0
    buffer_load_dwordx4 v168, s[12:15], s55 offen lds
    s_add_u32 s55, s54, 0x280000
    s_lshl_b32 s56, s32, 10
    s_add_u32 m0, s56, 0x14000
    s_nop 0
    buffer_load_dwordx4 v168, s[12:15], s55 offen lds
    s_add_u32 s55, s54, 0x2a0000
    s_lshl_b32 s56, s32, 10
    s_add_u32 m0, s56, 0x15000
    s_nop 0
    buffer_load_dwordx4 v168, s[12:15], s55 offen lds
    s_add_u32 s55, s54, 0x2c0000
    s_lshl_b32 s56, s32, 10
    s_add_u32 m0, s56, 0x16000
    s_nop 0
    buffer_load_dwordx4 v168, s[12:15], s55 offen lds
    s_add_u32 s55, s54, 0x2e0000
    s_lshl_b32 s56, s32, 10
    s_add_u32 m0, s56, 0x17000
    s_nop 0
    buffer_load_dwordx4 v168, s[12:15], s55 offen lds
    s_add_u32 s55, s54, 0x300000
    s_lshl_b32 s56, s32, 10
    s_add_u32 m0, s56, 0x18000
    s_nop 0
    buffer_load_dwordx4 v168, s[12:15], s55 offen lds
    s_add_u32 s55, s54, 0x320000
    s_lshl_b32 s56, s32, 10
    s_add_u32 m0, s56, 0x19000
    s_nop 0
    buffer_load_dwordx4 v168, s[12:15], s55 offen lds
    s_add_u32 s55, s54, 0x340000
    s_lshl_b32 s56, s32, 10
    s_add_u32 m0, s56, 0x1a000
    s_nop 0
    buffer_load_dwordx4 v168, s[12:15], s55 offen lds
    s_add_u32 s55, s54, 0x360000
    s_lshl_b32 s56, s32, 10
    s_add_u32 m0, s56, 0x1b000
    s_nop 0
    buffer_load_dwordx4 v168, s[12:15], s55 offen lds
    s_add_u32 s55, s54, 0x380000
    s_lshl_b32 s56, s32, 10
    s_add_u32 m0, s56, 0x1c000
    s_nop 0
    buffer_load_dwordx4 v168, s[12:15], s55 offen lds
    s_add_u32 s55, s54, 0x3a0000
    s_lshl_b32 s56, s32, 10
    s_add_u32 m0, s56, 0x1d000
    s_nop 0
    buffer_load_dwordx4 v168, s[12:15], s55 offen lds
    s_add_u32 s55, s54, 0x3c0000
    s_lshl_b32 s56, s32, 10
    s_add_u32 m0, s56, 0x1e000
    s_nop 0
    buffer_load_dwordx4 v168, s[12:15], s55 offen lds
    s_add_u32 s55, s54, 0x3e0000
    s_lshl_b32 s56, s32, 10
    s_add_u32 m0, s56, 0x1f000
    s_nop 0
    buffer_load_dwordx4 v168, s[12:15], s55 offen lds
    s_add_u32 s55, s54, 0x400000
    s_lshl_b32 s56, s32, 10
    s_add_u32 m0, s56, 0x20000
    s_nop 0
    buffer_load_dwordx4 v168, s[12:15], s55 offen lds
    s_add_u32 s55, s54, 0x420000
    s_lshl_b32 s56, s32, 10
    s_add_u32 m0, s56, 0x21000
    s_nop 0
    buffer_load_dwordx4 v168, s[12:15], s55 offen lds
    s_add_u32 s55, s54, 0x440000
    s_lshl_b32 s56, s32, 10
    s_add_u32 m0, s56, 0x22000
    s_nop 0
    buffer_load_dwordx4 v168, s[12:15], s55 offen lds
    s_add_u32 s55, s54, 0x460000
    s_lshl_b32 s56, s32, 10
    s_add_u32 m0, s56, 0x23000
    s_nop 0
    buffer_load_dwordx4 v168, s[12:15], s55 offen lds
    s_add_u32 s55, s54, 0x480000
    s_lshl_b32 s56, s32, 10
    s_add_u32 m0, s56, 0x24000
    s_nop 0
    buffer_load_dwordx4 v168, s[12:15], s55 offen lds
    s_add_u32 s55, s54, 0x4a0000
    s_lshl_b32 s56, s32, 10
    s_add_u32 m0, s56, 0x25000
    s_nop 0
    buffer_load_dwordx4 v168, s[12:15], s55 offen lds
    s_add_u32 s55, s54, 0x4c0000
    s_lshl_b32 s56, s32, 10
    s_add_u32 m0, s56, 0x26000
    s_nop 0
    buffer_load_dwordx4 v168, s[12:15], s55 offen lds
    s_add_u32 s55, s54, 0x4e0000
    s_lshl_b32 s56, s32, 10
    s_add_u32 m0, s56, 0x27000
    s_nop 0
    buffer_load_dwordx4 v168, s[12:15], s55 offen lds
    s_waitcnt vmcnt(20)
    s_barrier
    v_add_u32 v172, 0x0, v170
    v_add_u32 v173, 0x0, v171
    ds_read_b64_tr_b16 a[0:1], v172 offset:0
    ds_read_b64_tr_b16 a[2:3], v172 offset:1024
    ds_read_b64_tr_b16 a[4:5], v172 offset:8192
    ds_read_b64_tr_b16 a[6:7], v172 offset:9216
    ds_read_b64_tr_b16 a[8:9], v172 offset:16384
    ds_read_b64_tr_b16 a[10:11], v172 offset:17408
    ds_read_b64_tr_b16 a[12:13], v172 offset:24576
    ds_read_b64_tr_b16 a[14:15], v172 offset:25600
    ds_read_b64_tr_b16 a[16:17], v172 offset:32768
    ds_read_b64_tr_b16 a[18:19], v172 offset:33792
    ds_read_b64_tr_b16 a[80:81], v173 offset:0
    ds_read_b64_tr_b16 a[82:83], v173 offset:1024
    ds_read_b64_tr_b16 a[84:85], v173 offset:8192
    ds_read_b64_tr_b16 a[86:87], v173 offset:9216
    ds_read_b64_tr_b16 a[88:89], v173 offset:16384
    ds_read_b64_tr_b16 a[90:91], v173 offset:17408
    ds_read_b64_tr_b16 a[92:93], v173 offset:24576
    ds_read_b64_tr_b16 a[94:95], v173 offset:25600
    ds_read_b64_tr_b16 a[96:97], v173 offset:32768
    ds_read_b64_tr_b16 a[98:99], v173 offset:33792
    s_waitcnt lgkmcnt(0)
    v_add_u32 v172, 0xa000, v170
    v_add_u32 v173, 0xa000, v171
    ds_read_b64_tr_b16 a[20:21], v172 offset:0
    ds_read_b64_tr_b16 a[22:23], v172 offset:1024
    ds_read_b64_tr_b16 a[24:25], v172 offset:8192
    ds_read_b64_tr_b16 a[26:27], v172 offset:9216
    ds_read_b64_tr_b16 a[28:29], v172 offset:16384
    ds_read_b64_tr_b16 a[30:31], v172 offset:17408
    ds_read_b64_tr_b16 a[32:33], v172 offset:24576
    ds_read_b64_tr_b16 a[34:35], v172 offset:25600
    ds_read_b64_tr_b16 a[36:37], v172 offset:32768
    ds_read_b64_tr_b16 a[38:39], v172 offset:33792
    ds_read_b64_tr_b16 a[100:101], v173 offset:0
    ds_read_b64_tr_b16 a[102:103], v173 offset:1024
    ds_read_b64_tr_b16 a[104:105], v173 offset:8192
    ds_read_b64_tr_b16 a[106:107], v173 offset:9216
    ds_read_b64_tr_b16 a[108:109], v173 offset:16384
    ds_read_b64_tr_b16 a[110:111], v173 offset:17408
    ds_read_b64_tr_b16 a[112:113], v173 offset:24576
    ds_read_b64_tr_b16 a[114:115], v173 offset:25600
    ds_read_b64_tr_b16 a[116:117], v173 offset:32768
    ds_read_b64_tr_b16 a[118:119], v173 offset:33792
    s_waitcnt lgkmcnt(0)
    s_barrier
    s_add_u32 s55, s54, 0x0
    s_lshl_b32 s56, s32, 10
    s_add_u32 m0, s56, 0x0
    s_nop 0
    buffer_load_dwordx4 v168, s[16:19], s55 offen lds
    s_add_u32 s55, s54, 0x20000
    s_lshl_b32 s56, s32, 10
    s_add_u32 m0, s56, 0x1000
    s_nop 0
    buffer_load_dwordx4 v168, s[16:19], s55 offen lds
    s_add_u32 s55, s54, 0x40000
    s_lshl_b32 s56, s32, 10
    s_add_u32 m0, s56, 0x2000
    s_nop 0
    buffer_load_dwordx4 v168, s[16:19], s55 offen lds
    s_add_u32 s55, s54, 0x60000
    s_lshl_b32 s56, s32, 10
    s_add_u32 m0, s56, 0x3000
    s_nop 0
    buffer_load_dwordx4 v168, s[16:19], s55 offen lds
    s_add_u32 s55, s54, 0x80000
    s_lshl_b32 s56, s32, 10
    s_add_u32 m0, s56, 0x4000
    s_nop 0
    buffer_load_dwordx4 v168, s[16:19], s55 offen lds
    s_add_u32 s55, s54, 0xa0000
    s_lshl_b32 s56, s32, 10
    s_add_u32 m0, s56, 0x5000
    s_nop 0
    buffer_load_dwordx4 v168, s[16:19], s55 offen lds
    s_add_u32 s55, s54, 0xc0000
    s_lshl_b32 s56, s32, 10
    s_add_u32 m0, s56, 0x6000
    s_nop 0
    buffer_load_dwordx4 v168, s[16:19], s55 offen lds
    s_add_u32 s55, s54, 0xe0000
    s_lshl_b32 s56, s32, 10
    s_add_u32 m0, s56, 0x7000
    s_nop 0
    buffer_load_dwordx4 v168, s[16:19], s55 offen lds
    s_add_u32 s55, s54, 0x100000
    s_lshl_b32 s56, s32, 10
    s_add_u32 m0, s56, 0x8000
    s_nop 0
    buffer_load_dwordx4 v168, s[16:19], s55 offen lds
    s_add_u32 s55, s54, 0x120000
    s_lshl_b32 s56, s32, 10
    s_add_u32 m0, s56, 0x9000
    s_nop 0
    buffer_load_dwordx4 v168, s[16:19], s55 offen lds
    s_add_u32 s55, s54, 0x140000
    s_lshl_b32 s56, s32, 10
    s_add_u32 m0, s56, 0xa000
    s_nop 0
    buffer_load_dwordx4 v168, s[16:19], s55 offen lds
    s_add_u32 s55, s54, 0x160000
    s_lshl_b32 s56, s32, 10
    s_add_u32 m0, s56, 0xb000
    s_nop 0
    buffer_load_dwordx4 v168, s[16:19], s55 offen lds
    s_add_u32 s55, s54, 0x180000
    s_lshl_b32 s56, s32, 10
    s_add_u32 m0, s56, 0xc000
    s_nop 0
    buffer_load_dwordx4 v168, s[16:19], s55 offen lds
    s_add_u32 s55, s54, 0x1a0000
    s_lshl_b32 s56, s32, 10
    s_add_u32 m0, s56, 0xd000
    s_nop 0
    buffer_load_dwordx4 v168, s[16:19], s55 offen lds
    s_add_u32 s55, s54, 0x1c0000
    s_lshl_b32 s56, s32, 10
    s_add_u32 m0, s56, 0xe000
    s_nop 0
    buffer_load_dwordx4 v168, s[16:19], s55 offen lds
    s_add_u32 s55, s54, 0x1e0000
    s_lshl_b32 s56, s32, 10
    s_add_u32 m0, s56, 0xf000
    s_nop 0
    buffer_load_dwordx4 v168, s[16:19], s55 offen lds
    s_add_u32 s55, s54, 0x200000
    s_lshl_b32 s56, s32, 10
    s_add_u32 m0, s56, 0x10000
    s_nop 0
    buffer_load_dwordx4 v168, s[16:19], s55 offen lds
    s_add_u32 s55, s54, 0x220000
    s_lshl_b32 s56, s32, 10
    s_add_u32 m0, s56, 0x11000
    s_nop 0
    buffer_load_dwordx4 v168, s[16:19], s55 offen lds
    s_add_u32 s55, s54, 0x240000
    s_lshl_b32 s56, s32, 10
    s_add_u32 m0, s56, 0x12000
    s_nop 0
    buffer_load_dwordx4 v168, s[16:19], s55 offen lds
    s_add_u32 s55, s54, 0x260000
    s_lshl_b32 s56, s32, 10
    s_add_u32 m0, s56, 0x13000
    s_nop 0
    buffer_load_dwordx4 v168, s[16:19], s55 offen lds
    s_waitcnt vmcnt(20)
    s_barrier
    v_add_u32 v172, 0x14000, v170
    v_add_u32 v173, 0x14000, v171
    ds_read_b64_tr_b16 a[40:41], v172 offset:0
    ds_read_b64_tr_b16 a[42:43], v172 offset:1024
    ds_read_b64_tr_b16 a[44:45], v172 offset:8192
    ds_read_b64_tr_b16 a[46:47], v172 offset:9216
    ds_read_b64_tr_b16 a[48:49], v172 offset:16384
    ds_read_b64_tr_b16 a[50:51], v172 offset:17408
    ds_read_b64_tr_b16 a[52:53], v172 offset:24576
    ds_read_b64_tr_b16 a[54:55], v172 offset:25600
    ds_read_b64_tr_b16 a[56:57], v172 offset:32768
    ds_read_b64_tr_b16 a[58:59], v172 offset:33792
    ds_read_b64_tr_b16 a[120:121], v173 offset:0
    ds_read_b64_tr_b16 a[122:123], v173 offset:1024
    ds_read_b64_tr_b16 a[124:125], v173 offset:8192
    ds_read_b64_tr_b16 a[126:127], v173 offset:9216
    ds_read_b64_tr_b16 a[128:129], v173 offset:16384
    ds_read_b64_tr_b16 a[130:131], v173 offset:17408
    ds_read_b64_tr_b16 a[132:133], v173 offset:24576
    ds_read_b64_tr_b16 a[134:135], v173 offset:25600
    ds_read_b64_tr_b16 a[136:137], v173 offset:32768
    ds_read_b64_tr_b16 a[138:139], v173 offset:33792
    s_waitcnt lgkmcnt(0)
    v_add_u32 v172, 0x1e000, v170
    v_add_u32 v173, 0x1e000, v171
    ds_read_b64_tr_b16 a[60:61], v172 offset:0
    ds_read_b64_tr_b16 a[62:63], v172 offset:1024
    ds_read_b64_tr_b16 a[64:65], v172 offset:8192
    ds_read_b64_tr_b16 a[66:67], v172 offset:9216
    ds_read_b64_tr_b16 a[68:69], v172 offset:16384
    ds_read_b64_tr_b16 a[70:71], v172 offset:17408
    ds_read_b64_tr_b16 a[72:73], v172 offset:24576
    ds_read_b64_tr_b16 a[74:75], v172 offset:25600
    ds_read_b64_tr_b16 a[76:77], v172 offset:32768
    ds_read_b64_tr_b16 a[78:79], v172 offset:33792
    ds_read_b64_tr_b16 a[140:141], v173 offset:0
    ds_read_b64_tr_b16 a[142:143], v173 offset:1024
    ds_read_b64_tr_b16 a[144:145], v173 offset:8192
    ds_read_b64_tr_b16 a[146:147], v173 offset:9216
    ds_read_b64_tr_b16 a[148:149], v173 offset:16384
    ds_read_b64_tr_b16 a[150:151], v173 offset:17408
    ds_read_b64_tr_b16 a[152:153], v173 offset:24576
    ds_read_b64_tr_b16 a[154:155], v173 offset:25600
    ds_read_b64_tr_b16 a[156:157], v173 offset:32768
    ds_read_b64_tr_b16 a[158:159], v173 offset:33792
    s_waitcnt lgkmcnt(0)
    s_barrier
    s_add_u32 s55, s54, 0x280000
    s_lshl_b32 s56, s32, 10
    s_add_u32 m0, s56, 0x14000
    s_nop 0
    buffer_load_dwordx4 v168, s[16:19], s55 offen lds
    s_add_u32 s55, s54, 0x2a0000
    s_lshl_b32 s56, s32, 10
    s_add_u32 m0, s56, 0x15000
    s_nop 0
    buffer_load_dwordx4 v168, s[16:19], s55 offen lds
    s_add_u32 s55, s54, 0x2c0000
    s_lshl_b32 s56, s32, 10
    s_add_u32 m0, s56, 0x16000
    s_nop 0
    buffer_load_dwordx4 v168, s[16:19], s55 offen lds
    s_add_u32 s55, s54, 0x2e0000
    s_lshl_b32 s56, s32, 10
    s_add_u32 m0, s56, 0x17000
    s_nop 0
    buffer_load_dwordx4 v168, s[16:19], s55 offen lds
    s_add_u32 s55, s54, 0x300000
    s_lshl_b32 s56, s32, 10
    s_add_u32 m0, s56, 0x18000
    s_nop 0
    buffer_load_dwordx4 v168, s[16:19], s55 offen lds
    s_add_u32 s55, s54, 0x320000
    s_lshl_b32 s56, s32, 10
    s_add_u32 m0, s56, 0x19000
    s_nop 0
    buffer_load_dwordx4 v168, s[16:19], s55 offen lds
    s_add_u32 s55, s54, 0x340000
    s_lshl_b32 s56, s32, 10
    s_add_u32 m0, s56, 0x1a000
    s_nop 0
    buffer_load_dwordx4 v168, s[16:19], s55 offen lds
    s_add_u32 s55, s54, 0x360000
    s_lshl_b32 s56, s32, 10
    s_add_u32 m0, s56, 0x1b000
    s_nop 0
    buffer_load_dwordx4 v168, s[16:19], s55 offen lds
    s_add_u32 s55, s54, 0x380000
    s_lshl_b32 s56, s32, 10
    s_add_u32 m0, s56, 0x1c000
    s_nop 0
    buffer_load_dwordx4 v168, s[16:19], s55 offen lds
    s_add_u32 s55, s54, 0x3a0000
    s_lshl_b32 s56, s32, 10
    s_add_u32 m0, s56, 0x1d000
    s_nop 0
    buffer_load_dwordx4 v168, s[16:19], s55 offen lds
    s_add_u32 s55, s54, 0x3c0000
    s_lshl_b32 s56, s32, 10
    s_add_u32 m0, s56, 0x1e000
    s_nop 0
    buffer_load_dwordx4 v168, s[16:19], s55 offen lds
    s_add_u32 s55, s54, 0x3e0000
    s_lshl_b32 s56, s32, 10
    s_add_u32 m0, s56, 0x1f000
    s_nop 0
    buffer_load_dwordx4 v168, s[16:19], s55 offen lds
    s_add_u32 s55, s54, 0x400000
    s_lshl_b32 s56, s32, 10
    s_add_u32 m0, s56, 0x20000
    s_nop 0
    buffer_load_dwordx4 v168, s[16:19], s55 offen lds
    s_add_u32 s55, s54, 0x420000
    s_lshl_b32 s56, s32, 10
    s_add_u32 m0, s56, 0x21000
    s_nop 0
    buffer_load_dwordx4 v168, s[16:19], s55 offen lds
    s_add_u32 s55, s54, 0x440000
    s_lshl_b32 s56, s32, 10
    s_add_u32 m0, s56, 0x22000
    s_nop 0
    buffer_load_dwordx4 v168, s[16:19], s55 offen lds
    s_add_u32 s55, s54, 0x460000
    s_lshl_b32 s56, s32, 10
    s_add_u32 m0, s56, 0x23000
    s_nop 0
    buffer_load_dwordx4 v168, s[16:19], s55 offen lds
    s_add_u32 s55, s54, 0x480000
    s_lshl_b32 s56, s32, 10
    s_add_u32 m0, s56, 0x24000
    s_nop 0
    buffer_load_dwordx4 v168, s[16:19], s55 offen lds
    s_add_u32 s55, s54, 0x4a0000
    s_lshl_b32 s56, s32, 10
    s_add_u32 m0, s56, 0x25000
    s_nop 0
    buffer_load_dwordx4 v168, s[16:19], s55 offen lds
    s_add_u32 s55, s54, 0x4c0000
    s_lshl_b32 s56, s32, 10
    s_add_u32 m0, s56, 0x26000
    s_nop 0
    buffer_load_dwordx4 v168, s[16:19], s55 offen lds
    s_add_u32 s55, s54, 0x4e0000
    s_lshl_b32 s56, s32, 10
    s_add_u32 m0, s56, 0x27000
    s_nop 0
    buffer_load_dwordx4 v168, s[16:19], s55 offen lds
    s_waitcnt vmcnt(20)
    s_barrier
    v_add_u32 v172, 0x0, v170
    v_add_u32 v173, 0x0, v171
    ds_read_b64_tr_b16 a[160:161], v172 offset:0
    ds_read_b64_tr_b16 a[162:163], v172 offset:1024
    ds_read_b64_tr_b16 a[164:165], v172 offset:8192
    ds_read_b64_tr_b16 a[166:167], v172 offset:9216
    ds_read_b64_tr_b16 a[168:169], v172 offset:16384
    ds_read_b64_tr_b16 a[170:171], v172 offset:17408
    ds_read_b64_tr_b16 a[172:173], v172 offset:24576
    ds_read_b64_tr_b16 a[174:175], v172 offset:25600
    ds_read_b64_tr_b16 a[176:177], v172 offset:32768
    ds_read_b64_tr_b16 a[178:179], v172 offset:33792
    ds_read_b64_tr_b16 a[240:241], v173 offset:0
    ds_read_b64_tr_b16 a[242:243], v173 offset:1024
    ds_read_b64_tr_b16 a[244:245], v173 offset:8192
    ds_read_b64_tr_b16 a[246:247], v173 offset:9216
    ds_read_b64_tr_b16 a[248:249], v173 offset:16384
    ds_read_b64_tr_b16 a[250:251], v173 offset:17408
    ds_read_b64_tr_b16 a[252:253], v173 offset:24576
    ds_read_b64_tr_b16 a[254:255], v173 offset:25600
    ds_read_b64_tr_b16 v[192:193], v173 offset:32768
    ds_read_b64_tr_b16 v[194:195], v173 offset:33792
    s_waitcnt lgkmcnt(0)
    v_add_u32 v172, 0xa000, v170
    v_add_u32 v173, 0xa000, v171
    ds_read_b64_tr_b16 a[180:181], v172 offset:0
    ds_read_b64_tr_b16 a[182:183], v172 offset:1024
    ds_read_b64_tr_b16 a[184:185], v172 offset:8192
    ds_read_b64_tr_b16 a[186:187], v172 offset:9216
    ds_read_b64_tr_b16 a[188:189], v172 offset:16384
    ds_read_b64_tr_b16 a[190:191], v172 offset:17408
    ds_read_b64_tr_b16 a[192:193], v172 offset:24576
    ds_read_b64_tr_b16 a[194:195], v172 offset:25600
    ds_read_b64_tr_b16 a[196:197], v172 offset:32768
    ds_read_b64_tr_b16 a[198:199], v172 offset:33792
    ds_read_b64_tr_b16 v[196:197], v173 offset:0
    ds_read_b64_tr_b16 v[198:199], v173 offset:1024
    ds_read_b64_tr_b16 v[200:201], v173 offset:8192
    ds_read_b64_tr_b16 v[202:203], v173 offset:9216
    ds_read_b64_tr_b16 v[204:205], v173 offset:16384
    ds_read_b64_tr_b16 v[206:207], v173 offset:17408
    ds_read_b64_tr_b16 v[208:209], v173 offset:24576
    ds_read_b64_tr_b16 v[210:211], v173 offset:25600
    ds_read_b64_tr_b16 v[212:213], v173 offset:32768
    ds_read_b64_tr_b16 v[214:215], v173 offset:33792
    s_waitcnt lgkmcnt(0)
    s_barrier
    s_waitcnt vmcnt(0)
    s_barrier
    v_add_u32 v172, 0x14000, v170
    v_add_u32 v173, 0x14000, v171
    ds_read_b64_tr_b16 a[200:201], v172 offset:0
    ds_read_b64_tr_b16 a[202:203], v172 offset:1024
    ds_read_b64_tr_b16 a[204:205], v172 offset:8192
    ds_read_b64_tr_b16 a[206:207], v172 offset:9216
    ds_read_b64_tr_b16 a[208:209], v172 offset:16384
    ds_read_b64_tr_b16 a[210:211], v172 offset:17408
    ds_read_b64_tr_b16 a[212:213], v172 offset:24576
    ds_read_b64_tr_b16 a[214:215], v172 offset:25600
    ds_read_b64_tr_b16 a[216:217], v172 offset:32768
    ds_read_b64_tr_b16 a[218:219], v172 offset:33792
    ds_read_b64_tr_b16 v[216:217], v173 offset:0
    ds_read_b64_tr_b16 v[218:219], v173 offset:1024
    ds_read_b64_tr_b16 v[220:221], v173 offset:8192
    ds_read_b64_tr_b16 v[222:223], v173 offset:9216
    ds_read_b64_tr_b16 v[224:225], v173 offset:16384
    ds_read_b64_tr_b16 v[226:227], v173 offset:17408
    ds_read_b64_tr_b16 v[228:229], v173 offset:24576
    ds_read_b64_tr_b16 v[230:231], v173 offset:25600
    ds_read_b64_tr_b16 v[232:233], v173 offset:32768
    ds_read_b64_tr_b16 v[234:235], v173 offset:33792
    s_waitcnt lgkmcnt(0)
    v_add_u32 v172, 0x1e000, v170
    v_add_u32 v173, 0x1e000, v171
    ds_read_b64_tr_b16 a[220:221], v172 offset:0
    ds_read_b64_tr_b16 a[222:223], v172 offset:1024
    ds_read_b64_tr_b16 a[224:225], v172 offset:8192
    ds_read_b64_tr_b16 a[226:227], v172 offset:9216
    ds_read_b64_tr_b16 a[228:229], v172 offset:16384
    ds_read_b64_tr_b16 a[230:231], v172 offset:17408
    ds_read_b64_tr_b16 a[232:233], v172 offset:24576
    ds_read_b64_tr_b16 a[234:235], v172 offset:25600
    ds_read_b64_tr_b16 a[236:237], v172 offset:32768
    ds_read_b64_tr_b16 a[238:239], v172 offset:33792
    ds_read_b64_tr_b16 v[236:237], v173 offset:0
    ds_read_b64_tr_b16 v[238:239], v173 offset:1024
    ds_read_b64_tr_b16 v[240:241], v173 offset:8192
    ds_read_b64_tr_b16 v[242:243], v173 offset:9216
    ds_read_b64_tr_b16 v[244:245], v173 offset:16384
    ds_read_b64_tr_b16 v[246:247], v173 offset:17408
    ds_read_b64_tr_b16 v[248:249], v173 offset:24576
    ds_read_b64_tr_b16 v[250:251], v173 offset:25600
    ds_read_b64_tr_b16 v[252:253], v173 offset:32768
    ds_read_b64_tr_b16 v[254:255], v173 offset:33792
    s_waitcnt lgkmcnt(0)
    s_barrier
    s_cmp_eq_u32 s32, 0
    s_cbranch_scc0 HAfsb2_6
    v_mov_b32 v169, 36
    s_mov_b32 s58, 0x100000
HAfsbl_7:
    buffer_load_dword v170, v169, s[20:23], 0 offen sc1
    s_waitcnt vmcnt(0)
    v_cmp_gt_u32 vcc, 64, v170
    s_cbranch_vccz HAfsbd_8
    s_sub_u32 s58, s58, 1
    s_cbranch_scc0 HAfsbl_7
HAfsbd_8:
HAfsb2_6:
    s_mov_b32 s58, 0x400000
    s_mov_b32 s33, 0x0
    s_lshl_b32 s54, s28, 4
    v_and_b32 v31, 1, v3
    v_add_u32 v30, s54, v2
    v_mov_b32 v168, s30
    v_cmp_gt_u32 vcc, 2, v3
    s_nop 1
    v_cndmask_b32 v30, v168, v30, vcc
    v_mov_b32 v168, 0
    v_mov_b32 v169, 64
    v_cndmask_b32 v168, v168, v169, vcc
    v_add_u32 v30, v30, v168
    v_lshl_add_u32 v30, v31, 5, v30
    v_lshlrev_b32 v30, 2, v30
    v_add_u32 v30, 0xa600000, v30
    s_mov_b32 s74, 0x0
    s_lshl_b32 s75, s30, 2
    s_add_u32 s75, s75, 0xa600200
    s_mov_b32 s55, 0x34
    s_cmp_eq_u32 s32, 0
    s_cbranch_scc0 CZww_9
    s_mov_b32 s54, 0x1
    v_min_u32 v168, 0, v1
    v_mul_u32_u24 v168, 4, v168
    s_mov_b32 s43, 0x40000
CZwl_10:
    buffer_load_dword v169, v168, s[20:23], s55 offen sc1
    s_waitcnt vmcnt(0)
    v_cmp_gt_u32 vcc, 128, v169
    s_nop 1
    v_cndmask_b32 v169, 0, v169, vcc
    v_cmp_gt_u32 vcc, s54, v169
    s_cbranch_vccz CZwd_11
    s_sleep 1
    s_sub_u32 s43, s43, 1
    s_cbranch_scc0 CZwl_10
CZwd_11:
CZww_9:
    s_barrier
    s_mov_b32 s33, 0x0
    s_cmp_lt_u32 s33, s74
    s_cbranch_scc1 rdy_12
rdl_13:
    s_and_b32 s54, s33, 1
    buffer_load_dword v188, v30, s[8:11], 0 offen sc1
    s_waitcnt vmcnt(0)
    v_cmp_lt_u32 vcc, 127, v188
    s_nop 1
    v_cmp_gt_u32 vcc, 128, v188
    s_nop 1
    v_cndmask_b32 v188, 0, v188, vcc
    v_max_u32 v188, v188, v31
    s_nop 1
    v_min_u32_dpp v188, v188, v188 row_ror:1 row_mask:0xf bank_mask:0xf
    s_nop 1
    v_min_u32_dpp v188, v188, v188 row_ror:2 row_mask:0xf bank_mask:0xf
    s_nop 1
    v_min_u32_dpp v188, v188, v188 row_ror:4 row_mask:0xf bank_mask:0xf
    s_nop 1
    v_min_u32_dpp v188, v188, v188 row_ror:8 row_mask:0xf bank_mask:0xf
    s_nop 1
    v_readlane_b32 s54, v188, 0
    v_readlane_b32 s55, v188, 16
    v_readlane_b32 s56, v188, 32
    v_readlane_b32 s74, v188, 48
    s_nop 3
    s_min_u32 s54, s54, s55
    s_min_u32 s56, s56, s74
    s_min_u32 s74, s54, s56
    s_cmp_lt_u32 s33, s74
    s_cbranch_scc1 rdy_12
    s_sleep 1
    s_sub_u32 s58, s58, 1
    s_cbranch_scc0 rdl_13
    s_mov_b32 s58, 0
    s_mov_b32 s74, 0x40
rdy_12:
    v_and_b32 v168, 7, v2
    v_mul_u32_u24 v168, 1280, v168
    v_lshl_add_u32 v168, v3, 4, v168
    v_lshrrev_b32 v169, 3, v2
    v_lshl_add_u32 v168, v169, 6, v168
    s_and_b32 s56, s32, 1
    s_mul_i32 s56, s56, 640
    s_lshr_b32 s55, s32, 1
    s_lshl_b32 s55, s55, 28
    s_add_u32 s56, s56, s55
    v_add_u32 v168, s56, v168
    buffer_load_dwordx4 v[32:35], v168, s[24:27], 0 offen offset:0
    buffer_load_dwordx4 v[36:39], v168, s[24:27], 0 offen offset:128
    buffer_load_dwordx4 v[40:43], v168, s[24:27], 0 offen offset:256
    buffer_load_dwordx4 v[44:47], v168, s[24:27], 0 offen offset:384
    buffer_load_dwordx4 v[48:51], v168, s[24:27], 0 offen offset:512
    s_mov_b32 s39, 0x0
    s_mov_b32 s40, 0x2000000
    buffer_load_dwordx4 v[152:155], v12, s[8:11], s39 offen offset:0 sc1
    buffer_load_dwordx4 v[156:159], v12, s[8:11], s39 offen offset:1024 sc1
    s_mov_b32 s73, 0x9080000
    v_mov_b32 v184, 0
    v_mov_b32 v185, 0
    v_mov_b32 v186, 0
    v_mov_b32 v187, 0
    s_waitcnt vmcnt(0)
    ds_write_b128 v5, v[32:35] offset:0
    ds_write_b128 v5, v[36:39] offset:2048
    ds_write_b128 v5, v[40:43] offset:4096
    ds_write_b128 v5, v[44:47] offset:6144
    ds_write_b128 v5, v[48:51] offset:8192
    s_mov_b32 s34, 0x8c00000
    s_mov_b32 s35, 0x8c5f000
    s_mov_b32 s36, 0x8cbe000
    s_mov_b32 s37, 0x8d1d000
    s_waitcnt lgkmcnt(0)
    s_barrier
    s_mul_i32 s56, s31, 10240
    s_mul_i32 s55, s28, 174080
    s_add_u32 s56, s56, s55
    s_add_u32 s56, s56, 10240
    s_and_b32 s55, s32, 1
    s_mul_i32 s55, s55, 5120
    s_add_u32 s56, s56, s55
    v_add_u32 v9, s56, v6
    s_mul_i32 s56, s28, 10240
    s_mul_i32 s55, s31, 640
    s_add_u32 s56, s56, s55
    s_add_u32 s56, s56, 348160
    s_and_b32 s55, s32, 1
    s_mul_i32 s55, s55, 20480
    s_add_u32 s56, s56, s55
    v_add_u32 v10, s56, v6
    v_cmp_gt_u32 s[50:51], 40, v1
    s_mul_i32 s59, s28, -10240
    s_sub_u32 s59, s59, 10240
HAf_loop:
    ds_read_b128 v[32:35], v6 offset:0
    ds_read_b128 v[36:39], v6 offset:1024
    ds_read_b128 v[40:43], v6 offset:2048
    ds_read_b128 v[44:47], v6 offset:3072
    ds_read_b128 v[48:51], v6 offset:4096
    ds_read_b128 v[52:55], v6 offset:5120
    ds_read_b128 v[56:59], v6 offset:6144
    s_waitcnt lgkmcnt(6)
    v_mfma_f32_16x16x32_bf16 v[112:115], a[0:3], v[32:35], 0
    v_mfma_f32_16x16x32_bf16 v[116:119], a[80:83], v[32:35], 0
    ds_read_b128 v[60:63], v6 offset:7168
    s_waitcnt lgkmcnt(6)
    v_mfma_f32_16x16x32_bf16 v[112:115], a[4:7], v[36:39], v[112:115]
    v_mfma_f32_16x16x32_bf16 v[116:119], a[84:87], v[36:39], v[116:119]
    ds_read_b128 v[64:67], v6 offset:8192
    s_waitcnt lgkmcnt(6)
    v_mfma_f32_16x16x32_bf16 v[112:115], a[8:11], v[40:43], v[112:115]
    v_mfma_f32_16x16x32_bf16 v[116:119], a[88:91], v[40:43], v[116:119]
    ds_read_b128 v[68:71], v6 offset:9216
    s_waitcnt lgkmcnt(6)
    v_mfma_f32_16x16x32_bf16 v[112:115], a[12:15], v[44:47], v[112:115]
    v_mfma_f32_16x16x32_bf16 v[116:119], a[92:95], v[44:47], v[116:119]
    ds_read_b128 v[72:75], v6 offset:10240
    s_waitcnt lgkmcnt(6)
    v_mfma_f32_16x16x32_bf16 v[112:115], a[16:19], v[48:51], v[112:115]
    v_mfma_f32_16x16x32_bf16 v[116:119], a[96:99], v[48:51], v[116:119]
    ds_read_b128 v[76:79], v6 offset:11264
    s_waitcnt lgkmcnt(6)
    v_mfma_f32_16x16x32_bf16 v[112:115], a[20:23], v[52:55], v[112:115]
    v_mfma_f32_16x16x32_bf16 v[116:119], a[100:103], v[52:55], v[116:119]
    ds_read_b128 v[80:83], v6 offset:12288
    s_waitcnt lgkmcnt(6)
    v_mfma_f32_16x16x32_bf16 v[112:115], a[24:27], v[56:59], v[112:115]
    v_mfma_f32_16x16x32_bf16 v[116:119], a[104:107], v[56:59], v[116:119]
    ds_read_b128 v[84:87], v6 offset:13312
    s_waitcnt lgkmcnt(6)
    v_mfma_f32_16x16x32_bf16 v[112:115], a[28:31], v[60:63], v[112:115]
    v_mfma_f32_16x16x32_bf16 v[116:119], a[108:111], v[60:63], v[116:119]
    ds_read_b128 v[88:91], v6 offset:14336
    s_waitcnt lgkmcnt(6)
    v_mfma_f32_16x16x32_bf16 v[112:115], a[32:35], v[64:67], v[112:115]
    v_mfma_f32_16x16x32_bf16 v[116:119], a[112:115], v[64:67], v[116:119]
    ds_read_b128 v[92:95], v6 offset:15360
    s_waitcnt lgkmcnt(6)
    v_mfma_f32_16x16x32_bf16 v[112:115], a[36:39], v[68:71], v[112:115]
    v_mfma_f32_16x16x32_bf16 v[116:119], a[116:119], v[68:71], v[116:119]
    ds_read_b128 v[96:99], v6 offset:16384
    s_waitcnt lgkmcnt(6)
    v_mfma_f32_16x16x32_bf16 v[112:115], a[40:43], v[72:75], v[112:115]
    v_mfma_f32_16x16x32_bf16 v[116:119], a[120:123], v[72:75], v[116:119]
    ds_read_b128 v[100:103], v6 offset:17408
    s_waitcnt lgkmcnt(6)
    v_mfma_f32_16x16x32_bf16 v[112:115], a[44:47], v[76:79], v[112:115]
    v_mfma_f32_16x16x32_bf16 v[116:119], a[124:127], v[76:79], v[116:119]
    ds_read_b128 v[104:107], v6 offset:18432
    s_waitcnt lgkmcnt(6)
    v_mfma_f32_16x16x32_bf16 v[112:115], a[48:51], v[80:83], v[112:115]
    v_mfma_f32_16x16x32_bf16 v[116:119], a[128:131], v[80:83], v[116:119]
    ds_read_b128 v[108:111], v6 offset:19456
    s_waitcnt lgkmcnt(6)
    v_mfma_f32_16x16x32_bf16 v[112:115], a[52:55], v[84:87], v[112:115]
    v_mfma_f32_16x16x32_bf16 v[116:119], a[132:135], v[84:87], v[116:119]
    s_waitcnt lgkmcnt(5)
    v_mfma_f32_16x16x32_bf16 v[112:115], a[56:59], v[88:91], v[112:115]
    v_mfma_f32_16x16x32_bf16 v[116:119], a[136:139], v[88:91], v[116:119]
    s_waitcnt lgkmcnt(4)
    v_mfma_f32_16x16x32_bf16 v[112:115], a[60:63], v[92:95], v[112:115]
    v_mfma_f32_16x16x32_bf16 v[116:119], a[140:143], v[92:95], v[116:119]
    s_waitcnt lgkmcnt(3)
    v_mfma_f32_16x16x32_bf16 v[112:115], a[64:67], v[96:99], v[112:115]
    v_mfma_f32_16x16x32_bf16 v[116:119], a[144:147], v[96:99], v[116:119]
    s_waitcnt lgkmcnt(2)
    v_mfma_f32_16x16x32_bf16 v[112:115], a[68:71], v[100:103], v[112:115]
    v_mfma_f32_16x16x32_bf16 v[116:119], a[148:151], v[100:103], v[116:119]
    s_waitcnt lgkmcnt(1)
    v_mfma_f32_16x16x32_bf16 v[112:115], a[72:75], v[104:107], v[112:115]
    v_mfma_f32_16x16x32_bf16 v[116:119], a[152:155], v[104:107], v[116:119]
    s_waitcnt lgkmcnt(0)
    v_mfma_f32_16x16x32_bf16 v[112:115], a[76:79], v[108:111], v[112:115]
    v_mfma_f32_16x16x32_bf16 v[116:119], a[156:159], v[108:111], v[116:119]
    v_mfma_f32_16x16x32_bf16 v[120:123], a[160:163], v[32:35], 0
    v_mfma_f32_16x16x32_bf16 v[124:127], a[240:243], v[32:35], 0
    v_mfma_f32_16x16x32_bf16 v[120:123], a[164:167], v[36:39], v[120:123]
    v_mfma_f32_16x16x32_bf16 v[124:127], a[244:247], v[36:39], v[124:127]
    v_mfma_f32_16x16x32_bf16 v[120:123], a[168:171], v[40:43], v[120:123]
    v_mfma_f32_16x16x32_bf16 v[124:127], a[248:251], v[40:43], v[124:127]
    v_mfma_f32_16x16x32_bf16 v[120:123], a[172:175], v[44:47], v[120:123]
    v_mfma_f32_16x16x32_bf16 v[124:127], a[252:255], v[44:47], v[124:127]
    v_mfma_f32_16x16x32_bf16 v[120:123], a[176:179], v[48:51], v[120:123]
    v_add_f32_dpp v112, v112, v112 row_ror:8 row_mask:0xf bank_mask:0xf
    v_mfma_f32_16x16x32_bf16 v[124:127], v[192:195], v[48:51], v[124:127]
    v_add_f32_dpp v113, v113, v113 row_ror:8 row_mask:0xf bank_mask:0xf
    v_mfma_f32_16x16x32_bf16 v[120:123], a[180:183], v[52:55], v[120:123]
    v_add_f32_dpp v114, v114, v114 row_ror:8 row_mask:0xf bank_mask:0xf
    v_mfma_f32_16x16x32_bf16 v[124:127], v[196:199], v[52:55], v[124:127]
    v_add_f32_dpp v115, v115, v115 row_ror:8 row_mask:0xf bank_mask:0xf
    v_mfma_f32_16x16x32_bf16 v[120:123], a[184:187], v[56:59], v[120:123]
    v_add_f32_dpp v116, v116, v116 row_ror:8 row_mask:0xf bank_mask:0xf
    v_mfma_f32_16x16x32_bf16 v[124:127], v[200:203], v[56:59], v[124:127]
    v_add_f32_dpp v117, v117, v117 row_ror:8 row_mask:0xf bank_mask:0xf
    v_mfma_f32_16x16x32_bf16 v[120:123], a[188:191], v[60:63], v[120:123]
    v_add_f32_dpp v118, v118, v118 row_ror:8 row_mask:0xf bank_mask:0xf
    v_mfma_f32_16x16x32_bf16 v[124:127], v[204:207], v[60:63], v[124:127]
    v_add_f32_dpp v119, v119, v119 row_ror:8 row_mask:0xf bank_mask:0xf
    v_mfma_f32_16x16x32_bf16 v[120:123], a[192:195], v[64:67], v[120:123]
    v_cvt_pk_bf16_f32 v168, v112, v113
    v_mfma_f32_16x16x32_bf16 v[124:127], v[208:211], v[64:67], v[124:127]
    v_cvt_pk_bf16_f32 v169, v114, v115
    v_mfma_f32_16x16x32_bf16 v[120:123], a[196:199], v[68:71], v[120:123]
    v_cvt_pk_bf16_f32 v170, v116, v117
    v_mfma_f32_16x16x32_bf16 v[124:127], v[212:215], v[68:71], v[124:127]
    v_cvt_pk_bf16_f32 v171, v118, v119
    v_mfma_f32_16x16x32_bf16 v[120:123], a[200:203], v[72:75], v[120:123]
    v_mfma_f32_16x16x32_bf16 v[124:127], v[216:219], v[72:75], v[124:127]
    v_mfma_f32_16x16x32_bf16 v[112:115], v[152:155], v[168:171], 0
    v_mfma_f32_16x16x32_bf16 v[120:123], a[204:207], v[76:79], v[120:123]
    v_mfma_f32_16x16x32_bf16 v[116:119], v[156:159], v[168:171], 0
    v_mfma_f32_16x16x32_bf16 v[124:127], v[220:223], v[76:79], v[124:127]
    v_mfma_f32_16x16x32_bf16 v[120:123], a[208:211], v[80:83], v[120:123]
    v_mfma_f32_16x16x32_bf16 v[124:127], v[224:227], v[80:83], v[124:127]
    v_mfma_f32_16x16x32_bf16 v[120:123], a[212:215], v[84:87], v[120:123]
    v_mfma_f32_16x16x32_bf16 v[124:127], v[228:231], v[84:87], v[124:127]
    v_mfma_f32_16x16x32_bf16 v[120:123], a[216:219], v[88:91], v[120:123]
    v_mfma_f32_16x16x32_bf16 v[124:127], v[232:235], v[88:91], v[124:127]
    v_mfma_f32_16x16x32_bf16 v[120:123], a[220:223], v[92:95], v[120:123]
    v_mfma_f32_16x16x32_bf16 v[124:127], v[236:239], v[92:95], v[124:127]
    ds_write_b128 v15, v[112:115] offset:1152
    v_mfma_f32_16x16x32_bf16 v[120:123], a[224:227], v[96:99], v[120:123]
    ds_write_b128 v15, v[116:119] offset:2304
    v_mfma_f32_16x16x32_bf16 v[124:127], v[240:243], v[96:99], v[124:127]
    v_mfma_f32_16x16x32_bf16 v[120:123], a[228:231], v[100:103], v[120:123]
    v_mfma_f32_16x16x32_bf16 v[124:127], v[244:247], v[100:103], v[124:127]
    v_mfma_f32_16x16x32_bf16 v[120:123], a[232:235], v[104:107], v[120:123]
    v_mfma_f32_16x16x32_bf16 v[124:127], v[248:251], v[104:107], v[124:127]
    v_mfma_f32_16x16x32_bf16 v[120:123], a[236:239], v[108:111], v[120:123]
    v_mfma_f32_16x16x32_bf16 v[124:127], v[252:255], v[108:111], v[124:127]
    s_nop 7
    v_add_f32_dpp v120, v120, v120 row_ror:8 row_mask:0xf bank_mask:0xf
    v_add_f32_dpp v121, v121, v121 row_ror:8 row_mask:0xf bank_mask:0xf
    v_add_f32_dpp v122, v122, v122 row_ror:8 row_mask:0xf bank_mask:0xf
    v_add_f32_dpp v123, v123, v123 row_ror:8 row_mask:0xf bank_mask:0xf
    v_add_f32_dpp v124, v124, v124 row_ror:8 row_mask:0xf bank_mask:0xf
    v_add_f32_dpp v125, v125, v125 row_ror:8 row_mask:0xf bank_mask:0xf
    v_add_f32_dpp v126, v126, v126 row_ror:8 row_mask:0xf bank_mask:0xf
    v_add_f32_dpp v127, v127, v127 row_ror:8 row_mask:0xf bank_mask:0xf
    v_cvt_pk_bf16_f32 v184, v120, v121
    v_cvt_pk_bf16_f32 v185, v122, v123
    v_cvt_pk_bf16_f32 v186, v124, v125
    v_cvt_pk_bf16_f32 v187, v126, v127
    s_nop 1
    v_mfma_f32_16x16x32_bf16 v[172:175], v[184:187], v[168:171], 0
    s_nop 7
    ds_write_b128 v15, v[172:175]
    s_waitcnt lgkmcnt(0)
    s_barrier
    ds_read_b128 v[32:35], v16 offset:0
    ds_read_b128 v[36:39], v16 offset:3456
    ds_read_b128 v[40:43], v16 offset:6912
    ds_read_b128 v[44:47], v16 offset:10368
    s_waitcnt lgkmcnt(2)
    v_pk_add_f32 v[48:49], v[32:33], v[36:37]
    v_pk_add_f32 v[50:51], v[34:35], v[38:39]
    s_waitcnt lgkmcnt(0)
    v_pk_add_f32 v[52:53], v[40:41], v[44:45]
    v_pk_add_f32 v[54:55], v[42:43], v[46:47]
    v_pk_add_f32 v[48:49], v[48:49], v[52:53]
    v_pk_add_f32 v[50:51], v[50:51], v[54:55]
    v_cndmask_b32 v48, v27, v48, s[46:47]
    v_cndmask_b32 v49, v27, v49, s[46:47]
    v_cndmask_b32 v50, v27, v50, s[46:47]
    v_cndmask_b32 v51, v27, v51, s[46:47]
    v_max3_f32 v52, v48, v49, v50
    v_max_f32 v52, v52, v51
    s_nop 1
    v_max_f32_dpp v52, v52, v52 row_ror:8 row_mask:0xf bank_mask:0xf
    s_nop 1
    v_max_f32_dpp v52, v52, v52 row_ror:4 row_mask:0xf bank_mask:0xf
    s_nop 1
    v_max_f32_dpp v52, v52, v52 row_ror:2 row_mask:0xf bank_mask:0xf
    s_nop 1
    v_max_f32_dpp v52, v52, v52 row_ror:1 row_mask:0xf bank_mask:0xf
    v_mul_f32 v52, s57, v52
    v_fma_f32 v48, v48, s57, -v52
    v_fma_f32 v49, v49, s57, -v52
    v_fma_f32 v50, v50, s57, -v52
    v_fma_f32 v51, v51, s57, -v52
    v_exp_f32 v48, v48
    v_exp_f32 v49, v49
    v_exp_f32 v50, v50
    v_exp_f32 v51, v51
    s_nop 0
    v_add_f32 v53, v48, v49
    v_add_f32 v54, v50, v51
    v_add_f32 v53, v53, v54
    s_nop 1
    v_add_f32_dpp v53, v53, v53 row_ror:8 row_mask:0xf bank_mask:0xf
    s_nop 1
    v_add_f32_dpp v53, v53, v53 row_ror:4 row_mask:0xf bank_mask:0xf
    s_nop 1
    v_add_f32_dpp v53, v53, v53 row_ror:2 row_mask:0xf bank_mask:0xf
    s_nop 1
    v_add_f32_dpp v53, v53, v53 row_ror:1 row_mask:0xf bank_mask:0xf
    v_rcp_f32 v53, v53
    s_nop 0
    v_mul_f32 v48, v48, v53
    v_mul_f32 v49, v49, v53
    v_mul_f32 v50, v50, v53
    v_mul_f32 v51, v51, v53
    v_cvt_pk_bf16_f32 v54, v48, v49
    v_cvt_pk_bf16_f32 v55, v50, v51
    s_mov_b64 exec, s[48:49]
    buffer_store_dwordx2 v[54:55], v17, s[8:11], s34 offen
    s_mov_b64 exec, -1
    s_cmp_eq_u32 s33, 63
    s_cbranch_scc1 HAf_last
    s_lshl_b32 s73, s33, 17
    s_add_u32 s73, s73, 0x8400000
    s_mul_i32 s72, s33, 327680
    s_add_u32 s72, s72, 0x7000000
    s_add_u32 s72, s72, s59
    s_add_u32 s39, s39, 262144
    s_add_u32 s40, s40, 1310720
    s_add_u32 s33, s33, 1
    s_cmp_eq_u32 s32, 2
    s_cbranch_scc0 cp_14
    s_sub_u32 s54, s33, 1
    v_mov_b32 v189, s54
    v_mov_b32 v190, 0
    s_mov_b64 exec, 1
    buffer_store_dword v189, v190, s[8:11], s75 offen sc1
    s_mov_b64 exec, -1
cp_14:
    s_cmp_lt_u32 s33, s74
    s_cbranch_scc1 rdy_15
rdl_16:
    s_and_b32 s54, s33, 1
    buffer_load_dword v188, v30, s[8:11], 0 offen sc1
    s_waitcnt vmcnt(0)
    v_cmp_lt_u32 vcc, 127, v188
    s_nop 1
    v_cmp_gt_u32 vcc, 128, v188
    s_nop 1
    v_cndmask_b32 v188, 0, v188, vcc
    v_max_u32 v188, v188, v31
    s_nop 1
    v_min_u32_dpp v188, v188, v188 row_ror:1 row_mask:0xf bank_mask:0xf
    s_nop 1
    v_min_u32_dpp v188, v188, v188 row_ror:2 row_mask:0xf bank_mask:0xf
    s_nop 1
    v_min_u32_dpp v188, v188, v188 row_ror:4 row_mask:0xf bank_mask:0xf
    s_nop 1
    v_min_u32_dpp v188, v188, v188 row_ror:8 row_mask:0xf bank_mask:0xf
    s_nop 1
    v_readlane_b32 s54, v188, 0
    v_readlane_b32 s55, v188, 16
    v_readlane_b32 s56, v188, 32
    v_readlane_b32 s74, v188, 48
    s_nop 3
    s_min_u32 s54, s54, s55
    s_min_u32 s56, s56, s74
    s_min_u32 s74, s54, s56
    s_cmp_lt_u32 s33, s74
    s_cbranch_scc1 rdy_15
    s_sleep 1
    s_sub_u32 s58, s58, 1
    s_cbranch_scc0 rdl_16
    s_mov_b32 s58, 0
    s_mov_b32 s74, 0x40
rdy_15:
    buffer_load_dwordx4 v[152:155], v12, s[8:11], s39 offen offset:0 sc1
    buffer_load_dwordx4 v[156:159], v12, s[8:11], s39 offen offset:1024 sc1
    buffer_store_dwordx4 v[184:187], v28, s[8:11], s73 offen sc1
    s_mov_b64 exec, s[48:49]
    buffer_store_dwordx2 v[22:23], v17, s[8:11], s37 offen
    s_mov_b64 exec, -1
    s_cmp_lt_u32 s32, 2
    s_cbranch_scc1 HAfrem_17
HAfsp_19:
    s_add_u32 s55, s35, 4096
    buffer_load_dwordx4 v[52:55], v4, s[8:11], s35 offen offset:0 sc1
    buffer_load_dwordx4 v[56:59], v4, s[8:11], s35 offen offset:1024 sc1
    buffer_load_dwordx4 v[60:63], v4, s[8:11], s35 offen offset:2048 sc1
    buffer_load_dwordx4 v[64:67], v4, s[8:11], s35 offen offset:3072 sc1
    buffer_load_dwordx4 v[68:71], v4, s[8:11], s55 offen sc1
    s_waitcnt vmcnt(0)
    v_max3_u32 v188, v52, v53, v54
    v_max3_u32 v188, v188, v55, v56
    v_max3_u32 v188, v188, v57, v58
    v_max3_u32 v188, v188, v59, v60
    v_max3_u32 v188, v188, v61, v62
    v_max3_u32 v188, v188, v63, v64
    v_max3_u32 v188, v188, v65, v66
    v_max3_u32 v188, v188, v67, v68
    v_max3_u32 v188, v188, v69, v70
    v_max_u32 v188, v188, v71
    v_cmp_eq_u32 vcc, -1, v188
    s_cbranch_vccz HAfsd_20
    s_sub_u32 s58, s58, 1
    s_cbranch_scc0 HAfsp_19
    s_mov_b32 s58, 0
HAfsd_20:
    s_branch HAfjn_18
HAfrem_17:
    s_add_u32 s55, s37, 4096
    buffer_store_dwordx4 v[22:25], v9, s[8:11], s37 offen offset:0
    buffer_store_dwordx4 v[22:25], v9, s[8:11], s37 offen offset:1024
    buffer_store_dwordx4 v[22:25], v9, s[8:11], s37 offen offset:2048
    buffer_store_dwordx4 v[22:25], v9, s[8:11], s37 offen offset:3072
    buffer_store_dwordx4 v[22:25], v9, s[8:11], s55 offen
    s_mov_b64 exec, s[50:51]
    s_cmp_eq_u32 s32, 1
    s_cbranch_scc1 HAfhw1_21
    buffer_store_dwordx4 v[22:25], v10, s[8:11], s37 offen
    s_branch HAfhwj_22
HAfhw1_21:
    buffer_store_dwordx4 v[22:25], v10, s[8:11], s37 offen sc1
HAfhwj_22:
    s_mov_b64 exec, -1
HAfsp_23:
    s_add_u32 s55, s34, 4096
    buffer_load_dwordx4 v[72:75], v9, s[8:11], s34 offen offset:0 sc1
    buffer_load_dwordx4 v[76:79], v9, s[8:11], s34 offen offset:1024 sc1
    buffer_load_dwordx4 v[80:83], v9, s[8:11], s34 offen offset:2048 sc1
    buffer_load_dwordx4 v[84:87], v9, s[8:11], s34 offen offset:3072 sc1
    buffer_load_dwordx4 v[88:91], v9, s[8:11], s55 offen sc1
    s_waitcnt vmcnt(0)
    v_max3_u32 v188, v72, v73, v74
    v_max3_u32 v188, v188, v75, v76
    v_max3_u32 v188, v188, v77, v78
    v_max3_u32 v188, v188, v79, v80
    v_max3_u32 v188, v188, v81, v82
    v_max3_u32 v188, v188, v83, v84
    v_max3_u32 v188, v188, v85, v86
    v_max3_u32 v188, v188, v87, v88
    v_max3_u32 v188, v188, v89, v90
    v_max_u32 v188, v188, v91
    v_cmp_eq_u32 vcc, -1, v188
    s_cbranch_vccz HAfsd_24
    s_sub_u32 s58, s58, 1
    s_cbranch_scc0 HAfsp_23
    s_mov_b32 s58, 0
HAfsd_24:
    s_add_u32 s55, s72, 4096
    buffer_store_dwordx4 v[72:75], v9, s[8:11], s72 offen offset:0 sc1
    buffer_store_dwordx4 v[76:79], v9, s[8:11], s72 offen offset:1024 sc1
    buffer_store_dwordx4 v[80:83], v9, s[8:11], s72 offen offset:2048 sc1
    buffer_store_dwordx4 v[84:87], v9, s[8:11], s72 offen offset:3072 sc1
    buffer_store_dwordx4 v[88:91], v9, s[8:11], s55 offen sc1
HAfsp_25:
    buffer_load_dwordx4 v[32:35], v11, s[8:11], s35 offen sc1
    s_waitcnt vmcnt(0)
    v_max3_u32 v188, v32, v33, v34
    v_max_u32 v188, v188, v35
    v_cmp_eq_u32 vcc, -1, v188
    s_cbranch_vccz HAfsd_26
    s_sub_u32 s58, s58, 1
    s_cbranch_scc0 HAfsp_25
    s_mov_b32 s58, 0
HAfsd_26:
    s_add_u32 s55, s35, 4096
    buffer_load_dwordx4 v[52:55], v4, s[8:11], s35 offen offset:0 sc1
    buffer_load_dwordx4 v[56:59], v4, s[8:11], s35 offen offset:1024 sc1
    buffer_load_dwordx4 v[60:63], v4, s[8:11], s35 offen offset:2048 sc1
    buffer_load_dwordx4 v[64:67], v4, s[8:11], s35 offen offset:3072 sc1
    buffer_load_dwordx4 v[68:71], v4, s[8:11], s55 offen sc1
    s_waitcnt vmcnt(0)
    v_max3_u32 v188, v52, v53, v54
    v_max3_u32 v188, v188, v55, v56
    v_max3_u32 v188, v188, v57, v58
    v_max3_u32 v188, v188, v59, v60
    v_max3_u32 v188, v188, v61, v62
    v_max3_u32 v188, v188, v63, v64
    v_max3_u32 v188, v188, v65, v66
    v_max3_u32 v188, v188, v67, v68
    v_max3_u32 v188, v188, v69, v70
    v_max_u32 v188, v188, v71
    v_cmp_eq_u32 vcc, -1, v188
    s_cbranch_vccnz HAfrt_28
HAfok_27:
HAfjn_18:
    ds_write_b128 v5, v[52:55] offset:0
    ds_write_b128 v5, v[56:59] offset:2048
    ds_write_b128 v5, v[60:63] offset:4096
    ds_write_b128 v5, v[64:67] offset:6144
    ds_write_b128 v5, v[68:71] offset:8192
    s_mov_b32 s54, s34
    s_mov_b32 s34, s35
    s_mov_b32 s35, s36
    s_mov_b32 s36, s37
    s_mov_b32 s37, s54
    s_waitcnt lgkmcnt(0)
    s_barrier
    s_branch HAf_loop
HAf_last:
    s_cmp_eq_u32 s32, 2
    s_cbranch_scc0 cl_29
    s_mov_b32 s54, 0x3f
    v_mov_b32 v189, s54
    v_mov_b32 v190, 0
    s_mov_b64 exec, 1
    buffer_store_dword v189, v190, s[8:11], s75 offen sc1
    s_mov_b64 exec, -1
cl_29:
    s_lshl_b32 s73, s33, 17
    s_add_u32 s73, s73, 0x8400000
    buffer_store_dwordx4 v[184:187], v28, s[8:11], s73 offen sc1
    s_waitcnt vmcnt(0)
    s_barrier
    s_cmp_eq_u32 s32, 0
    s_cbranch_scc0 ce_30
    s_mov_b32 s54, 0x40
    v_mov_b32 v189, s54
    v_mov_b32 v190, 0
    s_mov_b64 exec, 1
    buffer_store_dword v189, v190, s[8:11], s75 offen sc1
    s_mov_b64 exec, -1
    s_waitcnt vmcnt(0)
ce_30:
    s_endpgm
HAfrt_28:
    s_sub_u32 s58, s58, 1
    s_cbranch_scc1 HAfbad_31
    s_add_u32 s55, s35, 4096
    buffer_load_dwordx4 v[52:55], v4, s[8:11], s35 offen offset:0 sc1
    buffer_load_dwordx4 v[56:59], v4, s[8:11], s35 offen offset:1024 sc1
    buffer_load_dwordx4 v[60:63], v4, s[8:11], s35 offen offset:2048 sc1
    buffer_load_dwordx4 v[64:67], v4, s[8:11], s35 offen offset:3072 sc1
    buffer_load_dwordx4 v[68:71], v4, s[8:11], s55 offen sc1
    s_waitcnt vmcnt(0)
    v_max3_u32 v188, v52, v53, v54
    v_max3_u32 v188, v188, v55, v56
    v_max3_u32 v188, v188, v57, v58
    v_max3_u32 v188, v188, v59, v60
    v_max3_u32 v188, v188, v61, v62
    v_max3_u32 v188, v188, v63, v64
    v_max3_u32 v188, v188, v65, v66
    v_max3_u32 v188, v188, v67, v68
    v_max3_u32 v188, v188, v69, v70
    v_max_u32 v188, v188, v71
    v_cmp_eq_u32 vcc, -1, v188
    s_cbranch_vccnz HAfrt_28
    s_branch HAfok_27
HAfbad_31:
    s_mov_b32 s58, 0
    s_branch HAfok_27
HslowA_2:
    s_mov_b32 s55, 0x8c00000
    s_mov_b64 exec, s[48:49]
    buffer_store_dwordx2 v[22:23], v17, s[8:11], s55 offen sc1
    s_mov_b64 exec, -1
    s_mov_b32 s55, 0x8c5f000
    s_mov_b64 exec, s[48:49]
    buffer_store_dwordx2 v[22:23], v17, s[8:11], s55 offen sc1
    s_mov_b64 exec, -1
    s_mov_b32 s55, 0x8cbe000
    s_mov_b64 exec, s[48:49]
    buffer_store_dwordx2 v[22:23], v17, s[8:11], s55 offen sc1
    s_mov_b64 exec, -1
    s_mov_b32 s55, 0x8d1d000
    s_mov_b64 exec, s[48:49]
    buffer_store_dwordx2 v[22:23], v17, s[8:11], s55 offen sc1
    s_mov_b64 exec, -1
    v_mov_b32 v168, 0
    s_mov_b64 exec, 1
    s_add_u32 s55, s41, 0
    buffer_store_dword v168, v13, s[8:11], s55 offen sc1
    s_mov_b64 exec, -1
    s_waitcnt vmcnt(0)
    s_barrier
    s_cmp_eq_u32 s32, 0
    s_cbranch_scc0 HAssb_32
    v_mov_b32 v168, 1
    v_mov_b32 v169, 36
    s_mov_b64 exec, 1
    buffer_atomic_add v168, v169, s[20:23], 0 offen
    s_mov_b64 exec, -1
    s_waitcnt vmcnt(0)
HAssb_32:
    s_lshr_b32 s56, s32, 1
    s_lshl_b32 s56, s56, 3
    v_lshlrev_b32 v172, 1, v3
    v_add_u32 v172, s56, v172
    v_xor_b32 v172, v172, v2
    v_lshlrev_b32 v172, 4, v172
    s_lshl_b32 s56, s32, 2
    v_add_u32 v173, s56, v3
    v_lshlrev_b32 v168, 13, v173
    v_add_u32 v168, v168, v172
    s_lshl_b32 s56, s32, 1
    s_lshl_b32 s56, s56, 1
    v_bfe_u32 v172, v1, 1, 1
    v_add_u32 v172, s56, v172
    v_lshrrev_b32 v173, 2, v2
    v_lshlrev_b32 v173, 1, v173
    v_and_b32 v170, 1, v3
    v_lshl_add_u32 v173, v170, 3, v173
    v_xor_b32 v172, v172, v173
    v_lshlrev_b32 v172, 4, v172
    v_and_b32 v173, 1, v1
    v_lshl_add_u32 v172, v173, 3, v172
    v_lshrrev_b32 v173, 2, v2
    v_mad_u32_u24 v173, v3, 8, v173
    v_lshl_add_u32 v170, v173, 8, v172
    s_lshl_b32 s56, s32, 1
    s_add_u32 s56, s56, 1
    s_lshl_b32 s56, s56, 1
    v_bfe_u32 v172, v1, 1, 1
    v_add_u32 v172, s56, v172
    v_lshrrev_b32 v173, 2, v2
    v_lshlrev_b32 v173, 1, v173
    v_and_b32 v171, 1, v3
    v_lshl_add_u32 v173, v171, 3, v173
    v_xor_b32 v172, v172, v173
    v_lshlrev_b32 v172, 4, v172
    v_and_b32 v173, 1, v1
    v_lshl_add_u32 v172, v173, 3, v172
    v_lshrrev_b32 v173, 2, v2
    v_mad_u32_u24 v173, v3, 8, v173
    v_lshl_add_u32 v171, v173, 8, v172
    s_lshl_b32 s54, s30, 8
    s_add_u32 s55, s54, 0x0
    s_lshl_b32 s56, s32, 10
    s_add_u32 m0, s56, 0x0
    s_nop 0
    buffer_load_dwordx4 v168, s[12:15], s55 offen lds
    s_add_u32 s55, s54, 0x20000
    s_lshl_b32 s56, s32, 10
    s_add_u32 m0, s56, 0x1000
    s_nop 0
    buffer_load_dwordx4 v168, s[12:15], s55 offen lds
    s_add_u32 s55, s54, 0x40000
    s_lshl_b32 s56, s32, 10
    s_add_u32 m0, s56, 0x2000
    s_nop 0
    buffer_load_dwordx4 v168, s[12:15], s55 offen lds
    s_add_u32 s55, s54, 0x60000
    s_lshl_b32 s56, s32, 10
    s_add_u32 m0, s56, 0x3000
    s_nop 0
    buffer_load_dwordx4 v168, s[12:15], s55 offen lds
    s_add_u32 s55, s54, 0x80000
    s_lshl_b32 s56, s32, 10
    s_add_u32 m0, s56, 0x4000
    s_nop 0
    buffer_load_dwordx4 v168, s[12:15], s55 offen lds
    s_add_u32 s55, s54, 0xa0000
    s_lshl_b32 s56, s32, 10
    s_add_u32 m0, s56, 0x5000
    s_nop 0
    buffer_load_dwordx4 v168, s[12:15], s55 offen lds
    s_add_u32 s55, s54, 0xc0000
    s_lshl_b32 s56, s32, 10
    s_add_u32 m0, s56, 0x6000
    s_nop 0
    buffer_load_dwordx4 v168, s[12:15], s55 offen lds
    s_add_u32 s55, s54, 0xe0000
    s_lshl_b32 s56, s32, 10
    s_add_u32 m0, s56, 0x7000
    s_nop 0
    buffer_load_dwordx4 v168, s[12:15], s55 offen lds
    s_add_u32 s55, s54, 0x100000
    s_lshl_b32 s56, s32, 10
    s_add_u32 m0, s56, 0x8000
    s_nop 0
    buffer_load_dwordx4 v168, s[12:15], s55 offen lds
    s_add_u32 s55, s54, 0x120000
    s_lshl_b32 s56, s32, 10
    s_add_u32 m0, s56, 0x9000
    s_nop 0
    buffer_load_dwordx4 v168, s[12:15], s55 offen lds
    s_add_u32 s55, s54, 0x140000
    s_lshl_b32 s56, s32, 10
    s_add_u32 m0, s56, 0xa000
    s_nop 0
    buffer_load_dwordx4 v168, s[12:15], s55 offen lds
    s_add_u32 s55, s54, 0x160000
    s_lshl_b32 s56, s32, 10
    s_add_u32 m0, s56, 0xb000
    s_nop 0
    buffer_load_dwordx4 v168, s[12:15], s55 offen lds
    s_add_u32 s55, s54, 0x180000
    s_lshl_b32 s56, s32, 10
    s_add_u32 m0, s56, 0xc000
    s_nop 0
    buffer_load_dwordx4 v168, s[12:15], s55 offen lds
    s_add_u32 s55, s54, 0x1a0000
    s_lshl_b32 s56, s32, 10
    s_add_u32 m0, s56, 0xd000
    s_nop 0
    buffer_load_dwordx4 v168, s[12:15], s55 offen lds
    s_add_u32 s55, s54, 0x1c0000
    s_lshl_b32 s56, s32, 10
    s_add_u32 m0, s56, 0xe000
    s_nop 0
    buffer_load_dwordx4 v168, s[12:15], s55 offen lds
    s_add_u32 s55, s54, 0x1e0000
    s_lshl_b32 s56, s32, 10
    s_add_u32 m0, s56, 0xf000
    s_nop 0
    buffer_load_dwordx4 v168, s[12:15], s55 offen lds
    s_add_u32 s55, s54, 0x200000
    s_lshl_b32 s56, s32, 10
    s_add_u32 m0, s56, 0x10000
    s_nop 0
    buffer_load_dwordx4 v168, s[12:15], s55 offen lds
    s_add_u32 s55, s54, 0x220000
    s_lshl_b32 s56, s32, 10
    s_add_u32 m0, s56, 0x11000
    s_nop 0
    buffer_load_dwordx4 v168, s[12:15], s55 offen lds
    s_add_u32 s55, s54, 0x240000
    s_lshl_b32 s56, s32, 10
    s_add_u32 m0, s56, 0x12000
    s_nop 0
    buffer_load_dwordx4 v168, s[12:15], s55 offen lds
    s_add_u32 s55, s54, 0x260000
    s_lshl_b32 s56, s32, 10
    s_add_u32 m0, s56, 0x13000
    s_nop 0
    buffer_load_dwordx4 v168, s[12:15], s55 offen lds
    s_add_u32 s55, s54, 0x280000
    s_lshl_b32 s56, s32, 10
    s_add_u32 m0, s56, 0x14000
    s_nop 0
    buffer_load_dwordx4 v168, s[12:15], s55 offen lds
    s_add_u32 s55, s54, 0x2a0000
    s_lshl_b32 s56, s32, 10
    s_add_u32 m0, s56, 0x15000
    s_nop 0
    buffer_load_dwordx4 v168, s[12:15], s55 offen lds
    s_add_u32 s55, s54, 0x2c0000
    s_lshl_b32 s56, s32, 10
    s_add_u32 m0, s56, 0x16000
    s_nop 0
    buffer_load_dwordx4 v168, s[12:15], s55 offen lds
    s_add_u32 s55, s54, 0x2e0000
    s_lshl_b32 s56, s32, 10
    s_add_u32 m0, s56, 0x17000
    s_nop 0
    buffer_load_dwordx4 v168, s[12:15], s55 offen lds
    s_add_u32 s55, s54, 0x300000
    s_lshl_b32 s56, s32, 10
    s_add_u32 m0, s56, 0x18000
    s_nop 0
    buffer_load_dwordx4 v168, s[12:15], s55 offen lds
    s_add_u32 s55, s54, 0x320000
    s_lshl_b32 s56, s32, 10
    s_add_u32 m0, s56, 0x19000
    s_nop 0
    buffer_load_dwordx4 v168, s[12:15], s55 offen lds
    s_add_u32 s55, s54, 0x340000
    s_lshl_b32 s56, s32, 10
    s_add_u32 m0, s56, 0x1a000
    s_nop 0
    buffer_load_dwordx4 v168, s[12:15], s55 offen lds
    s_add_u32 s55, s54, 0x360000
    s_lshl_b32 s56, s32, 10
    s_add_u32 m0, s56, 0x1b000
    s_nop 0
    buffer_load_dwordx4 v168, s[12:15], s55 offen lds
    s_add_u32 s55, s54, 0x380000
    s_lshl_b32 s56, s32, 10
    s_add_u32 m0, s56, 0x1c000
    s_nop 0
    buffer_load_dwordx4 v168, s[12:15], s55 offen lds
    s_add_u32 s55, s54, 0x3a0000
    s_lshl_b32 s56, s32, 10
    s_add_u32 m0, s56, 0x1d000
    s_nop 0
    buffer_load_dwordx4 v168, s[12:15], s55 offen lds
    s_add_u32 s55, s54, 0x3c0000
    s_lshl_b32 s56, s32, 10
    s_add_u32 m0, s56, 0x1e000
    s_nop 0
    buffer_load_dwordx4 v168, s[12:15], s55 offen lds
    s_add_u32 s55, s54, 0x3e0000
    s_lshl_b32 s56, s32, 10
    s_add_u32 m0, s56, 0x1f000
    s_nop 0
    buffer_load_dwordx4 v168, s[12:15], s55 offen lds
    s_add_u32 s55, s54, 0x400000
    s_lshl_b32 s56, s32, 10
    s_add_u32 m0, s56, 0x20000
    s_nop 0
    buffer_load_dwordx4 v168, s[12:15], s55 offen lds
    s_add_u32 s55, s54, 0x420000
    s_lshl_b32 s56, s32, 10
    s_add_u32 m0, s56, 0x21000
    s_nop 0
    buffer_load_dwordx4 v168, s[12:15], s55 offen lds
    s_add_u32 s55, s54, 0x440000
    s_lshl_b32 s56, s32, 10
    s_add_u32 m0, s56, 0x22000
    s_nop 0
    buffer_load_dwordx4 v168, s[12:15], s55 offen lds
    s_add_u32 s55, s54, 0x460000
    s_lshl_b32 s56, s32, 10
    s_add_u32 m0, s56, 0x23000
    s_nop 0
    buffer_load_dwordx4 v168, s[12:15], s55 offen lds
    s_add_u32 s55, s54, 0x480000
    s_lshl_b32 s56, s32, 10
    s_add_u32 m0, s56, 0x24000
    s_nop 0
    buffer_load_dwordx4 v168, s[12:15], s55 offen lds
    s_add_u32 s55, s54, 0x4a0000
    s_lshl_b32 s56, s32, 10
    s_add_u32 m0, s56, 0x25000
    s_nop 0
    buffer_load_dwordx4 v168, s[12:15], s55 offen lds
    s_add_u32 s55, s54, 0x4c0000
    s_lshl_b32 s56, s32, 10
    s_add_u32 m0, s56, 0x26000
    s_nop 0
    buffer_load_dwordx4 v168, s[12:15], s55 offen lds
    s_add_u32 s55, s54, 0x4e0000
    s_lshl_b32 s56, s32, 10
    s_add_u32 m0, s56, 0x27000
    s_nop 0
    buffer_load_dwordx4 v168, s[12:15], s55 offen lds
    s_waitcnt vmcnt(20)
    s_barrier
    v_add_u32 v172, 0x0, v170
    v_add_u32 v173, 0x0, v171
    ds_read_b64_tr_b16 a[0:1], v172 offset:0
    ds_read_b64_tr_b16 a[2:3], v172 offset:1024
    ds_read_b64_tr_b16 a[4:5], v172 offset:8192
    ds_read_b64_tr_b16 a[6:7], v172 offset:9216
    ds_read_b64_tr_b16 a[8:9], v172 offset:16384
    ds_read_b64_tr_b16 a[10:11], v172 offset:17408
    ds_read_b64_tr_b16 a[12:13], v172 offset:24576
    ds_read_b64_tr_b16 a[14:15], v172 offset:25600
    ds_read_b64_tr_b16 a[16:17], v172 offset:32768
    ds_read_b64_tr_b16 a[18:19], v172 offset:33792
    ds_read_b64_tr_b16 a[80:81], v173 offset:0
    ds_read_b64_tr_b16 a[82:83], v173 offset:1024
    ds_read_b64_tr_b16 a[84:85], v173 offset:8192
    ds_read_b64_tr_b16 a[86:87], v173 offset:9216
    ds_read_b64_tr_b16 a[88:89], v173 offset:16384
    ds_read_b64_tr_b16 a[90:91], v173 offset:17408
    ds_read_b64_tr_b16 a[92:93], v173 offset:24576
    ds_read_b64_tr_b16 a[94:95], v173 offset:25600
    ds_read_b64_tr_b16 a[96:97], v173 offset:32768
    ds_read_b64_tr_b16 a[98:99], v173 offset:33792
    s_waitcnt lgkmcnt(0)
    v_add_u32 v172, 0xa000, v170
    v_add_u32 v173, 0xa000, v171
    ds_read_b64_tr_b16 a[20:21], v172 offset:0
    ds_read_b64_tr_b16 a[22:23], v172 offset:1024
    ds_read_b64_tr_b16 a[24:25], v172 offset:8192
    ds_read_b64_tr_b16 a[26:27], v172 offset:9216
    ds_read_b64_tr_b16 a[28:29], v172 offset:16384
    ds_read_b64_tr_b16 a[30:31], v172 offset:17408
    ds_read_b64_tr_b16 a[32:33], v172 offset:24576
    ds_read_b64_tr_b16 a[34:35], v172 offset:25600
    ds_read_b64_tr_b16 a[36:37], v172 offset:32768
    ds_read_b64_tr_b16 a[38:39], v172 offset:33792
    ds_read_b64_tr_b16 a[100:101], v173 offset:0
    ds_read_b64_tr_b16 a[102:103], v173 offset:1024
    ds_read_b64_tr_b16 a[104:105], v173 offset:8192
    ds_read_b64_tr_b16 a[106:107], v173 offset:9216
    ds_read_b64_tr_b16 a[108:109], v173 offset:16384
    ds_read_b64_tr_b16 a[110:111], v173 offset:17408
    ds_read_b64_tr_b16 a[112:113], v173 offset:24576
    ds_read_b64_tr_b16 a[114:115], v173 offset:25600
    ds_read_b64_tr_b16 a[116:117], v173 offset:32768
    ds_read_b64_tr_b16 a[118:119], v173 offset:33792
    s_waitcnt lgkmcnt(0)
    s_barrier
    s_add_u32 s55, s54, 0x0
    s_lshl_b32 s56, s32, 10
    s_add_u32 m0, s56, 0x0
    s_nop 0
    buffer_load_dwordx4 v168, s[16:19], s55 offen lds
    s_add_u32 s55, s54, 0x20000
    s_lshl_b32 s56, s32, 10
    s_add_u32 m0, s56, 0x1000
    s_nop 0
    buffer_load_dwordx4 v168, s[16:19], s55 offen lds
    s_add_u32 s55, s54, 0x40000
    s_lshl_b32 s56, s32, 10
    s_add_u32 m0, s56, 0x2000
    s_nop 0
    buffer_load_dwordx4 v168, s[16:19], s55 offen lds
    s_add_u32 s55, s54, 0x60000
    s_lshl_b32 s56, s32, 10
    s_add_u32 m0, s56, 0x3000
    s_nop 0
    buffer_load_dwordx4 v168, s[16:19], s55 offen lds
    s_add_u32 s55, s54, 0x80000
    s_lshl_b32 s56, s32, 10
    s_add_u32 m0, s56, 0x4000
    s_nop 0
    buffer_load_dwordx4 v168, s[16:19], s55 offen lds
    s_add_u32 s55, s54, 0xa0000
    s_lshl_b32 s56, s32, 10
    s_add_u32 m0, s56, 0x5000
    s_nop 0
    buffer_load_dwordx4 v168, s[16:19], s55 offen lds
    s_add_u32 s55, s54, 0xc0000
    s_lshl_b32 s56, s32, 10
    s_add_u32 m0, s56, 0x6000
    s_nop 0
    buffer_load_dwordx4 v168, s[16:19], s55 offen lds
    s_add_u32 s55, s54, 0xe0000
    s_lshl_b32 s56, s32, 10
    s_add_u32 m0, s56, 0x7000
    s_nop 0
    buffer_load_dwordx4 v168, s[16:19], s55 offen lds
    s_add_u32 s55, s54, 0x100000
    s_lshl_b32 s56, s32, 10
    s_add_u32 m0, s56, 0x8000
    s_nop 0
    buffer_load_dwordx4 v168, s[16:19], s55 offen lds
    s_add_u32 s55, s54, 0x120000
    s_lshl_b32 s56, s32, 10
    s_add_u32 m0, s56, 0x9000
    s_nop 0
    buffer_load_dwordx4 v168, s[16:19], s55 offen lds
    s_add_u32 s55, s54, 0x140000
    s_lshl_b32 s56, s32, 10
    s_add_u32 m0, s56, 0xa000
    s_nop 0
    buffer_load_dwordx4 v168, s[16:19], s55 offen lds
    s_add_u32 s55, s54, 0x160000
    s_lshl_b32 s56, s32, 10
    s_add_u32 m0, s56, 0xb000
    s_nop 0
    buffer_load_dwordx4 v168, s[16:19], s55 offen lds
    s_add_u32 s55, s54, 0x180000
    s_lshl_b32 s56, s32, 10
    s_add_u32 m0, s56, 0xc000
    s_nop 0
    buffer_load_dwordx4 v168, s[16:19], s55 offen lds
    s_add_u32 s55, s54, 0x1a0000
    s_lshl_b32 s56, s32, 10
    s_add_u32 m0, s56, 0xd000
    s_nop 0
    buffer_load_dwordx4 v168, s[16:19], s55 offen lds
    s_add_u32 s55, s54, 0x1c0000
    s_lshl_b32 s56, s32, 10
    s_add_u32 m0, s56, 0xe000
    s_nop 0
    buffer_load_dwordx4 v168, s[16:19], s55 offen lds
    s_add_u32 s55, s54, 0x1e0000
    s_lshl_b32 s56, s32, 10
    s_add_u32 m0, s56, 0xf000
    s_nop 0
    buffer_load_dwordx4 v168, s[16:19], s55 offen lds
    s_add_u32 s55, s54, 0x200000
    s_lshl_b32 s56, s32, 10
    s_add_u32 m0, s56, 0x10000
    s_nop 0
    buffer_load_dwordx4 v168, s[16:19], s55 offen lds
    s_add_u32 s55, s54, 0x220000
    s_lshl_b32 s56, s32, 10
    s_add_u32 m0, s56, 0x11000
    s_nop 0
    buffer_load_dwordx4 v168, s[16:19], s55 offen lds
    s_add_u32 s55, s54, 0x240000
    s_lshl_b32 s56, s32, 10
    s_add_u32 m0, s56, 0x12000
    s_nop 0
    buffer_load_dwordx4 v168, s[16:19], s55 offen lds
    s_add_u32 s55, s54, 0x260000
    s_lshl_b32 s56, s32, 10
    s_add_u32 m0, s56, 0x13000
    s_nop 0
    buffer_load_dwordx4 v168, s[16:19], s55 offen lds
    s_waitcnt vmcnt(20)
    s_barrier
    v_add_u32 v172, 0x14000, v170
    v_add_u32 v173, 0x14000, v171
    ds_read_b64_tr_b16 a[40:41], v172 offset:0
    ds_read_b64_tr_b16 a[42:43], v172 offset:1024
    ds_read_b64_tr_b16 a[44:45], v172 offset:8192
    ds_read_b64_tr_b16 a[46:47], v172 offset:9216
    ds_read_b64_tr_b16 a[48:49], v172 offset:16384
    ds_read_b64_tr_b16 a[50:51], v172 offset:17408
    ds_read_b64_tr_b16 a[52:53], v172 offset:24576
    ds_read_b64_tr_b16 a[54:55], v172 offset:25600
    ds_read_b64_tr_b16 a[56:57], v172 offset:32768
    ds_read_b64_tr_b16 a[58:59], v172 offset:33792
    ds_read_b64_tr_b16 a[120:121], v173 offset:0
    ds_read_b64_tr_b16 a[122:123], v173 offset:1024
    ds_read_b64_tr_b16 a[124:125], v173 offset:8192
    ds_read_b64_tr_b16 a[126:127], v173 offset:9216
    ds_read_b64_tr_b16 a[128:129], v173 offset:16384
    ds_read_b64_tr_b16 a[130:131], v173 offset:17408
    ds_read_b64_tr_b16 a[132:133], v173 offset:24576
    ds_read_b64_tr_b16 a[134:135], v173 offset:25600
    ds_read_b64_tr_b16 a[136:137], v173 offset:32768
    ds_read_b64_tr_b16 a[138:139], v173 offset:33792
    s_waitcnt lgkmcnt(0)
    v_add_u32 v172, 0x1e000, v170
    v_add_u32 v173, 0x1e000, v171
    ds_read_b64_tr_b16 a[60:61], v172 offset:0
    ds_read_b64_tr_b16 a[62:63], v172 offset:1024
    ds_read_b64_tr_b16 a[64:65], v172 offset:8192
    ds_read_b64_tr_b16 a[66:67], v172 offset:9216
    ds_read_b64_tr_b16 a[68:69], v172 offset:16384
    ds_read_b64_tr_b16 a[70:71], v172 offset:17408
    ds_read_b64_tr_b16 a[72:73], v172 offset:24576
    ds_read_b64_tr_b16 a[74:75], v172 offset:25600
    ds_read_b64_tr_b16 a[76:77], v172 offset:32768
    ds_read_b64_tr_b16 a[78:79], v172 offset:33792
    ds_read_b64_tr_b16 a[140:141], v173 offset:0
    ds_read_b64_tr_b16 a[142:143], v173 offset:1024
    ds_read_b64_tr_b16 a[144:145], v173 offset:8192
    ds_read_b64_tr_b16 a[146:147], v173 offset:9216
    ds_read_b64_tr_b16 a[148:149], v173 offset:16384
    ds_read_b64_tr_b16 a[150:151], v173 offset:17408
    ds_read_b64_tr_b16 a[152:153], v173 offset:24576
    ds_read_b64_tr_b16 a[154:155], v173 offset:25600
    ds_read_b64_tr_b16 a[156:157], v173 offset:32768
    ds_read_b64_tr_b16 a[158:159], v173 offset:33792
    s_waitcnt lgkmcnt(0)
    s_barrier
    s_add_u32 s55, s54, 0x280000
    s_lshl_b32 s56, s32, 10
    s_add_u32 m0, s56, 0x14000
    s_nop 0
    buffer_load_dwordx4 v168, s[16:19], s55 offen lds
    s_add_u32 s55, s54, 0x2a0000
    s_lshl_b32 s56, s32, 10
    s_add_u32 m0, s56, 0x15000
    s_nop 0
    buffer_load_dwordx4 v168, s[16:19], s55 offen lds
    s_add_u32 s55, s54, 0x2c0000
    s_lshl_b32 s56, s32, 10
    s_add_u32 m0, s56, 0x16000
    s_nop 0
    buffer_load_dwordx4 v168, s[16:19], s55 offen lds
    s_add_u32 s55, s54, 0x2e0000
    s_lshl_b32 s56, s32, 10
    s_add_u32 m0, s56, 0x17000
    s_nop 0
    buffer_load_dwordx4 v168, s[16:19], s55 offen lds
    s_add_u32 s55, s54, 0x300000
    s_lshl_b32 s56, s32, 10
    s_add_u32 m0, s56, 0x18000
    s_nop 0
    buffer_load_dwordx4 v168, s[16:19], s55 offen lds
    s_add_u32 s55, s54, 0x320000
    s_lshl_b32 s56, s32, 10
    s_add_u32 m0, s56, 0x19000
    s_nop 0
    buffer_load_dwordx4 v168, s[16:19], s55 offen lds
    s_add_u32 s55, s54, 0x340000
    s_lshl_b32 s56, s32, 10
    s_add_u32 m0, s56, 0x1a000
    s_nop 0
    buffer_load_dwordx4 v168, s[16:19], s55 offen lds
    s_add_u32 s55, s54, 0x360000
    s_lshl_b32 s56, s32, 10
    s_add_u32 m0, s56, 0x1b000
    s_nop 0
    buffer_load_dwordx4 v168, s[16:19], s55 offen lds
    s_add_u32 s55, s54, 0x380000
    s_lshl_b32 s56, s32, 10
    s_add_u32 m0, s56, 0x1c000
    s_nop 0
    buffer_load_dwordx4 v168, s[16:19], s55 offen lds
    s_add_u32 s55, s54, 0x3a0000
    s_lshl_b32 s56, s32, 10
    s_add_u32 m0, s56, 0x1d000
    s_nop 0
    buffer_load_dwordx4 v168, s[16:19], s55 offen lds
    s_add_u32 s55, s54, 0x3c0000
    s_lshl_b32 s56, s32, 10
    s_add_u32 m0, s56, 0x1e000
    s_nop 0
    buffer_load_dwordx4 v168, s[16:19], s55 offen lds
    s_add_u32 s55, s54, 0x3e0000
    s_lshl_b32 s56, s32, 10
    s_add_u32 m0, s56, 0x1f000
    s_nop 0
    buffer_load_dwordx4 v168, s[16:19], s55 offen lds
    s_add_u32 s55, s54, 0x400000
    s_lshl_b32 s56, s32, 10
    s_add_u32 m0, s56, 0x20000
    s_nop 0
    buffer_load_dwordx4 v168, s[16:19], s55 offen lds
    s_add_u32 s55, s54, 0x420000
    s_lshl_b32 s56, s32, 10
    s_add_u32 m0, s56, 0x21000
    s_nop 0
    buffer_load_dwordx4 v168, s[16:19], s55 offen lds
    s_add_u32 s55, s54, 0x440000
    s_lshl_b32 s56, s32, 10
    s_add_u32 m0, s56, 0x22000
    s_nop 0
    buffer_load_dwordx4 v168, s[16:19], s55 offen lds
    s_add_u32 s55, s54, 0x460000
    s_lshl_b32 s56, s32, 10
    s_add_u32 m0, s56, 0x23000
    s_nop 0
    buffer_load_dwordx4 v168, s[16:19], s55 offen lds
    s_add_u32 s55, s54, 0x480000
    s_lshl_b32 s56, s32, 10
    s_add_u32 m0, s56, 0x24000
    s_nop 0
    buffer_load_dwordx4 v168, s[16:19], s55 offen lds
    s_add_u32 s55, s54, 0x4a0000
    s_lshl_b32 s56, s32, 10
    s_add_u32 m0, s56, 0x25000
    s_nop 0
    buffer_load_dwordx4 v168, s[16:19], s55 offen lds
    s_add_u32 s55, s54, 0x4c0000
    s_lshl_b32 s56, s32, 10
    s_add_u32 m0, s56, 0x26000
    s_nop 0
    buffer_load_dwordx4 v168, s[16:19], s55 offen lds
    s_add_u32 s55, s54, 0x4e0000
    s_lshl_b32 s56, s32, 10
    s_add_u32 m0, s56, 0x27000
    s_nop 0
    buffer_load_dwordx4 v168, s[16:19], s55 offen lds
    s_waitcnt vmcnt(20)
    s_barrier
    v_add_u32 v172, 0x0, v170
    v_add_u32 v173, 0x0, v171
    ds_read_b64_tr_b16 a[160:161], v172 offset:0
    ds_read_b64_tr_b16 a[162:163], v172 offset:1024
    ds_read_b64_tr_b16 a[164:165], v172 offset:8192
    ds_read_b64_tr_b16 a[166:167], v172 offset:9216
    ds_read_b64_tr_b16 a[168:169], v172 offset:16384
    ds_read_b64_tr_b16 a[170:171], v172 offset:17408
    ds_read_b64_tr_b16 a[172:173], v172 offset:24576
    ds_read_b64_tr_b16 a[174:175], v172 offset:25600
    ds_read_b64_tr_b16 a[176:177], v172 offset:32768
    ds_read_b64_tr_b16 a[178:179], v172 offset:33792
    ds_read_b64_tr_b16 a[240:241], v173 offset:0
    ds_read_b64_tr_b16 a[242:243], v173 offset:1024
    ds_read_b64_tr_b16 a[244:245], v173 offset:8192
    ds_read_b64_tr_b16 a[246:247], v173 offset:9216
    ds_read_b64_tr_b16 a[248:249], v173 offset:16384
    ds_read_b64_tr_b16 a[250:251], v173 offset:17408
    ds_read_b64_tr_b16 a[252:253], v173 offset:24576
    ds_read_b64_tr_b16 a[254:255], v173 offset:25600
    ds_read_b64_tr_b16 v[192:193], v173 offset:32768
    ds_read_b64_tr_b16 v[194:195], v173 offset:33792
    s_waitcnt lgkmcnt(0)
    v_add_u32 v172, 0xa000, v170
    v_add_u32 v173, 0xa000, v171
    ds_read_b64_tr_b16 a[180:181], v172 offset:0
    ds_read_b64_tr_b16 a[182:183], v172 offset:1024
    ds_read_b64_tr_b16 a[184:185], v172 offset:8192
    ds_read_b64_tr_b16 a[186:187], v172 offset:9216
    ds_read_b64_tr_b16 a[188:189], v172 offset:16384
    ds_read_b64_tr_b16 a[190:191], v172 offset:17408
    ds_read_b64_tr_b16 a[192:193], v172 offset:24576
    ds_read_b64_tr_b16 a[194:195], v172 offset:25600
    ds_read_b64_tr_b16 a[196:197], v172 offset:32768
    ds_read_b64_tr_b16 a[198:199], v172 offset:33792
    ds_read_b64_tr_b16 v[196:197], v173 offset:0
    ds_read_b64_tr_b16 v[198:199], v173 offset:1024
    ds_read_b64_tr_b16 v[200:201], v173 offset:8192
    ds_read_b64_tr_b16 v[202:203], v173 offset:9216
    ds_read_b64_tr_b16 v[204:205], v173 offset:16384
    ds_read_b64_tr_b16 v[206:207], v173 offset:17408
    ds_read_b64_tr_b16 v[208:209], v173 offset:24576
    ds_read_b64_tr_b16 v[210:211], v173 offset:25600
    ds_read_b64_tr_b16 v[212:213], v173 offset:32768
    ds_read_b64_tr_b16 v[214:215], v173 offset:33792
    s_waitcnt lgkmcnt(0)
    s_barrier
    s_waitcnt vmcnt(0)
    s_barrier
    v_add_u32 v172, 0x14000, v170
    v_add_u32 v173, 0x14000, v171
    ds_read_b64_tr_b16 a[200:201], v172 offset:0
    ds_read_b64_tr_b16 a[202:203], v172 offset:1024
    ds_read_b64_tr_b16 a[204:205], v172 offset:8192
    ds_read_b64_tr_b16 a[206:207], v172 offset:9216
    ds_read_b64_tr_b16 a[208:209], v172 offset:16384
    ds_read_b64_tr_b16 a[210:211], v172 offset:17408
    ds_read_b64_tr_b16 a[212:213], v172 offset:24576
    ds_read_b64_tr_b16 a[214:215], v172 offset:25600
    ds_read_b64_tr_b16 a[216:217], v172 offset:32768
    ds_read_b64_tr_b16 a[218:219], v172 offset:33792
    ds_read_b64_tr_b16 v[216:217], v173 offset:0
    ds_read_b64_tr_b16 v[218:219], v173 offset:1024
    ds_read_b64_tr_b16 v[220:221], v173 offset:8192
    ds_read_b64_tr_b16 v[222:223], v173 offset:9216
    ds_read_b64_tr_b16 v[224:225], v173 offset:16384
    ds_read_b64_tr_b16 v[226:227], v173 offset:17408
    ds_read_b64_tr_b16 v[228:229], v173 offset:24576
    ds_read_b64_tr_b16 v[230:231], v173 offset:25600
    ds_read_b64_tr_b16 v[232:233], v173 offset:32768
    ds_read_b64_tr_b16 v[234:235], v173 offset:33792
    s_waitcnt lgkmcnt(0)
    v_add_u32 v172, 0x1e000, v170
    v_add_u32 v173, 0x1e000, v171
    ds_read_b64_tr_b16 a[220:221], v172 offset:0
    ds_read_b64_tr_b16 a[222:223], v172 offset:1024
    ds_read_b64_tr_b16 a[224:225], v172 offset:8192
    ds_read_b64_tr_b16 a[226:227], v172 offset:9216
    ds_read_b64_tr_b16 a[228:229], v172 offset:16384
    ds_read_b64_tr_b16 a[230:231], v172 offset:17408
    ds_read_b64_tr_b16 a[232:233], v172 offset:24576
    ds_read_b64_tr_b16 a[234:235], v172 offset:25600
    ds_read_b64_tr_b16 a[236:237], v172 offset:32768
    ds_read_b64_tr_b16 a[238:239], v172 offset:33792
    ds_read_b64_tr_b16 v[236:237], v173 offset:0
    ds_read_b64_tr_b16 v[238:239], v173 offset:1024
    ds_read_b64_tr_b16 v[240:241], v173 offset:8192
    ds_read_b64_tr_b16 v[242:243], v173 offset:9216
    ds_read_b64_tr_b16 v[244:245], v173 offset:16384
    ds_read_b64_tr_b16 v[246:247], v173 offset:17408
    ds_read_b64_tr_b16 v[248:249], v173 offset:24576
    ds_read_b64_tr_b16 v[250:251], v173 offset:25600
    ds_read_b64_tr_b16 v[252:253], v173 offset:32768
    ds_read_b64_tr_b16 v[254:255], v173 offset:33792
    s_waitcnt lgkmcnt(0)
    s_barrier
    s_cmp_eq_u32 s32, 0
    s_cbranch_scc0 HAssb2_33
    v_mov_b32 v169, 36
    s_mov_b32 s58, 0x100000
HAssbl_34:
    buffer_load_dword v170, v169, s[20:23], 0 offen sc1
    s_waitcnt vmcnt(0)
    v_cmp_gt_u32 vcc, 64, v170
    s_cbranch_vccz HAssbd_35
    s_sub_u32 s58, s58, 1
    s_cbranch_scc0 HAssbl_34
HAssbd_35:
HAssb2_33:
    s_mov_b32 s58, 0x400000
    s_mov_b32 s33, 0x0
    s_lshl_b32 s54, s28, 4
    v_and_b32 v31, 1, v3
    v_add_u32 v30, s54, v2
    v_mov_b32 v168, s30
    v_cmp_gt_u32 vcc, 2, v3
    s_nop 1
    v_cndmask_b32 v30, v168, v30, vcc
    v_mov_b32 v168, 0
    v_mov_b32 v169, 64
    v_cndmask_b32 v168, v168, v169, vcc
    v_add_u32 v30, v30, v168
    v_lshl_add_u32 v30, v31, 5, v30
    v_lshlrev_b32 v30, 2, v30
    v_add_u32 v30, 0xa600000, v30
    s_mov_b32 s74, 0x0
    s_lshl_b32 s75, s30, 2
    s_add_u32 s75, s75, 0xa600200
    s_mov_b32 s55, 0x34
    s_cmp_eq_u32 s32, 0
    s_cbranch_scc0 CZww_36
    s_mov_b32 s54, 0x1
    v_min_u32 v168, 0, v1
    v_mul_u32_u24 v168, 4, v168
    s_mov_b32 s43, 0x40000
CZwl_37:
    buffer_load_dword v169, v168, s[20:23], s55 offen sc1
    s_waitcnt vmcnt(0)
    v_cmp_gt_u32 vcc, 128, v169
    s_nop 1
    v_cndmask_b32 v169, 0, v169, vcc
    v_cmp_gt_u32 vcc, s54, v169
    s_cbranch_vccz CZwd_38
    s_sleep 1
    s_sub_u32 s43, s43, 1
    s_cbranch_scc0 CZwl_37
CZwd_38:
CZww_36:
    s_barrier
    s_mov_b32 s33, 0x0
    s_cmp_lt_u32 s33, s74
    s_cbranch_scc1 rdy_39
rdl_40:
    s_and_b32 s54, s33, 1
    buffer_load_dword v188, v30, s[8:11], 0 offen sc1
    s_waitcnt vmcnt(0)
    v_cmp_lt_u32 vcc, 127, v188
    s_nop 1
    v_cmp_gt_u32 vcc, 128, v188
    s_nop 1
    v_cndmask_b32 v188, 0, v188, vcc
    v_max_u32 v188, v188, v31
    s_nop 1
    v_min_u32_dpp v188, v188, v188 row_ror:1 row_mask:0xf bank_mask:0xf
    s_nop 1
    v_min_u32_dpp v188, v188, v188 row_ror:2 row_mask:0xf bank_mask:0xf
    s_nop 1
    v_min_u32_dpp v188, v188, v188 row_ror:4 row_mask:0xf bank_mask:0xf
    s_nop 1
    v_min_u32_dpp v188, v188, v188 row_ror:8 row_mask:0xf bank_mask:0xf
    s_nop 1
    v_readlane_b32 s54, v188, 0
    v_readlane_b32 s55, v188, 16
    v_readlane_b32 s56, v188, 32
    v_readlane_b32 s74, v188, 48
    s_nop 3
    s_min_u32 s54, s54, s55
    s_min_u32 s56, s56, s74
    s_min_u32 s74, s54, s56
    s_cmp_lt_u32 s33, s74
    s_cbranch_scc1 rdy_39
    s_sleep 1
    s_sub_u32 s58, s58, 1
    s_cbranch_scc0 rdl_40
    s_mov_b32 s58, 0
    s_mov_b32 s74, 0x40
rdy_39:
    v_and_b32 v168, 7, v2
    v_mul_u32_u24 v168, 1280, v168
    v_lshl_add_u32 v168, v3, 4, v168
    v_lshrrev_b32 v169, 3, v2
    v_lshl_add_u32 v168, v169, 6, v168
    s_and_b32 s56, s32, 1
    s_mul_i32 s56, s56, 640
    s_lshr_b32 s55, s32, 1
    s_lshl_b32 s55, s55, 28
    s_add_u32 s56, s56, s55
    v_add_u32 v168, s56, v168
    buffer_load_dwordx4 v[32:35], v168, s[24:27], 0 offen offset:0
    buffer_load_dwordx4 v[36:39], v168, s[24:27], 0 offen offset:128
    buffer_load_dwordx4 v[40:43], v168, s[24:27], 0 offen offset:256
    buffer_load_dwordx4 v[44:47], v168, s[24:27], 0 offen offset:384
    buffer_load_dwordx4 v[48:51], v168, s[24:27], 0 offen offset:512
    s_mov_b32 s39, 0x0
    s_mov_b32 s40, 0x2000000
    buffer_load_dwordx4 v[152:155], v12, s[8:11], s39 offen offset:0 sc1
    buffer_load_dwordx4 v[156:159], v12, s[8:11], s39 offen offset:1024 sc1
    s_mov_b32 s73, 0x9080000
    v_mov_b32 v184, 0
    v_mov_b32 v185, 0
    v_mov_b32 v186, 0
    v_mov_b32 v187, 0
    s_waitcnt vmcnt(0)
    ds_write_b128 v5, v[32:35] offset:0
    ds_write_b128 v5, v[36:39] offset:2048
    ds_write_b128 v5, v[40:43] offset:4096
    ds_write_b128 v5, v[44:47] offset:6144
    ds_write_b128 v5, v[48:51] offset:8192
    s_mov_b32 s34, 0x8c00000
    s_mov_b32 s35, 0x8c5f000
    s_mov_b32 s36, 0x8cbe000
    s_mov_b32 s37, 0x8d1d000
    s_waitcnt lgkmcnt(0)
    s_barrier
    s_mul_i32 s56, s31, 10240
    s_mul_i32 s55, s28, 174080
    s_add_u32 s56, s56, s55
    s_add_u32 s56, s56, 10240
    s_and_b32 s55, s32, 1
    s_mul_i32 s55, s55, 5120
    s_add_u32 s56, s56, s55
    v_add_u32 v9, s56, v6
    s_mul_i32 s56, s28, 10240
    s_mul_i32 s55, s31, 640
    s_add_u32 s56, s56, s55
    s_add_u32 s56, s56, 348160
    s_and_b32 s55, s32, 1
    s_mul_i32 s55, s55, 20480
    s_add_u32 s56, s56, s55
    v_add_u32 v10, s56, v6
    v_cmp_gt_u32 s[50:51], 40, v1
    s_mul_i32 s59, s28, -10240
    s_sub_u32 s59, s59, 10240
HAs_loop:
    ds_read_b128 v[32:35], v6 offset:0
    ds_read_b128 v[36:39], v6 offset:1024
    ds_read_b128 v[40:43], v6 offset:2048
    ds_read_b128 v[44:47], v6 offset:3072
    ds_read_b128 v[48:51], v6 offset:4096
    ds_read_b128 v[52:55], v6 offset:5120
    ds_read_b128 v[56:59], v6 offset:6144
    s_waitcnt lgkmcnt(6)
    v_mfma_f32_16x16x32_bf16 v[112:115], a[0:3], v[32:35], 0
    v_mfma_f32_16x16x32_bf16 v[116:119], a[80:83], v[32:35], 0
    ds_read_b128 v[60:63], v6 offset:7168
    s_waitcnt lgkmcnt(6)
    v_mfma_f32_16x16x32_bf16 v[112:115], a[4:7], v[36:39], v[112:115]
    v_mfma_f32_16x16x32_bf16 v[116:119], a[84:87], v[36:39], v[116:119]
    ds_read_b128 v[64:67], v6 offset:8192
    s_waitcnt lgkmcnt(6)
    v_mfma_f32_16x16x32_bf16 v[112:115], a[8:11], v[40:43], v[112:115]
    v_mfma_f32_16x16x32_bf16 v[116:119], a[88:91], v[40:43], v[116:119]
    ds_read_b128 v[68:71], v6 offset:9216
    s_waitcnt lgkmcnt(6)
    v_mfma_f32_16x16x32_bf16 v[112:115], a[12:15], v[44:47], v[112:115]
    v_mfma_f32_16x16x32_bf16 v[116:119], a[92:95], v[44:47], v[116:119]
    ds_read_b128 v[72:75], v6 offset:10240
    s_waitcnt lgkmcnt(6)
    v_mfma_f32_16x16x32_bf16 v[112:115], a[16:19], v[48:51], v[112:115]
    v_mfma_f32_16x16x32_bf16 v[116:119], a[96:99], v[48:51], v[116:119]
    ds_read_b128 v[76:79], v6 offset:11264
    s_waitcnt lgkmcnt(6)
    v_mfma_f32_16x16x32_bf16 v[112:115], a[20:23], v[52:55], v[112:115]
    v_mfma_f32_16x16x32_bf16 v[116:119], a[100:103], v[52:55], v[116:119]
    ds_read_b128 v[80:83], v6 offset:12288
    s_waitcnt lgkmcnt(6)
    v_mfma_f32_16x16x32_bf16 v[112:115], a[24:27], v[56:59], v[112:115]
    v_mfma_f32_16x16x32_bf16 v[116:119], a[104:107], v[56:59], v[116:119]
    ds_read_b128 v[84:87], v6 offset:13312
    s_waitcnt lgkmcnt(6)
    v_mfma_f32_16x16x32_bf16 v[112:115], a[28:31], v[60:63], v[112:115]
    v_mfma_f32_16x16x32_bf16 v[116:119], a[108:111], v[60:63], v[116:119]
    ds_read_b128 v[88:91], v6 offset:14336
    s_waitcnt lgkmcnt(6)
    v_mfma_f32_16x16x32_bf16 v[112:115], a[32:35], v[64:67], v[112:115]
    v_mfma_f32_16x16x32_bf16 v[116:119], a[112:115], v[64:67], v[116:119]
    ds_read_b128 v[92:95], v6 offset:15360
    s_waitcnt lgkmcnt(6)
    v_mfma_f32_16x16x32_bf16 v[112:115], a[36:39], v[68:71], v[112:115]
    v_mfma_f32_16x16x32_bf16 v[116:119], a[116:119], v[68:71], v[116:119]
    ds_read_b128 v[96:99], v6 offset:16384
    s_waitcnt lgkmcnt(6)
    v_mfma_f32_16x16x32_bf16 v[112:115], a[40:43], v[72:75], v[112:115]
    v_mfma_f32_16x16x32_bf16 v[116:119], a[120:123], v[72:75], v[116:119]
    ds_read_b128 v[100:103], v6 offset:17408
    s_waitcnt lgkmcnt(6)
    v_mfma_f32_16x16x32_bf16 v[112:115], a[44:47], v[76:79], v[112:115]
    v_mfma_f32_16x16x32_bf16 v[116:119], a[124:127], v[76:79], v[116:119]
    ds_read_b128 v[104:107], v6 offset:18432
    s_waitcnt lgkmcnt(6)
    v_mfma_f32_16x16x32_bf16 v[112:115], a[48:51], v[80:83], v[112:115]
    v_mfma_f32_16x16x32_bf16 v[116:119], a[128:131], v[80:83], v[116:119]
    ds_read_b128 v[108:111], v6 offset:19456
    s_waitcnt lgkmcnt(6)
    v_mfma_f32_16x16x32_bf16 v[112:115], a[52:55], v[84:87], v[112:115]
    v_mfma_f32_16x16x32_bf16 v[116:119], a[132:135], v[84:87], v[116:119]
    s_waitcnt lgkmcnt(5)
    v_mfma_f32_16x16x32_bf16 v[112:115], a[56:59], v[88:91], v[112:115]
    v_mfma_f32_16x16x32_bf16 v[116:119], a[136:139], v[88:91], v[116:119]
    s_waitcnt lgkmcnt(4)
    v_mfma_f32_16x16x32_bf16 v[112:115], a[60:63], v[92:95], v[112:115]
    v_mfma_f32_16x16x32_bf16 v[116:119], a[140:143], v[92:95], v[116:119]
    s_waitcnt lgkmcnt(3)
    v_mfma_f32_16x16x32_bf16 v[112:115], a[64:67], v[96:99], v[112:115]
    v_mfma_f32_16x16x32_bf16 v[116:119], a[144:147], v[96:99], v[116:119]
    s_waitcnt lgkmcnt(2)
    v_mfma_f32_16x16x32_bf16 v[112:115], a[68:71], v[100:103], v[112:115]
    v_mfma_f32_16x16x32_bf16 v[116:119], a[148:151], v[100:103], v[116:119]
    s_waitcnt lgkmcnt(1)
    v_mfma_f32_16x16x32_bf16 v[112:115], a[72:75], v[104:107], v[112:115]
    v_mfma_f32_16x16x32_bf16 v[116:119], a[152:155], v[104:107], v[116:119]
    s_waitcnt lgkmcnt(0)
    v_mfma_f32_16x16x32_bf16 v[112:115], a[76:79], v[108:111], v[112:115]
    v_mfma_f32_16x16x32_bf16 v[116:119], a[156:159], v[108:111], v[116:119]
    v_mfma_f32_16x16x32_bf16 v[120:123], a[160:163], v[32:35], 0
    v_mfma_f32_16x16x32_bf16 v[124:127], a[240:243], v[32:35], 0
    v_mfma_f32_16x16x32_bf16 v[120:123], a[164:167], v[36:39], v[120:123]
    v_mfma_f32_16x16x32_bf16 v[124:127], a[244:247], v[36:39], v[124:127]
    v_mfma_f32_16x16x32_bf16 v[120:123], a[168:171], v[40:43], v[120:123]
    v_mfma_f32_16x16x32_bf16 v[124:127], a[248:251], v[40:43], v[124:127]
    v_mfma_f32_16x16x32_bf16 v[120:123], a[172:175], v[44:47], v[120:123]
    v_mfma_f32_16x16x32_bf16 v[124:127], a[252:255], v[44:47], v[124:127]
    v_mfma_f32_16x16x32_bf16 v[120:123], a[176:179], v[48:51], v[120:123]
    v_add_f32_dpp v112, v112, v112 row_ror:8 row_mask:0xf bank_mask:0xf
    v_mfma_f32_16x16x32_bf16 v[124:127], v[192:195], v[48:51], v[124:127]
    v_add_f32_dpp v113, v113, v113 row_ror:8 row_mask:0xf bank_mask:0xf
    v_mfma_f32_16x16x32_bf16 v[120:123], a[180:183], v[52:55], v[120:123]
    v_add_f32_dpp v114, v114, v114 row_ror:8 row_mask:0xf bank_mask:0xf
    v_mfma_f32_16x16x32_bf16 v[124:127], v[196:199], v[52:55], v[124:127]
    v_add_f32_dpp v115, v115, v115 row_ror:8 row_mask:0xf bank_mask:0xf
    v_mfma_f32_16x16x32_bf16 v[120:123], a[184:187], v[56:59], v[120:123]
    v_add_f32_dpp v116, v116, v116 row_ror:8 row_mask:0xf bank_mask:0xf
    v_mfma_f32_16x16x32_bf16 v[124:127], v[200:203], v[56:59], v[124:127]
    v_add_f32_dpp v117, v117, v117 row_ror:8 row_mask:0xf bank_mask:0xf
    v_mfma_f32_16x16x32_bf16 v[120:123], a[188:191], v[60:63], v[120:123]
    v_add_f32_dpp v118, v118, v118 row_ror:8 row_mask:0xf bank_mask:0xf
    v_mfma_f32_16x16x32_bf16 v[124:127], v[204:207], v[60:63], v[124:127]
    v_add_f32_dpp v119, v119, v119 row_ror:8 row_mask:0xf bank_mask:0xf
    v_mfma_f32_16x16x32_bf16 v[120:123], a[192:195], v[64:67], v[120:123]
    v_cvt_pk_bf16_f32 v168, v112, v113
    v_mfma_f32_16x16x32_bf16 v[124:127], v[208:211], v[64:67], v[124:127]
    v_cvt_pk_bf16_f32 v169, v114, v115
    v_mfma_f32_16x16x32_bf16 v[120:123], a[196:199], v[68:71], v[120:123]
    v_cvt_pk_bf16_f32 v170, v116, v117
    v_mfma_f32_16x16x32_bf16 v[124:127], v[212:215], v[68:71], v[124:127]
    v_cvt_pk_bf16_f32 v171, v118, v119
    v_mfma_f32_16x16x32_bf16 v[120:123], a[200:203], v[72:75], v[120:123]
    v_mfma_f32_16x16x32_bf16 v[124:127], v[216:219], v[72:75], v[124:127]
    v_mfma_f32_16x16x32_bf16 v[112:115], v[152:155], v[168:171], 0
    v_mfma_f32_16x16x32_bf16 v[120:123], a[204:207], v[76:79], v[120:123]
    v_mfma_f32_16x16x32_bf16 v[116:119], v[156:159], v[168:171], 0
    v_mfma_f32_16x16x32_bf16 v[124:127], v[220:223], v[76:79], v[124:127]
    v_mfma_f32_16x16x32_bf16 v[120:123], a[208:211], v[80:83], v[120:123]
    v_mfma_f32_16x16x32_bf16 v[124:127], v[224:227], v[80:83], v[124:127]
    v_mfma_f32_16x16x32_bf16 v[120:123], a[212:215], v[84:87], v[120:123]
    v_mfma_f32_16x16x32_bf16 v[124:127], v[228:231], v[84:87], v[124:127]
    v_mfma_f32_16x16x32_bf16 v[120:123], a[216:219], v[88:91], v[120:123]
    v_mfma_f32_16x16x32_bf16 v[124:127], v[232:235], v[88:91], v[124:127]
    v_mfma_f32_16x16x32_bf16 v[120:123], a[220:223], v[92:95], v[120:123]
    v_mfma_f32_16x16x32_bf16 v[124:127], v[236:239], v[92:95], v[124:127]
    ds_write_b128 v15, v[112:115] offset:1152
    v_mfma_f32_16x16x32_bf16 v[120:123], a[224:227], v[96:99], v[120:123]
    ds_write_b128 v15, v[116:119] offset:2304
    v_mfma_f32_16x16x32_bf16 v[124:127], v[240:243], v[96:99], v[124:127]
    v_mfma_f32_16x16x32_bf16 v[120:123], a[228:231], v[100:103], v[120:123]
    v_mfma_f32_16x16x32_bf16 v[124:127], v[244:247], v[100:103], v[124:127]
    v_mfma_f32_16x16x32_bf16 v[120:123], a[232:235], v[104:107], v[120:123]
    v_mfma_f32_16x16x32_bf16 v[124:127], v[248:251], v[104:107], v[124:127]
    v_mfma_f32_16x16x32_bf16 v[120:123], a[236:239], v[108:111], v[120:123]
    v_mfma_f32_16x16x32_bf16 v[124:127], v[252:255], v[108:111], v[124:127]
    s_nop 7
    v_add_f32_dpp v120, v120, v120 row_ror:8 row_mask:0xf bank_mask:0xf
    v_add_f32_dpp v121, v121, v121 row_ror:8 row_mask:0xf bank_mask:0xf
    v_add_f32_dpp v122, v122, v122 row_ror:8 row_mask:0xf bank_mask:0xf
    v_add_f32_dpp v123, v123, v123 row_ror:8 row_mask:0xf bank_mask:0xf
    v_add_f32_dpp v124, v124, v124 row_ror:8 row_mask:0xf bank_mask:0xf
    v_add_f32_dpp v125, v125, v125 row_ror:8 row_mask:0xf bank_mask:0xf
    v_add_f32_dpp v126, v126, v126 row_ror:8 row_mask:0xf bank_mask:0xf
    v_add_f32_dpp v127, v127, v127 row_ror:8 row_mask:0xf bank_mask:0xf
    v_cvt_pk_bf16_f32 v184, v120, v121
    v_cvt_pk_bf16_f32 v185, v122, v123
    v_cvt_pk_bf16_f32 v186, v124, v125
    v_cvt_pk_bf16_f32 v187, v126, v127
    s_nop 1
    v_mfma_f32_16x16x32_bf16 v[172:175], v[184:187], v[168:171], 0
    s_nop 7
    ds_write_b128 v15, v[172:175]
    s_waitcnt lgkmcnt(0)
    s_barrier
    ds_read_b128 v[32:35], v16 offset:0
    ds_read_b128 v[36:39], v16 offset:3456
    ds_read_b128 v[40:43], v16 offset:6912
    ds_read_b128 v[44:47], v16 offset:10368
    s_waitcnt lgkmcnt(2)
    v_pk_add_f32 v[48:49], v[32:33], v[36:37]
    v_pk_add_f32 v[50:51], v[34:35], v[38:39]
    s_waitcnt lgkmcnt(0)
    v_pk_add_f32 v[52:53], v[40:41], v[44:45]
    v_pk_add_f32 v[54:55], v[42:43], v[46:47]
    v_pk_add_f32 v[48:49], v[48:49], v[52:53]
    v_pk_add_f32 v[50:51], v[50:51], v[54:55]
    v_cndmask_b32 v48, v27, v48, s[46:47]
    v_cndmask_b32 v49, v27, v49, s[46:47]
    v_cndmask_b32 v50, v27, v50, s[46:47]
    v_cndmask_b32 v51, v27, v51, s[46:47]
    v_max3_f32 v52, v48, v49, v50
    v_max_f32 v52, v52, v51
    s_nop 1
    v_max_f32_dpp v52, v52, v52 row_ror:8 row_mask:0xf bank_mask:0xf
    s_nop 1
    v_max_f32_dpp v52, v52, v52 row_ror:4 row_mask:0xf bank_mask:0xf
    s_nop 1
    v_max_f32_dpp v52, v52, v52 row_ror:2 row_mask:0xf bank_mask:0xf
    s_nop 1
    v_max_f32_dpp v52, v52, v52 row_ror:1 row_mask:0xf bank_mask:0xf
    v_mul_f32 v52, s57, v52
    v_fma_f32 v48, v48, s57, -v52
    v_fma_f32 v49, v49, s57, -v52
    v_fma_f32 v50, v50, s57, -v52
    v_fma_f32 v51, v51, s57, -v52
    v_exp_f32 v48, v48
    v_exp_f32 v49, v49
    v_exp_f32 v50, v50
    v_exp_f32 v51, v51
    s_nop 0
    v_add_f32 v53, v48, v49
    v_add_f32 v54, v50, v51
    v_add_f32 v53, v53, v54
    s_nop 1
    v_add_f32_dpp v53, v53, v53 row_ror:8 row_mask:0xf bank_mask:0xf
    s_nop 1
    v_add_f32_dpp v53, v53, v53 row_ror:4 row_mask:0xf bank_mask:0xf
    s_nop 1
    v_add_f32_dpp v53, v53, v53 row_ror:2 row_mask:0xf bank_mask:0xf
    s_nop 1
    v_add_f32_dpp v53, v53, v53 row_ror:1 row_mask:0xf bank_mask:0xf
    v_rcp_f32 v53, v53
    s_nop 0
    v_mul_f32 v48, v48, v53
    v_mul_f32 v49, v49, v53
    v_mul_f32 v50, v50, v53
    v_mul_f32 v51, v51, v53
    v_cvt_pk_bf16_f32 v54, v48, v49
    v_cvt_pk_bf16_f32 v55, v50, v51
    s_mov_b64 exec, s[48:49]
    buffer_store_dwordx2 v[54:55], v17, s[8:11], s34 offen sc1
    s_mov_b64 exec, -1
    s_cmp_eq_u32 s33, 63
    s_cbranch_scc1 HAs_last
    s_lshl_b32 s73, s33, 17
    s_add_u32 s73, s73, 0x8400000
    s_mul_i32 s72, s33, 327680
    s_add_u32 s72, s72, 0x7000000
    s_add_u32 s72, s72, s59
    s_add_u32 s39, s39, 262144
    s_add_u32 s40, s40, 1310720
    s_add_u32 s33, s33, 1
    s_cmp_eq_u32 s32, 2
    s_cbranch_scc0 cp_41
    s_sub_u32 s54, s33, 1
    v_mov_b32 v189, s54
    v_mov_b32 v190, 0
    s_mov_b64 exec, 1
    buffer_store_dword v189, v190, s[8:11], s75 offen sc1
    s_mov_b64 exec, -1
cp_41:
    s_cmp_lt_u32 s33, s74
    s_cbranch_scc1 rdy_42
rdl_43:
    s_and_b32 s54, s33, 1
    buffer_load_dword v188, v30, s[8:11], 0 offen sc1
    s_waitcnt vmcnt(0)
    v_cmp_lt_u32 vcc, 127, v188
    s_nop 1
    v_cmp_gt_u32 vcc, 128, v188
    s_nop 1
    v_cndmask_b32 v188, 0, v188, vcc
    v_max_u32 v188, v188, v31
    s_nop 1
    v_min_u32_dpp v188, v188, v188 row_ror:1 row_mask:0xf bank_mask:0xf
    s_nop 1
    v_min_u32_dpp v188, v188, v188 row_ror:2 row_mask:0xf bank_mask:0xf
    s_nop 1
    v_min_u32_dpp v188, v188, v188 row_ror:4 row_mask:0xf bank_mask:0xf
    s_nop 1
    v_min_u32_dpp v188, v188, v188 row_ror:8 row_mask:0xf bank_mask:0xf
    s_nop 1
    v_readlane_b32 s54, v188, 0
    v_readlane_b32 s55, v188, 16
    v_readlane_b32 s56, v188, 32
    v_readlane_b32 s74, v188, 48
    s_nop 3
    s_min_u32 s54, s54, s55
    s_min_u32 s56, s56, s74
    s_min_u32 s74, s54, s56
    s_cmp_lt_u32 s33, s74
    s_cbranch_scc1 rdy_42
    s_sleep 1
    s_sub_u32 s58, s58, 1
    s_cbranch_scc0 rdl_43
    s_mov_b32 s58, 0
    s_mov_b32 s74, 0x40
rdy_42:
    buffer_load_dwordx4 v[152:155], v12, s[8:11], s39 offen offset:0 sc1
    buffer_load_dwordx4 v[156:159], v12, s[8:11], s39 offen offset:1024 sc1
    buffer_store_dwordx4 v[184:187], v28, s[8:11], s73 offen sc1
    s_mov_b64 exec, s[48:49]
    buffer_store_dwordx2 v[22:23], v17, s[8:11], s37 offen sc1
    s_mov_b64 exec, -1
    s_cmp_lt_u32 s32, 2
    s_cbranch_scc1 HAsrem_44
HAssp_46:
    s_add_u32 s55, s35, 4096
    buffer_load_dwordx4 v[52:55], v4, s[8:11], s35 offen offset:0 sc1
    buffer_load_dwordx4 v[56:59], v4, s[8:11], s35 offen offset:1024 sc1
    buffer_load_dwordx4 v[60:63], v4, s[8:11], s35 offen offset:2048 sc1
    buffer_load_dwordx4 v[64:67], v4, s[8:11], s35 offen offset:3072 sc1
    buffer_load_dwordx4 v[68:71], v4, s[8:11], s55 offen sc1
    s_waitcnt vmcnt(0)
    v_max3_u32 v188, v52, v53, v54
    v_max3_u32 v188, v188, v55, v56
    v_max3_u32 v188, v188, v57, v58
    v_max3_u32 v188, v188, v59, v60
    v_max3_u32 v188, v188, v61, v62
    v_max3_u32 v188, v188, v63, v64
    v_max3_u32 v188, v188, v65, v66
    v_max3_u32 v188, v188, v67, v68
    v_max3_u32 v188, v188, v69, v70
    v_max_u32 v188, v188, v71
    v_cmp_eq_u32 vcc, -1, v188
    s_cbranch_vccz HAssd_47
    s_sub_u32 s58, s58, 1
    s_cbranch_scc0 HAssp_46
    s_mov_b32 s58, 0
HAssd_47:
    s_branch HAsjn_45
HAsrem_44:
    s_add_u32 s55, s37, 4096
    buffer_store_dwordx4 v[22:25], v9, s[8:11], s37 offen offset:0 sc1
    buffer_store_dwordx4 v[22:25], v9, s[8:11], s37 offen offset:1024 sc1
    buffer_store_dwordx4 v[22:25], v9, s[8:11], s37 offen offset:2048 sc1
    buffer_store_dwordx4 v[22:25], v9, s[8:11], s37 offen offset:3072 sc1
    buffer_store_dwordx4 v[22:25], v9, s[8:11], s55 offen sc1
    s_mov_b64 exec, s[50:51]
    s_cmp_eq_u32 s32, 1
    s_cbranch_scc1 HAshw1_48
    buffer_store_dwordx4 v[22:25], v10, s[8:11], s37 offen sc1
    s_branch HAshwj_49
HAshw1_48:
    buffer_store_dwordx4 v[22:25], v10, s[8:11], s37 offen sc1
HAshwj_49:
    s_mov_b64 exec, -1
HAssp_50:
    s_add_u32 s55, s34, 4096
    buffer_load_dwordx4 v[72:75], v9, s[8:11], s34 offen offset:0 sc1
    buffer_load_dwordx4 v[76:79], v9, s[8:11], s34 offen offset:1024 sc1
    buffer_load_dwordx4 v[80:83], v9, s[8:11], s34 offen offset:2048 sc1
    buffer_load_dwordx4 v[84:87], v9, s[8:11], s34 offen offset:3072 sc1
    buffer_load_dwordx4 v[88:91], v9, s[8:11], s55 offen sc1
    s_waitcnt vmcnt(0)
    v_max3_u32 v188, v72, v73, v74
    v_max3_u32 v188, v188, v75, v76
    v_max3_u32 v188, v188, v77, v78
    v_max3_u32 v188, v188, v79, v80
    v_max3_u32 v188, v188, v81, v82
    v_max3_u32 v188, v188, v83, v84
    v_max3_u32 v188, v188, v85, v86
    v_max3_u32 v188, v188, v87, v88
    v_max3_u32 v188, v188, v89, v90
    v_max_u32 v188, v188, v91
    v_cmp_eq_u32 vcc, -1, v188
    s_cbranch_vccz HAssd_51
    s_sub_u32 s58, s58, 1
    s_cbranch_scc0 HAssp_50
    s_mov_b32 s58, 0
HAssd_51:
    s_add_u32 s55, s72, 4096
    buffer_store_dwordx4 v[72:75], v9, s[8:11], s72 offen offset:0 sc1
    buffer_store_dwordx4 v[76:79], v9, s[8:11], s72 offen offset:1024 sc1
    buffer_store_dwordx4 v[80:83], v9, s[8:11], s72 offen offset:2048 sc1
    buffer_store_dwordx4 v[84:87], v9, s[8:11], s72 offen offset:3072 sc1
    buffer_store_dwordx4 v[88:91], v9, s[8:11], s55 offen sc1
HAssp_52:
    buffer_load_dwordx4 v[32:35], v11, s[8:11], s35 offen sc1
    s_waitcnt vmcnt(0)
    v_max3_u32 v188, v32, v33, v34
    v_max_u32 v188, v188, v35
    v_cmp_eq_u32 vcc, -1, v188
    s_cbranch_vccz HAssd_53
    s_sub_u32 s58, s58, 1
    s_cbranch_scc0 HAssp_52
    s_mov_b32 s58, 0
HAssd_53:
    s_add_u32 s55, s35, 4096
    buffer_load_dwordx4 v[52:55], v4, s[8:11], s35 offen offset:0 sc1
    buffer_load_dwordx4 v[56:59], v4, s[8:11], s35 offen offset:1024 sc1
    buffer_load_dwordx4 v[60:63], v4, s[8:11], s35 offen offset:2048 sc1
    buffer_load_dwordx4 v[64:67], v4, s[8:11], s35 offen offset:3072 sc1
    buffer_load_dwordx4 v[68:71], v4, s[8:11], s55 offen sc1
    s_waitcnt vmcnt(0)
    v_max3_u32 v188, v52, v53, v54
    v_max3_u32 v188, v188, v55, v56
    v_max3_u32 v188, v188, v57, v58
    v_max3_u32 v188, v188, v59, v60
    v_max3_u32 v188, v188, v61, v62
    v_max3_u32 v188, v188, v63, v64
    v_max3_u32 v188, v188, v65, v66
    v_max3_u32 v188, v188, v67, v68
    v_max3_u32 v188, v188, v69, v70
    v_max_u32 v188, v188, v71
    v_cmp_eq_u32 vcc, -1, v188
    s_cbranch_vccnz HAsrt_55
HAsok_54:
HAsjn_45:
    ds_write_b128 v5, v[52:55] offset:0
    ds_write_b128 v5, v[56:59] offset:2048
    ds_write_b128 v5, v[60:63] offset:4096
    ds_write_b128 v5, v[64:67] offset:6144
    ds_write_b128 v5, v[68:71] offset:8192
    s_mov_b32 s54, s34
    s_mov_b32 s34, s35
    s_mov_b32 s35, s36
    s_mov_b32 s36, s37
    s_mov_b32 s37, s54
    s_waitcnt lgkmcnt(0)
    s_barrier
    s_branch HAs_loop
HAs_last:
    s_cmp_eq_u32 s32, 2
    s_cbranch_scc0 cl_56
    s_mov_b32 s54, 0x3f
    v_mov_b32 v189, s54
    v_mov_b32 v190, 0
    s_mov_b64 exec, 1
    buffer_store_dword v189, v190, s[8:11], s75 offen sc1
    s_mov_b64 exec, -1
cl_56:
    s_lshl_b32 s73, s33, 17
    s_add_u32 s73, s73, 0x8400000
    buffer_store_dwordx4 v[184:187], v28, s[8:11], s73 offen sc1
    s_waitcnt vmcnt(0)
    s_barrier
    s_cmp_eq_u32 s32, 0
    s_cbranch_scc0 ce_57
    s_mov_b32 s54, 0x40
    v_mov_b32 v189, s54
    v_mov_b32 v190, 0
    s_mov_b64 exec, 1
    buffer_store_dword v189, v190, s[8:11], s75 offen sc1
    s_mov_b64 exec, -1
    s_waitcnt vmcnt(0)
ce_57:
    s_endpgm
HAsrt_55:
    s_sub_u32 s58, s58, 1
    s_cbranch_scc1 HAsbad_58
    s_add_u32 s55, s35, 4096
    buffer_load_dwordx4 v[52:55], v4, s[8:11], s35 offen offset:0 sc1
    buffer_load_dwordx4 v[56:59], v4, s[8:11], s35 offen offset:1024 sc1
    buffer_load_dwordx4 v[60:63], v4, s[8:11], s35 offen offset:2048 sc1
    buffer_load_dwordx4 v[64:67], v4, s[8:11], s35 offen offset:3072 sc1
    buffer_load_dwordx4 v[68:71], v4, s[8:11], s55 offen sc1
    s_waitcnt vmcnt(0)
    v_max3_u32 v188, v52, v53, v54
    v_max3_u32 v188, v188, v55, v56
    v_max3_u32 v188, v188, v57, v58
    v_max3_u32 v188, v188, v59, v60
    v_max3_u32 v188, v188, v61, v62
    v_max3_u32 v188, v188, v63, v64
    v_max3_u32 v188, v188, v65, v66
    v_max3_u32 v188, v188, v67, v68
    v_max3_u32 v188, v188, v69, v70
    v_max_u32 v188, v188, v71
    v_cmp_eq_u32 vcc, -1, v188
    s_cbranch_vccnz HAsrt_55
    s_branch HAsok_54
HAsbad_58:
    s_mov_b32 s58, 0
    s_branch HAsok_54
f_cB:
    s_mov_b32 s12, s88
    s_and_b32 s13, s89, 0xffff
    s_mov_b32 s14, 0x500000
    s_mov_b32 s15, 0x00020000
    s_mov_b32 s16, s90
    s_and_b32 s17, s91, 0xffff
    s_mov_b32 s18, 0x500000
    s_mov_b32 s19, 0x00020000
    v_lshlrev_b32 v6, 4, v1
    v_cmp_gt_u32 s[44:45], 8, v2
    v_cmp_gt_u32 s[52:53], 2, v3
    v_and_b32 v168, 7, v2
    v_lshrrev_b32 v174, 3, v2
    s_mul_i32 s54, s28, 174080
    s_mul_i32 s55, s28, 10240
    s_sub_u32 s56, 30720, s55
    s_cmp_ge_u32 s32, 2
    s_cselect_b32 s55, s55, s56
    s_and_b32 s56, s32, 1
    s_mul_i32 s56, s56, 5120
    s_add_u32 s55, s55, s56
    s_add_u32 s55, s55, 348160
    v_lshl_add_u32 v169, v174, 9, s55
    v_lshl_add_u32 v169, v3, 7, v169
    v_lshl_add_u32 v4, v168, 4, v169
    s_and_b32 s56, s32, 1
    s_mul_i32 s56, s56, 10240
    s_lshr_b32 s55, s32, 1
    s_lshl_b32 s55, s55, 7
    s_add_u32 s56, s56, s55
    v_lshl_add_u32 v169, v174, 10, s56
    v_lshl_add_u32 v169, v3, 8, v169
    v_lshl_add_u32 v5, v168, 4, v169
    s_mul_i32 s41, s28, 768
    s_add_u32 s41, s41, 0x8d7c000
    s_lshl_b32 s56, s31, 2
    s_add_u32 s56, s56, s32
    s_lshl_b32 s56, s56, 2
    v_mov_b32 v16, s56
    s_lshl_b32 s56, s32, 4
    v_add_u32 v17, s56, v2
    v_lshlrev_b32 v17, 2, v17
    s_mul_i32 s56, s32, 5
    s_add_u32 s56, s56, s29
    s_mul_i32 s55, s56, 6554
    s_lshr_b32 s55, s55, 16
    s_mul_i32 s55, s55, 10
    s_sub_u32 s56, s56, s55
    s_lshl_b32 s56, s56, 10
    s_mul_i32 s55, s28, 10240
    s_add_u32 s56, s56, s55
    s_add_u32 s56, s56, 348160
    v_add_u32 v27, s56, v6
    v_mov_b32 v22, -1
    v_mov_b32 v23, -1
    v_mov_b32 v24, -1
    v_mov_b32 v25, -1
    s_mul_i32 s56, s32, 3072
    s_add_u32 s56, s56, 20480
    v_add_u32 v15, s56, v6
    s_lshl_b32 s56, s32, 11
    s_add_u32 s56, s56, s54
    v_lshl_add_u32 v169, v2, 6, s56
    v_lshl_add_u32 v7, v3, 4, v169
    s_lshl_b32 s56, s32, 9
    s_add_u32 s56, s56, s54
    s_add_u32 s56, s56, 8192
    v_lshl_add_u32 v169, v3, 7, s56
    v_lshl_add_u32 v8, v168, 4, v169
    s_mul_i32 s59, s31, 40
    v_add_u32 v170, s59, v2
    v_add_u32 v171, 16, v170
    v_add_u32 v172, s59, v168
    v_add_u32 v172, 32, v172
    s_mul_i32 s56, s32, 40960
    s_add_u32 s56, s56, s54
    s_add_u32 s56, s56, 10240
    v_mul_u32_u24 v169, 10240, v3
    v_add_u32 v169, s56, v169
    v_lshl_add_u32 v9, v170, 4, v169
    v_lshl_add_u32 v10, v171, 4, v169
    v_lshl_add_u32 v11, v172, 4, v169
    s_lshl_b32 s56, s28, 4
    s_lshl_b32 s60, s32, 2
    s_add_u32 s56, s56, s60
    s_mul_i32 s56, s56, 40960
    v_lshrrev_b32 v175, 4, v170
    v_lshlrev_b32 v175, 10, v175
    v_and_b32 v176, 15, v170
    v_lshl_add_u32 v176, v3, 4, v176
    v_lshl_add_u32 v175, v176, 4, v175
    v_add_u32 v12, s56, v175
    v_lshrrev_b32 v175, 4, v171
    v_lshlrev_b32 v175, 10, v175
    v_and_b32 v176, 15, v171
    v_lshl_add_u32 v176, v3, 4, v176
    v_lshl_add_u32 v175, v176, 4, v175
    v_add_u32 v13, s56, v175
    v_lshrrev_b32 v175, 4, v172
    v_lshlrev_b32 v175, 10, v175
    v_and_b32 v176, 15, v172
    v_lshl_add_u32 v176, v3, 4, v176
    v_lshl_add_u32 v175, v176, 4, v175
    v_add_u32 v14, s56, v175
    v_mul_u32_u24 v175, 40960, v174
    v_add_u32 v14, v14, v175
    s_mul_i32 s56, s32, 3072
    s_add_u32 s56, s56, 32768
    v_add_u32 v18, s56, v6
    s_lshl_b32 s56, s32, 10
    s_add_u32 s56, s56, 32768
    v_add_u32 v19, s56, v6
    s_lshl_b32 s56, s32, 1
    s_lshr_b32 s60, s59, 3
    s_add_u32 s56, s56, s60
    v_lshrrev_b32 v169, 1, v3
    v_add_u32 v169, s56, v169
    v_lshlrev_b32 v169, 7, v169
    v_lshl_add_u32 v169, v2, 4, v169
    v_and_b32 v170, 1, v3
    v_lshl_add_u32 v169, v170, 3, v169
    s_mul_i32 s56, s28, 10240
    s_add_u32 s56, s56, 348160
    v_add_u32 v20, s56, v169
    v_add_u32 v21, 20480, v20
    s_mov_b64 s[50:51], s[44:45]
    s_cmp_eq_u32 s32, 2
    s_cbranch_scc0 GBfm_59
    s_and_b64 s[50:51], s[44:45], s[52:53]
GBfm_59:
    s_cmp_eq_u32 s32, 3
    s_cbranch_scc0 GBfm_60
    s_mov_b64 s[50:51], 0
GBfm_60:
    s_mul_i32 s56, s31, 10240
    s_add_u32 s56, s56, s54
    s_add_u32 s56, s56, 10240
    s_lshl_b32 s60, s32, 8
    s_add_u32 s56, s56, s60
    v_lshrrev_b32 v169, 1, v3
    v_lshl_add_u32 v169, v169, 10, s56
    v_lshl_add_u32 v169, v2, 4, v169
    v_and_b32 v170, 1, v3
    v_lshl_add_u32 v26, v170, 3, v169
    s_mul_i32 s56, s30, 10240
    s_add_u32 s56, s56, s60
    v_lshrrev_b32 v169, 1, v3
    v_lshl_add_u32 v169, v169, 10, s56
    v_lshl_add_u32 v169, v2, 4, v169
    v_lshl_add_u32 v28, v170, 3, v169
    v_lshlrev_b32 v168, 2, v2
    v_and_b32 v168, 28, v168
    s_mov_b32 s43, 0x40000
dc_62:
    buffer_load_dword v169, v168, s[20:23], 0 offen sc1
    s_waitcnt vmcnt(0)
    v_mov_b32 v170, v169
    s_nop 1
    v_add_u32_dpp v170, v170, v170 row_ror:1 row_mask:0xf bank_mask:0xf
    s_nop 1
    v_add_u32_dpp v170, v170, v170 row_ror:2 row_mask:0xf bank_mask:0xf
    s_nop 1
    v_add_u32_dpp v170, v170, v170 row_ror:4 row_mask:0xf bank_mask:0xf
    s_nop 1
    v_readfirstlane_b32 s54, v170
    v_readlane_b32 s55, v169, 0
    v_readlane_b32 s56, v169, 1
    s_nop 3
    s_cmp_ge_u32 s54, 256
    s_cbranch_scc1 dd_63
    s_sleep 1
    s_sub_u32 s43, s43, 1
    s_cbranch_scc0 dc_62
dd_63:
    s_min_u32 s55, s55, s56
    s_cmp_lt_u32 s55, 32
    s_cbranch_scc1 HslowB_61
    s_mov_b32 s55, 0x8c00000
    s_add_u32 s56, s55, 0
    buffer_store_dwordx2 v[22:23], v26, s[8:11], s56 offen
    s_add_u32 s56, s55, 2048
    buffer_store_dwordx2 v[22:23], v26, s[8:11], s56 offen
    s_add_u32 s56, s55, 4096
    buffer_store_dwordx2 v[22:23], v26, s[8:11], s56 offen
    s_add_u32 s56, s55, 6144
    buffer_store_dwordx2 v[22:23], v26, s[8:11], s56 offen
    s_add_u32 s56, s55, 8192
    buffer_store_dwordx2 v[22:23], v26, s[8:11], s56 offen
    s_mov_b64 exec, s[50:51]
    s_cbranch_execz HBfpm_64
    buffer_store_dwordx2 v[22:23], v20, s[8:11], s55 offen
    buffer_store_dwordx2 v[22:23], v21, s[8:11], s55 offen sc1
HBfpm_64:
    s_mov_b64 exec, -1
    s_mov_b32 s55, 0x8c5f000
    s_add_u32 s56, s55, 0
    buffer_store_dwordx2 v[22:23], v26, s[8:11], s56 offen
    s_add_u32 s56, s55, 2048
    buffer_store_dwordx2 v[22:23], v26, s[8:11], s56 offen
    s_add_u32 s56, s55, 4096
    buffer_store_dwordx2 v[22:23], v26, s[8:11], s56 offen
    s_add_u32 s56, s55, 6144
    buffer_store_dwordx2 v[22:23], v26, s[8:11], s56 offen
    s_add_u32 s56, s55, 8192
    buffer_store_dwordx2 v[22:23], v26, s[8:11], s56 offen
    s_mov_b64 exec, s[50:51]
    s_cbranch_execz HBfpm_65
    buffer_store_dwordx2 v[22:23], v20, s[8:11], s55 offen
    buffer_store_dwordx2 v[22:23], v21, s[8:11], s55 offen sc1
HBfpm_65:
    s_mov_b64 exec, -1
    s_mov_b32 s55, 0x8cbe000
    s_add_u32 s56, s55, 0
    buffer_store_dwordx2 v[22:23], v26, s[8:11], s56 offen
    s_add_u32 s56, s55, 2048
    buffer_store_dwordx2 v[22:23], v26, s[8:11], s56 offen
    s_add_u32 s56, s55, 4096
    buffer_store_dwordx2 v[22:23], v26, s[8:11], s56 offen
    s_add_u32 s56, s55, 6144
    buffer_store_dwordx2 v[22:23], v26, s[8:11], s56 offen
    s_add_u32 s56, s55, 8192
    buffer_store_dwordx2 v[22:23], v26, s[8:11], s56 offen
    s_mov_b64 exec, s[50:51]
    s_cbranch_execz HBfpm_66
    buffer_store_dwordx2 v[22:23], v20, s[8:11], s55 offen
    buffer_store_dwordx2 v[22:23], v21, s[8:11], s55 offen sc1
HBfpm_66:
    s_mov_b64 exec, -1
    s_mov_b32 s55, 0x8d1d000
    s_add_u32 s56, s55, 0
    buffer_store_dwordx2 v[22:23], v26, s[8:11], s56 offen
    s_add_u32 s56, s55, 2048
    buffer_store_dwordx2 v[22:23], v26, s[8:11], s56 offen
    s_add_u32 s56, s55, 4096
    buffer_store_dwordx2 v[22:23], v26, s[8:11], s56 offen
    s_add_u32 s56, s55, 6144
    buffer_store_dwordx2 v[22:23], v26, s[8:11], s56 offen
    s_add_u32 s56, s55, 8192
    buffer_store_dwordx2 v[22:23], v26, s[8:11], s56 offen
    s_mov_b64 exec, s[50:51]
    s_cbranch_execz HBfpm_67
    buffer_store_dwordx2 v[22:23], v20, s[8:11], s55 offen
    buffer_store_dwordx2 v[22:23], v21, s[8:11], s55 offen sc1
HBfpm_67:
    s_mov_b64 exec, -1
    v_mov_b32 v168, 0
    s_mov_b64 exec, 1
    s_add_u32 s55, s41, 256
    buffer_store_dword v168, v16, s[8:11], s55 offen
    s_add_u32 s55, s41, 512
    buffer_store_dword v168, v16, s[8:11], s55 offen
    s_mov_b64 exec, -1
    s_waitcnt vmcnt(0)
    s_barrier
    s_cmp_eq_u32 s32, 0
    s_cbranch_scc0 HBfsb_68
    v_mov_b32 v168, 1
    v_mov_b32 v169, 36
    s_mov_b64 exec, 1
    buffer_atomic_add v168, v169, s[20:23], 0 offen
    s_mov_b64 exec, -1
    s_waitcnt vmcnt(0)
HBfsb_68:
    s_lshr_b32 s56, s32, 1
    s_lshl_b32 s56, s56, 3
    v_lshlrev_b32 v172, 1, v3
    v_add_u32 v172, s56, v172
    v_xor_b32 v172, v172, v2
    v_lshlrev_b32 v172, 4, v172
    s_lshl_b32 s56, s32, 2
    v_add_u32 v173, s56, v3
    v_lshlrev_b32 v168, 13, v173
    v_add_u32 v168, v168, v172
    s_and_b32 s56, s32, 1
    s_lshl_b32 s56, s56, 3
    v_lshlrev_b32 v172, 1, v3
    v_add_u32 v172, s56, v172
    v_xor_b32 v172, v172, v2
    v_lshlrev_b32 v172, 4, v172
    v_mul_u32_u24 v169, 1280, v173
    v_add_u32 v169, v169, v172
    s_lshl_b32 s56, s32, 1
    s_lshl_b32 s56, s56, 1
    v_bfe_u32 v172, v1, 1, 1
    v_add_u32 v172, s56, v172
    v_lshrrev_b32 v173, 2, v2
    v_lshlrev_b32 v173, 1, v173
    v_and_b32 v170, 1, v3
    v_lshl_add_u32 v173, v170, 3, v173
    v_xor_b32 v172, v172, v173
    v_lshlrev_b32 v172, 4, v172
    v_and_b32 v173, 1, v1
    v_lshl_add_u32 v172, v173, 3, v172
    v_lshrrev_b32 v173, 2, v2
    v_mad_u32_u24 v173, v3, 8, v173
    v_lshl_add_u32 v170, v173, 8, v172
    s_lshl_b32 s56, s32, 1
    s_add_u32 s56, s56, 1
    s_lshl_b32 s56, s56, 1
    v_bfe_u32 v172, v1, 1, 1
    v_add_u32 v172, s56, v172
    v_lshrrev_b32 v173, 2, v2
    v_lshlrev_b32 v173, 1, v173
    v_and_b32 v171, 1, v3
    v_lshl_add_u32 v173, v171, 3, v173
    v_xor_b32 v172, v172, v173
    v_lshlrev_b32 v172, 4, v172
    v_and_b32 v173, 1, v1
    v_lshl_add_u32 v172, v173, 3, v172
    v_lshrrev_b32 v173, 2, v2
    v_mad_u32_u24 v173, v3, 8, v173
    v_lshl_add_u32 v171, v173, 8, v172
    s_mov_b32 s56, s32
    s_lshl_b32 s56, s56, 1
    v_bfe_u32 v172, v1, 1, 1
    v_add_u32 v172, s56, v172
    v_lshrrev_b32 v173, 2, v2
    v_lshlrev_b32 v173, 1, v173
    v_and_b32 v174, 1, v3
    v_lshl_add_u32 v173, v174, 3, v173
    v_xor_b32 v172, v172, v173
    v_lshlrev_b32 v172, 4, v172
    v_and_b32 v173, 1, v1
    v_lshl_add_u32 v172, v173, 3, v172
    v_lshrrev_b32 v173, 2, v2
    v_mad_u32_u24 v173, v3, 4, v173
    v_lshl_add_u32 v174, v173, 8, v172
    s_add_u32 s56, s32, 4
    s_lshl_b32 s56, s56, 1
    v_bfe_u32 v172, v1, 1, 1
    v_add_u32 v172, s56, v172
    v_lshrrev_b32 v173, 2, v2
    v_lshlrev_b32 v173, 1, v173
    v_and_b32 v175, 1, v3
    v_lshl_add_u32 v173, v175, 3, v173
    v_xor_b32 v172, v172, v173
    v_lshlrev_b32 v172, 4, v172
    v_and_b32 v173, 1, v1
    v_lshl_add_u32 v172, v173, 3, v172
    v_lshrrev_b32 v173, 2, v2
    v_mad_u32_u24 v173, v3, 4, v173
    v_lshl_add_u32 v175, v173, 8, v172
    s_lshl_b32 s54, s30, 8
    s_add_u32 s55, s54, 0x0
    s_lshl_b32 s56, s32, 10
    s_add_u32 m0, s56, 0x0
    s_nop 0
    buffer_load_dwordx4 v168, s[12:15], s55 offen lds
    s_add_u32 s55, s54, 0x20000
    s_lshl_b32 s56, s32, 10
    s_add_u32 m0, s56, 0x1000
    s_nop 0
    buffer_load_dwordx4 v168, s[12:15], s55 offen lds
    s_add_u32 s55, s54, 0x40000
    s_lshl_b32 s56, s32, 10
    s_add_u32 m0, s56, 0x2000
    s_nop 0
    buffer_load_dwordx4 v168, s[12:15], s55 offen lds
    s_add_u32 s55, s54, 0x60000
    s_lshl_b32 s56, s32, 10
    s_add_u32 m0, s56, 0x3000
    s_nop 0
    buffer_load_dwordx4 v168, s[12:15], s55 offen lds
    s_add_u32 s55, s54, 0x80000
    s_lshl_b32 s56, s32, 10
    s_add_u32 m0, s56, 0x4000
    s_nop 0
    buffer_load_dwordx4 v168, s[12:15], s55 offen lds
    s_add_u32 s55, s54, 0xa0000
    s_lshl_b32 s56, s32, 10
    s_add_u32 m0, s56, 0x5000
    s_nop 0
    buffer_load_dwordx4 v168, s[12:15], s55 offen lds
    s_add_u32 s55, s54, 0xc0000
    s_lshl_b32 s56, s32, 10
    s_add_u32 m0, s56, 0x6000
    s_nop 0
    buffer_load_dwordx4 v168, s[12:15], s55 offen lds
    s_add_u32 s55, s54, 0xe0000
    s_lshl_b32 s56, s32, 10
    s_add_u32 m0, s56, 0x7000
    s_nop 0
    buffer_load_dwordx4 v168, s[12:15], s55 offen lds
    s_add_u32 s55, s54, 0x100000
    s_lshl_b32 s56, s32, 10
    s_add_u32 m0, s56, 0x8000
    s_nop 0
    buffer_load_dwordx4 v168, s[12:15], s55 offen lds
    s_add_u32 s55, s54, 0x120000
    s_lshl_b32 s56, s32, 10
    s_add_u32 m0, s56, 0x9000
    s_nop 0
    buffer_load_dwordx4 v168, s[12:15], s55 offen lds
    s_add_u32 s55, s54, 0x140000
    s_lshl_b32 s56, s32, 10
    s_add_u32 m0, s56, 0xa000
    s_nop 0
    buffer_load_dwordx4 v168, s[12:15], s55 offen lds
    s_add_u32 s55, s54, 0x160000
    s_lshl_b32 s56, s32, 10
    s_add_u32 m0, s56, 0xb000
    s_nop 0
    buffer_load_dwordx4 v168, s[12:15], s55 offen lds
    s_add_u32 s55, s54, 0x180000
    s_lshl_b32 s56, s32, 10
    s_add_u32 m0, s56, 0xc000
    s_nop 0
    buffer_load_dwordx4 v168, s[12:15], s55 offen lds
    s_add_u32 s55, s54, 0x1a0000
    s_lshl_b32 s56, s32, 10
    s_add_u32 m0, s56, 0xd000
    s_nop 0
    buffer_load_dwordx4 v168, s[12:15], s55 offen lds
    s_add_u32 s55, s54, 0x1c0000
    s_lshl_b32 s56, s32, 10
    s_add_u32 m0, s56, 0xe000
    s_nop 0
    buffer_load_dwordx4 v168, s[12:15], s55 offen lds
    s_add_u32 s55, s54, 0x1e0000
    s_lshl_b32 s56, s32, 10
    s_add_u32 m0, s56, 0xf000
    s_nop 0
    buffer_load_dwordx4 v168, s[12:15], s55 offen lds
    s_add_u32 s55, s54, 0x200000
    s_lshl_b32 s56, s32, 10
    s_add_u32 m0, s56, 0x10000
    s_nop 0
    buffer_load_dwordx4 v168, s[12:15], s55 offen lds
    s_add_u32 s55, s54, 0x220000
    s_lshl_b32 s56, s32, 10
    s_add_u32 m0, s56, 0x11000
    s_nop 0
    buffer_load_dwordx4 v168, s[12:15], s55 offen lds
    s_add_u32 s55, s54, 0x240000
    s_lshl_b32 s56, s32, 10
    s_add_u32 m0, s56, 0x12000
    s_nop 0
    buffer_load_dwordx4 v168, s[12:15], s55 offen lds
    s_add_u32 s55, s54, 0x260000
    s_lshl_b32 s56, s32, 10
    s_add_u32 m0, s56, 0x13000
    s_nop 0
    buffer_load_dwordx4 v168, s[12:15], s55 offen lds
    s_add_u32 s55, s54, 0x280000
    s_lshl_b32 s56, s32, 10
    s_add_u32 m0, s56, 0x14000
    s_nop 0
    buffer_load_dwordx4 v168, s[12:15], s55 offen lds
    s_add_u32 s55, s54, 0x2a0000
    s_lshl_b32 s56, s32, 10
    s_add_u32 m0, s56, 0x15000
    s_nop 0
    buffer_load_dwordx4 v168, s[12:15], s55 offen lds
    s_add_u32 s55, s54, 0x2c0000
    s_lshl_b32 s56, s32, 10
    s_add_u32 m0, s56, 0x16000
    s_nop 0
    buffer_load_dwordx4 v168, s[12:15], s55 offen lds
    s_add_u32 s55, s54, 0x2e0000
    s_lshl_b32 s56, s32, 10
    s_add_u32 m0, s56, 0x17000
    s_nop 0
    buffer_load_dwordx4 v168, s[12:15], s55 offen lds
    s_add_u32 s55, s54, 0x300000
    s_lshl_b32 s56, s32, 10
    s_add_u32 m0, s56, 0x18000
    s_nop 0
    buffer_load_dwordx4 v168, s[12:15], s55 offen lds
    s_add_u32 s55, s54, 0x320000
    s_lshl_b32 s56, s32, 10
    s_add_u32 m0, s56, 0x19000
    s_nop 0
    buffer_load_dwordx4 v168, s[12:15], s55 offen lds
    s_add_u32 s55, s54, 0x340000
    s_lshl_b32 s56, s32, 10
    s_add_u32 m0, s56, 0x1a000
    s_nop 0
    buffer_load_dwordx4 v168, s[12:15], s55 offen lds
    s_add_u32 s55, s54, 0x360000
    s_lshl_b32 s56, s32, 10
    s_add_u32 m0, s56, 0x1b000
    s_nop 0
    buffer_load_dwordx4 v168, s[12:15], s55 offen lds
    s_add_u32 s55, s54, 0x380000
    s_lshl_b32 s56, s32, 10
    s_add_u32 m0, s56, 0x1c000
    s_nop 0
    buffer_load_dwordx4 v168, s[12:15], s55 offen lds
    s_add_u32 s55, s54, 0x3a0000
    s_lshl_b32 s56, s32, 10
    s_add_u32 m0, s56, 0x1d000
    s_nop 0
    buffer_load_dwordx4 v168, s[12:15], s55 offen lds
    s_add_u32 s55, s54, 0x3c0000
    s_lshl_b32 s56, s32, 10
    s_add_u32 m0, s56, 0x1e000
    s_nop 0
    buffer_load_dwordx4 v168, s[12:15], s55 offen lds
    s_add_u32 s55, s54, 0x3e0000
    s_lshl_b32 s56, s32, 10
    s_add_u32 m0, s56, 0x1f000
    s_nop 0
    buffer_load_dwordx4 v168, s[12:15], s55 offen lds
    s_add_u32 s55, s54, 0x400000
    s_lshl_b32 s56, s32, 10
    s_add_u32 m0, s56, 0x20000
    s_nop 0
    buffer_load_dwordx4 v168, s[12:15], s55 offen lds
    s_add_u32 s55, s54, 0x420000
    s_lshl_b32 s56, s32, 10
    s_add_u32 m0, s56, 0x21000
    s_nop 0
    buffer_load_dwordx4 v168, s[12:15], s55 offen lds
    s_add_u32 s55, s54, 0x440000
    s_lshl_b32 s56, s32, 10
    s_add_u32 m0, s56, 0x22000
    s_nop 0
    buffer_load_dwordx4 v168, s[12:15], s55 offen lds
    s_add_u32 s55, s54, 0x460000
    s_lshl_b32 s56, s32, 10
    s_add_u32 m0, s56, 0x23000
    s_nop 0
    buffer_load_dwordx4 v168, s[12:15], s55 offen lds
    s_add_u32 s55, s54, 0x480000
    s_lshl_b32 s56, s32, 10
    s_add_u32 m0, s56, 0x24000
    s_nop 0
    buffer_load_dwordx4 v168, s[12:15], s55 offen lds
    s_add_u32 s55, s54, 0x4a0000
    s_lshl_b32 s56, s32, 10
    s_add_u32 m0, s56, 0x25000
    s_nop 0
    buffer_load_dwordx4 v168, s[12:15], s55 offen lds
    s_add_u32 s55, s54, 0x4c0000
    s_lshl_b32 s56, s32, 10
    s_add_u32 m0, s56, 0x26000
    s_nop 0
    buffer_load_dwordx4 v168, s[12:15], s55 offen lds
    s_add_u32 s55, s54, 0x4e0000
    s_lshl_b32 s56, s32, 10
    s_add_u32 m0, s56, 0x27000
    s_nop 0
    buffer_load_dwordx4 v168, s[12:15], s55 offen lds
    s_waitcnt vmcnt(20)
    s_barrier
    v_add_u32 v172, 0x0, v170
    v_add_u32 v173, 0x0, v171
    ds_read_b64_tr_b16 a[0:1], v172 offset:0
    ds_read_b64_tr_b16 a[2:3], v172 offset:1024
    ds_read_b64_tr_b16 a[4:5], v172 offset:8192
    ds_read_b64_tr_b16 a[6:7], v172 offset:9216
    ds_read_b64_tr_b16 a[8:9], v172 offset:16384
    ds_read_b64_tr_b16 a[10:11], v172 offset:17408
    ds_read_b64_tr_b16 a[12:13], v172 offset:24576
    ds_read_b64_tr_b16 a[14:15], v172 offset:25600
    ds_read_b64_tr_b16 a[16:17], v172 offset:32768
    ds_read_b64_tr_b16 a[18:19], v172 offset:33792
    ds_read_b64_tr_b16 a[80:81], v173 offset:0
    ds_read_b64_tr_b16 a[82:83], v173 offset:1024
    ds_read_b64_tr_b16 a[84:85], v173 offset:8192
    ds_read_b64_tr_b16 a[86:87], v173 offset:9216
    ds_read_b64_tr_b16 a[88:89], v173 offset:16384
    ds_read_b64_tr_b16 a[90:91], v173 offset:17408
    ds_read_b64_tr_b16 a[92:93], v173 offset:24576
    ds_read_b64_tr_b16 a[94:95], v173 offset:25600
    ds_read_b64_tr_b16 a[96:97], v173 offset:32768
    ds_read_b64_tr_b16 a[98:99], v173 offset:33792
    s_waitcnt lgkmcnt(0)
    v_add_u32 v172, 0xa000, v170
    v_add_u32 v173, 0xa000, v171
    ds_read_b64_tr_b16 a[20:21], v172 offset:0
    ds_read_b64_tr_b16 a[22:23], v172 offset:1024
    ds_read_b64_tr_b16 a[24:25], v172 offset:8192
    ds_read_b64_tr_b16 a[26:27], v172 offset:9216
    ds_read_b64_tr_b16 a[28:29], v172 offset:16384
    ds_read_b64_tr_b16 a[30:31], v172 offset:17408
    ds_read_b64_tr_b16 a[32:33], v172 offset:24576
    ds_read_b64_tr_b16 a[34:35], v172 offset:25600
    ds_read_b64_tr_b16 a[36:37], v172 offset:32768
    ds_read_b64_tr_b16 a[38:39], v172 offset:33792
    ds_read_b64_tr_b16 a[100:101], v173 offset:0
    ds_read_b64_tr_b16 a[102:103], v173 offset:1024
    ds_read_b64_tr_b16 a[104:105], v173 offset:8192
    ds_read_b64_tr_b16 a[106:107], v173 offset:9216
    ds_read_b64_tr_b16 a[108:109], v173 offset:16384
    ds_read_b64_tr_b16 a[110:111], v173 offset:17408
    ds_read_b64_tr_b16 a[112:113], v173 offset:24576
    ds_read_b64_tr_b16 a[114:115], v173 offset:25600
    ds_read_b64_tr_b16 a[116:117], v173 offset:32768
    ds_read_b64_tr_b16 a[118:119], v173 offset:33792
    s_waitcnt lgkmcnt(0)
    s_barrier
    s_mul_i32 s55, s30, 163840
    s_add_u32 s55, s55, 0x0
    s_lshl_b32 s56, s32, 10
    s_add_u32 m0, s56, 0x0
    s_nop 0
    buffer_load_dwordx4 v169, s[16:19], s55 offen lds
    s_mul_i32 s55, s30, 163840
    s_add_u32 s55, s55, 0x5000
    s_lshl_b32 s56, s32, 10
    s_add_u32 m0, s56, 0x1000
    s_nop 0
    buffer_load_dwordx4 v169, s[16:19], s55 offen lds
    s_mul_i32 s55, s30, 163840
    s_add_u32 s55, s55, 0xa000
    s_lshl_b32 s56, s32, 10
    s_add_u32 m0, s56, 0x2000
    s_nop 0
    buffer_load_dwordx4 v169, s[16:19], s55 offen lds
    s_mul_i32 s55, s30, 163840
    s_add_u32 s55, s55, 0xf000
    s_lshl_b32 s56, s32, 10
    s_add_u32 m0, s56, 0x3000
    s_nop 0
    buffer_load_dwordx4 v169, s[16:19], s55 offen lds
    s_mul_i32 s55, s30, 163840
    s_add_u32 s55, s55, 0x14000
    s_lshl_b32 s56, s32, 10
    s_add_u32 m0, s56, 0x4000
    s_nop 0
    buffer_load_dwordx4 v169, s[16:19], s55 offen lds
    s_mul_i32 s55, s30, 163840
    s_add_u32 s55, s55, 0x19000
    s_lshl_b32 s56, s32, 10
    s_add_u32 m0, s56, 0x5000
    s_nop 0
    buffer_load_dwordx4 v169, s[16:19], s55 offen lds
    s_mul_i32 s55, s30, 163840
    s_add_u32 s55, s55, 0x1e000
    s_lshl_b32 s56, s32, 10
    s_add_u32 m0, s56, 0x6000
    s_nop 0
    buffer_load_dwordx4 v169, s[16:19], s55 offen lds
    s_mul_i32 s55, s30, 163840
    s_add_u32 s55, s55, 0x23000
    s_lshl_b32 s56, s32, 10
    s_add_u32 m0, s56, 0x7000
    s_nop 0
    buffer_load_dwordx4 v169, s[16:19], s55 offen lds
    s_mul_i32 s55, s30, 163840
    s_add_u32 s55, s55, 0x100
    s_lshl_b32 s56, s32, 10
    s_add_u32 m0, s56, 0xa000
    s_nop 0
    buffer_load_dwordx4 v169, s[16:19], s55 offen lds
    s_mul_i32 s55, s30, 163840
    s_add_u32 s55, s55, 0x5100
    s_lshl_b32 s56, s32, 10
    s_add_u32 m0, s56, 0xb000
    s_nop 0
    buffer_load_dwordx4 v169, s[16:19], s55 offen lds
    s_mul_i32 s55, s30, 163840
    s_add_u32 s55, s55, 0xa100
    s_lshl_b32 s56, s32, 10
    s_add_u32 m0, s56, 0xc000
    s_nop 0
    buffer_load_dwordx4 v169, s[16:19], s55 offen lds
    s_mul_i32 s55, s30, 163840
    s_add_u32 s55, s55, 0xf100
    s_lshl_b32 s56, s32, 10
    s_add_u32 m0, s56, 0xd000
    s_nop 0
    buffer_load_dwordx4 v169, s[16:19], s55 offen lds
    s_mul_i32 s55, s30, 163840
    s_add_u32 s55, s55, 0x14100
    s_lshl_b32 s56, s32, 10
    s_add_u32 m0, s56, 0xe000
    s_nop 0
    buffer_load_dwordx4 v169, s[16:19], s55 offen lds
    s_mul_i32 s55, s30, 163840
    s_add_u32 s55, s55, 0x19100
    s_lshl_b32 s56, s32, 10
    s_add_u32 m0, s56, 0xf000
    s_nop 0
    buffer_load_dwordx4 v169, s[16:19], s55 offen lds
    s_mul_i32 s55, s30, 163840
    s_add_u32 s55, s55, 0x1e100
    s_lshl_b32 s56, s32, 10
    s_add_u32 m0, s56, 0x10000
    s_nop 0
    buffer_load_dwordx4 v169, s[16:19], s55 offen lds
    s_mul_i32 s55, s30, 163840
    s_add_u32 s55, s55, 0x23100
    s_lshl_b32 s56, s32, 10
    s_add_u32 m0, s56, 0x11000
    s_nop 0
    buffer_load_dwordx4 v169, s[16:19], s55 offen lds
    s_waitcnt vmcnt(16)
    s_barrier
    v_add_u32 v172, 0x14000, v170
    v_add_u32 v173, 0x14000, v171
    ds_read_b64_tr_b16 a[40:41], v172 offset:0
    ds_read_b64_tr_b16 a[42:43], v172 offset:1024
    ds_read_b64_tr_b16 a[44:45], v172 offset:8192
    ds_read_b64_tr_b16 a[46:47], v172 offset:9216
    ds_read_b64_tr_b16 a[48:49], v172 offset:16384
    ds_read_b64_tr_b16 a[50:51], v172 offset:17408
    ds_read_b64_tr_b16 a[52:53], v172 offset:24576
    ds_read_b64_tr_b16 a[54:55], v172 offset:25600
    ds_read_b64_tr_b16 a[56:57], v172 offset:32768
    ds_read_b64_tr_b16 a[58:59], v172 offset:33792
    ds_read_b64_tr_b16 a[120:121], v173 offset:0
    ds_read_b64_tr_b16 a[122:123], v173 offset:1024
    ds_read_b64_tr_b16 a[124:125], v173 offset:8192
    ds_read_b64_tr_b16 a[126:127], v173 offset:9216
    ds_read_b64_tr_b16 a[128:129], v173 offset:16384
    ds_read_b64_tr_b16 a[130:131], v173 offset:17408
    ds_read_b64_tr_b16 a[132:133], v173 offset:24576
    ds_read_b64_tr_b16 a[134:135], v173 offset:25600
    ds_read_b64_tr_b16 a[136:137], v173 offset:32768
    ds_read_b64_tr_b16 a[138:139], v173 offset:33792
    s_waitcnt lgkmcnt(0)
    v_add_u32 v172, 0x1e000, v170
    v_add_u32 v173, 0x1e000, v171
    ds_read_b64_tr_b16 a[60:61], v172 offset:0
    ds_read_b64_tr_b16 a[62:63], v172 offset:1024
    ds_read_b64_tr_b16 a[64:65], v172 offset:8192
    ds_read_b64_tr_b16 a[66:67], v172 offset:9216
    ds_read_b64_tr_b16 a[68:69], v172 offset:16384
    ds_read_b64_tr_b16 a[70:71], v172 offset:17408
    ds_read_b64_tr_b16 a[72:73], v172 offset:24576
    ds_read_b64_tr_b16 a[74:75], v172 offset:25600
    ds_read_b64_tr_b16 a[76:77], v172 offset:32768
    ds_read_b64_tr_b16 a[78:79], v172 offset:33792
    ds_read_b64_tr_b16 a[140:141], v173 offset:0
    ds_read_b64_tr_b16 a[142:143], v173 offset:1024
    ds_read_b64_tr_b16 a[144:145], v173 offset:8192
    ds_read_b64_tr_b16 a[146:147], v173 offset:9216
    ds_read_b64_tr_b16 a[148:149], v173 offset:16384
    ds_read_b64_tr_b16 a[150:151], v173 offset:17408
    ds_read_b64_tr_b16 a[152:153], v173 offset:24576
    ds_read_b64_tr_b16 a[154:155], v173 offset:25600
    ds_read_b64_tr_b16 a[156:157], v173 offset:32768
    ds_read_b64_tr_b16 a[158:159], v173 offset:33792
    s_waitcnt lgkmcnt(0)
    s_barrier
    s_mul_i32 s55, s30, 163840
    s_add_u32 s55, s55, 0x200
    s_lshl_b32 s56, s32, 10
    s_add_u32 m0, s56, 0x14000
    s_nop 0
    buffer_load_dwordx4 v169, s[16:19], s55 offen lds
    s_mul_i32 s55, s30, 163840
    s_add_u32 s55, s55, 0x5200
    s_lshl_b32 s56, s32, 10
    s_add_u32 m0, s56, 0x15000
    s_nop 0
    buffer_load_dwordx4 v169, s[16:19], s55 offen lds
    s_mul_i32 s55, s30, 163840
    s_add_u32 s55, s55, 0xa200
    s_lshl_b32 s56, s32, 10
    s_add_u32 m0, s56, 0x16000
    s_nop 0
    buffer_load_dwordx4 v169, s[16:19], s55 offen lds
    s_mul_i32 s55, s30, 163840
    s_add_u32 s55, s55, 0xf200
    s_lshl_b32 s56, s32, 10
    s_add_u32 m0, s56, 0x17000
    s_nop 0
    buffer_load_dwordx4 v169, s[16:19], s55 offen lds
    s_mul_i32 s55, s30, 163840
    s_add_u32 s55, s55, 0x14200
    s_lshl_b32 s56, s32, 10
    s_add_u32 m0, s56, 0x18000
    s_nop 0
    buffer_load_dwordx4 v169, s[16:19], s55 offen lds
    s_mul_i32 s55, s30, 163840
    s_add_u32 s55, s55, 0x19200
    s_lshl_b32 s56, s32, 10
    s_add_u32 m0, s56, 0x19000
    s_nop 0
    buffer_load_dwordx4 v169, s[16:19], s55 offen lds
    s_mul_i32 s55, s30, 163840
    s_add_u32 s55, s55, 0x1e200
    s_lshl_b32 s56, s32, 10
    s_add_u32 m0, s56, 0x1a000
    s_nop 0
    buffer_load_dwordx4 v169, s[16:19], s55 offen lds
    s_mul_i32 s55, s30, 163840
    s_add_u32 s55, s55, 0x23200
    s_lshl_b32 s56, s32, 10
    s_add_u32 m0, s56, 0x1b000
    s_nop 0
    buffer_load_dwordx4 v169, s[16:19], s55 offen lds
    s_mul_i32 s55, s30, 163840
    s_add_u32 s55, s55, 0x300
    s_lshl_b32 s56, s32, 10
    s_add_u32 m0, s56, 0x1e000
    s_nop 0
    buffer_load_dwordx4 v169, s[16:19], s55 offen lds
    s_mul_i32 s55, s30, 163840
    s_add_u32 s55, s55, 0x5300
    s_lshl_b32 s56, s32, 10
    s_add_u32 m0, s56, 0x1f000
    s_nop 0
    buffer_load_dwordx4 v169, s[16:19], s55 offen lds
    s_mul_i32 s55, s30, 163840
    s_add_u32 s55, s55, 0xa300
    s_lshl_b32 s56, s32, 10
    s_add_u32 m0, s56, 0x20000
    s_nop 0
    buffer_load_dwordx4 v169, s[16:19], s55 offen lds
    s_mul_i32 s55, s30, 163840
    s_add_u32 s55, s55, 0xf300
    s_lshl_b32 s56, s32, 10
    s_add_u32 m0, s56, 0x21000
    s_nop 0
    buffer_load_dwordx4 v169, s[16:19], s55 offen lds
    s_mul_i32 s55, s30, 163840
    s_add_u32 s55, s55, 0x14300
    s_lshl_b32 s56, s32, 10
    s_add_u32 m0, s56, 0x22000
    s_nop 0
    buffer_load_dwordx4 v169, s[16:19], s55 offen lds
    s_mul_i32 s55, s30, 163840
    s_add_u32 s55, s55, 0x19300
    s_lshl_b32 s56, s32, 10
    s_add_u32 m0, s56, 0x23000
    s_nop 0
    buffer_load_dwordx4 v169, s[16:19], s55 offen lds
    s_mul_i32 s55, s30, 163840
    s_add_u32 s55, s55, 0x1e300
    s_lshl_b32 s56, s32, 10
    s_add_u32 m0, s56, 0x24000
    s_nop 0
    buffer_load_dwordx4 v169, s[16:19], s55 offen lds
    s_mul_i32 s55, s30, 163840
    s_add_u32 s55, s55, 0x23300
    s_lshl_b32 s56, s32, 10
    s_add_u32 m0, s56, 0x25000
    s_nop 0
    buffer_load_dwordx4 v169, s[16:19], s55 offen lds
    s_waitcnt vmcnt(16)
    s_barrier
    v_add_u32 v172, 0x0, v174
    v_add_u32 v173, 0x0, v175
    ds_read_b64_tr_b16 a[160:161], v172 offset:0
    ds_read_b64_tr_b16 a[162:163], v172 offset:4096
    ds_read_b64_tr_b16 a[164:165], v172 offset:8192
    ds_read_b64_tr_b16 a[166:167], v172 offset:12288
    ds_read_b64_tr_b16 a[168:169], v172 offset:16384
    ds_read_b64_tr_b16 a[170:171], v172 offset:20480
    ds_read_b64_tr_b16 a[172:173], v172 offset:24576
    ds_read_b64_tr_b16 a[174:175], v172 offset:28672
    ds_read_b64_tr_b16 a[176:177], v173 offset:0
    ds_read_b64_tr_b16 a[178:179], v173 offset:4096
    ds_read_b64_tr_b16 a[180:181], v173 offset:8192
    ds_read_b64_tr_b16 a[182:183], v173 offset:12288
    ds_read_b64_tr_b16 a[184:185], v173 offset:16384
    ds_read_b64_tr_b16 a[186:187], v173 offset:20480
    ds_read_b64_tr_b16 a[188:189], v173 offset:24576
    ds_read_b64_tr_b16 a[190:191], v173 offset:28672
    s_waitcnt lgkmcnt(0)
    v_add_u32 v172, 0xa000, v174
    v_add_u32 v173, 0xa000, v175
    ds_read_b64_tr_b16 a[192:193], v172 offset:0
    ds_read_b64_tr_b16 a[194:195], v172 offset:4096
    ds_read_b64_tr_b16 a[196:197], v172 offset:8192
    ds_read_b64_tr_b16 a[198:199], v172 offset:12288
    ds_read_b64_tr_b16 a[200:201], v172 offset:16384
    ds_read_b64_tr_b16 a[202:203], v172 offset:20480
    ds_read_b64_tr_b16 a[204:205], v172 offset:24576
    ds_read_b64_tr_b16 a[206:207], v172 offset:28672
    ds_read_b64_tr_b16 a[208:209], v173 offset:0
    ds_read_b64_tr_b16 a[210:211], v173 offset:4096
    ds_read_b64_tr_b16 a[212:213], v173 offset:8192
    ds_read_b64_tr_b16 a[214:215], v173 offset:12288
    ds_read_b64_tr_b16 a[216:217], v173 offset:16384
    ds_read_b64_tr_b16 a[218:219], v173 offset:20480
    ds_read_b64_tr_b16 a[220:221], v173 offset:24576
    ds_read_b64_tr_b16 a[222:223], v173 offset:28672
    s_waitcnt lgkmcnt(0)
    s_barrier
    s_mul_i32 s55, s30, 163840
    s_add_u32 s55, s55, 0x400
    s_lshl_b32 s56, s32, 10
    s_add_u32 m0, s56, 0x0
    s_nop 0
    buffer_load_dwordx4 v169, s[16:19], s55 offen lds
    s_mul_i32 s55, s30, 163840
    s_add_u32 s55, s55, 0x5400
    s_lshl_b32 s56, s32, 10
    s_add_u32 m0, s56, 0x1000
    s_nop 0
    buffer_load_dwordx4 v169, s[16:19], s55 offen lds
    s_mul_i32 s55, s30, 163840
    s_add_u32 s55, s55, 0xa400
    s_lshl_b32 s56, s32, 10
    s_add_u32 m0, s56, 0x2000
    s_nop 0
    buffer_load_dwordx4 v169, s[16:19], s55 offen lds
    s_mul_i32 s55, s30, 163840
    s_add_u32 s55, s55, 0xf400
    s_lshl_b32 s56, s32, 10
    s_add_u32 m0, s56, 0x3000
    s_nop 0
    buffer_load_dwordx4 v169, s[16:19], s55 offen lds
    s_mul_i32 s55, s30, 163840
    s_add_u32 s55, s55, 0x14400
    s_lshl_b32 s56, s32, 10
    s_add_u32 m0, s56, 0x4000
    s_nop 0
    buffer_load_dwordx4 v169, s[16:19], s55 offen lds
    s_mul_i32 s55, s30, 163840
    s_add_u32 s55, s55, 0x19400
    s_lshl_b32 s56, s32, 10
    s_add_u32 m0, s56, 0x5000
    s_nop 0
    buffer_load_dwordx4 v169, s[16:19], s55 offen lds
    s_mul_i32 s55, s30, 163840
    s_add_u32 s55, s55, 0x1e400
    s_lshl_b32 s56, s32, 10
    s_add_u32 m0, s56, 0x6000
    s_nop 0
    buffer_load_dwordx4 v169, s[16:19], s55 offen lds
    s_mul_i32 s55, s30, 163840
    s_add_u32 s55, s55, 0x23400
    s_lshl_b32 s56, s32, 10
    s_add_u32 m0, s56, 0x7000
    s_nop 0
    buffer_load_dwordx4 v169, s[16:19], s55 offen lds
    s_waitcnt vmcnt(8)
    s_barrier
    v_add_u32 v172, 0x14000, v174
    v_add_u32 v173, 0x14000, v175
    ds_read_b64_tr_b16 a[224:225], v172 offset:0
    ds_read_b64_tr_b16 a[226:227], v172 offset:4096
    ds_read_b64_tr_b16 a[228:229], v172 offset:8192
    ds_read_b64_tr_b16 a[230:231], v172 offset:12288
    ds_read_b64_tr_b16 a[232:233], v172 offset:16384
    ds_read_b64_tr_b16 a[234:235], v172 offset:20480
    ds_read_b64_tr_b16 a[236:237], v172 offset:24576
    ds_read_b64_tr_b16 a[238:239], v172 offset:28672
    ds_read_b64_tr_b16 a[240:241], v173 offset:0
    ds_read_b64_tr_b16 a[242:243], v173 offset:4096
    ds_read_b64_tr_b16 a[244:245], v173 offset:8192
    ds_read_b64_tr_b16 a[246:247], v173 offset:12288
    ds_read_b64_tr_b16 a[248:249], v173 offset:16384
    ds_read_b64_tr_b16 a[250:251], v173 offset:20480
    ds_read_b64_tr_b16 a[252:253], v173 offset:24576
    ds_read_b64_tr_b16 a[254:255], v173 offset:28672
    s_waitcnt lgkmcnt(0)
    v_add_u32 v172, 0x1e000, v174
    v_add_u32 v173, 0x1e000, v175
    ds_read_b64_tr_b16 v[192:193], v172 offset:0
    ds_read_b64_tr_b16 v[194:195], v172 offset:4096
    ds_read_b64_tr_b16 v[196:197], v172 offset:8192
    ds_read_b64_tr_b16 v[198:199], v172 offset:12288
    ds_read_b64_tr_b16 v[200:201], v172 offset:16384
    ds_read_b64_tr_b16 v[202:203], v172 offset:20480
    ds_read_b64_tr_b16 v[204:205], v172 offset:24576
    ds_read_b64_tr_b16 v[206:207], v172 offset:28672
    ds_read_b64_tr_b16 v[208:209], v173 offset:0
    ds_read_b64_tr_b16 v[210:211], v173 offset:4096
    ds_read_b64_tr_b16 v[212:213], v173 offset:8192
    ds_read_b64_tr_b16 v[214:215], v173 offset:12288
    ds_read_b64_tr_b16 v[216:217], v173 offset:16384
    ds_read_b64_tr_b16 v[218:219], v173 offset:20480
    ds_read_b64_tr_b16 v[220:221], v173 offset:24576
    ds_read_b64_tr_b16 v[222:223], v173 offset:28672
    s_waitcnt lgkmcnt(0)
    s_barrier
    s_waitcnt vmcnt(0)
    s_barrier
    v_add_u32 v172, 0x0, v174
    v_add_u32 v173, 0x0, v175
    ds_read_b64_tr_b16 v[224:225], v172 offset:0
    ds_read_b64_tr_b16 v[226:227], v172 offset:4096
    ds_read_b64_tr_b16 v[228:229], v172 offset:8192
    ds_read_b64_tr_b16 v[230:231], v172 offset:12288
    ds_read_b64_tr_b16 v[232:233], v172 offset:16384
    ds_read_b64_tr_b16 v[234:235], v172 offset:20480
    ds_read_b64_tr_b16 v[236:237], v172 offset:24576
    ds_read_b64_tr_b16 v[238:239], v172 offset:28672
    ds_read_b64_tr_b16 v[240:241], v173 offset:0
    ds_read_b64_tr_b16 v[242:243], v173 offset:4096
    ds_read_b64_tr_b16 v[244:245], v173 offset:8192
    ds_read_b64_tr_b16 v[246:247], v173 offset:12288
    ds_read_b64_tr_b16 v[248:249], v173 offset:16384
    ds_read_b64_tr_b16 v[250:251], v173 offset:20480
    ds_read_b64_tr_b16 v[252:253], v173 offset:24576
    ds_read_b64_tr_b16 v[254:255], v173 offset:28672
    s_waitcnt lgkmcnt(0)
    s_barrier
    s_cmp_eq_u32 s32, 0
    s_cbranch_scc0 HBfsb2_69
    v_mov_b32 v169, 36
    s_mov_b32 s58, 0x100000
HBfsbl_70:
    buffer_load_dword v170, v169, s[20:23], 0 offen sc1
    s_waitcnt vmcnt(0)
    v_cmp_gt_u32 vcc, 64, v170
    s_cbranch_vccz HBfsbd_71
    s_sub_u32 s58, s58, 1
    s_cbranch_scc0 HBfsbl_70
HBfsbd_71:
HBfsb2_69:
    s_mov_b32 s58, 0x400000
    s_mov_b32 s33, 0x0
    s_lshl_b32 s54, s28, 4
    v_and_b32 v31, 1, v3
    v_add_u32 v30, s54, v2
    v_mov_b32 v168, s30
    v_cmp_gt_u32 vcc, 2, v3
    s_nop 1
    v_cndmask_b32 v30, v168, v30, vcc
    v_mov_b32 v168, 0
    v_mov_b32 v169, 64
    v_cndmask_b32 v168, v168, v169, vcc
    v_add_u32 v30, v30, v168
    v_lshl_add_u32 v30, v31, 5, v30
    v_lshlrev_b32 v30, 2, v30
    v_add_u32 v30, 0xa600000, v30
    s_mov_b32 s74, 0x0
    s_lshl_b32 s75, s30, 2
    s_add_u32 s75, s75, 0xa600200
    s_mov_b32 s55, 0x34
    s_cmp_eq_u32 s32, 0
    s_cbranch_scc0 CZww_72
    s_mov_b32 s54, 0x1
    v_min_u32 v168, 0, v1
    v_mul_u32_u24 v168, 4, v168
    s_mov_b32 s43, 0x40000
CZwl_73:
    buffer_load_dword v169, v168, s[20:23], s55 offen sc1
    s_waitcnt vmcnt(0)
    v_cmp_gt_u32 vcc, 128, v169
    s_nop 1
    v_cndmask_b32 v169, 0, v169, vcc
    v_cmp_gt_u32 vcc, s54, v169
    s_cbranch_vccz CZwd_74
    s_sleep 1
    s_sub_u32 s43, s43, 1
    s_cbranch_scc0 CZwl_73
CZwd_74:
CZww_72:
    s_barrier
    s_mov_b32 s33, 0x0
    s_cmp_lt_u32 s33, s74
    s_cbranch_scc1 rdy_75
rdl_76:
    s_and_b32 s54, s33, 1
    buffer_load_dword v188, v30, s[8:11], 0 offen sc1
    s_waitcnt vmcnt(0)
    v_cmp_lt_u32 vcc, 127, v188
    s_nop 1
    v_cmp_gt_u32 vcc, 128, v188
    s_nop 1
    v_cndmask_b32 v188, 0, v188, vcc
    v_max_u32 v188, v188, v31
    s_nop 1
    v_min_u32_dpp v188, v188, v188 row_ror:1 row_mask:0xf bank_mask:0xf
    s_nop 1
    v_min_u32_dpp v188, v188, v188 row_ror:2 row_mask:0xf bank_mask:0xf
    s_nop 1
    v_min_u32_dpp v188, v188, v188 row_ror:4 row_mask:0xf bank_mask:0xf
    s_nop 1
    v_min_u32_dpp v188, v188, v188 row_ror:8 row_mask:0xf bank_mask:0xf
    s_nop 1
    v_readlane_b32 s54, v188, 0
    v_readlane_b32 s55, v188, 16
    v_readlane_b32 s56, v188, 32
    v_readlane_b32 s74, v188, 48
    s_nop 3
    s_min_u32 s54, s54, s55
    s_min_u32 s56, s56, s74
    s_min_u32 s74, s54, s56
    s_cmp_lt_u32 s33, s74
    s_cbranch_scc1 rdy_75
    s_sleep 1
    s_sub_u32 s58, s58, 1
    s_cbranch_scc0 rdl_76
    s_mov_b32 s58, 0
    s_mov_b32 s74, 0x40
rdy_75:
    v_and_b32 v168, 7, v2
    v_mul_u32_u24 v168, 1280, v168
    v_lshl_add_u32 v168, v3, 4, v168
    v_lshrrev_b32 v169, 3, v2
    v_lshl_add_u32 v168, v169, 6, v168
    s_and_b32 s56, s32, 1
    s_mul_i32 s56, s56, 640
    s_lshr_b32 s55, s32, 1
    s_lshl_b32 s55, s55, 28
    s_add_u32 s56, s56, s55
    v_add_u32 v168, s56, v168
    buffer_load_dwordx4 v[32:35], v168, s[24:27], 0 offen offset:0
    buffer_load_dwordx4 v[36:39], v168, s[24:27], 0 offen offset:128
    buffer_load_dwordx4 v[40:43], v168, s[24:27], 0 offen offset:256
    buffer_load_dwordx4 v[44:47], v168, s[24:27], 0 offen offset:384
    buffer_load_dwordx4 v[48:51], v168, s[24:27], 0 offen offset:512
    s_mov_b32 s39, 0x0
    s_mov_b32 s40, 0x2000000
    s_mul_i32 s74, s28, -10240
    s_mul_i32 s57, s28, -10240
    s_sub_u32 s57, s57, 10240
    s_add_u32 s72, s57, 0x90ae000
    v_mov_b32 v176, 0
    v_mov_b32 v177, 0
    v_mov_b32 v178, 0
    v_mov_b32 v179, 0
    v_mov_b32 v180, 0
    v_mov_b32 v181, 0
    v_mov_b32 v182, 0
    v_mov_b32 v183, 0
    v_mov_b32 v184, 0
    v_mov_b32 v185, 0
    v_mov_b32 v186, 0
    v_mov_b32 v187, 0
    s_waitcnt vmcnt(0)
    ds_write_b128 v5, v[32:35] offset:0
    ds_write_b128 v5, v[36:39] offset:2048
    ds_write_b128 v5, v[40:43] offset:4096
    ds_write_b128 v5, v[44:47] offset:6144
    ds_write_b128 v5, v[48:51] offset:8192
    s_mov_b32 s34, 0x8c00000
    s_mov_b32 s35, 0x8c5f000
    s_mov_b32 s36, 0x8cbe000
    s_mov_b32 s37, 0x8d1d000
    s_waitcnt lgkmcnt(0)
    s_barrier
HBf_loop:
    ds_read_b128 v[32:35], v6 offset:0
    ds_read_b128 v[36:39], v6 offset:1024
    ds_read_b128 v[40:43], v6 offset:2048
    ds_read_b128 v[44:47], v6 offset:3072
    ds_read_b128 v[48:51], v6 offset:4096
    ds_read_b128 v[52:55], v6 offset:5120
    ds_read_b128 v[56:59], v6 offset:6144
    s_waitcnt lgkmcnt(6)
    v_mfma_f32_16x16x32_bf16 v[112:115], a[0:3], v[32:35], 0
    v_mfma_f32_16x16x32_bf16 v[116:119], a[80:83], v[32:35], 0
    ds_read_b128 v[60:63], v6 offset:7168
    s_waitcnt lgkmcnt(6)
    v_mfma_f32_16x16x32_bf16 v[112:115], a[4:7], v[36:39], v[112:115]
    v_mfma_f32_16x16x32_bf16 v[116:119], a[84:87], v[36:39], v[116:119]
    s_add_u32 s56, s40, 0
    buffer_load_dwordx4 v[128:131], v12, s[8:11], s56 offen sc1
    ds_read_b128 v[64:67], v6 offset:8192
    s_waitcnt lgkmcnt(6)
    v_mfma_f32_16x16x32_bf16 v[112:115], a[8:11], v[40:43], v[112:115]
    v_mfma_f32_16x16x32_bf16 v[116:119], a[88:91], v[40:43], v[116:119]
    ds_read_b128 v[68:71], v6 offset:9216
    s_waitcnt lgkmcnt(6)
    v_mfma_f32_16x16x32_bf16 v[112:115], a[12:15], v[44:47], v[112:115]
    v_mfma_f32_16x16x32_bf16 v[116:119], a[92:95], v[44:47], v[116:119]
    s_add_u32 s56, s40, 0
    buffer_load_dwordx4 v[132:135], v13, s[8:11], s56 offen sc1
    ds_read_b128 v[72:75], v6 offset:10240
    s_waitcnt lgkmcnt(6)
    v_mfma_f32_16x16x32_bf16 v[112:115], a[16:19], v[48:51], v[112:115]
    v_mfma_f32_16x16x32_bf16 v[116:119], a[96:99], v[48:51], v[116:119]
    ds_read_b128 v[76:79], v6 offset:11264
    s_waitcnt lgkmcnt(6)
    v_mfma_f32_16x16x32_bf16 v[112:115], a[20:23], v[52:55], v[112:115]
    v_mfma_f32_16x16x32_bf16 v[116:119], a[100:103], v[52:55], v[116:119]
    s_add_u32 s56, s40, 40960
    buffer_load_dwordx4 v[136:139], v12, s[8:11], s56 offen sc1
    ds_read_b128 v[80:83], v6 offset:12288
    s_waitcnt lgkmcnt(6)
    v_mfma_f32_16x16x32_bf16 v[112:115], a[24:27], v[56:59], v[112:115]
    v_mfma_f32_16x16x32_bf16 v[116:119], a[104:107], v[56:59], v[116:119]
    ds_read_b128 v[84:87], v6 offset:13312
    s_waitcnt lgkmcnt(6)
    v_mfma_f32_16x16x32_bf16 v[112:115], a[28:31], v[60:63], v[112:115]
    v_mfma_f32_16x16x32_bf16 v[116:119], a[108:111], v[60:63], v[116:119]
    s_add_u32 s56, s40, 40960
    buffer_load_dwordx4 v[140:143], v13, s[8:11], s56 offen sc1
    ds_read_b128 v[88:91], v6 offset:14336
    s_waitcnt lgkmcnt(6)
    v_mfma_f32_16x16x32_bf16 v[112:115], a[32:35], v[64:67], v[112:115]
    v_mfma_f32_16x16x32_bf16 v[116:119], a[112:115], v[64:67], v[116:119]
    ds_read_b128 v[92:95], v6 offset:15360
    s_waitcnt lgkmcnt(6)
    v_mfma_f32_16x16x32_bf16 v[112:115], a[36:39], v[68:71], v[112:115]
    v_mfma_f32_16x16x32_bf16 v[116:119], a[116:119], v[68:71], v[116:119]
    s_add_u32 s56, s40, 81920
    buffer_load_dwordx4 v[144:147], v12, s[8:11], s56 offen sc1
    ds_read_b128 v[96:99], v6 offset:16384
    s_waitcnt lgkmcnt(6)
    v_mfma_f32_16x16x32_bf16 v[112:115], a[40:43], v[72:75], v[112:115]
    v_mfma_f32_16x16x32_bf16 v[116:119], a[120:123], v[72:75], v[116:119]
    ds_read_b128 v[100:103], v6 offset:17408
    s_waitcnt lgkmcnt(6)
    v_mfma_f32_16x16x32_bf16 v[112:115], a[44:47], v[76:79], v[112:115]
    v_mfma_f32_16x16x32_bf16 v[116:119], a[124:127], v[76:79], v[116:119]
    s_add_u32 s56, s40, 81920
    buffer_load_dwordx4 v[148:151], v13, s[8:11], s56 offen sc1
    ds_read_b128 v[104:107], v6 offset:18432
    s_waitcnt lgkmcnt(6)
    v_mfma_f32_16x16x32_bf16 v[112:115], a[48:51], v[80:83], v[112:115]
    v_mfma_f32_16x16x32_bf16 v[116:119], a[128:131], v[80:83], v[116:119]
    ds_read_b128 v[108:111], v6 offset:19456
    s_waitcnt lgkmcnt(6)
    v_mfma_f32_16x16x32_bf16 v[112:115], a[52:55], v[84:87], v[112:115]
    v_mfma_f32_16x16x32_bf16 v[116:119], a[132:135], v[84:87], v[116:119]
    s_add_u32 s56, s40, 122880
    buffer_load_dwordx4 v[152:155], v12, s[8:11], s56 offen sc1
    s_waitcnt lgkmcnt(5)
    v_mfma_f32_16x16x32_bf16 v[112:115], a[56:59], v[88:91], v[112:115]
    v_mfma_f32_16x16x32_bf16 v[116:119], a[136:139], v[88:91], v[116:119]
    s_waitcnt lgkmcnt(4)
    v_mfma_f32_16x16x32_bf16 v[112:115], a[60:63], v[92:95], v[112:115]
    v_mfma_f32_16x16x32_bf16 v[116:119], a[140:143], v[92:95], v[116:119]
    s_add_u32 s56, s40, 122880
    buffer_load_dwordx4 v[156:159], v13, s[8:11], s56 offen sc1
    s_waitcnt lgkmcnt(3)
    v_mfma_f32_16x16x32_bf16 v[112:115], a[64:67], v[96:99], v[112:115]
    v_mfma_f32_16x16x32_bf16 v[116:119], a[144:147], v[96:99], v[116:119]
    s_waitcnt lgkmcnt(2)
    v_mfma_f32_16x16x32_bf16 v[112:115], a[68:71], v[100:103], v[112:115]
    v_mfma_f32_16x16x32_bf16 v[116:119], a[148:151], v[100:103], v[116:119]
    s_add_u32 s56, s40, 0
    buffer_load_dwordx4 v[160:163], v14, s[8:11], s56 offen sc1
    s_waitcnt lgkmcnt(1)
    v_mfma_f32_16x16x32_bf16 v[112:115], a[72:75], v[104:107], v[112:115]
    v_mfma_f32_16x16x32_bf16 v[116:119], a[152:155], v[104:107], v[116:119]
    s_waitcnt lgkmcnt(0)
    v_mfma_f32_16x16x32_bf16 v[112:115], a[76:79], v[108:111], v[112:115]
    v_mfma_f32_16x16x32_bf16 v[116:119], a[156:159], v[108:111], v[116:119]
    s_add_u32 s56, s40, 81920
    buffer_load_dwordx4 v[164:167], v14, s[8:11], s56 offen sc1
    s_nop 7
    v_add_f32_dpp v112, v112, v112 row_ror:8 row_mask:0xf bank_mask:0xf
    v_add_f32_dpp v113, v113, v113 row_ror:8 row_mask:0xf bank_mask:0xf
    v_add_f32_dpp v114, v114, v114 row_ror:8 row_mask:0xf bank_mask:0xf
    v_add_f32_dpp v115, v115, v115 row_ror:8 row_mask:0xf bank_mask:0xf
    v_add_f32_dpp v116, v116, v116 row_ror:8 row_mask:0xf bank_mask:0xf
    v_add_f32_dpp v117, v117, v117 row_ror:8 row_mask:0xf bank_mask:0xf
    v_add_f32_dpp v118, v118, v118 row_ror:8 row_mask:0xf bank_mask:0xf
    v_add_f32_dpp v119, v119, v119 row_ror:8 row_mask:0xf bank_mask:0xf
    v_cvt_pk_bf16_f32 v168, v112, v113
    v_cvt_pk_bf16_f32 v169, v114, v115
    v_cvt_pk_bf16_f32 v170, v116, v117
    v_cvt_pk_bf16_f32 v171, v118, v119
    ds_write_b128 v15, v[168:171]
    s_waitcnt lgkmcnt(0)
    s_barrier
    ds_read_b128 v[32:35], v6 offset:20480
    ds_read_b128 v[36:39], v6 offset:23552
    ds_read_b128 v[40:43], v6 offset:26624
    ds_read_b128 v[44:47], v6 offset:29696
    s_waitcnt lgkmcnt(0)
    v_mfma_f32_16x16x32_bf16 v[48:51], v[32:35], a[160:163], 0
    v_mfma_f32_16x16x32_bf16 v[52:55], v[32:35], a[176:179], 0
    v_mfma_f32_16x16x32_bf16 v[48:51], v[36:39], a[164:167], v[48:51]
    v_mfma_f32_16x16x32_bf16 v[52:55], v[36:39], a[180:183], v[52:55]
    v_mfma_f32_16x16x32_bf16 v[48:51], v[40:43], a[168:171], v[48:51]
    v_mfma_f32_16x16x32_bf16 v[52:55], v[40:43], a[184:187], v[52:55]
    v_mfma_f32_16x16x32_bf16 v[48:51], v[44:47], a[172:175], v[48:51]
    v_mfma_f32_16x16x32_bf16 v[52:55], v[44:47], a[188:191], v[52:55]
    v_mfma_f32_16x16x32_bf16 v[56:59], v[32:35], a[192:195], 0
    v_mfma_f32_16x16x32_bf16 v[60:63], v[32:35], a[208:211], 0
    v_mfma_f32_16x16x32_bf16 v[56:59], v[36:39], a[196:199], v[56:59]
    v_mfma_f32_16x16x32_bf16 v[60:63], v[36:39], a[212:215], v[60:63]
    v_mfma_f32_16x16x32_bf16 v[56:59], v[40:43], a[200:203], v[56:59]
    v_mfma_f32_16x16x32_bf16 v[60:63], v[40:43], a[216:219], v[60:63]
    v_mfma_f32_16x16x32_bf16 v[56:59], v[44:47], a[204:207], v[56:59]
    v_cvt_pk_bf16_f32 v112, v48, v49
    v_cvt_pk_bf16_f32 v113, v50, v51
    v_mfma_f32_16x16x32_bf16 v[60:63], v[44:47], a[220:223], v[60:63]
    v_cvt_pk_bf16_f32 v114, v52, v53
    v_cvt_pk_bf16_f32 v115, v54, v55
    v_cndmask_b32 v100, v114, v112, s[52:53]
    v_cndmask_b32 v101, v115, v113, s[52:53]
    s_add_u32 s56, s34, 0
    buffer_store_dwordx2 v[100:101], v26, s[8:11], s56 offen
    v_mfma_f32_16x16x32_bf16 v[64:67], v[32:35], a[224:227], 0
    v_mfma_f32_16x16x32_bf16 v[68:71], v[32:35], a[240:243], 0
    v_mfma_f32_16x16x32_bf16 v[64:67], v[36:39], a[228:231], v[64:67]
    v_mfma_f32_16x16x32_bf16 v[68:71], v[36:39], a[244:247], v[68:71]
    v_mfma_f32_16x16x32_bf16 v[64:67], v[40:43], a[232:235], v[64:67]
    v_mfma_f32_16x16x32_bf16 v[68:71], v[40:43], a[248:251], v[68:71]
    v_mfma_f32_16x16x32_bf16 v[64:67], v[44:47], a[236:239], v[64:67]
    v_cvt_pk_bf16_f32 v112, v56, v57
    v_cvt_pk_bf16_f32 v113, v58, v59
    v_mfma_f32_16x16x32_bf16 v[68:71], v[44:47], a[252:255], v[68:71]
    v_cvt_pk_bf16_f32 v114, v60, v61
    v_cvt_pk_bf16_f32 v115, v62, v63
    v_cndmask_b32 v102, v114, v112, s[52:53]
    v_cndmask_b32 v103, v115, v113, s[52:53]
    s_add_u32 s56, s34, 2048
    buffer_store_dwordx2 v[102:103], v26, s[8:11], s56 offen
    v_mfma_f32_16x16x32_bf16 v[72:75], v[32:35], v[192:195], 0
    v_mfma_f32_16x16x32_bf16 v[76:79], v[32:35], v[208:211], 0
    v_mfma_f32_16x16x32_bf16 v[72:75], v[36:39], v[196:199], v[72:75]
    v_mfma_f32_16x16x32_bf16 v[76:79], v[36:39], v[212:215], v[76:79]
    v_mfma_f32_16x16x32_bf16 v[72:75], v[40:43], v[200:203], v[72:75]
    v_mfma_f32_16x16x32_bf16 v[76:79], v[40:43], v[216:219], v[76:79]
    v_mfma_f32_16x16x32_bf16 v[72:75], v[44:47], v[204:207], v[72:75]
    v_cvt_pk_bf16_f32 v112, v64, v65
    v_cvt_pk_bf16_f32 v113, v66, v67
    v_mfma_f32_16x16x32_bf16 v[76:79], v[44:47], v[220:223], v[76:79]
    v_cvt_pk_bf16_f32 v114, v68, v69
    v_cvt_pk_bf16_f32 v115, v70, v71
    v_cndmask_b32 v104, v114, v112, s[52:53]
    v_cndmask_b32 v105, v115, v113, s[52:53]
    s_add_u32 s56, s34, 4096
    buffer_store_dwordx2 v[104:105], v26, s[8:11], s56 offen
    v_mfma_f32_16x16x32_bf16 v[80:83], v[32:35], v[224:227], 0
    v_mfma_f32_16x16x32_bf16 v[84:87], v[32:35], v[240:243], 0
    v_mfma_f32_16x16x32_bf16 v[80:83], v[36:39], v[228:231], v[80:83]
    v_mfma_f32_16x16x32_bf16 v[84:87], v[36:39], v[244:247], v[84:87]
    v_mfma_f32_16x16x32_bf16 v[80:83], v[40:43], v[232:235], v[80:83]
    v_mfma_f32_16x16x32_bf16 v[84:87], v[40:43], v[248:251], v[84:87]
    v_mfma_f32_16x16x32_bf16 v[80:83], v[44:47], v[236:239], v[80:83]
    v_cvt_pk_bf16_f32 v112, v72, v73
    v_cvt_pk_bf16_f32 v113, v74, v75
    v_mfma_f32_16x16x32_bf16 v[84:87], v[44:47], v[252:255], v[84:87]
    v_cvt_pk_bf16_f32 v114, v76, v77
    v_cvt_pk_bf16_f32 v115, v78, v79
    v_cndmask_b32 v106, v114, v112, s[52:53]
    v_cndmask_b32 v107, v115, v113, s[52:53]
    s_add_u32 s56, s34, 6144
    buffer_store_dwordx2 v[106:107], v26, s[8:11], s56 offen
    s_nop 7
    v_cvt_pk_bf16_f32 v112, v80, v81
    v_cvt_pk_bf16_f32 v113, v82, v83
    v_cvt_pk_bf16_f32 v114, v84, v85
    v_cvt_pk_bf16_f32 v115, v86, v87
    v_cndmask_b32 v108, v114, v112, s[52:53]
    v_cndmask_b32 v109, v115, v113, s[52:53]
    s_add_u32 s56, s34, 8192
    buffer_store_dwordx2 v[108:109], v26, s[8:11], s56 offen
    s_cmp_eq_u32 s33, 63
    s_cbranch_scc1 HBf_last
HBfsp_77:
    buffer_load_dwordx4 v[176:179], v9, s[8:11], s34 offen sc1
    buffer_load_dwordx4 v[180:183], v10, s[8:11], s34 offen sc1
    buffer_load_dwordx4 v[184:187], v11, s[8:11], s34 offen sc1
    buffer_load_dwordx4 v[96:99], v8, s[8:11], s34 offen sc1
    buffer_load_dwordx4 v[88:91], v7, s[8:11], s34 offen sc1
    buffer_load_dwordx4 v[92:95], v7, s[8:11], s34 offen offset:1024 sc1
    s_waitcnt vmcnt(0)
    v_max3_u32 v188, v88, v89, v90
    v_max3_u32 v188, v188, v91, v92
    v_max3_u32 v188, v188, v93, v94
    v_max3_u32 v188, v188, v95, v96
    v_max3_u32 v188, v188, v97, v98
    v_max3_u32 v188, v188, v99, v176
    v_max3_u32 v188, v188, v177, v178
    v_max3_u32 v188, v188, v179, v180
    v_max3_u32 v188, v188, v181, v182
    v_max3_u32 v188, v188, v183, v184
    v_max3_u32 v188, v188, v185, v186
    v_max_u32 v188, v188, v187
    v_cmp_eq_u32 vcc, -1, v188
    s_cbranch_vccz HBfsd_78
    s_sub_u32 s58, s58, 1
    s_cbranch_scc0 HBfsp_77
    s_mov_b32 s58, 0
HBfsd_78:
    v_mfma_f32_16x16x32_bf16 v[52:55], v[184:187], v[96:99], 0
    v_mfma_f32_16x16x32_bf16 v[32:35], v[176:179], v[96:99], 0
    v_mfma_f32_16x16x32_bf16 v[36:39], v[136:139], v[88:91], 0
    v_mfma_f32_16x16x32_bf16 v[40:43], v[180:183], v[96:99], 0
    v_mfma_f32_16x16x32_bf16 v[44:47], v[140:143], v[88:91], 0
    v_mfma_f32_16x16x32_bf16 v[48:51], v[160:163], v[88:91], 0
    v_mfma_f32_16x16x32_bf16 v[32:35], v[128:131], v[88:91], v[32:35]
    v_mfma_f32_16x16x32_bf16 v[36:39], v[152:155], v[92:95], v[36:39]
    v_mfma_f32_16x16x32_bf16 v[40:43], v[132:135], v[88:91], v[40:43]
    v_mfma_f32_16x16x32_bf16 v[44:47], v[156:159], v[92:95], v[44:47]
    v_mfma_f32_16x16x32_bf16 v[48:51], v[164:167], v[92:95], v[48:51]
    v_mfma_f32_16x16x32_bf16 v[32:35], v[144:147], v[92:95], v[32:35]
    v_mfma_f32_16x16x32_bf16 v[40:43], v[148:151], v[92:95], v[40:43]
    s_nop 3
    v_cndmask_b32 v52, 0, v52, s[52:53]
    v_cndmask_b32 v53, 0, v53, s[52:53]
    v_cndmask_b32 v54, 0, v54, s[52:53]
    v_cndmask_b32 v55, 0, v55, s[52:53]
    v_pk_add_f32 v[48:49], v[48:49], v[52:53]
    v_pk_add_f32 v[50:51], v[50:51], v[54:55]
    ds_write_b128 v18, v[48:51] offset:2048
    v_add_f32_dpp v32, v36, v32 row_ror:8 row_mask:0xf bank_mask:0xf
    v_add_f32_dpp v33, v37, v33 row_ror:8 row_mask:0xf bank_mask:0xf
    v_add_f32_dpp v34, v38, v34 row_ror:8 row_mask:0xf bank_mask:0xf
    v_add_f32_dpp v35, v39, v35 row_ror:8 row_mask:0xf bank_mask:0xf
    ds_write_b128 v18, v[32:35] offset:0
    v_add_f32_dpp v40, v44, v40 row_ror:8 row_mask:0xf bank_mask:0xf
    v_add_f32_dpp v41, v45, v41 row_ror:8 row_mask:0xf bank_mask:0xf
    v_add_f32_dpp v42, v46, v42 row_ror:8 row_mask:0xf bank_mask:0xf
    v_add_f32_dpp v43, v47, v43 row_ror:8 row_mask:0xf bank_mask:0xf
    ds_write_b128 v18, v[40:43] offset:1024
    s_waitcnt lgkmcnt(0)
    s_barrier
    s_mov_b64 exec, s[50:51]
    s_cbranch_execz HBfmp_79
    ds_read_b128 v[56:59], v19 offset:0
    ds_read_b128 v[60:63], v19 offset:3072
    ds_read_b128 v[64:67], v19 offset:6144
    ds_read_b128 v[68:71], v19 offset:9216
    s_cmp_eq_u32 s32, 2
    s_cbranch_scc0 HBfw2d_80
    ds_read_b128 v[72:75], v19 offset:640
    ds_read_b128 v[76:79], v19 offset:3712
    ds_read_b128 v[80:83], v19 offset:6784
    ds_read_b128 v[84:87], v19 offset:9856
    s_waitcnt lgkmcnt(0)
    v_pk_add_f32 v[56:57], v[56:57], v[72:73]
    v_pk_add_f32 v[58:59], v[58:59], v[74:75]
    v_pk_add_f32 v[60:61], v[60:61], v[76:77]
    v_pk_add_f32 v[62:63], v[62:63], v[78:79]
    v_pk_add_f32 v[64:65], v[64:65], v[80:81]
    v_pk_add_f32 v[66:67], v[66:67], v[82:83]
    v_pk_add_f32 v[68:69], v[68:69], v[84:85]
    v_pk_add_f32 v[70:71], v[70:71], v[86:87]
HBfw2d_80:
    s_waitcnt lgkmcnt(0)
    v_pk_add_f32 v[56:57], v[56:57], v[60:61]
    v_pk_add_f32 v[58:59], v[58:59], v[62:63]
    v_pk_add_f32 v[64:65], v[64:65], v[68:69]
    v_pk_add_f32 v[66:67], v[66:67], v[70:71]
    v_pk_add_f32 v[56:57], v[56:57], v[64:65]
    v_pk_add_f32 v[58:59], v[58:59], v[66:67]
    v_cvt_pk_bf16_f32 v72, v56, v57
    v_cvt_pk_bf16_f32 v73, v58, v59
    buffer_store_dwordx2 v[72:73], v20, s[8:11], s35 offen
    buffer_store_dwordx2 v[72:73], v21, s[8:11], s35 offen sc1
HBfmp_79:
    s_mov_b64 exec, -1
    s_mul_i32 s72, s33, 327680
    s_add_u32 s72, s72, 0x7000000
    s_add_u32 s72, s72, s57
    s_add_u32 s39, s39, 262144
    s_add_u32 s40, s40, 1310720
    s_add_u32 s33, s33, 1
    s_cmp_lt_u32 s33, s74
    s_cbranch_scc1 rdy_81
rdl_82:
    s_and_b32 s54, s33, 1
    buffer_load_dword v188, v30, s[8:11], 0 offen sc1
    s_waitcnt vmcnt(0)
    v_cmp_lt_u32 vcc, 127, v188
    s_nop 1
    v_cmp_gt_u32 vcc, 128, v188
    s_nop 1
    v_cndmask_b32 v188, 0, v188, vcc
    v_max_u32 v188, v188, v31
    s_nop 1
    v_min_u32_dpp v188, v188, v188 row_ror:1 row_mask:0xf bank_mask:0xf
    s_nop 1
    v_min_u32_dpp v188, v188, v188 row_ror:2 row_mask:0xf bank_mask:0xf
    s_nop 1
    v_min_u32_dpp v188, v188, v188 row_ror:4 row_mask:0xf bank_mask:0xf
    s_nop 1
    v_min_u32_dpp v188, v188, v188 row_ror:8 row_mask:0xf bank_mask:0xf
    s_nop 1
    v_readlane_b32 s54, v188, 0
    v_readlane_b32 s55, v188, 16
    v_readlane_b32 s56, v188, 32
    v_readlane_b32 s74, v188, 48
    s_nop 3
    s_min_u32 s54, s54, s55
    s_min_u32 s56, s56, s74
    s_min_u32 s74, s54, s56
    s_cmp_lt_u32 s33, s74
    s_cbranch_scc1 rdy_81
    s_sleep 1
    s_sub_u32 s58, s58, 1
    s_cbranch_scc0 rdl_82
    s_mov_b32 s58, 0
    s_mov_b32 s74, 0x40
rdy_81:
    s_cmp_lt_u32 s32, 2
    s_cbranch_scc1 HBfrem_84
HBfsp_85:
    s_add_u32 s55, s35, 4096
    buffer_load_dwordx4 v[52:55], v4, s[8:11], s35 offen offset:0 sc1
    buffer_load_dwordx4 v[56:59], v4, s[8:11], s35 offen offset:1024 sc1
    buffer_load_dwordx4 v[60:63], v4, s[8:11], s35 offen offset:2048 sc1
    buffer_load_dwordx4 v[64:67], v4, s[8:11], s35 offen offset:3072 sc1
    buffer_load_dwordx4 v[68:71], v4, s[8:11], s55 offen sc1
    s_waitcnt vmcnt(0)
    v_max3_u32 v188, v52, v53, v54
    v_max3_u32 v188, v188, v55, v56
    v_max3_u32 v188, v188, v57, v58
    v_max3_u32 v188, v188, v59, v60
    v_max3_u32 v188, v188, v61, v62
    v_max3_u32 v188, v188, v63, v64
    v_max3_u32 v188, v188, v65, v66
    v_max3_u32 v188, v188, v67, v68
    v_max3_u32 v188, v188, v69, v70
    v_max_u32 v188, v188, v71
    v_cmp_eq_u32 vcc, -1, v188
    s_cbranch_vccz HBfsd_86
    s_sub_u32 s58, s58, 1
    s_cbranch_scc0 HBfsp_85
    s_mov_b32 s58, 0
HBfsd_86:
    s_branch HBfjn_83
HBfrem_84:
HBfsp_87:
    buffer_load_dwordx4 v[32:35], v27, s[8:11], s35 offen sc1
    s_waitcnt vmcnt(0)
    v_max3_u32 v188, v32, v33, v34
    v_max_u32 v188, v188, v35
    v_cmp_eq_u32 vcc, -1, v188
    s_cbranch_vccz HBfsd_88
    s_sub_u32 s58, s58, 1
    s_cbranch_scc0 HBfsp_87
    s_mov_b32 s58, 0
HBfsd_88:
    s_add_u32 s55, s35, 4096
    buffer_load_dwordx4 v[52:55], v4, s[8:11], s35 offen offset:0 sc1
    buffer_load_dwordx4 v[56:59], v4, s[8:11], s35 offen offset:1024 sc1
    buffer_load_dwordx4 v[60:63], v4, s[8:11], s35 offen offset:2048 sc1
    buffer_load_dwordx4 v[64:67], v4, s[8:11], s35 offen offset:3072 sc1
    buffer_load_dwordx4 v[68:71], v4, s[8:11], s55 offen sc1
    s_waitcnt vmcnt(0)
    v_max3_u32 v188, v52, v53, v54
    v_max3_u32 v188, v188, v55, v56
    v_max3_u32 v188, v188, v57, v58
    v_max3_u32 v188, v188, v59, v60
    v_max3_u32 v188, v188, v61, v62
    v_max3_u32 v188, v188, v63, v64
    v_max3_u32 v188, v188, v65, v66
    v_max3_u32 v188, v188, v67, v68
    v_max3_u32 v188, v188, v69, v70
    v_max_u32 v188, v188, v71
    v_cmp_eq_u32 vcc, -1, v188
    s_cbranch_vccnz HBfrt_90
HBfok_89:
HBfjn_83:
    ds_write_b128 v5, v[52:55] offset:0
    ds_write_b128 v5, v[56:59] offset:2048
    ds_write_b128 v5, v[60:63] offset:4096
    ds_write_b128 v5, v[64:67] offset:6144
    ds_write_b128 v5, v[68:71] offset:8192
    s_mov_b32 s54, s34
    s_mov_b32 s34, s35
    s_mov_b32 s35, s36
    s_mov_b32 s36, s37
    s_mov_b32 s37, s54
    s_waitcnt lgkmcnt(0)
    s_barrier
    s_branch HBf_loop
HBf_last:
    s_mul_i32 s72, s33, 327680
    s_add_u32 s72, s72, 0x7000000
    s_add_u32 s56, s72, 0
    buffer_store_dwordx2 v[100:101], v28, s[8:11], s56 offen sc1
    s_add_u32 s56, s72, 2048
    buffer_store_dwordx2 v[102:103], v28, s[8:11], s56 offen sc1
    s_add_u32 s56, s72, 4096
    buffer_store_dwordx2 v[104:105], v28, s[8:11], s56 offen sc1
    s_add_u32 s56, s72, 6144
    buffer_store_dwordx2 v[106:107], v28, s[8:11], s56 offen sc1
    s_add_u32 s56, s72, 8192
    buffer_store_dwordx2 v[108:109], v28, s[8:11], s56 offen sc1
    s_waitcnt vmcnt(0)
    s_barrier
    s_cmp_eq_u32 s32, 0
    s_cbranch_scc0 ce_91
    s_add_u32 s75, s75, 128
    s_mov_b32 s54, 0x40
    v_mov_b32 v189, s54
    v_mov_b32 v190, 0
    s_mov_b64 exec, 1
    buffer_store_dword v189, v190, s[8:11], s75 offen sc1
    s_mov_b64 exec, -1
    s_waitcnt vmcnt(0)
ce_91:
    s_endpgm
HBfrt_90:
    s_sub_u32 s58, s58, 1
    s_cbranch_scc1 HBfbad_92
    s_add_u32 s55, s35, 4096
    buffer_load_dwordx4 v[52:55], v4, s[8:11], s35 offen offset:0 sc1
    buffer_load_dwordx4 v[56:59], v4, s[8:11], s35 offen offset:1024 sc1
    buffer_load_dwordx4 v[60:63], v4, s[8:11], s35 offen offset:2048 sc1
    buffer_load_dwordx4 v[64:67], v4, s[8:11], s35 offen offset:3072 sc1
    buffer_load_dwordx4 v[68:71], v4, s[8:11], s55 offen sc1
    s_waitcnt vmcnt(0)
    v_max3_u32 v188, v52, v53, v54
    v_max3_u32 v188, v188, v55, v56
    v_max3_u32 v188, v188, v57, v58
    v_max3_u32 v188, v188, v59, v60
    v_max3_u32 v188, v188, v61, v62
    v_max3_u32 v188, v188, v63, v64
    v_max3_u32 v188, v188, v65, v66
    v_max3_u32 v188, v188, v67, v68
    v_max3_u32 v188, v188, v69, v70
    v_max_u32 v188, v188, v71
    v_cmp_eq_u32 vcc, -1, v188
    s_cbranch_vccnz HBfrt_90
    s_branch HBfok_89
HBfbad_92:
    s_mov_b32 s58, 0
    s_branch HBfok_89
HslowB_61:
    s_mov_b32 s55, 0x8c00000
    s_add_u32 s56, s55, 0
    buffer_store_dwordx2 v[22:23], v26, s[8:11], s56 offen sc1
    s_add_u32 s56, s55, 2048
    buffer_store_dwordx2 v[22:23], v26, s[8:11], s56 offen sc1
    s_add_u32 s56, s55, 4096
    buffer_store_dwordx2 v[22:23], v26, s[8:11], s56 offen sc1
    s_add_u32 s56, s55, 6144
    buffer_store_dwordx2 v[22:23], v26, s[8:11], s56 offen sc1
    s_add_u32 s56, s55, 8192
    buffer_store_dwordx2 v[22:23], v26, s[8:11], s56 offen sc1
    s_mov_b64 exec, s[50:51]
    s_cbranch_execz HBspm_93
    buffer_store_dwordx2 v[22:23], v20, s[8:11], s55 offen sc1
    buffer_store_dwordx2 v[22:23], v21, s[8:11], s55 offen sc1
HBspm_93:
    s_mov_b64 exec, -1
    s_mov_b32 s55, 0x8c5f000
    s_add_u32 s56, s55, 0
    buffer_store_dwordx2 v[22:23], v26, s[8:11], s56 offen sc1
    s_add_u32 s56, s55, 2048
    buffer_store_dwordx2 v[22:23], v26, s[8:11], s56 offen sc1
    s_add_u32 s56, s55, 4096
    buffer_store_dwordx2 v[22:23], v26, s[8:11], s56 offen sc1
    s_add_u32 s56, s55, 6144
    buffer_store_dwordx2 v[22:23], v26, s[8:11], s56 offen sc1
    s_add_u32 s56, s55, 8192
    buffer_store_dwordx2 v[22:23], v26, s[8:11], s56 offen sc1
    s_mov_b64 exec, s[50:51]
    s_cbranch_execz HBspm_94
    buffer_store_dwordx2 v[22:23], v20, s[8:11], s55 offen sc1
    buffer_store_dwordx2 v[22:23], v21, s[8:11], s55 offen sc1
HBspm_94:
    s_mov_b64 exec, -1
    s_mov_b32 s55, 0x8cbe000
    s_add_u32 s56, s55, 0
    buffer_store_dwordx2 v[22:23], v26, s[8:11], s56 offen sc1
    s_add_u32 s56, s55, 2048
    buffer_store_dwordx2 v[22:23], v26, s[8:11], s56 offen sc1
    s_add_u32 s56, s55, 4096
    buffer_store_dwordx2 v[22:23], v26, s[8:11], s56 offen sc1
    s_add_u32 s56, s55, 6144
    buffer_store_dwordx2 v[22:23], v26, s[8:11], s56 offen sc1
    s_add_u32 s56, s55, 8192
    buffer_store_dwordx2 v[22:23], v26, s[8:11], s56 offen sc1
    s_mov_b64 exec, s[50:51]
    s_cbranch_execz HBspm_95
    buffer_store_dwordx2 v[22:23], v20, s[8:11], s55 offen sc1
    buffer_store_dwordx2 v[22:23], v21, s[8:11], s55 offen sc1
HBspm_95:
    s_mov_b64 exec, -1
    s_mov_b32 s55, 0x8d1d000
    s_add_u32 s56, s55, 0
    buffer_store_dwordx2 v[22:23], v26, s[8:11], s56 offen sc1
    s_add_u32 s56, s55, 2048
    buffer_store_dwordx2 v[22:23], v26, s[8:11], s56 offen sc1
    s_add_u32 s56, s55, 4096
    buffer_store_dwordx2 v[22:23], v26, s[8:11], s56 offen sc1
    s_add_u32 s56, s55, 6144
    buffer_store_dwordx2 v[22:23], v26, s[8:11], s56 offen sc1
    s_add_u32 s56, s55, 8192
    buffer_store_dwordx2 v[22:23], v26, s[8:11], s56 offen sc1
    s_mov_b64 exec, s[50:51]
    s_cbranch_execz HBspm_96
    buffer_store_dwordx2 v[22:23], v20, s[8:11], s55 offen sc1
    buffer_store_dwordx2 v[22:23], v21, s[8:11], s55 offen sc1
HBspm_96:
    s_mov_b64 exec, -1
    v_mov_b32 v168, 0
    s_mov_b64 exec, 1
    s_add_u32 s55, s41, 256
    buffer_store_dword v168, v16, s[8:11], s55 offen sc1
    s_add_u32 s55, s41, 512
    buffer_store_dword v168, v16, s[8:11], s55 offen sc1
    s_mov_b64 exec, -1
    s_waitcnt vmcnt(0)
    s_barrier
    s_cmp_eq_u32 s32, 0
    s_cbranch_scc0 HBssb_97
    v_mov_b32 v168, 1
    v_mov_b32 v169, 36
    s_mov_b64 exec, 1
    buffer_atomic_add v168, v169, s[20:23], 0 offen
    s_mov_b64 exec, -1
    s_waitcnt vmcnt(0)
HBssb_97:
    s_lshr_b32 s56, s32, 1
    s_lshl_b32 s56, s56, 3
    v_lshlrev_b32 v172, 1, v3
    v_add_u32 v172, s56, v172
    v_xor_b32 v172, v172, v2
    v_lshlrev_b32 v172, 4, v172
    s_lshl_b32 s56, s32, 2
    v_add_u32 v173, s56, v3
    v_lshlrev_b32 v168, 13, v173
    v_add_u32 v168, v168, v172
    s_and_b32 s56, s32, 1
    s_lshl_b32 s56, s56, 3
    v_lshlrev_b32 v172, 1, v3
    v_add_u32 v172, s56, v172
    v_xor_b32 v172, v172, v2
    v_lshlrev_b32 v172, 4, v172
    v_mul_u32_u24 v169, 1280, v173
    v_add_u32 v169, v169, v172
    s_lshl_b32 s56, s32, 1
    s_lshl_b32 s56, s56, 1
    v_bfe_u32 v172, v1, 1, 1
    v_add_u32 v172, s56, v172
    v_lshrrev_b32 v173, 2, v2
    v_lshlrev_b32 v173, 1, v173
    v_and_b32 v170, 1, v3
    v_lshl_add_u32 v173, v170, 3, v173
    v_xor_b32 v172, v172, v173
    v_lshlrev_b32 v172, 4, v172
    v_and_b32 v173, 1, v1
    v_lshl_add_u32 v172, v173, 3, v172
    v_lshrrev_b32 v173, 2, v2
    v_mad_u32_u24 v173, v3, 8, v173
    v_lshl_add_u32 v170, v173, 8, v172
    s_lshl_b32 s56, s32, 1
    s_add_u32 s56, s56, 1
    s_lshl_b32 s56, s56, 1
    v_bfe_u32 v172, v1, 1, 1
    v_add_u32 v172, s56, v172
    v_lshrrev_b32 v173, 2, v2
    v_lshlrev_b32 v173, 1, v173
    v_and_b32 v171, 1, v3
    v_lshl_add_u32 v173, v171, 3, v173
    v_xor_b32 v172, v172, v173
    v_lshlrev_b32 v172, 4, v172
    v_and_b32 v173, 1, v1
    v_lshl_add_u32 v172, v173, 3, v172
    v_lshrrev_b32 v173, 2, v2
    v_mad_u32_u24 v173, v3, 8, v173
    v_lshl_add_u32 v171, v173, 8, v172
    s_mov_b32 s56, s32
    s_lshl_b32 s56, s56, 1
    v_bfe_u32 v172, v1, 1, 1
    v_add_u32 v172, s56, v172
    v_lshrrev_b32 v173, 2, v2
    v_lshlrev_b32 v173, 1, v173
    v_and_b32 v174, 1, v3
    v_lshl_add_u32 v173, v174, 3, v173
    v_xor_b32 v172, v172, v173
    v_lshlrev_b32 v172, 4, v172
    v_and_b32 v173, 1, v1
    v_lshl_add_u32 v172, v173, 3, v172
    v_lshrrev_b32 v173, 2, v2
    v_mad_u32_u24 v173, v3, 4, v173
    v_lshl_add_u32 v174, v173, 8, v172
    s_add_u32 s56, s32, 4
    s_lshl_b32 s56, s56, 1
    v_bfe_u32 v172, v1, 1, 1
    v_add_u32 v172, s56, v172
    v_lshrrev_b32 v173, 2, v2
    v_lshlrev_b32 v173, 1, v173
    v_and_b32 v175, 1, v3
    v_lshl_add_u32 v173, v175, 3, v173
    v_xor_b32 v172, v172, v173
    v_lshlrev_b32 v172, 4, v172
    v_and_b32 v173, 1, v1
    v_lshl_add_u32 v172, v173, 3, v172
    v_lshrrev_b32 v173, 2, v2
    v_mad_u32_u24 v173, v3, 4, v173
    v_lshl_add_u32 v175, v173, 8, v172
    s_lshl_b32 s54, s30, 8
    s_add_u32 s55, s54, 0x0
    s_lshl_b32 s56, s32, 10
    s_add_u32 m0, s56, 0x0
    s_nop 0
    buffer_load_dwordx4 v168, s[12:15], s55 offen lds
    s_add_u32 s55, s54, 0x20000
    s_lshl_b32 s56, s32, 10
    s_add_u32 m0, s56, 0x1000
    s_nop 0
    buffer_load_dwordx4 v168, s[12:15], s55 offen lds
    s_add_u32 s55, s54, 0x40000
    s_lshl_b32 s56, s32, 10
    s_add_u32 m0, s56, 0x2000
    s_nop 0
    buffer_load_dwordx4 v168, s[12:15], s55 offen lds
    s_add_u32 s55, s54, 0x60000
    s_lshl_b32 s56, s32, 10
    s_add_u32 m0, s56, 0x3000
    s_nop 0
    buffer_load_dwordx4 v168, s[12:15], s55 offen lds
    s_add_u32 s55, s54, 0x80000
    s_lshl_b32 s56, s32, 10
    s_add_u32 m0, s56, 0x4000
    s_nop 0
    buffer_load_dwordx4 v168, s[12:15], s55 offen lds
    s_add_u32 s55, s54, 0xa0000
    s_lshl_b32 s56, s32, 10
    s_add_u32 m0, s56, 0x5000
    s_nop 0
    buffer_load_dwordx4 v168, s[12:15], s55 offen lds
    s_add_u32 s55, s54, 0xc0000
    s_lshl_b32 s56, s32, 10
    s_add_u32 m0, s56, 0x6000
    s_nop 0
    buffer_load_dwordx4 v168, s[12:15], s55 offen lds
    s_add_u32 s55, s54, 0xe0000
    s_lshl_b32 s56, s32, 10
    s_add_u32 m0, s56, 0x7000
    s_nop 0
    buffer_load_dwordx4 v168, s[12:15], s55 offen lds
    s_add_u32 s55, s54, 0x100000
    s_lshl_b32 s56, s32, 10
    s_add_u32 m0, s56, 0x8000
    s_nop 0
    buffer_load_dwordx4 v168, s[12:15], s55 offen lds
    s_add_u32 s55, s54, 0x120000
    s_lshl_b32 s56, s32, 10
    s_add_u32 m0, s56, 0x9000
    s_nop 0
    buffer_load_dwordx4 v168, s[12:15], s55 offen lds
    s_add_u32 s55, s54, 0x140000
    s_lshl_b32 s56, s32, 10
    s_add_u32 m0, s56, 0xa000
    s_nop 0
    buffer_load_dwordx4 v168, s[12:15], s55 offen lds
    s_add_u32 s55, s54, 0x160000
    s_lshl_b32 s56, s32, 10
    s_add_u32 m0, s56, 0xb000
    s_nop 0
    buffer_load_dwordx4 v168, s[12:15], s55 offen lds
    s_add_u32 s55, s54, 0x180000
    s_lshl_b32 s56, s32, 10
    s_add_u32 m0, s56, 0xc000
    s_nop 0
    buffer_load_dwordx4 v168, s[12:15], s55 offen lds
    s_add_u32 s55, s54, 0x1a0000
    s_lshl_b32 s56, s32, 10
    s_add_u32 m0, s56, 0xd000
    s_nop 0
    buffer_load_dwordx4 v168, s[12:15], s55 offen lds
    s_add_u32 s55, s54, 0x1c0000
    s_lshl_b32 s56, s32, 10
    s_add_u32 m0, s56, 0xe000
    s_nop 0
    buffer_load_dwordx4 v168, s[12:15], s55 offen lds
    s_add_u32 s55, s54, 0x1e0000
    s_lshl_b32 s56, s32, 10
    s_add_u32 m0, s56, 0xf000
    s_nop 0
    buffer_load_dwordx4 v168, s[12:15], s55 offen lds
    s_add_u32 s55, s54, 0x200000
    s_lshl_b32 s56, s32, 10
    s_add_u32 m0, s56, 0x10000
    s_nop 0
    buffer_load_dwordx4 v168, s[12:15], s55 offen lds
    s_add_u32 s55, s54, 0x220000
    s_lshl_b32 s56, s32, 10
    s_add_u32 m0, s56, 0x11000
    s_nop 0
    buffer_load_dwordx4 v168, s[12:15], s55 offen lds
    s_add_u32 s55, s54, 0x240000
    s_lshl_b32 s56, s32, 10
    s_add_u32 m0, s56, 0x12000
    s_nop 0
    buffer_load_dwordx4 v168, s[12:15], s55 offen lds
    s_add_u32 s55, s54, 0x260000
    s_lshl_b32 s56, s32, 10
    s_add_u32 m0, s56, 0x13000
    s_nop 0
    buffer_load_dwordx4 v168, s[12:15], s55 offen lds
    s_add_u32 s55, s54, 0x280000
    s_lshl_b32 s56, s32, 10
    s_add_u32 m0, s56, 0x14000
    s_nop 0
    buffer_load_dwordx4 v168, s[12:15], s55 offen lds
    s_add_u32 s55, s54, 0x2a0000
    s_lshl_b32 s56, s32, 10
    s_add_u32 m0, s56, 0x15000
    s_nop 0
    buffer_load_dwordx4 v168, s[12:15], s55 offen lds
    s_add_u32 s55, s54, 0x2c0000
    s_lshl_b32 s56, s32, 10
    s_add_u32 m0, s56, 0x16000
    s_nop 0
    buffer_load_dwordx4 v168, s[12:15], s55 offen lds
    s_add_u32 s55, s54, 0x2e0000
    s_lshl_b32 s56, s32, 10
    s_add_u32 m0, s56, 0x17000
    s_nop 0
    buffer_load_dwordx4 v168, s[12:15], s55 offen lds
    s_add_u32 s55, s54, 0x300000
    s_lshl_b32 s56, s32, 10
    s_add_u32 m0, s56, 0x18000
    s_nop 0
    buffer_load_dwordx4 v168, s[12:15], s55 offen lds
    s_add_u32 s55, s54, 0x320000
    s_lshl_b32 s56, s32, 10
    s_add_u32 m0, s56, 0x19000
    s_nop 0
    buffer_load_dwordx4 v168, s[12:15], s55 offen lds
    s_add_u32 s55, s54, 0x340000
    s_lshl_b32 s56, s32, 10
    s_add_u32 m0, s56, 0x1a000
    s_nop 0
    buffer_load_dwordx4 v168, s[12:15], s55 offen lds
    s_add_u32 s55, s54, 0x360000
    s_lshl_b32 s56, s32, 10
    s_add_u32 m0, s56, 0x1b000
    s_nop 0
    buffer_load_dwordx4 v168, s[12:15], s55 offen lds
    s_add_u32 s55, s54, 0x380000
    s_lshl_b32 s56, s32, 10
    s_add_u32 m0, s56, 0x1c000
    s_nop 0
    buffer_load_dwordx4 v168, s[12:15], s55 offen lds
    s_add_u32 s55, s54, 0x3a0000
    s_lshl_b32 s56, s32, 10
    s_add_u32 m0, s56, 0x1d000
    s_nop 0
    buffer_load_dwordx4 v168, s[12:15], s55 offen lds
    s_add_u32 s55, s54, 0x3c0000
    s_lshl_b32 s56, s32, 10
    s_add_u32 m0, s56, 0x1e000
    s_nop 0
    buffer_load_dwordx4 v168, s[12:15], s55 offen lds
    s_add_u32 s55, s54, 0x3e0000
    s_lshl_b32 s56, s32, 10
    s_add_u32 m0, s56, 0x1f000
    s_nop 0
    buffer_load_dwordx4 v168, s[12:15], s55 offen lds
    s_add_u32 s55, s54, 0x400000
    s_lshl_b32 s56, s32, 10
    s_add_u32 m0, s56, 0x20000
    s_nop 0
    buffer_load_dwordx4 v168, s[12:15], s55 offen lds
    s_add_u32 s55, s54, 0x420000
    s_lshl_b32 s56, s32, 10
    s_add_u32 m0, s56, 0x21000
    s_nop 0
    buffer_load_dwordx4 v168, s[12:15], s55 offen lds
    s_add_u32 s55, s54, 0x440000
    s_lshl_b32 s56, s32, 10
    s_add_u32 m0, s56, 0x22000
    s_nop 0
    buffer_load_dwordx4 v168, s[12:15], s55 offen lds
    s_add_u32 s55, s54, 0x460000
    s_lshl_b32 s56, s32, 10
    s_add_u32 m0, s56, 0x23000
    s_nop 0
    buffer_load_dwordx4 v168, s[12:15], s55 offen lds
    s_add_u32 s55, s54, 0x480000
    s_lshl_b32 s56, s32, 10
    s_add_u32 m0, s56, 0x24000
    s_nop 0
    buffer_load_dwordx4 v168, s[12:15], s55 offen lds
    s_add_u32 s55, s54, 0x4a0000
    s_lshl_b32 s56, s32, 10
    s_add_u32 m0, s56, 0x25000
    s_nop 0
    buffer_load_dwordx4 v168, s[12:15], s55 offen lds
    s_add_u32 s55, s54, 0x4c0000
    s_lshl_b32 s56, s32, 10
    s_add_u32 m0, s56, 0x26000
    s_nop 0
    buffer_load_dwordx4 v168, s[12:15], s55 offen lds
    s_add_u32 s55, s54, 0x4e0000
    s_lshl_b32 s56, s32, 10
    s_add_u32 m0, s56, 0x27000
    s_nop 0
    buffer_load_dwordx4 v168, s[12:15], s55 offen lds
    s_waitcnt vmcnt(20)
    s_barrier
    v_add_u32 v172, 0x0, v170
    v_add_u32 v173, 0x0, v171
    ds_read_b64_tr_b16 a[0:1], v172 offset:0
    ds_read_b64_tr_b16 a[2:3], v172 offset:1024
    ds_read_b64_tr_b16 a[4:5], v172 offset:8192
    ds_read_b64_tr_b16 a[6:7], v172 offset:9216
    ds_read_b64_tr_b16 a[8:9], v172 offset:16384
    ds_read_b64_tr_b16 a[10:11], v172 offset:17408
    ds_read_b64_tr_b16 a[12:13], v172 offset:24576
    ds_read_b64_tr_b16 a[14:15], v172 offset:25600
    ds_read_b64_tr_b16 a[16:17], v172 offset:32768
    ds_read_b64_tr_b16 a[18:19], v172 offset:33792
    ds_read_b64_tr_b16 a[80:81], v173 offset:0
    ds_read_b64_tr_b16 a[82:83], v173 offset:1024
    ds_read_b64_tr_b16 a[84:85], v173 offset:8192
    ds_read_b64_tr_b16 a[86:87], v173 offset:9216
    ds_read_b64_tr_b16 a[88:89], v173 offset:16384
    ds_read_b64_tr_b16 a[90:91], v173 offset:17408
    ds_read_b64_tr_b16 a[92:93], v173 offset:24576
    ds_read_b64_tr_b16 a[94:95], v173 offset:25600
    ds_read_b64_tr_b16 a[96:97], v173 offset:32768
    ds_read_b64_tr_b16 a[98:99], v173 offset:33792
    s_waitcnt lgkmcnt(0)
    v_add_u32 v172, 0xa000, v170
    v_add_u32 v173, 0xa000, v171
    ds_read_b64_tr_b16 a[20:21], v172 offset:0
    ds_read_b64_tr_b16 a[22:23], v172 offset:1024
    ds_read_b64_tr_b16 a[24:25], v172 offset:8192
    ds_read_b64_tr_b16 a[26:27], v172 offset:9216
    ds_read_b64_tr_b16 a[28:29], v172 offset:16384
    ds_read_b64_tr_b16 a[30:31], v172 offset:17408
    ds_read_b64_tr_b16 a[32:33], v172 offset:24576
    ds_read_b64_tr_b16 a[34:35], v172 offset:25600
    ds_read_b64_tr_b16 a[36:37], v172 offset:32768
    ds_read_b64_tr_b16 a[38:39], v172 offset:33792
    ds_read_b64_tr_b16 a[100:101], v173 offset:0
    ds_read_b64_tr_b16 a[102:103], v173 offset:1024
    ds_read_b64_tr_b16 a[104:105], v173 offset:8192
    ds_read_b64_tr_b16 a[106:107], v173 offset:9216
    ds_read_b64_tr_b16 a[108:109], v173 offset:16384
    ds_read_b64_tr_b16 a[110:111], v173 offset:17408
    ds_read_b64_tr_b16 a[112:113], v173 offset:24576
    ds_read_b64_tr_b16 a[114:115], v173 offset:25600
    ds_read_b64_tr_b16 a[116:117], v173 offset:32768
    ds_read_b64_tr_b16 a[118:119], v173 offset:33792
    s_waitcnt lgkmcnt(0)
    s_barrier
    s_mul_i32 s55, s30, 163840
    s_add_u32 s55, s55, 0x0
    s_lshl_b32 s56, s32, 10
    s_add_u32 m0, s56, 0x0
    s_nop 0
    buffer_load_dwordx4 v169, s[16:19], s55 offen lds
    s_mul_i32 s55, s30, 163840
    s_add_u32 s55, s55, 0x5000
    s_lshl_b32 s56, s32, 10
    s_add_u32 m0, s56, 0x1000
    s_nop 0
    buffer_load_dwordx4 v169, s[16:19], s55 offen lds
    s_mul_i32 s55, s30, 163840
    s_add_u32 s55, s55, 0xa000
    s_lshl_b32 s56, s32, 10
    s_add_u32 m0, s56, 0x2000
    s_nop 0
    buffer_load_dwordx4 v169, s[16:19], s55 offen lds
    s_mul_i32 s55, s30, 163840
    s_add_u32 s55, s55, 0xf000
    s_lshl_b32 s56, s32, 10
    s_add_u32 m0, s56, 0x3000
    s_nop 0
    buffer_load_dwordx4 v169, s[16:19], s55 offen lds
    s_mul_i32 s55, s30, 163840
    s_add_u32 s55, s55, 0x14000
    s_lshl_b32 s56, s32, 10
    s_add_u32 m0, s56, 0x4000
    s_nop 0
    buffer_load_dwordx4 v169, s[16:19], s55 offen lds
    s_mul_i32 s55, s30, 163840
    s_add_u32 s55, s55, 0x19000
    s_lshl_b32 s56, s32, 10
    s_add_u32 m0, s56, 0x5000
    s_nop 0
    buffer_load_dwordx4 v169, s[16:19], s55 offen lds
    s_mul_i32 s55, s30, 163840
    s_add_u32 s55, s55, 0x1e000
    s_lshl_b32 s56, s32, 10
    s_add_u32 m0, s56, 0x6000
    s_nop 0
    buffer_load_dwordx4 v169, s[16:19], s55 offen lds
    s_mul_i32 s55, s30, 163840
    s_add_u32 s55, s55, 0x23000
    s_lshl_b32 s56, s32, 10
    s_add_u32 m0, s56, 0x7000
    s_nop 0
    buffer_load_dwordx4 v169, s[16:19], s55 offen lds
    s_mul_i32 s55, s30, 163840
    s_add_u32 s55, s55, 0x100
    s_lshl_b32 s56, s32, 10
    s_add_u32 m0, s56, 0xa000
    s_nop 0
    buffer_load_dwordx4 v169, s[16:19], s55 offen lds
    s_mul_i32 s55, s30, 163840
    s_add_u32 s55, s55, 0x5100
    s_lshl_b32 s56, s32, 10
    s_add_u32 m0, s56, 0xb000
    s_nop 0
    buffer_load_dwordx4 v169, s[16:19], s55 offen lds
    s_mul_i32 s55, s30, 163840
    s_add_u32 s55, s55, 0xa100
    s_lshl_b32 s56, s32, 10
    s_add_u32 m0, s56, 0xc000
    s_nop 0
    buffer_load_dwordx4 v169, s[16:19], s55 offen lds
    s_mul_i32 s55, s30, 163840
    s_add_u32 s55, s55, 0xf100
    s_lshl_b32 s56, s32, 10
    s_add_u32 m0, s56, 0xd000
    s_nop 0
    buffer_load_dwordx4 v169, s[16:19], s55 offen lds
    s_mul_i32 s55, s30, 163840
    s_add_u32 s55, s55, 0x14100
    s_lshl_b32 s56, s32, 10
    s_add_u32 m0, s56, 0xe000
    s_nop 0
    buffer_load_dwordx4 v169, s[16:19], s55 offen lds
    s_mul_i32 s55, s30, 163840
    s_add_u32 s55, s55, 0x19100
    s_lshl_b32 s56, s32, 10
    s_add_u32 m0, s56, 0xf000
    s_nop 0
    buffer_load_dwordx4 v169, s[16:19], s55 offen lds
    s_mul_i32 s55, s30, 163840
    s_add_u32 s55, s55, 0x1e100
    s_lshl_b32 s56, s32, 10
    s_add_u32 m0, s56, 0x10000
    s_nop 0
    buffer_load_dwordx4 v169, s[16:19], s55 offen lds
    s_mul_i32 s55, s30, 163840
    s_add_u32 s55, s55, 0x23100
    s_lshl_b32 s56, s32, 10
    s_add_u32 m0, s56, 0x11000
    s_nop 0
    buffer_load_dwordx4 v169, s[16:19], s55 offen lds
    s_waitcnt vmcnt(16)
    s_barrier
    v_add_u32 v172, 0x14000, v170
    v_add_u32 v173, 0x14000, v171
    ds_read_b64_tr_b16 a[40:41], v172 offset:0
    ds_read_b64_tr_b16 a[42:43], v172 offset:1024
    ds_read_b64_tr_b16 a[44:45], v172 offset:8192
    ds_read_b64_tr_b16 a[46:47], v172 offset:9216
    ds_read_b64_tr_b16 a[48:49], v172 offset:16384
    ds_read_b64_tr_b16 a[50:51], v172 offset:17408
    ds_read_b64_tr_b16 a[52:53], v172 offset:24576
    ds_read_b64_tr_b16 a[54:55], v172 offset:25600
    ds_read_b64_tr_b16 a[56:57], v172 offset:32768
    ds_read_b64_tr_b16 a[58:59], v172 offset:33792
    ds_read_b64_tr_b16 a[120:121], v173 offset:0
    ds_read_b64_tr_b16 a[122:123], v173 offset:1024
    ds_read_b64_tr_b16 a[124:125], v173 offset:8192
    ds_read_b64_tr_b16 a[126:127], v173 offset:9216
    ds_read_b64_tr_b16 a[128:129], v173 offset:16384
    ds_read_b64_tr_b16 a[130:131], v173 offset:17408
    ds_read_b64_tr_b16 a[132:133], v173 offset:24576
    ds_read_b64_tr_b16 a[134:135], v173 offset:25600
    ds_read_b64_tr_b16 a[136:137], v173 offset:32768
    ds_read_b64_tr_b16 a[138:139], v173 offset:33792
    s_waitcnt lgkmcnt(0)
    v_add_u32 v172, 0x1e000, v170
    v_add_u32 v173, 0x1e000, v171
    ds_read_b64_tr_b16 a[60:61], v172 offset:0
    ds_read_b64_tr_b16 a[62:63], v172 offset:1024
    ds_read_b64_tr_b16 a[64:65], v172 offset:8192
    ds_read_b64_tr_b16 a[66:67], v172 offset:9216
    ds_read_b64_tr_b16 a[68:69], v172 offset:16384
    ds_read_b64_tr_b16 a[70:71], v172 offset:17408
    ds_read_b64_tr_b16 a[72:73], v172 offset:24576
    ds_read_b64_tr_b16 a[74:75], v172 offset:25600
    ds_read_b64_tr_b16 a[76:77], v172 offset:32768
    ds_read_b64_tr_b16 a[78:79], v172 offset:33792
    ds_read_b64_tr_b16 a[140:141], v173 offset:0
    ds_read_b64_tr_b16 a[142:143], v173 offset:1024
    ds_read_b64_tr_b16 a[144:145], v173 offset:8192
    ds_read_b64_tr_b16 a[146:147], v173 offset:9216
    ds_read_b64_tr_b16 a[148:149], v173 offset:16384
    ds_read_b64_tr_b16 a[150:151], v173 offset:17408
    ds_read_b64_tr_b16 a[152:153], v173 offset:24576
    ds_read_b64_tr_b16 a[154:155], v173 offset:25600
    ds_read_b64_tr_b16 a[156:157], v173 offset:32768
    ds_read_b64_tr_b16 a[158:159], v173 offset:33792
    s_waitcnt lgkmcnt(0)
    s_barrier
    s_mul_i32 s55, s30, 163840
    s_add_u32 s55, s55, 0x200
    s_lshl_b32 s56, s32, 10
    s_add_u32 m0, s56, 0x14000
    s_nop 0
    buffer_load_dwordx4 v169, s[16:19], s55 offen lds
    s_mul_i32 s55, s30, 163840
    s_add_u32 s55, s55, 0x5200
    s_lshl_b32 s56, s32, 10
    s_add_u32 m0, s56, 0x15000
    s_nop 0
    buffer_load_dwordx4 v169, s[16:19], s55 offen lds
    s_mul_i32 s55, s30, 163840
    s_add_u32 s55, s55, 0xa200
    s_lshl_b32 s56, s32, 10
    s_add_u32 m0, s56, 0x16000
    s_nop 0
    buffer_load_dwordx4 v169, s[16:19], s55 offen lds
    s_mul_i32 s55, s30, 163840
    s_add_u32 s55, s55, 0xf200
    s_lshl_b32 s56, s32, 10
    s_add_u32 m0, s56, 0x17000
    s_nop 0
    buffer_load_dwordx4 v169, s[16:19], s55 offen lds
    s_mul_i32 s55, s30, 163840
    s_add_u32 s55, s55, 0x14200
    s_lshl_b32 s56, s32, 10
    s_add_u32 m0, s56, 0x18000
    s_nop 0
    buffer_load_dwordx4 v169, s[16:19], s55 offen lds
    s_mul_i32 s55, s30, 163840
    s_add_u32 s55, s55, 0x19200
    s_lshl_b32 s56, s32, 10
    s_add_u32 m0, s56, 0x19000
    s_nop 0
    buffer_load_dwordx4 v169, s[16:19], s55 offen lds
    s_mul_i32 s55, s30, 163840
    s_add_u32 s55, s55, 0x1e200
    s_lshl_b32 s56, s32, 10
    s_add_u32 m0, s56, 0x1a000
    s_nop 0
    buffer_load_dwordx4 v169, s[16:19], s55 offen lds
    s_mul_i32 s55, s30, 163840
    s_add_u32 s55, s55, 0x23200
    s_lshl_b32 s56, s32, 10
    s_add_u32 m0, s56, 0x1b000
    s_nop 0
    buffer_load_dwordx4 v169, s[16:19], s55 offen lds
    s_mul_i32 s55, s30, 163840
    s_add_u32 s55, s55, 0x300
    s_lshl_b32 s56, s32, 10
    s_add_u32 m0, s56, 0x1e000
    s_nop 0
    buffer_load_dwordx4 v169, s[16:19], s55 offen lds
    s_mul_i32 s55, s30, 163840
    s_add_u32 s55, s55, 0x5300
    s_lshl_b32 s56, s32, 10
    s_add_u32 m0, s56, 0x1f000
    s_nop 0
    buffer_load_dwordx4 v169, s[16:19], s55 offen lds
    s_mul_i32 s55, s30, 163840
    s_add_u32 s55, s55, 0xa300
    s_lshl_b32 s56, s32, 10
    s_add_u32 m0, s56, 0x20000
    s_nop 0
    buffer_load_dwordx4 v169, s[16:19], s55 offen lds
    s_mul_i32 s55, s30, 163840
    s_add_u32 s55, s55, 0xf300
    s_lshl_b32 s56, s32, 10
    s_add_u32 m0, s56, 0x21000
    s_nop 0
    buffer_load_dwordx4 v169, s[16:19], s55 offen lds
    s_mul_i32 s55, s30, 163840
    s_add_u32 s55, s55, 0x14300
    s_lshl_b32 s56, s32, 10
    s_add_u32 m0, s56, 0x22000
    s_nop 0
    buffer_load_dwordx4 v169, s[16:19], s55 offen lds
    s_mul_i32 s55, s30, 163840
    s_add_u32 s55, s55, 0x19300
    s_lshl_b32 s56, s32, 10
    s_add_u32 m0, s56, 0x23000
    s_nop 0
    buffer_load_dwordx4 v169, s[16:19], s55 offen lds
    s_mul_i32 s55, s30, 163840
    s_add_u32 s55, s55, 0x1e300
    s_lshl_b32 s56, s32, 10
    s_add_u32 m0, s56, 0x24000
    s_nop 0
    buffer_load_dwordx4 v169, s[16:19], s55 offen lds
    s_mul_i32 s55, s30, 163840
    s_add_u32 s55, s55, 0x23300
    s_lshl_b32 s56, s32, 10
    s_add_u32 m0, s56, 0x25000
    s_nop 0
    buffer_load_dwordx4 v169, s[16:19], s55 offen lds
    s_waitcnt vmcnt(16)
    s_barrier
    v_add_u32 v172, 0x0, v174
    v_add_u32 v173, 0x0, v175
    ds_read_b64_tr_b16 a[160:161], v172 offset:0
    ds_read_b64_tr_b16 a[162:163], v172 offset:4096
    ds_read_b64_tr_b16 a[164:165], v172 offset:8192
    ds_read_b64_tr_b16 a[166:167], v172 offset:12288
    ds_read_b64_tr_b16 a[168:169], v172 offset:16384
    ds_read_b64_tr_b16 a[170:171], v172 offset:20480
    ds_read_b64_tr_b16 a[172:173], v172 offset:24576
    ds_read_b64_tr_b16 a[174:175], v172 offset:28672
    ds_read_b64_tr_b16 a[176:177], v173 offset:0
    ds_read_b64_tr_b16 a[178:179], v173 offset:4096
    ds_read_b64_tr_b16 a[180:181], v173 offset:8192
    ds_read_b64_tr_b16 a[182:183], v173 offset:12288
    ds_read_b64_tr_b16 a[184:185], v173 offset:16384
    ds_read_b64_tr_b16 a[186:187], v173 offset:20480
    ds_read_b64_tr_b16 a[188:189], v173 offset:24576
    ds_read_b64_tr_b16 a[190:191], v173 offset:28672
    s_waitcnt lgkmcnt(0)
    v_add_u32 v172, 0xa000, v174
    v_add_u32 v173, 0xa000, v175
    ds_read_b64_tr_b16 a[192:193], v172 offset:0
    ds_read_b64_tr_b16 a[194:195], v172 offset:4096
    ds_read_b64_tr_b16 a[196:197], v172 offset:8192
    ds_read_b64_tr_b16 a[198:199], v172 offset:12288
    ds_read_b64_tr_b16 a[200:201], v172 offset:16384
    ds_read_b64_tr_b16 a[202:203], v172 offset:20480
    ds_read_b64_tr_b16 a[204:205], v172 offset:24576
    ds_read_b64_tr_b16 a[206:207], v172 offset:28672
    ds_read_b64_tr_b16 a[208:209], v173 offset:0
    ds_read_b64_tr_b16 a[210:211], v173 offset:4096
    ds_read_b64_tr_b16 a[212:213], v173 offset:8192
    ds_read_b64_tr_b16 a[214:215], v173 offset:12288
    ds_read_b64_tr_b16 a[216:217], v173 offset:16384
    ds_read_b64_tr_b16 a[218:219], v173 offset:20480
    ds_read_b64_tr_b16 a[220:221], v173 offset:24576
    ds_read_b64_tr_b16 a[222:223], v173 offset:28672
    s_waitcnt lgkmcnt(0)
    s_barrier
    s_mul_i32 s55, s30, 163840
    s_add_u32 s55, s55, 0x400
    s_lshl_b32 s56, s32, 10
    s_add_u32 m0, s56, 0x0
    s_nop 0
    buffer_load_dwordx4 v169, s[16:19], s55 offen lds
    s_mul_i32 s55, s30, 163840
    s_add_u32 s55, s55, 0x5400
    s_lshl_b32 s56, s32, 10
    s_add_u32 m0, s56, 0x1000
    s_nop 0
    buffer_load_dwordx4 v169, s[16:19], s55 offen lds
    s_mul_i32 s55, s30, 163840
    s_add_u32 s55, s55, 0xa400
    s_lshl_b32 s56, s32, 10
    s_add_u32 m0, s56, 0x2000
    s_nop 0
    buffer_load_dwordx4 v169, s[16:19], s55 offen lds
    s_mul_i32 s55, s30, 163840
    s_add_u32 s55, s55, 0xf400
    s_lshl_b32 s56, s32, 10
    s_add_u32 m0, s56, 0x3000
    s_nop 0
    buffer_load_dwordx4 v169, s[16:19], s55 offen lds
    s_mul_i32 s55, s30, 163840
    s_add_u32 s55, s55, 0x14400
    s_lshl_b32 s56, s32, 10
    s_add_u32 m0, s56, 0x4000
    s_nop 0
    buffer_load_dwordx4 v169, s[16:19], s55 offen lds
    s_mul_i32 s55, s30, 163840
    s_add_u32 s55, s55, 0x19400
    s_lshl_b32 s56, s32, 10
    s_add_u32 m0, s56, 0x5000
    s_nop 0
    buffer_load_dwordx4 v169, s[16:19], s55 offen lds
    s_mul_i32 s55, s30, 163840
    s_add_u32 s55, s55, 0x1e400
    s_lshl_b32 s56, s32, 10
    s_add_u32 m0, s56, 0x6000
    s_nop 0
    buffer_load_dwordx4 v169, s[16:19], s55 offen lds
    s_mul_i32 s55, s30, 163840
    s_add_u32 s55, s55, 0x23400
    s_lshl_b32 s56, s32, 10
    s_add_u32 m0, s56, 0x7000
    s_nop 0
    buffer_load_dwordx4 v169, s[16:19], s55 offen lds
    s_waitcnt vmcnt(8)
    s_barrier
    v_add_u32 v172, 0x14000, v174
    v_add_u32 v173, 0x14000, v175
    ds_read_b64_tr_b16 a[224:225], v172 offset:0
    ds_read_b64_tr_b16 a[226:227], v172 offset:4096
    ds_read_b64_tr_b16 a[228:229], v172 offset:8192
    ds_read_b64_tr_b16 a[230:231], v172 offset:12288
    ds_read_b64_tr_b16 a[232:233], v172 offset:16384
    ds_read_b64_tr_b16 a[234:235], v172 offset:20480
    ds_read_b64_tr_b16 a[236:237], v172 offset:24576
    ds_read_b64_tr_b16 a[238:239], v172 offset:28672
    ds_read_b64_tr_b16 a[240:241], v173 offset:0
    ds_read_b64_tr_b16 a[242:243], v173 offset:4096
    ds_read_b64_tr_b16 a[244:245], v173 offset:8192
    ds_read_b64_tr_b16 a[246:247], v173 offset:12288
    ds_read_b64_tr_b16 a[248:249], v173 offset:16384
    ds_read_b64_tr_b16 a[250:251], v173 offset:20480
    ds_read_b64_tr_b16 a[252:253], v173 offset:24576
    ds_read_b64_tr_b16 a[254:255], v173 offset:28672
    s_waitcnt lgkmcnt(0)
    v_add_u32 v172, 0x1e000, v174
    v_add_u32 v173, 0x1e000, v175
    ds_read_b64_tr_b16 v[192:193], v172 offset:0
    ds_read_b64_tr_b16 v[194:195], v172 offset:4096
    ds_read_b64_tr_b16 v[196:197], v172 offset:8192
    ds_read_b64_tr_b16 v[198:199], v172 offset:12288
    ds_read_b64_tr_b16 v[200:201], v172 offset:16384
    ds_read_b64_tr_b16 v[202:203], v172 offset:20480
    ds_read_b64_tr_b16 v[204:205], v172 offset:24576
    ds_read_b64_tr_b16 v[206:207], v172 offset:28672
    ds_read_b64_tr_b16 v[208:209], v173 offset:0
    ds_read_b64_tr_b16 v[210:211], v173 offset:4096
    ds_read_b64_tr_b16 v[212:213], v173 offset:8192
    ds_read_b64_tr_b16 v[214:215], v173 offset:12288
    ds_read_b64_tr_b16 v[216:217], v173 offset:16384
    ds_read_b64_tr_b16 v[218:219], v173 offset:20480
    ds_read_b64_tr_b16 v[220:221], v173 offset:24576
    ds_read_b64_tr_b16 v[222:223], v173 offset:28672
    s_waitcnt lgkmcnt(0)
    s_barrier
    s_waitcnt vmcnt(0)
    s_barrier
    v_add_u32 v172, 0x0, v174
    v_add_u32 v173, 0x0, v175
    ds_read_b64_tr_b16 v[224:225], v172 offset:0
    ds_read_b64_tr_b16 v[226:227], v172 offset:4096
    ds_read_b64_tr_b16 v[228:229], v172 offset:8192
    ds_read_b64_tr_b16 v[230:231], v172 offset:12288
    ds_read_b64_tr_b16 v[232:233], v172 offset:16384
    ds_read_b64_tr_b16 v[234:235], v172 offset:20480
    ds_read_b64_tr_b16 v[236:237], v172 offset:24576
    ds_read_b64_tr_b16 v[238:239], v172 offset:28672
    ds_read_b64_tr_b16 v[240:241], v173 offset:0
    ds_read_b64_tr_b16 v[242:243], v173 offset:4096
    ds_read_b64_tr_b16 v[244:245], v173 offset:8192
    ds_read_b64_tr_b16 v[246:247], v173 offset:12288
    ds_read_b64_tr_b16 v[248:249], v173 offset:16384
    ds_read_b64_tr_b16 v[250:251], v173 offset:20480
    ds_read_b64_tr_b16 v[252:253], v173 offset:24576
    ds_read_b64_tr_b16 v[254:255], v173 offset:28672
    s_waitcnt lgkmcnt(0)
    s_barrier
    s_cmp_eq_u32 s32, 0
    s_cbranch_scc0 HBssb2_98
    v_mov_b32 v169, 36
    s_mov_b32 s58, 0x100000
HBssbl_99:
    buffer_load_dword v170, v169, s[20:23], 0 offen sc1
    s_waitcnt vmcnt(0)
    v_cmp_gt_u32 vcc, 64, v170
    s_cbranch_vccz HBssbd_100
    s_sub_u32 s58, s58, 1
    s_cbranch_scc0 HBssbl_99
HBssbd_100:
HBssb2_98:
    s_mov_b32 s58, 0x400000
    s_mov_b32 s33, 0x0
    s_lshl_b32 s54, s28, 4
    v_and_b32 v31, 1, v3
    v_add_u32 v30, s54, v2
    v_mov_b32 v168, s30
    v_cmp_gt_u32 vcc, 2, v3
    s_nop 1
    v_cndmask_b32 v30, v168, v30, vcc
    v_mov_b32 v168, 0
    v_mov_b32 v169, 64
    v_cndmask_b32 v168, v168, v169, vcc
    v_add_u32 v30, v30, v168
    v_lshl_add_u32 v30, v31, 5, v30
    v_lshlrev_b32 v30, 2, v30
    v_add_u32 v30, 0xa600000, v30
    s_mov_b32 s74, 0x0
    s_lshl_b32 s75, s30, 2
    s_add_u32 s75, s75, 0xa600200
    s_mov_b32 s55, 0x34
    s_cmp_eq_u32 s32, 0
    s_cbranch_scc0 CZww_101
    s_mov_b32 s54, 0x1
    v_min_u32 v168, 0, v1
    v_mul_u32_u24 v168, 4, v168
    s_mov_b32 s43, 0x40000
CZwl_102:
    buffer_load_dword v169, v168, s[20:23], s55 offen sc1
    s_waitcnt vmcnt(0)
    v_cmp_gt_u32 vcc, 128, v169
    s_nop 1
    v_cndmask_b32 v169, 0, v169, vcc
    v_cmp_gt_u32 vcc, s54, v169
    s_cbranch_vccz CZwd_103
    s_sleep 1
    s_sub_u32 s43, s43, 1
    s_cbranch_scc0 CZwl_102
CZwd_103:
CZww_101:
    s_barrier
    s_mov_b32 s33, 0x0
    s_cmp_lt_u32 s33, s74
    s_cbranch_scc1 rdy_104
rdl_105:
    s_and_b32 s54, s33, 1
    buffer_load_dword v188, v30, s[8:11], 0 offen sc1
    s_waitcnt vmcnt(0)
    v_cmp_lt_u32 vcc, 127, v188
    s_nop 1
    v_cmp_gt_u32 vcc, 128, v188
    s_nop 1
    v_cndmask_b32 v188, 0, v188, vcc
    v_max_u32 v188, v188, v31
    s_nop 1
    v_min_u32_dpp v188, v188, v188 row_ror:1 row_mask:0xf bank_mask:0xf
    s_nop 1
    v_min_u32_dpp v188, v188, v188 row_ror:2 row_mask:0xf bank_mask:0xf
    s_nop 1
    v_min_u32_dpp v188, v188, v188 row_ror:4 row_mask:0xf bank_mask:0xf
    s_nop 1
    v_min_u32_dpp v188, v188, v188 row_ror:8 row_mask:0xf bank_mask:0xf
    s_nop 1
    v_readlane_b32 s54, v188, 0
    v_readlane_b32 s55, v188, 16
    v_readlane_b32 s56, v188, 32
    v_readlane_b32 s74, v188, 48
    s_nop 3
    s_min_u32 s54, s54, s55
    s_min_u32 s56, s56, s74
    s_min_u32 s74, s54, s56
    s_cmp_lt_u32 s33, s74
    s_cbranch_scc1 rdy_104
    s_sleep 1
    s_sub_u32 s58, s58, 1
    s_cbranch_scc0 rdl_105
    s_mov_b32 s58, 0
    s_mov_b32 s74, 0x40
rdy_104:
    v_and_b32 v168, 7, v2
    v_mul_u32_u24 v168, 1280, v168
    v_lshl_add_u32 v168, v3, 4, v168
    v_lshrrev_b32 v169, 3, v2
    v_lshl_add_u32 v168, v169, 6, v168
    s_and_b32 s56, s32, 1
    s_mul_i32 s56, s56, 640
    s_lshr_b32 s55, s32, 1
    s_lshl_b32 s55, s55, 28
    s_add_u32 s56, s56, s55
    v_add_u32 v168, s56, v168
    buffer_load_dwordx4 v[32:35], v168, s[24:27], 0 offen offset:0
    buffer_load_dwordx4 v[36:39], v168, s[24:27], 0 offen offset:128
    buffer_load_dwordx4 v[40:43], v168, s[24:27], 0 offen offset:256
    buffer_load_dwordx4 v[44:47], v168, s[24:27], 0 offen offset:384
    buffer_load_dwordx4 v[48:51], v168, s[24:27], 0 offen offset:512
    s_mov_b32 s39, 0x0
    s_mov_b32 s40, 0x2000000
    s_mul_i32 s74, s28, -10240
    s_mul_i32 s57, s28, -10240
    s_sub_u32 s57, s57, 10240
    s_add_u32 s72, s57, 0x90ae000
    v_mov_b32 v176, 0
    v_mov_b32 v177, 0
    v_mov_b32 v178, 0
    v_mov_b32 v179, 0
    v_mov_b32 v180, 0
    v_mov_b32 v181, 0
    v_mov_b32 v182, 0
    v_mov_b32 v183, 0
    v_mov_b32 v184, 0
    v_mov_b32 v185, 0
    v_mov_b32 v186, 0
    v_mov_b32 v187, 0
    s_waitcnt vmcnt(0)
    ds_write_b128 v5, v[32:35] offset:0
    ds_write_b128 v5, v[36:39] offset:2048
    ds_write_b128 v5, v[40:43] offset:4096
    ds_write_b128 v5, v[44:47] offset:6144
    ds_write_b128 v5, v[48:51] offset:8192
    s_mov_b32 s34, 0x8c00000
    s_mov_b32 s35, 0x8c5f000
    s_mov_b32 s36, 0x8cbe000
    s_mov_b32 s37, 0x8d1d000
    s_waitcnt lgkmcnt(0)
    s_barrier
HBs_loop:
    ds_read_b128 v[32:35], v6 offset:0
    ds_read_b128 v[36:39], v6 offset:1024
    ds_read_b128 v[40:43], v6 offset:2048
    ds_read_b128 v[44:47], v6 offset:3072
    ds_read_b128 v[48:51], v6 offset:4096
    ds_read_b128 v[52:55], v6 offset:5120
    ds_read_b128 v[56:59], v6 offset:6144
    s_waitcnt lgkmcnt(6)
    v_mfma_f32_16x16x32_bf16 v[112:115], a[0:3], v[32:35], 0
    v_mfma_f32_16x16x32_bf16 v[116:119], a[80:83], v[32:35], 0
    ds_read_b128 v[60:63], v6 offset:7168
    s_waitcnt lgkmcnt(6)
    v_mfma_f32_16x16x32_bf16 v[112:115], a[4:7], v[36:39], v[112:115]
    v_mfma_f32_16x16x32_bf16 v[116:119], a[84:87], v[36:39], v[116:119]
    s_add_u32 s56, s40, 0
    buffer_load_dwordx4 v[128:131], v12, s[8:11], s56 offen sc1
    ds_read_b128 v[64:67], v6 offset:8192
    s_waitcnt lgkmcnt(6)
    v_mfma_f32_16x16x32_bf16 v[112:115], a[8:11], v[40:43], v[112:115]
    v_mfma_f32_16x16x32_bf16 v[116:119], a[88:91], v[40:43], v[116:119]
    ds_read_b128 v[68:71], v6 offset:9216
    s_waitcnt lgkmcnt(6)
    v_mfma_f32_16x16x32_bf16 v[112:115], a[12:15], v[44:47], v[112:115]
    v_mfma_f32_16x16x32_bf16 v[116:119], a[92:95], v[44:47], v[116:119]
    s_add_u32 s56, s40, 0
    buffer_load_dwordx4 v[132:135], v13, s[8:11], s56 offen sc1
    ds_read_b128 v[72:75], v6 offset:10240
    s_waitcnt lgkmcnt(6)
    v_mfma_f32_16x16x32_bf16 v[112:115], a[16:19], v[48:51], v[112:115]
    v_mfma_f32_16x16x32_bf16 v[116:119], a[96:99], v[48:51], v[116:119]
    ds_read_b128 v[76:79], v6 offset:11264
    s_waitcnt lgkmcnt(6)
    v_mfma_f32_16x16x32_bf16 v[112:115], a[20:23], v[52:55], v[112:115]
    v_mfma_f32_16x16x32_bf16 v[116:119], a[100:103], v[52:55], v[116:119]
    s_add_u32 s56, s40, 40960
    buffer_load_dwordx4 v[136:139], v12, s[8:11], s56 offen sc1
    ds_read_b128 v[80:83], v6 offset:12288
    s_waitcnt lgkmcnt(6)
    v_mfma_f32_16x16x32_bf16 v[112:115], a[24:27], v[56:59], v[112:115]
    v_mfma_f32_16x16x32_bf16 v[116:119], a[104:107], v[56:59], v[116:119]
    ds_read_b128 v[84:87], v6 offset:13312
    s_waitcnt lgkmcnt(6)
    v_mfma_f32_16x16x32_bf16 v[112:115], a[28:31], v[60:63], v[112:115]
    v_mfma_f32_16x16x32_bf16 v[116:119], a[108:111], v[60:63], v[116:119]
    s_add_u32 s56, s40, 40960
    buffer_load_dwordx4 v[140:143], v13, s[8:11], s56 offen sc1
    ds_read_b128 v[88:91], v6 offset:14336
    s_waitcnt lgkmcnt(6)
    v_mfma_f32_16x16x32_bf16 v[112:115], a[32:35], v[64:67], v[112:115]
    v_mfma_f32_16x16x32_bf16 v[116:119], a[112:115], v[64:67], v[116:119]
    ds_read_b128 v[92:95], v6 offset:15360
    s_waitcnt lgkmcnt(6)
    v_mfma_f32_16x16x32_bf16 v[112:115], a[36:39], v[68:71], v[112:115]
    v_mfma_f32_16x16x32_bf16 v[116:119], a[116:119], v[68:71], v[116:119]
    s_add_u32 s56, s40, 81920
    buffer_load_dwordx4 v[144:147], v12, s[8:11], s56 offen sc1
    ds_read_b128 v[96:99], v6 offset:16384
    s_waitcnt lgkmcnt(6)
    v_mfma_f32_16x16x32_bf16 v[112:115], a[40:43], v[72:75], v[112:115]
    v_mfma_f32_16x16x32_bf16 v[116:119], a[120:123], v[72:75], v[116:119]
    ds_read_b128 v[100:103], v6 offset:17408
    s_waitcnt lgkmcnt(6)
    v_mfma_f32_16x16x32_bf16 v[112:115], a[44:47], v[76:79], v[112:115]
    v_mfma_f32_16x16x32_bf16 v[116:119], a[124:127], v[76:79], v[116:119]
    s_add_u32 s56, s40, 81920
    buffer_load_dwordx4 v[148:151], v13, s[8:11], s56 offen sc1
    ds_read_b128 v[104:107], v6 offset:18432
    s_waitcnt lgkmcnt(6)
    v_mfma_f32_16x16x32_bf16 v[112:115], a[48:51], v[80:83], v[112:115]
    v_mfma_f32_16x16x32_bf16 v[116:119], a[128:131], v[80:83], v[116:119]
    ds_read_b128 v[108:111], v6 offset:19456
    s_waitcnt lgkmcnt(6)
    v_mfma_f32_16x16x32_bf16 v[112:115], a[52:55], v[84:87], v[112:115]
    v_mfma_f32_16x16x32_bf16 v[116:119], a[132:135], v[84:87], v[116:119]
    s_add_u32 s56, s40, 122880
    buffer_load_dwordx4 v[152:155], v12, s[8:11], s56 offen sc1
    s_waitcnt lgkmcnt(5)
    v_mfma_f32_16x16x32_bf16 v[112:115], a[56:59], v[88:91], v[112:115]
    v_mfma_f32_16x16x32_bf16 v[116:119], a[136:139], v[88:91], v[116:119]
    s_waitcnt lgkmcnt(4)
    v_mfma_f32_16x16x32_bf16 v[112:115], a[60:63], v[92:95], v[112:115]
    v_mfma_f32_16x16x32_bf16 v[116:119], a[140:143], v[92:95], v[116:119]
    s_add_u32 s56, s40, 122880
    buffer_load_dwordx4 v[156:159], v13, s[8:11], s56 offen sc1
    s_waitcnt lgkmcnt(3)
    v_mfma_f32_16x16x32_bf16 v[112:115], a[64:67], v[96:99], v[112:115]
    v_mfma_f32_16x16x32_bf16 v[116:119], a[144:147], v[96:99], v[116:119]
    s_waitcnt lgkmcnt(2)
    v_mfma_f32_16x16x32_bf16 v[112:115], a[68:71], v[100:103], v[112:115]
    v_mfma_f32_16x16x32_bf16 v[116:119], a[148:151], v[100:103], v[116:119]
    s_add_u32 s56, s40, 0
    buffer_load_dwordx4 v[160:163], v14, s[8:11], s56 offen sc1
    s_waitcnt lgkmcnt(1)
    v_mfma_f32_16x16x32_bf16 v[112:115], a[72:75], v[104:107], v[112:115]
    v_mfma_f32_16x16x32_bf16 v[116:119], a[152:155], v[104:107], v[116:119]
    s_waitcnt lgkmcnt(0)
    v_mfma_f32_16x16x32_bf16 v[112:115], a[76:79], v[108:111], v[112:115]
    v_mfma_f32_16x16x32_bf16 v[116:119], a[156:159], v[108:111], v[116:119]
    s_add_u32 s56, s40, 81920
    buffer_load_dwordx4 v[164:167], v14, s[8:11], s56 offen sc1
    s_nop 7
    v_add_f32_dpp v112, v112, v112 row_ror:8 row_mask:0xf bank_mask:0xf
    v_add_f32_dpp v113, v113, v113 row_ror:8 row_mask:0xf bank_mask:0xf
    v_add_f32_dpp v114, v114, v114 row_ror:8 row_mask:0xf bank_mask:0xf
    v_add_f32_dpp v115, v115, v115 row_ror:8 row_mask:0xf bank_mask:0xf
    v_add_f32_dpp v116, v116, v116 row_ror:8 row_mask:0xf bank_mask:0xf
    v_add_f32_dpp v117, v117, v117 row_ror:8 row_mask:0xf bank_mask:0xf
    v_add_f32_dpp v118, v118, v118 row_ror:8 row_mask:0xf bank_mask:0xf
    v_add_f32_dpp v119, v119, v119 row_ror:8 row_mask:0xf bank_mask:0xf
    v_cvt_pk_bf16_f32 v168, v112, v113
    v_cvt_pk_bf16_f32 v169, v114, v115
    v_cvt_pk_bf16_f32 v170, v116, v117
    v_cvt_pk_bf16_f32 v171, v118, v119
    ds_write_b128 v15, v[168:171]
    s_waitcnt lgkmcnt(0)
    s_barrier
    ds_read_b128 v[32:35], v6 offset:20480
    ds_read_b128 v[36:39], v6 offset:23552
    ds_read_b128 v[40:43], v6 offset:26624
    ds_read_b128 v[44:47], v6 offset:29696
    s_waitcnt lgkmcnt(0)
    v_mfma_f32_16x16x32_bf16 v[48:51], v[32:35], a[160:163], 0
    v_mfma_f32_16x16x32_bf16 v[52:55], v[32:35], a[176:179], 0
    v_mfma_f32_16x16x32_bf16 v[48:51], v[36:39], a[164:167], v[48:51]
    v_mfma_f32_16x16x32_bf16 v[52:55], v[36:39], a[180:183], v[52:55]
    v_mfma_f32_16x16x32_bf16 v[48:51], v[40:43], a[168:171], v[48:51]
    v_mfma_f32_16x16x32_bf16 v[52:55], v[40:43], a[184:187], v[52:55]
    v_mfma_f32_16x16x32_bf16 v[48:51], v[44:47], a[172:175], v[48:51]
    v_mfma_f32_16x16x32_bf16 v[52:55], v[44:47], a[188:191], v[52:55]
    v_mfma_f32_16x16x32_bf16 v[56:59], v[32:35], a[192:195], 0
    v_mfma_f32_16x16x32_bf16 v[60:63], v[32:35], a[208:211], 0
    v_mfma_f32_16x16x32_bf16 v[56:59], v[36:39], a[196:199], v[56:59]
    v_mfma_f32_16x16x32_bf16 v[60:63], v[36:39], a[212:215], v[60:63]
    v_mfma_f32_16x16x32_bf16 v[56:59], v[40:43], a[200:203], v[56:59]
    v_mfma_f32_16x16x32_bf16 v[60:63], v[40:43], a[216:219], v[60:63]
    v_mfma_f32_16x16x32_bf16 v[56:59], v[44:47], a[204:207], v[56:59]
    v_cvt_pk_bf16_f32 v112, v48, v49
    v_cvt_pk_bf16_f32 v113, v50, v51
    v_mfma_f32_16x16x32_bf16 v[60:63], v[44:47], a[220:223], v[60:63]
    v_cvt_pk_bf16_f32 v114, v52, v53
    v_cvt_pk_bf16_f32 v115, v54, v55
    v_cndmask_b32 v100, v114, v112, s[52:53]
    v_cndmask_b32 v101, v115, v113, s[52:53]
    s_add_u32 s56, s34, 0
    buffer_store_dwordx2 v[100:101], v26, s[8:11], s56 offen sc1
    v_mfma_f32_16x16x32_bf16 v[64:67], v[32:35], a[224:227], 0
    v_mfma_f32_16x16x32_bf16 v[68:71], v[32:35], a[240:243], 0
    v_mfma_f32_16x16x32_bf16 v[64:67], v[36:39], a[228:231], v[64:67]
    v_mfma_f32_16x16x32_bf16 v[68:71], v[36:39], a[244:247], v[68:71]
    v_mfma_f32_16x16x32_bf16 v[64:67], v[40:43], a[232:235], v[64:67]
    v_mfma_f32_16x16x32_bf16 v[68:71], v[40:43], a[248:251], v[68:71]
    v_mfma_f32_16x16x32_bf16 v[64:67], v[44:47], a[236:239], v[64:67]
    v_cvt_pk_bf16_f32 v112, v56, v57
    v_cvt_pk_bf16_f32 v113, v58, v59
    v_mfma_f32_16x16x32_bf16 v[68:71], v[44:47], a[252:255], v[68:71]
    v_cvt_pk_bf16_f32 v114, v60, v61
    v_cvt_pk_bf16_f32 v115, v62, v63
    v_cndmask_b32 v102, v114, v112, s[52:53]
    v_cndmask_b32 v103, v115, v113, s[52:53]
    s_add_u32 s56, s34, 2048
    buffer_store_dwordx2 v[102:103], v26, s[8:11], s56 offen sc1
    v_mfma_f32_16x16x32_bf16 v[72:75], v[32:35], v[192:195], 0
    v_mfma_f32_16x16x32_bf16 v[76:79], v[32:35], v[208:211], 0
    v_mfma_f32_16x16x32_bf16 v[72:75], v[36:39], v[196:199], v[72:75]
    v_mfma_f32_16x16x32_bf16 v[76:79], v[36:39], v[212:215], v[76:79]
    v_mfma_f32_16x16x32_bf16 v[72:75], v[40:43], v[200:203], v[72:75]
    v_mfma_f32_16x16x32_bf16 v[76:79], v[40:43], v[216:219], v[76:79]
    v_mfma_f32_16x16x32_bf16 v[72:75], v[44:47], v[204:207], v[72:75]
    v_cvt_pk_bf16_f32 v112, v64, v65
    v_cvt_pk_bf16_f32 v113, v66, v67
    v_mfma_f32_16x16x32_bf16 v[76:79], v[44:47], v[220:223], v[76:79]
    v_cvt_pk_bf16_f32 v114, v68, v69
    v_cvt_pk_bf16_f32 v115, v70, v71
    v_cndmask_b32 v104, v114, v112, s[52:53]
    v_cndmask_b32 v105, v115, v113, s[52:53]
    s_add_u32 s56, s34, 4096
    buffer_store_dwordx2 v[104:105], v26, s[8:11], s56 offen sc1
    v_mfma_f32_16x16x32_bf16 v[80:83], v[32:35], v[224:227], 0
    v_mfma_f32_16x16x32_bf16 v[84:87], v[32:35], v[240:243], 0
    v_mfma_f32_16x16x32_bf16 v[80:83], v[36:39], v[228:231], v[80:83]
    v_mfma_f32_16x16x32_bf16 v[84:87], v[36:39], v[244:247], v[84:87]
    v_mfma_f32_16x16x32_bf16 v[80:83], v[40:43], v[232:235], v[80:83]
    v_mfma_f32_16x16x32_bf16 v[84:87], v[40:43], v[248:251], v[84:87]
    v_mfma_f32_16x16x32_bf16 v[80:83], v[44:47], v[236:239], v[80:83]
    v_cvt_pk_bf16_f32 v112, v72, v73
    v_cvt_pk_bf16_f32 v113, v74, v75
    v_mfma_f32_16x16x32_bf16 v[84:87], v[44:47], v[252:255], v[84:87]
    v_cvt_pk_bf16_f32 v114, v76, v77
    v_cvt_pk_bf16_f32 v115, v78, v79
    v_cndmask_b32 v106, v114, v112, s[52:53]
    v_cndmask_b32 v107, v115, v113, s[52:53]
    s_add_u32 s56, s34, 6144
    buffer_store_dwordx2 v[106:107], v26, s[8:11], s56 offen sc1
    s_nop 7
    v_cvt_pk_bf16_f32 v112, v80, v81
    v_cvt_pk_bf16_f32 v113, v82, v83
    v_cvt_pk_bf16_f32 v114, v84, v85
    v_cvt_pk_bf16_f32 v115, v86, v87
    v_cndmask_b32 v108, v114, v112, s[52:53]
    v_cndmask_b32 v109, v115, v113, s[52:53]
    s_add_u32 s56, s34, 8192
    buffer_store_dwordx2 v[108:109], v26, s[8:11], s56 offen sc1
    s_cmp_eq_u32 s33, 63
    s_cbranch_scc1 HBs_last
HBssp_106:
    buffer_load_dwordx4 v[176:179], v9, s[8:11], s34 offen sc1
    buffer_load_dwordx4 v[180:183], v10, s[8:11], s34 offen sc1
    buffer_load_dwordx4 v[184:187], v11, s[8:11], s34 offen sc1
    buffer_load_dwordx4 v[96:99], v8, s[8:11], s34 offen sc1
    buffer_load_dwordx4 v[88:91], v7, s[8:11], s34 offen sc1
    buffer_load_dwordx4 v[92:95], v7, s[8:11], s34 offen offset:1024 sc1
    s_waitcnt vmcnt(0)
    v_max3_u32 v188, v88, v89, v90
    v_max3_u32 v188, v188, v91, v92
    v_max3_u32 v188, v188, v93, v94
    v_max3_u32 v188, v188, v95, v96
    v_max3_u32 v188, v188, v97, v98
    v_max3_u32 v188, v188, v99, v176
    v_max3_u32 v188, v188, v177, v178
    v_max3_u32 v188, v188, v179, v180
    v_max3_u32 v188, v188, v181, v182
    v_max3_u32 v188, v188, v183, v184
    v_max3_u32 v188, v188, v185, v186
    v_max_u32 v188, v188, v187
    v_cmp_eq_u32 vcc, -1, v188
    s_cbranch_vccz HBssd_107
    s_sub_u32 s58, s58, 1
    s_cbranch_scc0 HBssp_106
    s_mov_b32 s58, 0
HBssd_107:
    v_mfma_f32_16x16x32_bf16 v[52:55], v[184:187], v[96:99], 0
    v_mfma_f32_16x16x32_bf16 v[32:35], v[176:179], v[96:99], 0
    v_mfma_f32_16x16x32_bf16 v[36:39], v[136:139], v[88:91], 0
    v_mfma_f32_16x16x32_bf16 v[40:43], v[180:183], v[96:99], 0
    v_mfma_f32_16x16x32_bf16 v[44:47], v[140:143], v[88:91], 0
    v_mfma_f32_16x16x32_bf16 v[48:51], v[160:163], v[88:91], 0
    v_mfma_f32_16x16x32_bf16 v[32:35], v[128:131], v[88:91], v[32:35]
    v_mfma_f32_16x16x32_bf16 v[36:39], v[152:155], v[92:95], v[36:39]
    v_mfma_f32_16x16x32_bf16 v[40:43], v[132:135], v[88:91], v[40:43]
    v_mfma_f32_16x16x32_bf16 v[44:47], v[156:159], v[92:95], v[44:47]
    v_mfma_f32_16x16x32_bf16 v[48:51], v[164:167], v[92:95], v[48:51]
    v_mfma_f32_16x16x32_bf16 v[32:35], v[144:147], v[92:95], v[32:35]
    v_mfma_f32_16x16x32_bf16 v[40:43], v[148:151], v[92:95], v[40:43]
    s_nop 3
    v_cndmask_b32 v52, 0, v52, s[52:53]
    v_cndmask_b32 v53, 0, v53, s[52:53]
    v_cndmask_b32 v54, 0, v54, s[52:53]
    v_cndmask_b32 v55, 0, v55, s[52:53]
    v_pk_add_f32 v[48:49], v[48:49], v[52:53]
    v_pk_add_f32 v[50:51], v[50:51], v[54:55]
    ds_write_b128 v18, v[48:51] offset:2048
    v_add_f32_dpp v32, v36, v32 row_ror:8 row_mask:0xf bank_mask:0xf
    v_add_f32_dpp v33, v37, v33 row_ror:8 row_mask:0xf bank_mask:0xf
    v_add_f32_dpp v34, v38, v34 row_ror:8 row_mask:0xf bank_mask:0xf
    v_add_f32_dpp v35, v39, v35 row_ror:8 row_mask:0xf bank_mask:0xf
    ds_write_b128 v18, v[32:35] offset:0
    v_add_f32_dpp v40, v44, v40 row_ror:8 row_mask:0xf bank_mask:0xf
    v_add_f32_dpp v41, v45, v41 row_ror:8 row_mask:0xf bank_mask:0xf
    v_add_f32_dpp v42, v46, v42 row_ror:8 row_mask:0xf bank_mask:0xf
    v_add_f32_dpp v43, v47, v43 row_ror:8 row_mask:0xf bank_mask:0xf
    ds_write_b128 v18, v[40:43] offset:1024
    s_waitcnt lgkmcnt(0)
    s_barrier
    s_mov_b64 exec, s[50:51]
    s_cbranch_execz HBsmp_108
    ds_read_b128 v[56:59], v19 offset:0
    ds_read_b128 v[60:63], v19 offset:3072
    ds_read_b128 v[64:67], v19 offset:6144
    ds_read_b128 v[68:71], v19 offset:9216
    s_cmp_eq_u32 s32, 2
    s_cbranch_scc0 HBsw2d_109
    ds_read_b128 v[72:75], v19 offset:640
    ds_read_b128 v[76:79], v19 offset:3712
    ds_read_b128 v[80:83], v19 offset:6784
    ds_read_b128 v[84:87], v19 offset:9856
    s_waitcnt lgkmcnt(0)
    v_pk_add_f32 v[56:57], v[56:57], v[72:73]
    v_pk_add_f32 v[58:59], v[58:59], v[74:75]
    v_pk_add_f32 v[60:61], v[60:61], v[76:77]
    v_pk_add_f32 v[62:63], v[62:63], v[78:79]
    v_pk_add_f32 v[64:65], v[64:65], v[80:81]
    v_pk_add_f32 v[66:67], v[66:67], v[82:83]
    v_pk_add_f32 v[68:69], v[68:69], v[84:85]
    v_pk_add_f32 v[70:71], v[70:71], v[86:87]
HBsw2d_109:
    s_waitcnt lgkmcnt(0)
    v_pk_add_f32 v[56:57], v[56:57], v[60:61]
    v_pk_add_f32 v[58:59], v[58:59], v[62:63]
    v_pk_add_f32 v[64:65], v[64:65], v[68:69]
    v_pk_add_f32 v[66:67], v[66:67], v[70:71]
    v_pk_add_f32 v[56:57], v[56:57], v[64:65]
    v_pk_add_f32 v[58:59], v[58:59], v[66:67]
    v_cvt_pk_bf16_f32 v72, v56, v57
    v_cvt_pk_bf16_f32 v73, v58, v59
    buffer_store_dwordx2 v[72:73], v20, s[8:11], s35 offen sc1
    buffer_store_dwordx2 v[72:73], v21, s[8:11], s35 offen sc1
HBsmp_108:
    s_mov_b64 exec, -1
    s_mul_i32 s72, s33, 327680
    s_add_u32 s72, s72, 0x7000000
    s_add_u32 s72, s72, s57
    s_add_u32 s39, s39, 262144
    s_add_u32 s40, s40, 1310720
    s_add_u32 s33, s33, 1
    s_cmp_lt_u32 s33, s74
    s_cbranch_scc1 rdy_110
rdl_111:
    s_and_b32 s54, s33, 1
    buffer_load_dword v188, v30, s[8:11], 0 offen sc1
    s_waitcnt vmcnt(0)
    v_cmp_lt_u32 vcc, 127, v188
    s_nop 1
    v_cmp_gt_u32 vcc, 128, v188
    s_nop 1
    v_cndmask_b32 v188, 0, v188, vcc
    v_max_u32 v188, v188, v31
    s_nop 1
    v_min_u32_dpp v188, v188, v188 row_ror:1 row_mask:0xf bank_mask:0xf
    s_nop 1
    v_min_u32_dpp v188, v188, v188 row_ror:2 row_mask:0xf bank_mask:0xf
    s_nop 1
    v_min_u32_dpp v188, v188, v188 row_ror:4 row_mask:0xf bank_mask:0xf
    s_nop 1
    v_min_u32_dpp v188, v188, v188 row_ror:8 row_mask:0xf bank_mask:0xf
    s_nop 1
    v_readlane_b32 s54, v188, 0
    v_readlane_b32 s55, v188, 16
    v_readlane_b32 s56, v188, 32
    v_readlane_b32 s74, v188, 48
    s_nop 3
    s_min_u32 s54, s54, s55
    s_min_u32 s56, s56, s74
    s_min_u32 s74, s54, s56
    s_cmp_lt_u32 s33, s74
    s_cbranch_scc1 rdy_110
    s_sleep 1
    s_sub_u32 s58, s58, 1
    s_cbranch_scc0 rdl_111
    s_mov_b32 s58, 0
    s_mov_b32 s74, 0x40
rdy_110:
    s_cmp_lt_u32 s32, 2
    s_cbranch_scc1 HBsrem_113
HBssp_114:
    s_add_u32 s55, s35, 4096
    buffer_load_dwordx4 v[52:55], v4, s[8:11], s35 offen offset:0 sc1
    buffer_load_dwordx4 v[56:59], v4, s[8:11], s35 offen offset:1024 sc1
    buffer_load_dwordx4 v[60:63], v4, s[8:11], s35 offen offset:2048 sc1
    buffer_load_dwordx4 v[64:67], v4, s[8:11], s35 offen offset:3072 sc1
    buffer_load_dwordx4 v[68:71], v4, s[8:11], s55 offen sc1
    s_waitcnt vmcnt(0)
    v_max3_u32 v188, v52, v53, v54
    v_max3_u32 v188, v188, v55, v56
    v_max3_u32 v188, v188, v57, v58
    v_max3_u32 v188, v188, v59, v60
    v_max3_u32 v188, v188, v61, v62
    v_max3_u32 v188, v188, v63, v64
    v_max3_u32 v188, v188, v65, v66
    v_max3_u32 v188, v188, v67, v68
    v_max3_u32 v188, v188, v69, v70
    v_max_u32 v188, v188, v71
    v_cmp_eq_u32 vcc, -1, v188
    s_cbranch_vccz HBssd_115
    s_sub_u32 s58, s58, 1
    s_cbranch_scc0 HBssp_114
    s_mov_b32 s58, 0
HBssd_115:
    s_branch HBsjn_112
HBsrem_113:
HBssp_116:
    buffer_load_dwordx4 v[32:35], v27, s[8:11], s35 offen sc1
    s_waitcnt vmcnt(0)
    v_max3_u32 v188, v32, v33, v34
    v_max_u32 v188, v188, v35
    v_cmp_eq_u32 vcc, -1, v188
    s_cbranch_vccz HBssd_117
    s_sub_u32 s58, s58, 1
    s_cbranch_scc0 HBssp_116
    s_mov_b32 s58, 0
HBssd_117:
    s_add_u32 s55, s35, 4096
    buffer_load_dwordx4 v[52:55], v4, s[8:11], s35 offen offset:0 sc1
    buffer_load_dwordx4 v[56:59], v4, s[8:11], s35 offen offset:1024 sc1
    buffer_load_dwordx4 v[60:63], v4, s[8:11], s35 offen offset:2048 sc1
    buffer_load_dwordx4 v[64:67], v4, s[8:11], s35 offen offset:3072 sc1
    buffer_load_dwordx4 v[68:71], v4, s[8:11], s55 offen sc1
    s_waitcnt vmcnt(0)
    v_max3_u32 v188, v52, v53, v54
    v_max3_u32 v188, v188, v55, v56
    v_max3_u32 v188, v188, v57, v58
    v_max3_u32 v188, v188, v59, v60
    v_max3_u32 v188, v188, v61, v62
    v_max3_u32 v188, v188, v63, v64
    v_max3_u32 v188, v188, v65, v66
    v_max3_u32 v188, v188, v67, v68
    v_max3_u32 v188, v188, v69, v70
    v_max_u32 v188, v188, v71
    v_cmp_eq_u32 vcc, -1, v188
    s_cbranch_vccnz HBsrt_119
HBsok_118:
HBsjn_112:
    ds_write_b128 v5, v[52:55] offset:0
    ds_write_b128 v5, v[56:59] offset:2048
    ds_write_b128 v5, v[60:63] offset:4096
    ds_write_b128 v5, v[64:67] offset:6144
    ds_write_b128 v5, v[68:71] offset:8192
    s_mov_b32 s54, s34
    s_mov_b32 s34, s35
    s_mov_b32 s35, s36
    s_mov_b32 s36, s37
    s_mov_b32 s37, s54
    s_waitcnt lgkmcnt(0)
    s_barrier
    s_branch HBs_loop
HBs_last:
    s_mul_i32 s72, s33, 327680
    s_add_u32 s72, s72, 0x7000000
    s_add_u32 s56, s72, 0
    buffer_store_dwordx2 v[100:101], v28, s[8:11], s56 offen sc1
    s_add_u32 s56, s72, 2048
    buffer_store_dwordx2 v[102:103], v28, s[8:11], s56 offen sc1
    s_add_u32 s56, s72, 4096
    buffer_store_dwordx2 v[104:105], v28, s[8:11], s56 offen sc1
    s_add_u32 s56, s72, 6144
    buffer_store_dwordx2 v[106:107], v28, s[8:11], s56 offen sc1
    s_add_u32 s56, s72, 8192
    buffer_store_dwordx2 v[108:109], v28, s[8:11], s56 offen sc1
    s_waitcnt vmcnt(0)
    s_barrier
    s_cmp_eq_u32 s32, 0
    s_cbranch_scc0 ce_120
    s_add_u32 s75, s75, 128
    s_mov_b32 s54, 0x40
    v_mov_b32 v189, s54
    v_mov_b32 v190, 0
    s_mov_b64 exec, 1
    buffer_store_dword v189, v190, s[8:11], s75 offen sc1
    s_mov_b64 exec, -1
    s_waitcnt vmcnt(0)
ce_120:
    s_endpgm
HBsrt_119:
    s_sub_u32 s58, s58, 1
    s_cbranch_scc1 HBsbad_121
    s_add_u32 s55, s35, 4096
    buffer_load_dwordx4 v[52:55], v4, s[8:11], s35 offen offset:0 sc1
    buffer_load_dwordx4 v[56:59], v4, s[8:11], s35 offen offset:1024 sc1
    buffer_load_dwordx4 v[60:63], v4, s[8:11], s35 offen offset:2048 sc1
    buffer_load_dwordx4 v[64:67], v4, s[8:11], s35 offen offset:3072 sc1
    buffer_load_dwordx4 v[68:71], v4, s[8:11], s55 offen sc1
    s_waitcnt vmcnt(0)
    v_max3_u32 v188, v52, v53, v54
    v_max3_u32 v188, v188, v55, v56
    v_max3_u32 v188, v188, v57, v58
    v_max3_u32 v188, v188, v59, v60
    v_max3_u32 v188, v188, v61, v62
    v_max3_u32 v188, v188, v63, v64
    v_max3_u32 v188, v188, v65, v66
    v_max3_u32 v188, v188, v67, v68
    v_max3_u32 v188, v188, v69, v70
    v_max_u32 v188, v188, v71
    v_cmp_eq_u32 vcc, -1, v188
    s_cbranch_vccnz HBsrt_119
    s_branch HBsok_118
HBsbad_121:
    s_mov_b32 s58, 0
    s_branch HBsok_118
f_work:
    s_cmp_eq_u32 s32, 0
    s_cbranch_scc0 Ftk_122
    s_mov_b32 s54, 0x20
    v_mov_b32 v4, 1
    v_mov_b32 v5, s54
    v_mov_b32 v6, 0
    s_mov_b64 exec, 1
    buffer_atomic_add v4, v5, s[20:23], 0 offen sc0
    s_waitcnt vmcnt(0)
    ds_write_b32 v6, v4
    s_waitcnt lgkmcnt(0)
    s_mov_b64 exec, -1
Ftk_122:
    s_barrier
    v_mov_b32 v6, 0
    ds_read_b32 v4, v6
    s_waitcnt lgkmcnt(0)
    v_readfirstlane_b32 s40, v4
    s_barrier
    s_cmp_ge_u32 s40, 192
    s_cbranch_scc1 f_spare
    s_cmp_ge_u32 s40, 128
    s_cbranch_scc1 f_aq
    s_mov_b32 s24, s76
    s_and_b32 s25, s77, 0xffff
    s_mov_b32 s26, 0x280000
    s_mov_b32 s27, 0x00020000
    s_and_b32 s33, s40, 1
    s_mov_b32 s35, 0x2
    s_lshr_b32 s30, s40, 2
    s_mov_b32 s45, s33
    s_bfe_u32 s54, s40, 0x10001
    s_lshl_b32 s54, s54, 6
    s_lshl_b32 s55, s33, 5
    s_add_u32 s54, s54, s55
    s_add_u32 s54, s54, s30
    s_lshl_b32 s41, s54, 2
    s_add_u32 s41, s41, 0xa600000
    s_bitcmp1_b32 s40, 1
    s_cbranch_scc1 f_pB
    s_mov_b32 s12, s84
    s_and_b32 s13, s85, 0xffff
    s_mov_b32 s14, 0x500000
    s_mov_b32 s15, 0x00020000
    s_mov_b32 s16, s86
    s_and_b32 s17, s87, 0xffff
    s_mov_b32 s18, 0x500000
    s_mov_b32 s19, 0x00020000
    s_lshr_b32 s56, s32, 1
    s_lshl_b32 s56, s56, 3
    v_lshlrev_b32 v172, 1, v3
    v_add_u32 v172, s56, v172
    v_xor_b32 v172, v172, v2
    v_lshlrev_b32 v172, 4, v172
    s_lshl_b32 s56, s32, 2
    v_add_u32 v173, s56, v3
    v_lshlrev_b32 v168, 13, v173
    v_add_u32 v168, v168, v172
    s_lshl_b32 s56, s32, 1
    s_lshl_b32 s56, s56, 1
    v_bfe_u32 v172, v1, 1, 1
    v_add_u32 v172, s56, v172
    v_lshrrev_b32 v173, 2, v2
    v_lshlrev_b32 v173, 1, v173
    v_and_b32 v170, 1, v3
    v_lshl_add_u32 v173, v170, 3, v173
    v_xor_b32 v172, v172, v173
    v_lshlrev_b32 v172, 4, v172
    v_and_b32 v173, 1, v1
    v_lshl_add_u32 v172, v173, 3, v172
    v_lshrrev_b32 v173, 2, v2
    v_mad_u32_u24 v173, v3, 8, v173
    v_lshl_add_u32 v170, v173, 8, v172
    s_lshl_b32 s56, s32, 1
    s_add_u32 s56, s56, 1
    s_lshl_b32 s56, s56, 1
    v_bfe_u32 v172, v1, 1, 1
    v_add_u32 v172, s56, v172
    v_lshrrev_b32 v173, 2, v2
    v_lshlrev_b32 v173, 1, v173
    v_and_b32 v171, 1, v3
    v_lshl_add_u32 v173, v171, 3, v173
    v_xor_b32 v172, v172, v173
    v_lshlrev_b32 v172, 4, v172
    v_and_b32 v173, 1, v1
    v_lshl_add_u32 v172, v173, 3, v172
    v_lshrrev_b32 v173, 2, v2
    v_mad_u32_u24 v173, v3, 8, v173
    v_lshl_add_u32 v171, v173, 8, v172
    s_lshl_b32 s54, s30, 8
    s_add_u32 s55, s54, 0x0
    s_lshl_b32 s56, s32, 10
    s_add_u32 m0, s56, 0x0
    s_nop 0
    buffer_load_dwordx4 v168, s[12:15], s55 offen lds
    s_add_u32 s55, s54, 0x20000
    s_lshl_b32 s56, s32, 10
    s_add_u32 m0, s56, 0x1000
    s_nop 0
    buffer_load_dwordx4 v168, s[12:15], s55 offen lds
    s_add_u32 s55, s54, 0x40000
    s_lshl_b32 s56, s32, 10
    s_add_u32 m0, s56, 0x2000
    s_nop 0
    buffer_load_dwordx4 v168, s[12:15], s55 offen lds
    s_add_u32 s55, s54, 0x60000
    s_lshl_b32 s56, s32, 10
    s_add_u32 m0, s56, 0x3000
    s_nop 0
    buffer_load_dwordx4 v168, s[12:15], s55 offen lds
    s_add_u32 s55, s54, 0x80000
    s_lshl_b32 s56, s32, 10
    s_add_u32 m0, s56, 0x4000
    s_nop 0
    buffer_load_dwordx4 v168, s[12:15], s55 offen lds
    s_add_u32 s55, s54, 0xa0000
    s_lshl_b32 s56, s32, 10
    s_add_u32 m0, s56, 0x5000
    s_nop 0
    buffer_load_dwordx4 v168, s[12:15], s55 offen lds
    s_add_u32 s55, s54, 0xc0000
    s_lshl_b32 s56, s32, 10
    s_add_u32 m0, s56, 0x6000
    s_nop 0
    buffer_load_dwordx4 v168, s[12:15], s55 offen lds
    s_add_u32 s55, s54, 0xe0000
    s_lshl_b32 s56, s32, 10
    s_add_u32 m0, s56, 0x7000
    s_nop 0
    buffer_load_dwordx4 v168, s[12:15], s55 offen lds
    s_add_u32 s55, s54, 0x100000
    s_lshl_b32 s56, s32, 10
    s_add_u32 m0, s56, 0x8000
    s_nop 0
    buffer_load_dwordx4 v168, s[12:15], s55 offen lds
    s_add_u32 s55, s54, 0x120000
    s_lshl_b32 s56, s32, 10
    s_add_u32 m0, s56, 0x9000
    s_nop 0
    buffer_load_dwordx4 v168, s[12:15], s55 offen lds
    s_add_u32 s55, s54, 0x140000
    s_lshl_b32 s56, s32, 10
    s_add_u32 m0, s56, 0xa000
    s_nop 0
    buffer_load_dwordx4 v168, s[12:15], s55 offen lds
    s_add_u32 s55, s54, 0x160000
    s_lshl_b32 s56, s32, 10
    s_add_u32 m0, s56, 0xb000
    s_nop 0
    buffer_load_dwordx4 v168, s[12:15], s55 offen lds
    s_add_u32 s55, s54, 0x180000
    s_lshl_b32 s56, s32, 10
    s_add_u32 m0, s56, 0xc000
    s_nop 0
    buffer_load_dwordx4 v168, s[12:15], s55 offen lds
    s_add_u32 s55, s54, 0x1a0000
    s_lshl_b32 s56, s32, 10
    s_add_u32 m0, s56, 0xd000
    s_nop 0
    buffer_load_dwordx4 v168, s[12:15], s55 offen lds
    s_add_u32 s55, s54, 0x1c0000
    s_lshl_b32 s56, s32, 10
    s_add_u32 m0, s56, 0xe000
    s_nop 0
    buffer_load_dwordx4 v168, s[12:15], s55 offen lds
    s_add_u32 s55, s54, 0x1e0000
    s_lshl_b32 s56, s32, 10
    s_add_u32 m0, s56, 0xf000
    s_nop 0
    buffer_load_dwordx4 v168, s[12:15], s55 offen lds
    s_add_u32 s55, s54, 0x200000
    s_lshl_b32 s56, s32, 10
    s_add_u32 m0, s56, 0x10000
    s_nop 0
    buffer_load_dwordx4 v168, s[12:15], s55 offen lds
    s_add_u32 s55, s54, 0x220000
    s_lshl_b32 s56, s32, 10
    s_add_u32 m0, s56, 0x11000
    s_nop 0
    buffer_load_dwordx4 v168, s[12:15], s55 offen lds
    s_add_u32 s55, s54, 0x240000
    s_lshl_b32 s56, s32, 10
    s_add_u32 m0, s56, 0x12000
    s_nop 0
    buffer_load_dwordx4 v168, s[12:15], s55 offen lds
    s_add_u32 s55, s54, 0x260000
    s_lshl_b32 s56, s32, 10
    s_add_u32 m0, s56, 0x13000
    s_nop 0
    buffer_load_dwordx4 v168, s[12:15], s55 offen lds
    s_add_u32 s55, s54, 0x280000
    s_lshl_b32 s56, s32, 10
    s_add_u32 m0, s56, 0x14000
    s_nop 0
    buffer_load_dwordx4 v168, s[12:15], s55 offen lds
    s_add_u32 s55, s54, 0x2a0000
    s_lshl_b32 s56, s32, 10
    s_add_u32 m0, s56, 0x15000
    s_nop 0
    buffer_load_dwordx4 v168, s[12:15], s55 offen lds
    s_add_u32 s55, s54, 0x2c0000
    s_lshl_b32 s56, s32, 10
    s_add_u32 m0, s56, 0x16000
    s_nop 0
    buffer_load_dwordx4 v168, s[12:15], s55 offen lds
    s_add_u32 s55, s54, 0x2e0000
    s_lshl_b32 s56, s32, 10
    s_add_u32 m0, s56, 0x17000
    s_nop 0
    buffer_load_dwordx4 v168, s[12:15], s55 offen lds
    s_add_u32 s55, s54, 0x300000
    s_lshl_b32 s56, s32, 10
    s_add_u32 m0, s56, 0x18000
    s_nop 0
    buffer_load_dwordx4 v168, s[12:15], s55 offen lds
    s_add_u32 s55, s54, 0x320000
    s_lshl_b32 s56, s32, 10
    s_add_u32 m0, s56, 0x19000
    s_nop 0
    buffer_load_dwordx4 v168, s[12:15], s55 offen lds
    s_add_u32 s55, s54, 0x340000
    s_lshl_b32 s56, s32, 10
    s_add_u32 m0, s56, 0x1a000
    s_nop 0
    buffer_load_dwordx4 v168, s[12:15], s55 offen lds
    s_add_u32 s55, s54, 0x360000
    s_lshl_b32 s56, s32, 10
    s_add_u32 m0, s56, 0x1b000
    s_nop 0
    buffer_load_dwordx4 v168, s[12:15], s55 offen lds
    s_add_u32 s55, s54, 0x380000
    s_lshl_b32 s56, s32, 10
    s_add_u32 m0, s56, 0x1c000
    s_nop 0
    buffer_load_dwordx4 v168, s[12:15], s55 offen lds
    s_add_u32 s55, s54, 0x3a0000
    s_lshl_b32 s56, s32, 10
    s_add_u32 m0, s56, 0x1d000
    s_nop 0
    buffer_load_dwordx4 v168, s[12:15], s55 offen lds
    s_add_u32 s55, s54, 0x3c0000
    s_lshl_b32 s56, s32, 10
    s_add_u32 m0, s56, 0x1e000
    s_nop 0
    buffer_load_dwordx4 v168, s[12:15], s55 offen lds
    s_add_u32 s55, s54, 0x3e0000
    s_lshl_b32 s56, s32, 10
    s_add_u32 m0, s56, 0x1f000
    s_nop 0
    buffer_load_dwordx4 v168, s[12:15], s55 offen lds
    s_add_u32 s55, s54, 0x400000
    s_lshl_b32 s56, s32, 10
    s_add_u32 m0, s56, 0x20000
    s_nop 0
    buffer_load_dwordx4 v168, s[12:15], s55 offen lds
    s_add_u32 s55, s54, 0x420000
    s_lshl_b32 s56, s32, 10
    s_add_u32 m0, s56, 0x21000
    s_nop 0
    buffer_load_dwordx4 v168, s[12:15], s55 offen lds
    s_add_u32 s55, s54, 0x440000
    s_lshl_b32 s56, s32, 10
    s_add_u32 m0, s56, 0x22000
    s_nop 0
    buffer_load_dwordx4 v168, s[12:15], s55 offen lds
    s_add_u32 s55, s54, 0x460000
    s_lshl_b32 s56, s32, 10
    s_add_u32 m0, s56, 0x23000
    s_nop 0
    buffer_load_dwordx4 v168, s[12:15], s55 offen lds
    s_add_u32 s55, s54, 0x480000
    s_lshl_b32 s56, s32, 10
    s_add_u32 m0, s56, 0x24000
    s_nop 0
    buffer_load_dwordx4 v168, s[12:15], s55 offen lds
    s_add_u32 s55, s54, 0x4a0000
    s_lshl_b32 s56, s32, 10
    s_add_u32 m0, s56, 0x25000
    s_nop 0
    buffer_load_dwordx4 v168, s[12:15], s55 offen lds
    s_add_u32 s55, s54, 0x4c0000
    s_lshl_b32 s56, s32, 10
    s_add_u32 m0, s56, 0x26000
    s_nop 0
    buffer_load_dwordx4 v168, s[12:15], s55 offen lds
    s_add_u32 s55, s54, 0x4e0000
    s_lshl_b32 s56, s32, 10
    s_add_u32 m0, s56, 0x27000
    s_nop 0
    buffer_load_dwordx4 v168, s[12:15], s55 offen lds
    s_waitcnt vmcnt(20)
    s_barrier
    v_add_u32 v172, 0x0, v170
    v_add_u32 v173, 0x0, v171
    ds_read_b64_tr_b16 a[0:1], v172 offset:0
    ds_read_b64_tr_b16 a[2:3], v172 offset:1024
    ds_read_b64_tr_b16 a[4:5], v172 offset:8192
    ds_read_b64_tr_b16 a[6:7], v172 offset:9216
    ds_read_b64_tr_b16 a[8:9], v172 offset:16384
    ds_read_b64_tr_b16 a[10:11], v172 offset:17408
    ds_read_b64_tr_b16 a[12:13], v172 offset:24576
    ds_read_b64_tr_b16 a[14:15], v172 offset:25600
    ds_read_b64_tr_b16 a[16:17], v172 offset:32768
    ds_read_b64_tr_b16 a[18:19], v172 offset:33792
    ds_read_b64_tr_b16 a[80:81], v173 offset:0
    ds_read_b64_tr_b16 a[82:83], v173 offset:1024
    ds_read_b64_tr_b16 a[84:85], v173 offset:8192
    ds_read_b64_tr_b16 a[86:87], v173 offset:9216
    ds_read_b64_tr_b16 a[88:89], v173 offset:16384
    ds_read_b64_tr_b16 a[90:91], v173 offset:17408
    ds_read_b64_tr_b16 a[92:93], v173 offset:24576
    ds_read_b64_tr_b16 a[94:95], v173 offset:25600
    ds_read_b64_tr_b16 a[96:97], v173 offset:32768
    ds_read_b64_tr_b16 a[98:99], v173 offset:33792
    s_waitcnt lgkmcnt(0)
    v_add_u32 v172, 0xa000, v170
    v_add_u32 v173, 0xa000, v171
    ds_read_b64_tr_b16 a[20:21], v172 offset:0
    ds_read_b64_tr_b16 a[22:23], v172 offset:1024
    ds_read_b64_tr_b16 a[24:25], v172 offset:8192
    ds_read_b64_tr_b16 a[26:27], v172 offset:9216
    ds_read_b64_tr_b16 a[28:29], v172 offset:16384
    ds_read_b64_tr_b16 a[30:31], v172 offset:17408
    ds_read_b64_tr_b16 a[32:33], v172 offset:24576
    ds_read_b64_tr_b16 a[34:35], v172 offset:25600
    ds_read_b64_tr_b16 a[36:37], v172 offset:32768
    ds_read_b64_tr_b16 a[38:39], v172 offset:33792
    ds_read_b64_tr_b16 a[100:101], v173 offset:0
    ds_read_b64_tr_b16 a[102:103], v173 offset:1024
    ds_read_b64_tr_b16 a[104:105], v173 offset:8192
    ds_read_b64_tr_b16 a[106:107], v173 offset:9216
    ds_read_b64_tr_b16 a[108:109], v173 offset:16384
    ds_read_b64_tr_b16 a[110:111], v173 offset:17408
    ds_read_b64_tr_b16 a[112:113], v173 offset:24576
    ds_read_b64_tr_b16 a[114:115], v173 offset:25600
    ds_read_b64_tr_b16 a[116:117], v173 offset:32768
    ds_read_b64_tr_b16 a[118:119], v173 offset:33792
    s_waitcnt lgkmcnt(0)
    s_barrier
    s_add_u32 s55, s54, 0x0
    s_lshl_b32 s56, s32, 10
    s_add_u32 m0, s56, 0x0
    s_nop 0
    buffer_load_dwordx4 v168, s[16:19], s55 offen lds
    s_add_u32 s55, s54, 0x20000
    s_lshl_b32 s56, s32, 10
    s_add_u32 m0, s56, 0x1000
    s_nop 0
    buffer_load_dwordx4 v168, s[16:19], s55 offen lds
    s_add_u32 s55, s54, 0x40000
    s_lshl_b32 s56, s32, 10
    s_add_u32 m0, s56, 0x2000
    s_nop 0
    buffer_load_dwordx4 v168, s[16:19], s55 offen lds
    s_add_u32 s55, s54, 0x60000
    s_lshl_b32 s56, s32, 10
    s_add_u32 m0, s56, 0x3000
    s_nop 0
    buffer_load_dwordx4 v168, s[16:19], s55 offen lds
    s_add_u32 s55, s54, 0x80000
    s_lshl_b32 s56, s32, 10
    s_add_u32 m0, s56, 0x4000
    s_nop 0
    buffer_load_dwordx4 v168, s[16:19], s55 offen lds
    s_add_u32 s55, s54, 0xa0000
    s_lshl_b32 s56, s32, 10
    s_add_u32 m0, s56, 0x5000
    s_nop 0
    buffer_load_dwordx4 v168, s[16:19], s55 offen lds
    s_add_u32 s55, s54, 0xc0000
    s_lshl_b32 s56, s32, 10
    s_add_u32 m0, s56, 0x6000
    s_nop 0
    buffer_load_dwordx4 v168, s[16:19], s55 offen lds
    s_add_u32 s55, s54, 0xe0000
    s_lshl_b32 s56, s32, 10
    s_add_u32 m0, s56, 0x7000
    s_nop 0
    buffer_load_dwordx4 v168, s[16:19], s55 offen lds
    s_add_u32 s55, s54, 0x100000
    s_lshl_b32 s56, s32, 10
    s_add_u32 m0, s56, 0x8000
    s_nop 0
    buffer_load_dwordx4 v168, s[16:19], s55 offen lds
    s_add_u32 s55, s54, 0x120000
    s_lshl_b32 s56, s32, 10
    s_add_u32 m0, s56, 0x9000
    s_nop 0
    buffer_load_dwordx4 v168, s[16:19], s55 offen lds
    s_add_u32 s55, s54, 0x140000
    s_lshl_b32 s56, s32, 10
    s_add_u32 m0, s56, 0xa000
    s_nop 0
    buffer_load_dwordx4 v168, s[16:19], s55 offen lds
    s_add_u32 s55, s54, 0x160000
    s_lshl_b32 s56, s32, 10
    s_add_u32 m0, s56, 0xb000
    s_nop 0
    buffer_load_dwordx4 v168, s[16:19], s55 offen lds
    s_add_u32 s55, s54, 0x180000
    s_lshl_b32 s56, s32, 10
    s_add_u32 m0, s56, 0xc000
    s_nop 0
    buffer_load_dwordx4 v168, s[16:19], s55 offen lds
    s_add_u32 s55, s54, 0x1a0000
    s_lshl_b32 s56, s32, 10
    s_add_u32 m0, s56, 0xd000
    s_nop 0
    buffer_load_dwordx4 v168, s[16:19], s55 offen lds
    s_add_u32 s55, s54, 0x1c0000
    s_lshl_b32 s56, s32, 10
    s_add_u32 m0, s56, 0xe000
    s_nop 0
    buffer_load_dwordx4 v168, s[16:19], s55 offen lds
    s_add_u32 s55, s54, 0x1e0000
    s_lshl_b32 s56, s32, 10
    s_add_u32 m0, s56, 0xf000
    s_nop 0
    buffer_load_dwordx4 v168, s[16:19], s55 offen lds
    s_add_u32 s55, s54, 0x200000
    s_lshl_b32 s56, s32, 10
    s_add_u32 m0, s56, 0x10000
    s_nop 0
    buffer_load_dwordx4 v168, s[16:19], s55 offen lds
    s_add_u32 s55, s54, 0x220000
    s_lshl_b32 s56, s32, 10
    s_add_u32 m0, s56, 0x11000
    s_nop 0
    buffer_load_dwordx4 v168, s[16:19], s55 offen lds
    s_add_u32 s55, s54, 0x240000
    s_lshl_b32 s56, s32, 10
    s_add_u32 m0, s56, 0x12000
    s_nop 0
    buffer_load_dwordx4 v168, s[16:19], s55 offen lds
    s_add_u32 s55, s54, 0x260000
    s_lshl_b32 s56, s32, 10
    s_add_u32 m0, s56, 0x13000
    s_nop 0
    buffer_load_dwordx4 v168, s[16:19], s55 offen lds
    s_waitcnt vmcnt(20)
    s_barrier
    v_add_u32 v172, 0x14000, v170
    v_add_u32 v173, 0x14000, v171
    ds_read_b64_tr_b16 a[40:41], v172 offset:0
    ds_read_b64_tr_b16 a[42:43], v172 offset:1024
    ds_read_b64_tr_b16 a[44:45], v172 offset:8192
    ds_read_b64_tr_b16 a[46:47], v172 offset:9216
    ds_read_b64_tr_b16 a[48:49], v172 offset:16384
    ds_read_b64_tr_b16 a[50:51], v172 offset:17408
    ds_read_b64_tr_b16 a[52:53], v172 offset:24576
    ds_read_b64_tr_b16 a[54:55], v172 offset:25600
    ds_read_b64_tr_b16 a[56:57], v172 offset:32768
    ds_read_b64_tr_b16 a[58:59], v172 offset:33792
    ds_read_b64_tr_b16 a[120:121], v173 offset:0
    ds_read_b64_tr_b16 a[122:123], v173 offset:1024
    ds_read_b64_tr_b16 a[124:125], v173 offset:8192
    ds_read_b64_tr_b16 a[126:127], v173 offset:9216
    ds_read_b64_tr_b16 a[128:129], v173 offset:16384
    ds_read_b64_tr_b16 a[130:131], v173 offset:17408
    ds_read_b64_tr_b16 a[132:133], v173 offset:24576
    ds_read_b64_tr_b16 a[134:135], v173 offset:25600
    ds_read_b64_tr_b16 a[136:137], v173 offset:32768
    ds_read_b64_tr_b16 a[138:139], v173 offset:33792
    s_waitcnt lgkmcnt(0)
    v_add_u32 v172, 0x1e000, v170
    v_add_u32 v173, 0x1e000, v171
    ds_read_b64_tr_b16 a[60:61], v172 offset:0
    ds_read_b64_tr_b16 a[62:63], v172 offset:1024
    ds_read_b64_tr_b16 a[64:65], v172 offset:8192
    ds_read_b64_tr_b16 a[66:67], v172 offset:9216
    ds_read_b64_tr_b16 a[68:69], v172 offset:16384
    ds_read_b64_tr_b16 a[70:71], v172 offset:17408
    ds_read_b64_tr_b16 a[72:73], v172 offset:24576
    ds_read_b64_tr_b16 a[74:75], v172 offset:25600
    ds_read_b64_tr_b16 a[76:77], v172 offset:32768
    ds_read_b64_tr_b16 a[78:79], v172 offset:33792
    ds_read_b64_tr_b16 a[140:141], v173 offset:0
    ds_read_b64_tr_b16 a[142:143], v173 offset:1024
    ds_read_b64_tr_b16 a[144:145], v173 offset:8192
    ds_read_b64_tr_b16 a[146:147], v173 offset:9216
    ds_read_b64_tr_b16 a[148:149], v173 offset:16384
    ds_read_b64_tr_b16 a[150:151], v173 offset:17408
    ds_read_b64_tr_b16 a[152:153], v173 offset:24576
    ds_read_b64_tr_b16 a[154:155], v173 offset:25600
    ds_read_b64_tr_b16 a[156:157], v173 offset:32768
    ds_read_b64_tr_b16 a[158:159], v173 offset:33792
    s_waitcnt lgkmcnt(0)
    s_barrier
    s_add_u32 s55, s54, 0x280000
    s_lshl_b32 s56, s32, 10
    s_add_u32 m0, s56, 0x14000
    s_nop 0
    buffer_load_dwordx4 v168, s[16:19], s55 offen lds
    s_add_u32 s55, s54, 0x2a0000
    s_lshl_b32 s56, s32, 10
    s_add_u32 m0, s56, 0x15000
    s_nop 0
    buffer_load_dwordx4 v168, s[16:19], s55 offen lds
    s_add_u32 s55, s54, 0x2c0000
    s_lshl_b32 s56, s32, 10
    s_add_u32 m0, s56, 0x16000
    s_nop 0
    buffer_load_dwordx4 v168, s[16:19], s55 offen lds
    s_add_u32 s55, s54, 0x2e0000
    s_lshl_b32 s56, s32, 10
    s_add_u32 m0, s56, 0x17000
    s_nop 0
    buffer_load_dwordx4 v168, s[16:19], s55 offen lds
    s_add_u32 s55, s54, 0x300000
    s_lshl_b32 s56, s32, 10
    s_add_u32 m0, s56, 0x18000
    s_nop 0
    buffer_load_dwordx4 v168, s[16:19], s55 offen lds
    s_add_u32 s55, s54, 0x320000
    s_lshl_b32 s56, s32, 10
    s_add_u32 m0, s56, 0x19000
    s_nop 0
    buffer_load_dwordx4 v168, s[16:19], s55 offen lds
    s_add_u32 s55, s54, 0x340000
    s_lshl_b32 s56, s32, 10
    s_add_u32 m0, s56, 0x1a000
    s_nop 0
    buffer_load_dwordx4 v168, s[16:19], s55 offen lds
    s_add_u32 s55, s54, 0x360000
    s_lshl_b32 s56, s32, 10
    s_add_u32 m0, s56, 0x1b000
    s_nop 0
    buffer_load_dwordx4 v168, s[16:19], s55 offen lds
    s_add_u32 s55, s54, 0x380000
    s_lshl_b32 s56, s32, 10
    s_add_u32 m0, s56, 0x1c000
    s_nop 0
    buffer_load_dwordx4 v168, s[16:19], s55 offen lds
    s_add_u32 s55, s54, 0x3a0000
    s_lshl_b32 s56, s32, 10
    s_add_u32 m0, s56, 0x1d000
    s_nop 0
    buffer_load_dwordx4 v168, s[16:19], s55 offen lds
    s_add_u32 s55, s54, 0x3c0000
    s_lshl_b32 s56, s32, 10
    s_add_u32 m0, s56, 0x1e000
    s_nop 0
    buffer_load_dwordx4 v168, s[16:19], s55 offen lds
    s_add_u32 s55, s54, 0x3e0000
    s_lshl_b32 s56, s32, 10
    s_add_u32 m0, s56, 0x1f000
    s_nop 0
    buffer_load_dwordx4 v168, s[16:19], s55 offen lds
    s_add_u32 s55, s54, 0x400000
    s_lshl_b32 s56, s32, 10
    s_add_u32 m0, s56, 0x20000
    s_nop 0
    buffer_load_dwordx4 v168, s[16:19], s55 offen lds
    s_add_u32 s55, s54, 0x420000
    s_lshl_b32 s56, s32, 10
    s_add_u32 m0, s56, 0x21000
    s_nop 0
    buffer_load_dwordx4 v168, s[16:19], s55 offen lds
    s_add_u32 s55, s54, 0x440000
    s_lshl_b32 s56, s32, 10
    s_add_u32 m0, s56, 0x22000
    s_nop 0
    buffer_load_dwordx4 v168, s[16:19], s55 offen lds
    s_add_u32 s55, s54, 0x460000
    s_lshl_b32 s56, s32, 10
    s_add_u32 m0, s56, 0x23000
    s_nop 0
    buffer_load_dwordx4 v168, s[16:19], s55 offen lds
    s_add_u32 s55, s54, 0x480000
    s_lshl_b32 s56, s32, 10
    s_add_u32 m0, s56, 0x24000
    s_nop 0
    buffer_load_dwordx4 v168, s[16:19], s55 offen lds
    s_add_u32 s55, s54, 0x4a0000
    s_lshl_b32 s56, s32, 10
    s_add_u32 m0, s56, 0x25000
    s_nop 0
    buffer_load_dwordx4 v168, s[16:19], s55 offen lds
    s_add_u32 s55, s54, 0x4c0000
    s_lshl_b32 s56, s32, 10
    s_add_u32 m0, s56, 0x26000
    s_nop 0
    buffer_load_dwordx4 v168, s[16:19], s55 offen lds
    s_add_u32 s55, s54, 0x4e0000
    s_lshl_b32 s56, s32, 10
    s_add_u32 m0, s56, 0x27000
    s_nop 0
    buffer_load_dwordx4 v168, s[16:19], s55 offen lds
    s_waitcnt vmcnt(20)
    s_barrier
    v_add_u32 v172, 0x0, v170
    v_add_u32 v173, 0x0, v171
    ds_read_b64_tr_b16 a[160:161], v172 offset:0
    ds_read_b64_tr_b16 a[162:163], v172 offset:1024
    ds_read_b64_tr_b16 a[164:165], v172 offset:8192
    ds_read_b64_tr_b16 a[166:167], v172 offset:9216
    ds_read_b64_tr_b16 a[168:169], v172 offset:16384
    ds_read_b64_tr_b16 a[170:171], v172 offset:17408
    ds_read_b64_tr_b16 a[172:173], v172 offset:24576
    ds_read_b64_tr_b16 a[174:175], v172 offset:25600
    ds_read_b64_tr_b16 a[176:177], v172 offset:32768
    ds_read_b64_tr_b16 a[178:179], v172 offset:33792
    ds_read_b64_tr_b16 a[240:241], v173 offset:0
    ds_read_b64_tr_b16 a[242:243], v173 offset:1024
    ds_read_b64_tr_b16 a[244:245], v173 offset:8192
    ds_read_b64_tr_b16 a[246:247], v173 offset:9216
    ds_read_b64_tr_b16 a[248:249], v173 offset:16384
    ds_read_b64_tr_b16 a[250:251], v173 offset:17408
    ds_read_b64_tr_b16 a[252:253], v173 offset:24576
    ds_read_b64_tr_b16 a[254:255], v173 offset:25600
    ds_read_b64_tr_b16 v[192:193], v173 offset:32768
    ds_read_b64_tr_b16 v[194:195], v173 offset:33792
    s_waitcnt lgkmcnt(0)
    v_add_u32 v172, 0xa000, v170
    v_add_u32 v173, 0xa000, v171
    ds_read_b64_tr_b16 a[180:181], v172 offset:0
    ds_read_b64_tr_b16 a[182:183], v172 offset:1024
    ds_read_b64_tr_b16 a[184:185], v172 offset:8192
    ds_read_b64_tr_b16 a[186:187], v172 offset:9216
    ds_read_b64_tr_b16 a[188:189], v172 offset:16384
    ds_read_b64_tr_b16 a[190:191], v172 offset:17408
    ds_read_b64_tr_b16 a[192:193], v172 offset:24576
    ds_read_b64_tr_b16 a[194:195], v172 offset:25600
    ds_read_b64_tr_b16 a[196:197], v172 offset:32768
    ds_read_b64_tr_b16 a[198:199], v172 offset:33792
    ds_read_b64_tr_b16 v[196:197], v173 offset:0
    ds_read_b64_tr_b16 v[198:199], v173 offset:1024
    ds_read_b64_tr_b16 v[200:201], v173 offset:8192
    ds_read_b64_tr_b16 v[202:203], v173 offset:9216
    ds_read_b64_tr_b16 v[204:205], v173 offset:16384
    ds_read_b64_tr_b16 v[206:207], v173 offset:17408
    ds_read_b64_tr_b16 v[208:209], v173 offset:24576
    ds_read_b64_tr_b16 v[210:211], v173 offset:25600
    ds_read_b64_tr_b16 v[212:213], v173 offset:32768
    ds_read_b64_tr_b16 v[214:215], v173 offset:33792
    s_waitcnt lgkmcnt(0)
    s_barrier
    s_waitcnt vmcnt(0)
    s_barrier
    v_add_u32 v172, 0x14000, v170
    v_add_u32 v173, 0x14000, v171
    ds_read_b64_tr_b16 a[200:201], v172 offset:0
    ds_read_b64_tr_b16 a[202:203], v172 offset:1024
    ds_read_b64_tr_b16 a[204:205], v172 offset:8192
    ds_read_b64_tr_b16 a[206:207], v172 offset:9216
    ds_read_b64_tr_b16 a[208:209], v172 offset:16384
    ds_read_b64_tr_b16 a[210:211], v172 offset:17408
    ds_read_b64_tr_b16 a[212:213], v172 offset:24576
    ds_read_b64_tr_b16 a[214:215], v172 offset:25600
    ds_read_b64_tr_b16 a[216:217], v172 offset:32768
    ds_read_b64_tr_b16 a[218:219], v172 offset:33792
    ds_read_b64_tr_b16 v[216:217], v173 offset:0
    ds_read_b64_tr_b16 v[218:219], v173 offset:1024
    ds_read_b64_tr_b16 v[220:221], v173 offset:8192
    ds_read_b64_tr_b16 v[222:223], v173 offset:9216
    ds_read_b64_tr_b16 v[224:225], v173 offset:16384
    ds_read_b64_tr_b16 v[226:227], v173 offset:17408
    ds_read_b64_tr_b16 v[228:229], v173 offset:24576
    ds_read_b64_tr_b16 v[230:231], v173 offset:25600
    ds_read_b64_tr_b16 v[232:233], v173 offset:32768
    ds_read_b64_tr_b16 v[234:235], v173 offset:33792
    s_waitcnt lgkmcnt(0)
    v_add_u32 v172, 0x1e000, v170
    v_add_u32 v173, 0x1e000, v171
    ds_read_b64_tr_b16 a[220:221], v172 offset:0
    ds_read_b64_tr_b16 a[222:223], v172 offset:1024
    ds_read_b64_tr_b16 a[224:225], v172 offset:8192
    ds_read_b64_tr_b16 a[226:227], v172 offset:9216
    ds_read_b64_tr_b16 a[228:229], v172 offset:16384
    ds_read_b64_tr_b16 a[230:231], v172 offset:17408
    ds_read_b64_tr_b16 a[232:233], v172 offset:24576
    ds_read_b64_tr_b16 a[234:235], v172 offset:25600
    ds_read_b64_tr_b16 a[236:237], v172 offset:32768
    ds_read_b64_tr_b16 a[238:239], v172 offset:33792
    ds_read_b64_tr_b16 v[236:237], v173 offset:0
    ds_read_b64_tr_b16 v[238:239], v173 offset:1024
    ds_read_b64_tr_b16 v[240:241], v173 offset:8192
    ds_read_b64_tr_b16 v[242:243], v173 offset:9216
    ds_read_b64_tr_b16 v[244:245], v173 offset:16384
    ds_read_b64_tr_b16 v[246:247], v173 offset:17408
    ds_read_b64_tr_b16 v[248:249], v173 offset:24576
    ds_read_b64_tr_b16 v[250:251], v173 offset:25600
    ds_read_b64_tr_b16 v[252:253], v173 offset:32768
    ds_read_b64_tr_b16 v[254:255], v173 offset:33792
    s_waitcnt lgkmcnt(0)
    s_barrier
    v_lshlrev_b32 v6, 4, v1
    v_mul_u32_u24 v7, 1280, v2
    v_lshl_add_u32 v7, v3, 4, v7
    s_lshr_b32 s54, s32, 1
    s_mul_i32 s54, s54, 20480
    s_and_b32 s55, s32, 1
    s_mul_i32 s55, s55, 640
    s_add_u32 s54, s54, s55
    v_add_u32 v7, s54, v7
    s_lshl_b32 s54, s30, 13
    s_lshl_b32 s55, s32, 11
    s_add_u32 s54, s54, s55
    v_add_u32 v8, s54, v6
    s_mov_b32 s55, 0x34
    s_cmp_eq_u32 s32, 0
    s_cbranch_scc0 PZww_123
    s_mov_b32 s54, 0x1
    v_min_u32 v170, 0, v1
    v_mul_u32_u24 v170, 4, v170
    s_mov_b32 s43, 0x40000
PZwl_124:
    buffer_load_dword v171, v170, s[20:23], s55 offen sc1
    s_waitcnt vmcnt(0)
    v_cmp_gt_u32 vcc, 128, v171
    s_nop 1
    v_cndmask_b32 v171, 0, v171, vcc
    v_cmp_gt_u32 vcc, s54, v171
    s_cbranch_vccz PZwd_125
    s_sleep 1
    s_sub_u32 s43, s43, 1
    s_cbranch_scc0 PZwl_124
PZwd_125:
PZww_123:
    s_barrier
    s_mov_b32 s36, 0x0
    s_mul_i32 s54, s33, 40960
    s_mul_i32 s55, s32, 10240
    s_add_u32 s55, s55, s36
    s_add_u32 m0, s55, 0
    s_add_u32 s56, s54, 0
    buffer_load_dwordx4 v7, s[24:27], s56 offen lds
    s_add_u32 m0, s55, 1024
    s_add_u32 s56, s54, 64
    buffer_load_dwordx4 v7, s[24:27], s56 offen lds
    s_add_u32 m0, s55, 2048
    s_add_u32 s56, s54, 128
    buffer_load_dwordx4 v7, s[24:27], s56 offen lds
    s_add_u32 m0, s55, 3072
    s_add_u32 s56, s54, 192
    buffer_load_dwordx4 v7, s[24:27], s56 offen lds
    s_add_u32 m0, s55, 4096
    s_add_u32 s56, s54, 256
    buffer_load_dwordx4 v7, s[24:27], s56 offen lds
    s_add_u32 m0, s55, 5120
    s_add_u32 s56, s54, 320
    buffer_load_dwordx4 v7, s[24:27], s56 offen lds
    s_add_u32 m0, s55, 6144
    s_add_u32 s56, s54, 384
    buffer_load_dwordx4 v7, s[24:27], s56 offen lds
    s_add_u32 m0, s55, 7168
    s_add_u32 s56, s54, 448
    buffer_load_dwordx4 v7, s[24:27], s56 offen lds
    s_add_u32 m0, s55, 8192
    s_add_u32 s56, s54, 512
    buffer_load_dwordx4 v7, s[24:27], s56 offen lds
    s_add_u32 m0, s55, 9216
    s_add_u32 s56, s54, 576
    buffer_load_dwordx4 v7, s[24:27], s56 offen lds
    s_waitcnt vmcnt(0)
PA_loop:
    s_barrier
    s_add_u32 s37, s33, s35
    s_xor_b32 s38, s36, 40960
    s_cmp_ge_u32 s37, 64
    s_cbranch_scc1 PA_nopf
    s_mul_i32 s54, s37, 40960
    s_mul_i32 s55, s32, 10240
    s_add_u32 s55, s55, s38
    s_add_u32 m0, s55, 0
    s_add_u32 s56, s54, 0
    buffer_load_dwordx4 v7, s[24:27], s56 offen lds
    s_add_u32 m0, s55, 1024
    s_add_u32 s56, s54, 64
    buffer_load_dwordx4 v7, s[24:27], s56 offen lds
    s_add_u32 m0, s55, 2048
    s_add_u32 s56, s54, 128
    buffer_load_dwordx4 v7, s[24:27], s56 offen lds
    s_add_u32 m0, s55, 3072
    s_add_u32 s56, s54, 192
    buffer_load_dwordx4 v7, s[24:27], s56 offen lds
    s_add_u32 m0, s55, 4096
    s_add_u32 s56, s54, 256
    buffer_load_dwordx4 v7, s[24:27], s56 offen lds
    s_add_u32 m0, s55, 5120
    s_add_u32 s56, s54, 320
    buffer_load_dwordx4 v7, s[24:27], s56 offen lds
    s_add_u32 m0, s55, 6144
    s_add_u32 s56, s54, 384
    buffer_load_dwordx4 v7, s[24:27], s56 offen lds
    s_add_u32 m0, s55, 7168
    s_add_u32 s56, s54, 448
    buffer_load_dwordx4 v7, s[24:27], s56 offen lds
    s_add_u32 m0, s55, 8192
    s_add_u32 s56, s54, 512
    buffer_load_dwordx4 v7, s[24:27], s56 offen lds
    s_add_u32 m0, s55, 9216
    s_add_u32 s56, s54, 576
    buffer_load_dwordx4 v7, s[24:27], s56 offen lds
PA_nopf:
    v_add_u32 v168, s36, v6
    ds_read_b128 v[32:35], v168 offset:0
    ds_read_b128 v[36:39], v168 offset:20480
    ds_read_b128 v[40:43], v168 offset:1024
    ds_read_b128 v[44:47], v168 offset:21504
    ds_read_b128 v[48:51], v168 offset:2048
    ds_read_b128 v[52:55], v168 offset:22528
    ds_read_b128 v[56:59], v168 offset:3072
    ds_read_b128 v[60:63], v168 offset:23552
    s_waitcnt lgkmcnt(7)
    v_mfma_f32_16x16x32_bf16 v[64:67], a[0:3], v[32:35], 0
    v_mfma_f32_16x16x32_bf16 v[68:71], a[80:83], v[32:35], 0
    v_mfma_f32_16x16x32_bf16 v[72:75], a[160:163], v[32:35], 0
    v_mfma_f32_16x16x32_bf16 v[76:79], a[240:243], v[32:35], 0
    ds_read_b128 v[32:35], v168 offset:4096
    s_waitcnt lgkmcnt(7)
    v_mfma_f32_16x16x32_bf16 v[80:83], a[0:3], v[36:39], 0
    v_mfma_f32_16x16x32_bf16 v[84:87], a[80:83], v[36:39], 0
    v_mfma_f32_16x16x32_bf16 v[88:91], a[160:163], v[36:39], 0
    v_mfma_f32_16x16x32_bf16 v[92:95], a[240:243], v[36:39], 0
    ds_read_b128 v[36:39], v168 offset:24576
    s_waitcnt lgkmcnt(7)
    v_mfma_f32_16x16x32_bf16 v[64:67], a[4:7], v[40:43], v[64:67]
    v_mfma_f32_16x16x32_bf16 v[68:71], a[84:87], v[40:43], v[68:71]
    v_mfma_f32_16x16x32_bf16 v[72:75], a[164:167], v[40:43], v[72:75]
    v_mfma_f32_16x16x32_bf16 v[76:79], a[244:247], v[40:43], v[76:79]
    ds_read_b128 v[40:43], v168 offset:5120
    s_waitcnt lgkmcnt(7)
    v_mfma_f32_16x16x32_bf16 v[80:83], a[4:7], v[44:47], v[80:83]
    v_mfma_f32_16x16x32_bf16 v[84:87], a[84:87], v[44:47], v[84:87]
    v_mfma_f32_16x16x32_bf16 v[88:91], a[164:167], v[44:47], v[88:91]
    v_mfma_f32_16x16x32_bf16 v[92:95], a[244:247], v[44:47], v[92:95]
    ds_read_b128 v[44:47], v168 offset:25600
    s_waitcnt lgkmcnt(7)
    v_mfma_f32_16x16x32_bf16 v[64:67], a[8:11], v[48:51], v[64:67]
    v_mfma_f32_16x16x32_bf16 v[68:71], a[88:91], v[48:51], v[68:71]
    v_mfma_f32_16x16x32_bf16 v[72:75], a[168:171], v[48:51], v[72:75]
    v_mfma_f32_16x16x32_bf16 v[76:79], a[248:251], v[48:51], v[76:79]
    ds_read_b128 v[48:51], v168 offset:6144
    s_waitcnt lgkmcnt(7)
    v_mfma_f32_16x16x32_bf16 v[80:83], a[8:11], v[52:55], v[80:83]
    v_mfma_f32_16x16x32_bf16 v[84:87], a[88:91], v[52:55], v[84:87]
    v_mfma_f32_16x16x32_bf16 v[88:91], a[168:171], v[52:55], v[88:91]
    v_mfma_f32_16x16x32_bf16 v[92:95], a[248:251], v[52:55], v[92:95]
    ds_read_b128 v[52:55], v168 offset:26624
    s_waitcnt lgkmcnt(7)
    v_mfma_f32_16x16x32_bf16 v[64:67], a[12:15], v[56:59], v[64:67]
    v_mfma_f32_16x16x32_bf16 v[68:71], a[92:95], v[56:59], v[68:71]
    v_mfma_f32_16x16x32_bf16 v[72:75], a[172:175], v[56:59], v[72:75]
    v_mfma_f32_16x16x32_bf16 v[76:79], a[252:255], v[56:59], v[76:79]
    ds_read_b128 v[56:59], v168 offset:7168
    s_waitcnt lgkmcnt(7)
    v_mfma_f32_16x16x32_bf16 v[80:83], a[12:15], v[60:63], v[80:83]
    v_mfma_f32_16x16x32_bf16 v[84:87], a[92:95], v[60:63], v[84:87]
    v_mfma_f32_16x16x32_bf16 v[88:91], a[172:175], v[60:63], v[88:91]
    v_mfma_f32_16x16x32_bf16 v[92:95], a[252:255], v[60:63], v[92:95]
    ds_read_b128 v[60:63], v168 offset:27648
    s_waitcnt lgkmcnt(7)
    v_mfma_f32_16x16x32_bf16 v[64:67], a[16:19], v[32:35], v[64:67]
    v_mfma_f32_16x16x32_bf16 v[68:71], a[96:99], v[32:35], v[68:71]
    v_mfma_f32_16x16x32_bf16 v[72:75], a[176:179], v[32:35], v[72:75]
    v_mfma_f32_16x16x32_bf16 v[76:79], v[192:195], v[32:35], v[76:79]
    ds_read_b128 v[32:35], v168 offset:8192
    s_waitcnt lgkmcnt(7)
    v_mfma_f32_16x16x32_bf16 v[80:83], a[16:19], v[36:39], v[80:83]
    v_mfma_f32_16x16x32_bf16 v[84:87], a[96:99], v[36:39], v[84:87]
    v_mfma_f32_16x16x32_bf16 v[88:91], a[176:179], v[36:39], v[88:91]
    v_mfma_f32_16x16x32_bf16 v[92:95], v[192:195], v[36:39], v[92:95]
    ds_read_b128 v[36:39], v168 offset:28672
    s_waitcnt lgkmcnt(7)
    v_mfma_f32_16x16x32_bf16 v[64:67], a[20:23], v[40:43], v[64:67]
    v_mfma_f32_16x16x32_bf16 v[68:71], a[100:103], v[40:43], v[68:71]
    v_mfma_f32_16x16x32_bf16 v[72:75], a[180:183], v[40:43], v[72:75]
    v_mfma_f32_16x16x32_bf16 v[76:79], v[196:199], v[40:43], v[76:79]
    ds_read_b128 v[40:43], v168 offset:9216
    s_waitcnt lgkmcnt(7)
    v_mfma_f32_16x16x32_bf16 v[80:83], a[20:23], v[44:47], v[80:83]
    v_mfma_f32_16x16x32_bf16 v[84:87], a[100:103], v[44:47], v[84:87]
    v_mfma_f32_16x16x32_bf16 v[88:91], a[180:183], v[44:47], v[88:91]
    v_mfma_f32_16x16x32_bf16 v[92:95], v[196:199], v[44:47], v[92:95]
    ds_read_b128 v[44:47], v168 offset:29696
    s_waitcnt lgkmcnt(7)
    v_mfma_f32_16x16x32_bf16 v[64:67], a[24:27], v[48:51], v[64:67]
    v_mfma_f32_16x16x32_bf16 v[68:71], a[104:107], v[48:51], v[68:71]
    v_mfma_f32_16x16x32_bf16 v[72:75], a[184:187], v[48:51], v[72:75]
    v_mfma_f32_16x16x32_bf16 v[76:79], v[200:203], v[48:51], v[76:79]
    ds_read_b128 v[48:51], v168 offset:10240
    s_waitcnt lgkmcnt(7)
    v_mfma_f32_16x16x32_bf16 v[80:83], a[24:27], v[52:55], v[80:83]
    v_mfma_f32_16x16x32_bf16 v[84:87], a[104:107], v[52:55], v[84:87]
    v_mfma_f32_16x16x32_bf16 v[88:91], a[184:187], v[52:55], v[88:91]
    v_mfma_f32_16x16x32_bf16 v[92:95], v[200:203], v[52:55], v[92:95]
    ds_read_b128 v[52:55], v168 offset:30720
    s_waitcnt lgkmcnt(7)
    v_mfma_f32_16x16x32_bf16 v[64:67], a[28:31], v[56:59], v[64:67]
    v_mfma_f32_16x16x32_bf16 v[68:71], a[108:111], v[56:59], v[68:71]
    v_mfma_f32_16x16x32_bf16 v[72:75], a[188:191], v[56:59], v[72:75]
    v_mfma_f32_16x16x32_bf16 v[76:79], v[204:207], v[56:59], v[76:79]
    ds_read_b128 v[56:59], v168 offset:11264
    s_waitcnt lgkmcnt(7)
    v_mfma_f32_16x16x32_bf16 v[80:83], a[28:31], v[60:63], v[80:83]
    v_mfma_f32_16x16x32_bf16 v[84:87], a[108:111], v[60:63], v[84:87]
    v_mfma_f32_16x16x32_bf16 v[88:91], a[188:191], v[60:63], v[88:91]
    v_mfma_f32_16x16x32_bf16 v[92:95], v[204:207], v[60:63], v[92:95]
    ds_read_b128 v[60:63], v168 offset:31744
    s_waitcnt lgkmcnt(7)
    v_mfma_f32_16x16x32_bf16 v[64:67], a[32:35], v[32:35], v[64:67]
    v_mfma_f32_16x16x32_bf16 v[68:71], a[112:115], v[32:35], v[68:71]
    v_mfma_f32_16x16x32_bf16 v[72:75], a[192:195], v[32:35], v[72:75]
    v_mfma_f32_16x16x32_bf16 v[76:79], v[208:211], v[32:35], v[76:79]
    ds_read_b128 v[32:35], v168 offset:12288
    s_waitcnt lgkmcnt(7)
    v_mfma_f32_16x16x32_bf16 v[80:83], a[32:35], v[36:39], v[80:83]
    v_mfma_f32_16x16x32_bf16 v[84:87], a[112:115], v[36:39], v[84:87]
    v_mfma_f32_16x16x32_bf16 v[88:91], a[192:195], v[36:39], v[88:91]
    v_mfma_f32_16x16x32_bf16 v[92:95], v[208:211], v[36:39], v[92:95]
    ds_read_b128 v[36:39], v168 offset:32768
    s_waitcnt lgkmcnt(7)
    v_mfma_f32_16x16x32_bf16 v[64:67], a[36:39], v[40:43], v[64:67]
    v_mfma_f32_16x16x32_bf16 v[68:71], a[116:119], v[40:43], v[68:71]
    v_mfma_f32_16x16x32_bf16 v[72:75], a[196:199], v[40:43], v[72:75]
    v_mfma_f32_16x16x32_bf16 v[76:79], v[212:215], v[40:43], v[76:79]
    ds_read_b128 v[40:43], v168 offset:13312
    s_waitcnt lgkmcnt(7)
    v_mfma_f32_16x16x32_bf16 v[80:83], a[36:39], v[44:47], v[80:83]
    v_mfma_f32_16x16x32_bf16 v[84:87], a[116:119], v[44:47], v[84:87]
    v_mfma_f32_16x16x32_bf16 v[88:91], a[196:199], v[44:47], v[88:91]
    v_mfma_f32_16x16x32_bf16 v[92:95], v[212:215], v[44:47], v[92:95]
    ds_read_b128 v[44:47], v168 offset:33792
    s_waitcnt lgkmcnt(7)
    v_mfma_f32_16x16x32_bf16 v[64:67], a[40:43], v[48:51], v[64:67]
    v_mfma_f32_16x16x32_bf16 v[68:71], a[120:123], v[48:51], v[68:71]
    v_mfma_f32_16x16x32_bf16 v[72:75], a[200:203], v[48:51], v[72:75]
    v_mfma_f32_16x16x32_bf16 v[76:79], v[216:219], v[48:51], v[76:79]
    ds_read_b128 v[48:51], v168 offset:14336
    s_waitcnt lgkmcnt(7)
    v_mfma_f32_16x16x32_bf16 v[80:83], a[40:43], v[52:55], v[80:83]
    v_mfma_f32_16x16x32_bf16 v[84:87], a[120:123], v[52:55], v[84:87]
    v_mfma_f32_16x16x32_bf16 v[88:91], a[200:203], v[52:55], v[88:91]
    v_mfma_f32_16x16x32_bf16 v[92:95], v[216:219], v[52:55], v[92:95]
    ds_read_b128 v[52:55], v168 offset:34816
    s_waitcnt lgkmcnt(7)
    v_mfma_f32_16x16x32_bf16 v[64:67], a[44:47], v[56:59], v[64:67]
    v_mfma_f32_16x16x32_bf16 v[68:71], a[124:127], v[56:59], v[68:71]
    v_mfma_f32_16x16x32_bf16 v[72:75], a[204:207], v[56:59], v[72:75]
    v_mfma_f32_16x16x32_bf16 v[76:79], v[220:223], v[56:59], v[76:79]
    ds_read_b128 v[56:59], v168 offset:15360
    s_waitcnt lgkmcnt(7)
    v_mfma_f32_16x16x32_bf16 v[80:83], a[44:47], v[60:63], v[80:83]
    v_mfma_f32_16x16x32_bf16 v[84:87], a[124:127], v[60:63], v[84:87]
    v_mfma_f32_16x16x32_bf16 v[88:91], a[204:207], v[60:63], v[88:91]
    v_mfma_f32_16x16x32_bf16 v[92:95], v[220:223], v[60:63], v[92:95]
    ds_read_b128 v[60:63], v168 offset:35840
    s_waitcnt lgkmcnt(7)
    v_mfma_f32_16x16x32_bf16 v[64:67], a[48:51], v[32:35], v[64:67]
    v_mfma_f32_16x16x32_bf16 v[68:71], a[128:131], v[32:35], v[68:71]
    v_mfma_f32_16x16x32_bf16 v[72:75], a[208:211], v[32:35], v[72:75]
    v_mfma_f32_16x16x32_bf16 v[76:79], v[224:227], v[32:35], v[76:79]
    ds_read_b128 v[32:35], v168 offset:16384
    s_waitcnt lgkmcnt(7)
    v_mfma_f32_16x16x32_bf16 v[80:83], a[48:51], v[36:39], v[80:83]
    v_mfma_f32_16x16x32_bf16 v[84:87], a[128:131], v[36:39], v[84:87]
    v_mfma_f32_16x16x32_bf16 v[88:91], a[208:211], v[36:39], v[88:91]
    v_mfma_f32_16x16x32_bf16 v[92:95], v[224:227], v[36:39], v[92:95]
    ds_read_b128 v[36:39], v168 offset:36864
    s_waitcnt lgkmcnt(7)
    v_mfma_f32_16x16x32_bf16 v[64:67], a[52:55], v[40:43], v[64:67]
    v_mfma_f32_16x16x32_bf16 v[68:71], a[132:135], v[40:43], v[68:71]
    v_mfma_f32_16x16x32_bf16 v[72:75], a[212:215], v[40:43], v[72:75]
    v_mfma_f32_16x16x32_bf16 v[76:79], v[228:231], v[40:43], v[76:79]
    ds_read_b128 v[40:43], v168 offset:17408
    s_waitcnt lgkmcnt(7)
    v_mfma_f32_16x16x32_bf16 v[80:83], a[52:55], v[44:47], v[80:83]
    v_mfma_f32_16x16x32_bf16 v[84:87], a[132:135], v[44:47], v[84:87]
    v_mfma_f32_16x16x32_bf16 v[88:91], a[212:215], v[44:47], v[88:91]
    v_mfma_f32_16x16x32_bf16 v[92:95], v[228:231], v[44:47], v[92:95]
    ds_read_b128 v[44:47], v168 offset:37888
    s_waitcnt lgkmcnt(7)
    v_mfma_f32_16x16x32_bf16 v[64:67], a[56:59], v[48:51], v[64:67]
    v_mfma_f32_16x16x32_bf16 v[68:71], a[136:139], v[48:51], v[68:71]
    v_mfma_f32_16x16x32_bf16 v[72:75], a[216:219], v[48:51], v[72:75]
    v_mfma_f32_16x16x32_bf16 v[76:79], v[232:235], v[48:51], v[76:79]
    ds_read_b128 v[48:51], v168 offset:18432
    s_waitcnt lgkmcnt(7)
    v_mfma_f32_16x16x32_bf16 v[80:83], a[56:59], v[52:55], v[80:83]
    v_mfma_f32_16x16x32_bf16 v[84:87], a[136:139], v[52:55], v[84:87]
    v_mfma_f32_16x16x32_bf16 v[88:91], a[216:219], v[52:55], v[88:91]
    v_mfma_f32_16x16x32_bf16 v[92:95], v[232:235], v[52:55], v[92:95]
    ds_read_b128 v[52:55], v168 offset:38912
    s_waitcnt lgkmcnt(7)
    v_mfma_f32_16x16x32_bf16 v[64:67], a[60:63], v[56:59], v[64:67]
    v_mfma_f32_16x16x32_bf16 v[68:71], a[140:143], v[56:59], v[68:71]
    v_mfma_f32_16x16x32_bf16 v[72:75], a[220:223], v[56:59], v[72:75]
    v_mfma_f32_16x16x32_bf16 v[76:79], v[236:239], v[56:59], v[76:79]
    ds_read_b128 v[56:59], v168 offset:19456
    s_waitcnt lgkmcnt(7)
    v_mfma_f32_16x16x32_bf16 v[80:83], a[60:63], v[60:63], v[80:83]
    v_mfma_f32_16x16x32_bf16 v[84:87], a[140:143], v[60:63], v[84:87]
    v_mfma_f32_16x16x32_bf16 v[88:91], a[220:223], v[60:63], v[88:91]
    v_mfma_f32_16x16x32_bf16 v[92:95], v[236:239], v[60:63], v[92:95]
    ds_read_b128 v[60:63], v168 offset:39936
    s_waitcnt lgkmcnt(7)
    v_mfma_f32_16x16x32_bf16 v[64:67], a[64:67], v[32:35], v[64:67]
    v_mfma_f32_16x16x32_bf16 v[68:71], a[144:147], v[32:35], v[68:71]
    v_mfma_f32_16x16x32_bf16 v[72:75], a[224:227], v[32:35], v[72:75]
    v_mfma_f32_16x16x32_bf16 v[76:79], v[240:243], v[32:35], v[76:79]
    s_waitcnt lgkmcnt(6)
    v_mfma_f32_16x16x32_bf16 v[80:83], a[64:67], v[36:39], v[80:83]
    v_mfma_f32_16x16x32_bf16 v[84:87], a[144:147], v[36:39], v[84:87]
    v_mfma_f32_16x16x32_bf16 v[88:91], a[224:227], v[36:39], v[88:91]
    v_mfma_f32_16x16x32_bf16 v[92:95], v[240:243], v[36:39], v[92:95]
    s_waitcnt lgkmcnt(5)
    v_mfma_f32_16x16x32_bf16 v[64:67], a[68:71], v[40:43], v[64:67]
    v_mfma_f32_16x16x32_bf16 v[68:71], a[148:151], v[40:43], v[68:71]
    v_mfma_f32_16x16x32_bf16 v[72:75], a[228:231], v[40:43], v[72:75]
    v_mfma_f32_16x16x32_bf16 v[76:79], v[244:247], v[40:43], v[76:79]
    s_waitcnt lgkmcnt(4)
    v_mfma_f32_16x16x32_bf16 v[80:83], a[68:71], v[44:47], v[80:83]
    v_mfma_f32_16x16x32_bf16 v[84:87], a[148:151], v[44:47], v[84:87]
    v_mfma_f32_16x16x32_bf16 v[88:91], a[228:231], v[44:47], v[88:91]
    v_mfma_f32_16x16x32_bf16 v[92:95], v[244:247], v[44:47], v[92:95]
    s_waitcnt lgkmcnt(3)
    v_mfma_f32_16x16x32_bf16 v[64:67], a[72:75], v[48:51], v[64:67]
    v_mfma_f32_16x16x32_bf16 v[68:71], a[152:155], v[48:51], v[68:71]
    v_mfma_f32_16x16x32_bf16 v[72:75], a[232:235], v[48:51], v[72:75]
    v_mfma_f32_16x16x32_bf16 v[76:79], v[248:251], v[48:51], v[76:79]
    s_waitcnt lgkmcnt(2)
    v_mfma_f32_16x16x32_bf16 v[80:83], a[72:75], v[52:55], v[80:83]
    v_mfma_f32_16x16x32_bf16 v[84:87], a[152:155], v[52:55], v[84:87]
    v_mfma_f32_16x16x32_bf16 v[88:91], a[232:235], v[52:55], v[88:91]
    v_mfma_f32_16x16x32_bf16 v[92:95], v[248:251], v[52:55], v[92:95]
    s_waitcnt lgkmcnt(1)
    v_mfma_f32_16x16x32_bf16 v[64:67], a[76:79], v[56:59], v[64:67]
    v_mfma_f32_16x16x32_bf16 v[68:71], a[156:159], v[56:59], v[68:71]
    v_mfma_f32_16x16x32_bf16 v[72:75], a[236:239], v[56:59], v[72:75]
    v_mfma_f32_16x16x32_bf16 v[76:79], v[252:255], v[56:59], v[76:79]
    s_waitcnt lgkmcnt(0)
    v_mfma_f32_16x16x32_bf16 v[80:83], a[76:79], v[60:63], v[80:83]
    v_mfma_f32_16x16x32_bf16 v[84:87], a[156:159], v[60:63], v[84:87]
    v_mfma_f32_16x16x32_bf16 v[88:91], a[236:239], v[60:63], v[88:91]
    v_mfma_f32_16x16x32_bf16 v[92:95], v[252:255], v[60:63], v[92:95]
    s_nop 7
    s_lshl_b32 s54, s33, 18
    s_add_u32 s55, s54, 0x1000000
    v_cvt_pk_bf16_f32 v32, v64, v65
    v_cvt_pk_bf16_f32 v33, v66, v67
    v_cvt_pk_bf16_f32 v34, v68, v69
    v_cvt_pk_bf16_f32 v35, v70, v71
    buffer_store_dwordx4 v[32:35], v8, s[8:11], s55 offen offset:0 sc1
    v_cvt_pk_bf16_f32 v36, v80, v81
    v_cvt_pk_bf16_f32 v37, v82, v83
    v_cvt_pk_bf16_f32 v38, v84, v85
    v_cvt_pk_bf16_f32 v39, v86, v87
    buffer_store_dwordx4 v[36:39], v8, s[8:11], s55 offen offset:1024 sc1
    s_add_u32 s55, s54, 0x0
    v_cvt_pk_bf16_f32 v40, v72, v73
    v_cvt_pk_bf16_f32 v41, v74, v75
    v_cvt_pk_bf16_f32 v42, v76, v77
    v_cvt_pk_bf16_f32 v43, v78, v79
    buffer_store_dwordx4 v[40:43], v8, s[8:11], s55 offen offset:0 sc1
    v_cvt_pk_bf16_f32 v44, v88, v89
    v_cvt_pk_bf16_f32 v45, v90, v91
    v_cvt_pk_bf16_f32 v46, v92, v93
    v_cvt_pk_bf16_f32 v47, v94, v95
    buffer_store_dwordx4 v[44:47], v8, s[8:11], s55 offen offset:1024 sc1
    s_waitcnt vmcnt(0)
    s_barrier
    s_cmp_eq_u32 s32, 0
    s_cbranch_scc0 ps_126
    v_mov_b32 v170, s37
    v_mov_b32 v171, 0
    s_mov_b64 exec, 1
    buffer_store_dword v170, v171, s[8:11], s41 offen sc1
    s_mov_b64 exec, -1
ps_126:
    s_waitcnt vmcnt(4)
    s_mov_b32 s33, s37
    s_mov_b32 s36, s38
    s_cmp_lt_u32 s33, 64
    s_cbranch_scc1 PA_loop
    s_waitcnt vmcnt(0)
    s_branch f_queue
f_pB:
    s_mov_b32 s12, s88
    s_and_b32 s13, s89, 0xffff
    s_mov_b32 s14, 0x500000
    s_mov_b32 s15, 0x00020000
    s_mov_b32 s16, s90
    s_and_b32 s17, s91, 0xffff
    s_mov_b32 s18, 0x500000
    s_mov_b32 s19, 0x00020000
    s_lshr_b32 s56, s32, 1
    s_lshl_b32 s56, s56, 3
    v_lshlrev_b32 v172, 1, v3
    v_add_u32 v172, s56, v172
    v_xor_b32 v172, v172, v2
    v_lshlrev_b32 v172, 4, v172
    s_lshl_b32 s56, s32, 2
    v_add_u32 v173, s56, v3
    v_lshlrev_b32 v168, 13, v173
    v_add_u32 v168, v168, v172
    s_and_b32 s56, s32, 1
    s_lshl_b32 s56, s56, 3
    v_lshlrev_b32 v172, 1, v3
    v_add_u32 v172, s56, v172
    v_xor_b32 v172, v172, v2
    v_lshlrev_b32 v172, 4, v172
    v_mul_u32_u24 v169, 1280, v173
    v_add_u32 v169, v169, v172
    s_lshl_b32 s56, s32, 1
    s_lshl_b32 s56, s56, 1
    v_bfe_u32 v172, v1, 1, 1
    v_add_u32 v172, s56, v172
    v_lshrrev_b32 v173, 2, v2
    v_lshlrev_b32 v173, 1, v173
    v_and_b32 v170, 1, v3
    v_lshl_add_u32 v173, v170, 3, v173
    v_xor_b32 v172, v172, v173
    v_lshlrev_b32 v172, 4, v172
    v_and_b32 v173, 1, v1
    v_lshl_add_u32 v172, v173, 3, v172
    v_lshrrev_b32 v173, 2, v2
    v_mad_u32_u24 v173, v3, 8, v173
    v_lshl_add_u32 v170, v173, 8, v172
    s_lshl_b32 s56, s32, 1
    s_add_u32 s56, s56, 1
    s_lshl_b32 s56, s56, 1
    v_bfe_u32 v172, v1, 1, 1
    v_add_u32 v172, s56, v172
    v_lshrrev_b32 v173, 2, v2
    v_lshlrev_b32 v173, 1, v173
    v_and_b32 v171, 1, v3
    v_lshl_add_u32 v173, v171, 3, v173
    v_xor_b32 v172, v172, v173
    v_lshlrev_b32 v172, 4, v172
    v_and_b32 v173, 1, v1
    v_lshl_add_u32 v172, v173, 3, v172
    v_lshrrev_b32 v173, 2, v2
    v_mad_u32_u24 v173, v3, 8, v173
    v_lshl_add_u32 v171, v173, 8, v172
    s_mov_b32 s56, s32
    s_lshl_b32 s56, s56, 1
    v_bfe_u32 v172, v1, 1, 1
    v_add_u32 v172, s56, v172
    v_lshrrev_b32 v173, 2, v2
    v_lshlrev_b32 v173, 1, v173
    v_and_b32 v174, 1, v3
    v_lshl_add_u32 v173, v174, 3, v173
    v_xor_b32 v172, v172, v173
    v_lshlrev_b32 v172, 4, v172
    v_and_b32 v173, 1, v1
    v_lshl_add_u32 v172, v173, 3, v172
    v_lshrrev_b32 v173, 2, v2
    v_mad_u32_u24 v173, v3, 4, v173
    v_lshl_add_u32 v174, v173, 8, v172
    s_add_u32 s56, s32, 4
    s_lshl_b32 s56, s56, 1
    v_bfe_u32 v172, v1, 1, 1
    v_add_u32 v172, s56, v172
    v_lshrrev_b32 v173, 2, v2
    v_lshlrev_b32 v173, 1, v173
    v_and_b32 v175, 1, v3
    v_lshl_add_u32 v173, v175, 3, v173
    v_xor_b32 v172, v172, v173
    v_lshlrev_b32 v172, 4, v172
    v_and_b32 v173, 1, v1
    v_lshl_add_u32 v172, v173, 3, v172
    v_lshrrev_b32 v173, 2, v2
    v_mad_u32_u24 v173, v3, 4, v173
    v_lshl_add_u32 v175, v173, 8, v172
    s_lshl_b32 s54, s30, 8
    s_add_u32 s55, s54, 0x0
    s_lshl_b32 s56, s32, 10
    s_add_u32 m0, s56, 0x0
    s_nop 0
    buffer_load_dwordx4 v168, s[12:15], s55 offen lds
    s_add_u32 s55, s54, 0x20000
    s_lshl_b32 s56, s32, 10
    s_add_u32 m0, s56, 0x1000
    s_nop 0
    buffer_load_dwordx4 v168, s[12:15], s55 offen lds
    s_add_u32 s55, s54, 0x40000
    s_lshl_b32 s56, s32, 10
    s_add_u32 m0, s56, 0x2000
    s_nop 0
    buffer_load_dwordx4 v168, s[12:15], s55 offen lds
    s_add_u32 s55, s54, 0x60000
    s_lshl_b32 s56, s32, 10
    s_add_u32 m0, s56, 0x3000
    s_nop 0
    buffer_load_dwordx4 v168, s[12:15], s55 offen lds
    s_add_u32 s55, s54, 0x80000
    s_lshl_b32 s56, s32, 10
    s_add_u32 m0, s56, 0x4000
    s_nop 0
    buffer_load_dwordx4 v168, s[12:15], s55 offen lds
    s_add_u32 s55, s54, 0xa0000
    s_lshl_b32 s56, s32, 10
    s_add_u32 m0, s56, 0x5000
    s_nop 0
    buffer_load_dwordx4 v168, s[12:15], s55 offen lds
    s_add_u32 s55, s54, 0xc0000
    s_lshl_b32 s56, s32, 10
    s_add_u32 m0, s56, 0x6000
    s_nop 0
    buffer_load_dwordx4 v168, s[12:15], s55 offen lds
    s_add_u32 s55, s54, 0xe0000
    s_lshl_b32 s56, s32, 10
    s_add_u32 m0, s56, 0x7000
    s_nop 0
    buffer_load_dwordx4 v168, s[12:15], s55 offen lds
    s_add_u32 s55, s54, 0x100000
    s_lshl_b32 s56, s32, 10
    s_add_u32 m0, s56, 0x8000
    s_nop 0
    buffer_load_dwordx4 v168, s[12:15], s55 offen lds
    s_add_u32 s55, s54, 0x120000
    s_lshl_b32 s56, s32, 10
    s_add_u32 m0, s56, 0x9000
    s_nop 0
    buffer_load_dwordx4 v168, s[12:15], s55 offen lds
    s_add_u32 s55, s54, 0x140000
    s_lshl_b32 s56, s32, 10
    s_add_u32 m0, s56, 0xa000
    s_nop 0
    buffer_load_dwordx4 v168, s[12:15], s55 offen lds
    s_add_u32 s55, s54, 0x160000
    s_lshl_b32 s56, s32, 10
    s_add_u32 m0, s56, 0xb000
    s_nop 0
    buffer_load_dwordx4 v168, s[12:15], s55 offen lds
    s_add_u32 s55, s54, 0x180000
    s_lshl_b32 s56, s32, 10
    s_add_u32 m0, s56, 0xc000
    s_nop 0
    buffer_load_dwordx4 v168, s[12:15], s55 offen lds
    s_add_u32 s55, s54, 0x1a0000
    s_lshl_b32 s56, s32, 10
    s_add_u32 m0, s56, 0xd000
    s_nop 0
    buffer_load_dwordx4 v168, s[12:15], s55 offen lds
    s_add_u32 s55, s54, 0x1c0000
    s_lshl_b32 s56, s32, 10
    s_add_u32 m0, s56, 0xe000
    s_nop 0
    buffer_load_dwordx4 v168, s[12:15], s55 offen lds
    s_add_u32 s55, s54, 0x1e0000
    s_lshl_b32 s56, s32, 10
    s_add_u32 m0, s56, 0xf000
    s_nop 0
    buffer_load_dwordx4 v168, s[12:15], s55 offen lds
    s_add_u32 s55, s54, 0x200000
    s_lshl_b32 s56, s32, 10
    s_add_u32 m0, s56, 0x10000
    s_nop 0
    buffer_load_dwordx4 v168, s[12:15], s55 offen lds
    s_add_u32 s55, s54, 0x220000
    s_lshl_b32 s56, s32, 10
    s_add_u32 m0, s56, 0x11000
    s_nop 0
    buffer_load_dwordx4 v168, s[12:15], s55 offen lds
    s_add_u32 s55, s54, 0x240000
    s_lshl_b32 s56, s32, 10
    s_add_u32 m0, s56, 0x12000
    s_nop 0
    buffer_load_dwordx4 v168, s[12:15], s55 offen lds
    s_add_u32 s55, s54, 0x260000
    s_lshl_b32 s56, s32, 10
    s_add_u32 m0, s56, 0x13000
    s_nop 0
    buffer_load_dwordx4 v168, s[12:15], s55 offen lds
    s_add_u32 s55, s54, 0x280000
    s_lshl_b32 s56, s32, 10
    s_add_u32 m0, s56, 0x14000
    s_nop 0
    buffer_load_dwordx4 v168, s[12:15], s55 offen lds
    s_add_u32 s55, s54, 0x2a0000
    s_lshl_b32 s56, s32, 10
    s_add_u32 m0, s56, 0x15000
    s_nop 0
    buffer_load_dwordx4 v168, s[12:15], s55 offen lds
    s_add_u32 s55, s54, 0x2c0000
    s_lshl_b32 s56, s32, 10
    s_add_u32 m0, s56, 0x16000
    s_nop 0
    buffer_load_dwordx4 v168, s[12:15], s55 offen lds
    s_add_u32 s55, s54, 0x2e0000
    s_lshl_b32 s56, s32, 10
    s_add_u32 m0, s56, 0x17000
    s_nop 0
    buffer_load_dwordx4 v168, s[12:15], s55 offen lds
    s_add_u32 s55, s54, 0x300000
    s_lshl_b32 s56, s32, 10
    s_add_u32 m0, s56, 0x18000
    s_nop 0
    buffer_load_dwordx4 v168, s[12:15], s55 offen lds
    s_add_u32 s55, s54, 0x320000
    s_lshl_b32 s56, s32, 10
    s_add_u32 m0, s56, 0x19000
    s_nop 0
    buffer_load_dwordx4 v168, s[12:15], s55 offen lds
    s_add_u32 s55, s54, 0x340000
    s_lshl_b32 s56, s32, 10
    s_add_u32 m0, s56, 0x1a000
    s_nop 0
    buffer_load_dwordx4 v168, s[12:15], s55 offen lds
    s_add_u32 s55, s54, 0x360000
    s_lshl_b32 s56, s32, 10
    s_add_u32 m0, s56, 0x1b000
    s_nop 0
    buffer_load_dwordx4 v168, s[12:15], s55 offen lds
    s_add_u32 s55, s54, 0x380000
    s_lshl_b32 s56, s32, 10
    s_add_u32 m0, s56, 0x1c000
    s_nop 0
    buffer_load_dwordx4 v168, s[12:15], s55 offen lds
    s_add_u32 s55, s54, 0x3a0000
    s_lshl_b32 s56, s32, 10
    s_add_u32 m0, s56, 0x1d000
    s_nop 0
    buffer_load_dwordx4 v168, s[12:15], s55 offen lds
    s_add_u32 s55, s54, 0x3c0000
    s_lshl_b32 s56, s32, 10
    s_add_u32 m0, s56, 0x1e000
    s_nop 0
    buffer_load_dwordx4 v168, s[12:15], s55 offen lds
    s_add_u32 s55, s54, 0x3e0000
    s_lshl_b32 s56, s32, 10
    s_add_u32 m0, s56, 0x1f000
    s_nop 0
    buffer_load_dwordx4 v168, s[12:15], s55 offen lds
    s_add_u32 s55, s54, 0x400000
    s_lshl_b32 s56, s32, 10
    s_add_u32 m0, s56, 0x20000
    s_nop 0
    buffer_load_dwordx4 v168, s[12:15], s55 offen lds
    s_add_u32 s55, s54, 0x420000
    s_lshl_b32 s56, s32, 10
    s_add_u32 m0, s56, 0x21000
    s_nop 0
    buffer_load_dwordx4 v168, s[12:15], s55 offen lds
    s_add_u32 s55, s54, 0x440000
    s_lshl_b32 s56, s32, 10
    s_add_u32 m0, s56, 0x22000
    s_nop 0
    buffer_load_dwordx4 v168, s[12:15], s55 offen lds
    s_add_u32 s55, s54, 0x460000
    s_lshl_b32 s56, s32, 10
    s_add_u32 m0, s56, 0x23000
    s_nop 0
    buffer_load_dwordx4 v168, s[12:15], s55 offen lds
    s_add_u32 s55, s54, 0x480000
    s_lshl_b32 s56, s32, 10
    s_add_u32 m0, s56, 0x24000
    s_nop 0
    buffer_load_dwordx4 v168, s[12:15], s55 offen lds
    s_add_u32 s55, s54, 0x4a0000
    s_lshl_b32 s56, s32, 10
    s_add_u32 m0, s56, 0x25000
    s_nop 0
    buffer_load_dwordx4 v168, s[12:15], s55 offen lds
    s_add_u32 s55, s54, 0x4c0000
    s_lshl_b32 s56, s32, 10
    s_add_u32 m0, s56, 0x26000
    s_nop 0
    buffer_load_dwordx4 v168, s[12:15], s55 offen lds
    s_add_u32 s55, s54, 0x4e0000
    s_lshl_b32 s56, s32, 10
    s_add_u32 m0, s56, 0x27000
    s_nop 0
    buffer_load_dwordx4 v168, s[12:15], s55 offen lds
    s_waitcnt vmcnt(20)
    s_barrier
    v_add_u32 v172, 0x0, v170
    v_add_u32 v173, 0x0, v171
    ds_read_b64_tr_b16 a[0:1], v172 offset:0
    ds_read_b64_tr_b16 a[2:3], v172 offset:1024
    ds_read_b64_tr_b16 a[4:5], v172 offset:8192
    ds_read_b64_tr_b16 a[6:7], v172 offset:9216
    ds_read_b64_tr_b16 a[8:9], v172 offset:16384
    ds_read_b64_tr_b16 a[10:11], v172 offset:17408
    ds_read_b64_tr_b16 a[12:13], v172 offset:24576
    ds_read_b64_tr_b16 a[14:15], v172 offset:25600
    ds_read_b64_tr_b16 a[16:17], v172 offset:32768
    ds_read_b64_tr_b16 a[18:19], v172 offset:33792
    ds_read_b64_tr_b16 a[80:81], v173 offset:0
    ds_read_b64_tr_b16 a[82:83], v173 offset:1024
    ds_read_b64_tr_b16 a[84:85], v173 offset:8192
    ds_read_b64_tr_b16 a[86:87], v173 offset:9216
    ds_read_b64_tr_b16 a[88:89], v173 offset:16384
    ds_read_b64_tr_b16 a[90:91], v173 offset:17408
    ds_read_b64_tr_b16 a[92:93], v173 offset:24576
    ds_read_b64_tr_b16 a[94:95], v173 offset:25600
    ds_read_b64_tr_b16 a[96:97], v173 offset:32768
    ds_read_b64_tr_b16 a[98:99], v173 offset:33792
    s_waitcnt lgkmcnt(0)
    v_add_u32 v172, 0xa000, v170
    v_add_u32 v173, 0xa000, v171
    ds_read_b64_tr_b16 a[20:21], v172 offset:0
    ds_read_b64_tr_b16 a[22:23], v172 offset:1024
    ds_read_b64_tr_b16 a[24:25], v172 offset:8192
    ds_read_b64_tr_b16 a[26:27], v172 offset:9216
    ds_read_b64_tr_b16 a[28:29], v172 offset:16384
    ds_read_b64_tr_b16 a[30:31], v172 offset:17408
    ds_read_b64_tr_b16 a[32:33], v172 offset:24576
    ds_read_b64_tr_b16 a[34:35], v172 offset:25600
    ds_read_b64_tr_b16 a[36:37], v172 offset:32768
    ds_read_b64_tr_b16 a[38:39], v172 offset:33792
    ds_read_b64_tr_b16 a[100:101], v173 offset:0
    ds_read_b64_tr_b16 a[102:103], v173 offset:1024
    ds_read_b64_tr_b16 a[104:105], v173 offset:8192
    ds_read_b64_tr_b16 a[106:107], v173 offset:9216
    ds_read_b64_tr_b16 a[108:109], v173 offset:16384
    ds_read_b64_tr_b16 a[110:111], v173 offset:17408
    ds_read_b64_tr_b16 a[112:113], v173 offset:24576
    ds_read_b64_tr_b16 a[114:115], v173 offset:25600
    ds_read_b64_tr_b16 a[116:117], v173 offset:32768
    ds_read_b64_tr_b16 a[118:119], v173 offset:33792
    s_waitcnt lgkmcnt(0)
    s_barrier
    s_mul_i32 s55, s30, 163840
    s_add_u32 s55, s55, 0x0
    s_lshl_b32 s56, s32, 10
    s_add_u32 m0, s56, 0x0
    s_nop 0
    buffer_load_dwordx4 v169, s[16:19], s55 offen lds
    s_mul_i32 s55, s30, 163840
    s_add_u32 s55, s55, 0x5000
    s_lshl_b32 s56, s32, 10
    s_add_u32 m0, s56, 0x1000
    s_nop 0
    buffer_load_dwordx4 v169, s[16:19], s55 offen lds
    s_mul_i32 s55, s30, 163840
    s_add_u32 s55, s55, 0xa000
    s_lshl_b32 s56, s32, 10
    s_add_u32 m0, s56, 0x2000
    s_nop 0
    buffer_load_dwordx4 v169, s[16:19], s55 offen lds
    s_mul_i32 s55, s30, 163840
    s_add_u32 s55, s55, 0xf000
    s_lshl_b32 s56, s32, 10
    s_add_u32 m0, s56, 0x3000
    s_nop 0
    buffer_load_dwordx4 v169, s[16:19], s55 offen lds
    s_mul_i32 s55, s30, 163840
    s_add_u32 s55, s55, 0x14000
    s_lshl_b32 s56, s32, 10
    s_add_u32 m0, s56, 0x4000
    s_nop 0
    buffer_load_dwordx4 v169, s[16:19], s55 offen lds
    s_mul_i32 s55, s30, 163840
    s_add_u32 s55, s55, 0x19000
    s_lshl_b32 s56, s32, 10
    s_add_u32 m0, s56, 0x5000
    s_nop 0
    buffer_load_dwordx4 v169, s[16:19], s55 offen lds
    s_mul_i32 s55, s30, 163840
    s_add_u32 s55, s55, 0x1e000
    s_lshl_b32 s56, s32, 10
    s_add_u32 m0, s56, 0x6000
    s_nop 0
    buffer_load_dwordx4 v169, s[16:19], s55 offen lds
    s_mul_i32 s55, s30, 163840
    s_add_u32 s55, s55, 0x23000
    s_lshl_b32 s56, s32, 10
    s_add_u32 m0, s56, 0x7000
    s_nop 0
    buffer_load_dwordx4 v169, s[16:19], s55 offen lds
    s_mul_i32 s55, s30, 163840
    s_add_u32 s55, s55, 0x100
    s_lshl_b32 s56, s32, 10
    s_add_u32 m0, s56, 0xa000
    s_nop 0
    buffer_load_dwordx4 v169, s[16:19], s55 offen lds
    s_mul_i32 s55, s30, 163840
    s_add_u32 s55, s55, 0x5100
    s_lshl_b32 s56, s32, 10
    s_add_u32 m0, s56, 0xb000
    s_nop 0
    buffer_load_dwordx4 v169, s[16:19], s55 offen lds
    s_mul_i32 s55, s30, 163840
    s_add_u32 s55, s55, 0xa100
    s_lshl_b32 s56, s32, 10
    s_add_u32 m0, s56, 0xc000
    s_nop 0
    buffer_load_dwordx4 v169, s[16:19], s55 offen lds
    s_mul_i32 s55, s30, 163840
    s_add_u32 s55, s55, 0xf100
    s_lshl_b32 s56, s32, 10
    s_add_u32 m0, s56, 0xd000
    s_nop 0
    buffer_load_dwordx4 v169, s[16:19], s55 offen lds
    s_mul_i32 s55, s30, 163840
    s_add_u32 s55, s55, 0x14100
    s_lshl_b32 s56, s32, 10
    s_add_u32 m0, s56, 0xe000
    s_nop 0
    buffer_load_dwordx4 v169, s[16:19], s55 offen lds
    s_mul_i32 s55, s30, 163840
    s_add_u32 s55, s55, 0x19100
    s_lshl_b32 s56, s32, 10
    s_add_u32 m0, s56, 0xf000
    s_nop 0
    buffer_load_dwordx4 v169, s[16:19], s55 offen lds
    s_mul_i32 s55, s30, 163840
    s_add_u32 s55, s55, 0x1e100
    s_lshl_b32 s56, s32, 10
    s_add_u32 m0, s56, 0x10000
    s_nop 0
    buffer_load_dwordx4 v169, s[16:19], s55 offen lds
    s_mul_i32 s55, s30, 163840
    s_add_u32 s55, s55, 0x23100
    s_lshl_b32 s56, s32, 10
    s_add_u32 m0, s56, 0x11000
    s_nop 0
    buffer_load_dwordx4 v169, s[16:19], s55 offen lds
    s_waitcnt vmcnt(16)
    s_barrier
    v_add_u32 v172, 0x14000, v170
    v_add_u32 v173, 0x14000, v171
    ds_read_b64_tr_b16 a[40:41], v172 offset:0
    ds_read_b64_tr_b16 a[42:43], v172 offset:1024
    ds_read_b64_tr_b16 a[44:45], v172 offset:8192
    ds_read_b64_tr_b16 a[46:47], v172 offset:9216
    ds_read_b64_tr_b16 a[48:49], v172 offset:16384
    ds_read_b64_tr_b16 a[50:51], v172 offset:17408
    ds_read_b64_tr_b16 a[52:53], v172 offset:24576
    ds_read_b64_tr_b16 a[54:55], v172 offset:25600
    ds_read_b64_tr_b16 a[56:57], v172 offset:32768
    ds_read_b64_tr_b16 a[58:59], v172 offset:33792
    ds_read_b64_tr_b16 a[120:121], v173 offset:0
    ds_read_b64_tr_b16 a[122:123], v173 offset:1024
    ds_read_b64_tr_b16 a[124:125], v173 offset:8192
    ds_read_b64_tr_b16 a[126:127], v173 offset:9216
    ds_read_b64_tr_b16 a[128:129], v173 offset:16384
    ds_read_b64_tr_b16 a[130:131], v173 offset:17408
    ds_read_b64_tr_b16 a[132:133], v173 offset:24576
    ds_read_b64_tr_b16 a[134:135], v173 offset:25600
    ds_read_b64_tr_b16 a[136:137], v173 offset:32768
    ds_read_b64_tr_b16 a[138:139], v173 offset:33792
    s_waitcnt lgkmcnt(0)
    v_add_u32 v172, 0x1e000, v170
    v_add_u32 v173, 0x1e000, v171
    ds_read_b64_tr_b16 a[60:61], v172 offset:0
    ds_read_b64_tr_b16 a[62:63], v172 offset:1024
    ds_read_b64_tr_b16 a[64:65], v172 offset:8192
    ds_read_b64_tr_b16 a[66:67], v172 offset:9216
    ds_read_b64_tr_b16 a[68:69], v172 offset:16384
    ds_read_b64_tr_b16 a[70:71], v172 offset:17408
    ds_read_b64_tr_b16 a[72:73], v172 offset:24576
    ds_read_b64_tr_b16 a[74:75], v172 offset:25600
    ds_read_b64_tr_b16 a[76:77], v172 offset:32768
    ds_read_b64_tr_b16 a[78:79], v172 offset:33792
    ds_read_b64_tr_b16 a[140:141], v173 offset:0
    ds_read_b64_tr_b16 a[142:143], v173 offset:1024
    ds_read_b64_tr_b16 a[144:145], v173 offset:8192
    ds_read_b64_tr_b16 a[146:147], v173 offset:9216
    ds_read_b64_tr_b16 a[148:149], v173 offset:16384
    ds_read_b64_tr_b16 a[150:151], v173 offset:17408
    ds_read_b64_tr_b16 a[152:153], v173 offset:24576
    ds_read_b64_tr_b16 a[154:155], v173 offset:25600
    ds_read_b64_tr_b16 a[156:157], v173 offset:32768
    ds_read_b64_tr_b16 a[158:159], v173 offset:33792
    s_waitcnt lgkmcnt(0)
    s_barrier
    s_mul_i32 s55, s30, 163840
    s_add_u32 s55, s55, 0x200
    s_lshl_b32 s56, s32, 10
    s_add_u32 m0, s56, 0x14000
    s_nop 0
    buffer_load_dwordx4 v169, s[16:19], s55 offen lds
    s_mul_i32 s55, s30, 163840
    s_add_u32 s55, s55, 0x5200
    s_lshl_b32 s56, s32, 10
    s_add_u32 m0, s56, 0x15000
    s_nop 0
    buffer_load_dwordx4 v169, s[16:19], s55 offen lds
    s_mul_i32 s55, s30, 163840
    s_add_u32 s55, s55, 0xa200
    s_lshl_b32 s56, s32, 10
    s_add_u32 m0, s56, 0x16000
    s_nop 0
    buffer_load_dwordx4 v169, s[16:19], s55 offen lds
    s_mul_i32 s55, s30, 163840
    s_add_u32 s55, s55, 0xf200
    s_lshl_b32 s56, s32, 10
    s_add_u32 m0, s56, 0x17000
    s_nop 0
    buffer_load_dwordx4 v169, s[16:19], s55 offen lds
    s_mul_i32 s55, s30, 163840
    s_add_u32 s55, s55, 0x14200
    s_lshl_b32 s56, s32, 10
    s_add_u32 m0, s56, 0x18000
    s_nop 0
    buffer_load_dwordx4 v169, s[16:19], s55 offen lds
    s_mul_i32 s55, s30, 163840
    s_add_u32 s55, s55, 0x19200
    s_lshl_b32 s56, s32, 10
    s_add_u32 m0, s56, 0x19000
    s_nop 0
    buffer_load_dwordx4 v169, s[16:19], s55 offen lds
    s_mul_i32 s55, s30, 163840
    s_add_u32 s55, s55, 0x1e200
    s_lshl_b32 s56, s32, 10
    s_add_u32 m0, s56, 0x1a000
    s_nop 0
    buffer_load_dwordx4 v169, s[16:19], s55 offen lds
    s_mul_i32 s55, s30, 163840
    s_add_u32 s55, s55, 0x23200
    s_lshl_b32 s56, s32, 10
    s_add_u32 m0, s56, 0x1b000
    s_nop 0
    buffer_load_dwordx4 v169, s[16:19], s55 offen lds
    s_mul_i32 s55, s30, 163840
    s_add_u32 s55, s55, 0x300
    s_lshl_b32 s56, s32, 10
    s_add_u32 m0, s56, 0x1e000
    s_nop 0
    buffer_load_dwordx4 v169, s[16:19], s55 offen lds
    s_mul_i32 s55, s30, 163840
    s_add_u32 s55, s55, 0x5300
    s_lshl_b32 s56, s32, 10
    s_add_u32 m0, s56, 0x1f000
    s_nop 0
    buffer_load_dwordx4 v169, s[16:19], s55 offen lds
    s_mul_i32 s55, s30, 163840
    s_add_u32 s55, s55, 0xa300
    s_lshl_b32 s56, s32, 10
    s_add_u32 m0, s56, 0x20000
    s_nop 0
    buffer_load_dwordx4 v169, s[16:19], s55 offen lds
    s_mul_i32 s55, s30, 163840
    s_add_u32 s55, s55, 0xf300
    s_lshl_b32 s56, s32, 10
    s_add_u32 m0, s56, 0x21000
    s_nop 0
    buffer_load_dwordx4 v169, s[16:19], s55 offen lds
    s_mul_i32 s55, s30, 163840
    s_add_u32 s55, s55, 0x14300
    s_lshl_b32 s56, s32, 10
    s_add_u32 m0, s56, 0x22000
    s_nop 0
    buffer_load_dwordx4 v169, s[16:19], s55 offen lds
    s_mul_i32 s55, s30, 163840
    s_add_u32 s55, s55, 0x19300
    s_lshl_b32 s56, s32, 10
    s_add_u32 m0, s56, 0x23000
    s_nop 0
    buffer_load_dwordx4 v169, s[16:19], s55 offen lds
    s_mul_i32 s55, s30, 163840
    s_add_u32 s55, s55, 0x1e300
    s_lshl_b32 s56, s32, 10
    s_add_u32 m0, s56, 0x24000
    s_nop 0
    buffer_load_dwordx4 v169, s[16:19], s55 offen lds
    s_mul_i32 s55, s30, 163840
    s_add_u32 s55, s55, 0x23300
    s_lshl_b32 s56, s32, 10
    s_add_u32 m0, s56, 0x25000
    s_nop 0
    buffer_load_dwordx4 v169, s[16:19], s55 offen lds
    s_waitcnt vmcnt(16)
    s_barrier
    v_add_u32 v172, 0x0, v174
    v_add_u32 v173, 0x0, v175
    ds_read_b64_tr_b16 a[160:161], v172 offset:0
    ds_read_b64_tr_b16 a[162:163], v172 offset:4096
    ds_read_b64_tr_b16 a[164:165], v172 offset:8192
    ds_read_b64_tr_b16 a[166:167], v172 offset:12288
    ds_read_b64_tr_b16 a[168:169], v172 offset:16384
    ds_read_b64_tr_b16 a[170:171], v172 offset:20480
    ds_read_b64_tr_b16 a[172:173], v172 offset:24576
    ds_read_b64_tr_b16 a[174:175], v172 offset:28672
    ds_read_b64_tr_b16 a[176:177], v173 offset:0
    ds_read_b64_tr_b16 a[178:179], v173 offset:4096
    ds_read_b64_tr_b16 a[180:181], v173 offset:8192
    ds_read_b64_tr_b16 a[182:183], v173 offset:12288
    ds_read_b64_tr_b16 a[184:185], v173 offset:16384
    ds_read_b64_tr_b16 a[186:187], v173 offset:20480
    ds_read_b64_tr_b16 a[188:189], v173 offset:24576
    ds_read_b64_tr_b16 a[190:191], v173 offset:28672
    s_waitcnt lgkmcnt(0)
    v_add_u32 v172, 0xa000, v174
    v_add_u32 v173, 0xa000, v175
    ds_read_b64_tr_b16 a[192:193], v172 offset:0
    ds_read_b64_tr_b16 a[194:195], v172 offset:4096
    ds_read_b64_tr_b16 a[196:197], v172 offset:8192
    ds_read_b64_tr_b16 a[198:199], v172 offset:12288
    ds_read_b64_tr_b16 a[200:201], v172 offset:16384
    ds_read_b64_tr_b16 a[202:203], v172 offset:20480
    ds_read_b64_tr_b16 a[204:205], v172 offset:24576
    ds_read_b64_tr_b16 a[206:207], v172 offset:28672
    ds_read_b64_tr_b16 a[208:209], v173 offset:0
    ds_read_b64_tr_b16 a[210:211], v173 offset:4096
    ds_read_b64_tr_b16 a[212:213], v173 offset:8192
    ds_read_b64_tr_b16 a[214:215], v173 offset:12288
    ds_read_b64_tr_b16 a[216:217], v173 offset:16384
    ds_read_b64_tr_b16 a[218:219], v173 offset:20480
    ds_read_b64_tr_b16 a[220:221], v173 offset:24576
    ds_read_b64_tr_b16 a[222:223], v173 offset:28672
    s_waitcnt lgkmcnt(0)
    s_barrier
    s_mul_i32 s55, s30, 163840
    s_add_u32 s55, s55, 0x400
    s_lshl_b32 s56, s32, 10
    s_add_u32 m0, s56, 0x0
    s_nop 0
    buffer_load_dwordx4 v169, s[16:19], s55 offen lds
    s_mul_i32 s55, s30, 163840
    s_add_u32 s55, s55, 0x5400
    s_lshl_b32 s56, s32, 10
    s_add_u32 m0, s56, 0x1000
    s_nop 0
    buffer_load_dwordx4 v169, s[16:19], s55 offen lds
    s_mul_i32 s55, s30, 163840
    s_add_u32 s55, s55, 0xa400
    s_lshl_b32 s56, s32, 10
    s_add_u32 m0, s56, 0x2000
    s_nop 0
    buffer_load_dwordx4 v169, s[16:19], s55 offen lds
    s_mul_i32 s55, s30, 163840
    s_add_u32 s55, s55, 0xf400
    s_lshl_b32 s56, s32, 10
    s_add_u32 m0, s56, 0x3000
    s_nop 0
    buffer_load_dwordx4 v169, s[16:19], s55 offen lds
    s_mul_i32 s55, s30, 163840
    s_add_u32 s55, s55, 0x14400
    s_lshl_b32 s56, s32, 10
    s_add_u32 m0, s56, 0x4000
    s_nop 0
    buffer_load_dwordx4 v169, s[16:19], s55 offen lds
    s_mul_i32 s55, s30, 163840
    s_add_u32 s55, s55, 0x19400
    s_lshl_b32 s56, s32, 10
    s_add_u32 m0, s56, 0x5000
    s_nop 0
    buffer_load_dwordx4 v169, s[16:19], s55 offen lds
    s_mul_i32 s55, s30, 163840
    s_add_u32 s55, s55, 0x1e400
    s_lshl_b32 s56, s32, 10
    s_add_u32 m0, s56, 0x6000
    s_nop 0
    buffer_load_dwordx4 v169, s[16:19], s55 offen lds
    s_mul_i32 s55, s30, 163840
    s_add_u32 s55, s55, 0x23400
    s_lshl_b32 s56, s32, 10
    s_add_u32 m0, s56, 0x7000
    s_nop 0
    buffer_load_dwordx4 v169, s[16:19], s55 offen lds
    s_waitcnt vmcnt(8)
    s_barrier
    v_add_u32 v172, 0x14000, v174
    v_add_u32 v173, 0x14000, v175
    ds_read_b64_tr_b16 a[224:225], v172 offset:0
    ds_read_b64_tr_b16 a[226:227], v172 offset:4096
    ds_read_b64_tr_b16 a[228:229], v172 offset:8192
    ds_read_b64_tr_b16 a[230:231], v172 offset:12288
    ds_read_b64_tr_b16 a[232:233], v172 offset:16384
    ds_read_b64_tr_b16 a[234:235], v172 offset:20480
    ds_read_b64_tr_b16 a[236:237], v172 offset:24576
    ds_read_b64_tr_b16 a[238:239], v172 offset:28672
    ds_read_b64_tr_b16 a[240:241], v173 offset:0
    ds_read_b64_tr_b16 a[242:243], v173 offset:4096
    ds_read_b64_tr_b16 a[244:245], v173 offset:8192
    ds_read_b64_tr_b16 a[246:247], v173 offset:12288
    ds_read_b64_tr_b16 a[248:249], v173 offset:16384
    ds_read_b64_tr_b16 a[250:251], v173 offset:20480
    ds_read_b64_tr_b16 a[252:253], v173 offset:24576
    ds_read_b64_tr_b16 a[254:255], v173 offset:28672
    s_waitcnt lgkmcnt(0)
    v_add_u32 v172, 0x1e000, v174
    v_add_u32 v173, 0x1e000, v175
    ds_read_b64_tr_b16 v[192:193], v172 offset:0
    ds_read_b64_tr_b16 v[194:195], v172 offset:4096
    ds_read_b64_tr_b16 v[196:197], v172 offset:8192
    ds_read_b64_tr_b16 v[198:199], v172 offset:12288
    ds_read_b64_tr_b16 v[200:201], v172 offset:16384
    ds_read_b64_tr_b16 v[202:203], v172 offset:20480
    ds_read_b64_tr_b16 v[204:205], v172 offset:24576
    ds_read_b64_tr_b16 v[206:207], v172 offset:28672
    ds_read_b64_tr_b16 v[208:209], v173 offset:0
    ds_read_b64_tr_b16 v[210:211], v173 offset:4096
    ds_read_b64_tr_b16 v[212:213], v173 offset:8192
    ds_read_b64_tr_b16 v[214:215], v173 offset:12288
    ds_read_b64_tr_b16 v[216:217], v173 offset:16384
    ds_read_b64_tr_b16 v[218:219], v173 offset:20480
    ds_read_b64_tr_b16 v[220:221], v173 offset:24576
    ds_read_b64_tr_b16 v[222:223], v173 offset:28672
    s_waitcnt lgkmcnt(0)
    s_barrier
    s_waitcnt vmcnt(0)
    s_barrier
    v_add_u32 v172, 0x0, v174
    v_add_u32 v173, 0x0, v175
    ds_read_b64_tr_b16 v[224:225], v172 offset:0
    ds_read_b64_tr_b16 v[226:227], v172 offset:4096
    ds_read_b64_tr_b16 v[228:229], v172 offset:8192
    ds_read_b64_tr_b16 v[230:231], v172 offset:12288
    ds_read_b64_tr_b16 v[232:233], v172 offset:16384
    ds_read_b64_tr_b16 v[234:235], v172 offset:20480
    ds_read_b64_tr_b16 v[236:237], v172 offset:24576
    ds_read_b64_tr_b16 v[238:239], v172 offset:28672
    ds_read_b64_tr_b16 v[240:241], v173 offset:0
    ds_read_b64_tr_b16 v[242:243], v173 offset:4096
    ds_read_b64_tr_b16 v[244:245], v173 offset:8192
    ds_read_b64_tr_b16 v[246:247], v173 offset:12288
    ds_read_b64_tr_b16 v[248:249], v173 offset:16384
    ds_read_b64_tr_b16 v[250:251], v173 offset:20480
    ds_read_b64_tr_b16 v[252:253], v173 offset:24576
    ds_read_b64_tr_b16 v[254:255], v173 offset:28672
    s_waitcnt lgkmcnt(0)
    s_barrier
    v_lshlrev_b32 v6, 4, v1
    v_mul_u32_u24 v7, 1280, v2
    v_lshl_add_u32 v7, v3, 4, v7
    s_lshr_b32 s54, s32, 1
    s_mul_i32 s54, s54, 20480
    s_and_b32 s55, s32, 1
    s_mul_i32 s55, s55, 640
    s_add_u32 s54, s54, s55
    v_add_u32 v7, s54, v7
    s_mul_i32 s54, s30, 40960
    s_lshl_b32 s55, s32, 10
    s_add_u32 s54, s54, s55
    v_add_u32 v8, s54, v6
    s_mov_b32 s55, 0x34
    s_cmp_eq_u32 s32, 0
    s_cbranch_scc0 PZww_127
    s_mov_b32 s54, 0x1
    v_min_u32 v170, 0, v1
    v_mul_u32_u24 v170, 4, v170
    s_mov_b32 s43, 0x40000
PZwl_128:
    buffer_load_dword v171, v170, s[20:23], s55 offen sc1
    s_waitcnt vmcnt(0)
    v_cmp_gt_u32 vcc, 128, v171
    s_nop 1
    v_cndmask_b32 v171, 0, v171, vcc
    v_cmp_gt_u32 vcc, s54, v171
    s_cbranch_vccz PZwd_129
    s_sleep 1
    s_sub_u32 s43, s43, 1
    s_cbranch_scc0 PZwl_128
PZwd_129:
PZww_127:
    s_barrier
    s_mov_b32 s36, 0x0
    s_mul_i32 s54, s33, 40960
    s_mul_i32 s55, s32, 10240
    s_add_u32 s55, s55, s36
    s_add_u32 m0, s55, 0
    s_add_u32 s56, s54, 0
    buffer_load_dwordx4 v7, s[24:27], s56 offen lds
    s_add_u32 m0, s55, 1024
    s_add_u32 s56, s54, 64
    buffer_load_dwordx4 v7, s[24:27], s56 offen lds
    s_add_u32 m0, s55, 2048
    s_add_u32 s56, s54, 128
    buffer_load_dwordx4 v7, s[24:27], s56 offen lds
    s_add_u32 m0, s55, 3072
    s_add_u32 s56, s54, 192
    buffer_load_dwordx4 v7, s[24:27], s56 offen lds
    s_add_u32 m0, s55, 4096
    s_add_u32 s56, s54, 256
    buffer_load_dwordx4 v7, s[24:27], s56 offen lds
    s_add_u32 m0, s55, 5120
    s_add_u32 s56, s54, 320
    buffer_load_dwordx4 v7, s[24:27], s56 offen lds
    s_add_u32 m0, s55, 6144
    s_add_u32 s56, s54, 384
    buffer_load_dwordx4 v7, s[24:27], s56 offen lds
    s_add_u32 m0, s55, 7168
    s_add_u32 s56, s54, 448
    buffer_load_dwordx4 v7, s[24:27], s56 offen lds
    s_add_u32 m0, s55, 8192
    s_add_u32 s56, s54, 512
    buffer_load_dwordx4 v7, s[24:27], s56 offen lds
    s_add_u32 m0, s55, 9216
    s_add_u32 s56, s54, 576
    buffer_load_dwordx4 v7, s[24:27], s56 offen lds
    s_waitcnt vmcnt(0)
PB_loop:
    s_barrier
    s_add_u32 s37, s33, s35
    s_xor_b32 s38, s36, 40960
    s_cmp_ge_u32 s37, 64
    s_cbranch_scc1 PB_nopf
    s_mul_i32 s54, s37, 40960
    s_mul_i32 s55, s32, 10240
    s_add_u32 s55, s55, s38
    s_add_u32 m0, s55, 0
    s_add_u32 s56, s54, 0
    buffer_load_dwordx4 v7, s[24:27], s56 offen lds
    s_add_u32 m0, s55, 1024
    s_add_u32 s56, s54, 64
    buffer_load_dwordx4 v7, s[24:27], s56 offen lds
    s_add_u32 m0, s55, 2048
    s_add_u32 s56, s54, 128
    buffer_load_dwordx4 v7, s[24:27], s56 offen lds
    s_add_u32 m0, s55, 3072
    s_add_u32 s56, s54, 192
    buffer_load_dwordx4 v7, s[24:27], s56 offen lds
    s_add_u32 m0, s55, 4096
    s_add_u32 s56, s54, 256
    buffer_load_dwordx4 v7, s[24:27], s56 offen lds
    s_add_u32 m0, s55, 5120
    s_add_u32 s56, s54, 320
    buffer_load_dwordx4 v7, s[24:27], s56 offen lds
    s_add_u32 m0, s55, 6144
    s_add_u32 s56, s54, 384
    buffer_load_dwordx4 v7, s[24:27], s56 offen lds
    s_add_u32 m0, s55, 7168
    s_add_u32 s56, s54, 448
    buffer_load_dwordx4 v7, s[24:27], s56 offen lds
    s_add_u32 m0, s55, 8192
    s_add_u32 s56, s54, 512
    buffer_load_dwordx4 v7, s[24:27], s56 offen lds
    s_add_u32 m0, s55, 9216
    s_add_u32 s56, s54, 576
    buffer_load_dwordx4 v7, s[24:27], s56 offen lds
PB_nopf:
    v_add_u32 v168, s36, v6
    ds_read_b128 v[32:35], v168 offset:0
    ds_read_b128 v[36:39], v168 offset:20480
    ds_read_b128 v[40:43], v168 offset:1024
    ds_read_b128 v[44:47], v168 offset:21504
    ds_read_b128 v[48:51], v168 offset:2048
    ds_read_b128 v[52:55], v168 offset:22528
    ds_read_b128 v[56:59], v168 offset:3072
    ds_read_b128 v[60:63], v168 offset:23552
    s_waitcnt lgkmcnt(7)
    v_mfma_f32_16x16x32_bf16 v[64:67], a[0:3], v[32:35], 0
    v_mfma_f32_16x16x32_bf16 v[68:71], a[80:83], v[32:35], 0
    ds_read_b128 v[32:35], v168 offset:4096
    s_waitcnt lgkmcnt(7)
    v_mfma_f32_16x16x32_bf16 v[72:75], a[0:3], v[36:39], 0
    v_mfma_f32_16x16x32_bf16 v[76:79], a[80:83], v[36:39], 0
    ds_read_b128 v[36:39], v168 offset:24576
    s_waitcnt lgkmcnt(7)
    v_mfma_f32_16x16x32_bf16 v[64:67], a[4:7], v[40:43], v[64:67]
    v_mfma_f32_16x16x32_bf16 v[68:71], a[84:87], v[40:43], v[68:71]
    ds_read_b128 v[40:43], v168 offset:5120
    s_waitcnt lgkmcnt(7)
    v_mfma_f32_16x16x32_bf16 v[72:75], a[4:7], v[44:47], v[72:75]
    v_mfma_f32_16x16x32_bf16 v[76:79], a[84:87], v[44:47], v[76:79]
    ds_read_b128 v[44:47], v168 offset:25600
    s_waitcnt lgkmcnt(7)
    v_mfma_f32_16x16x32_bf16 v[64:67], a[8:11], v[48:51], v[64:67]
    v_mfma_f32_16x16x32_bf16 v[68:71], a[88:91], v[48:51], v[68:71]
    ds_read_b128 v[48:51], v168 offset:6144
    s_waitcnt lgkmcnt(7)
    v_mfma_f32_16x16x32_bf16 v[72:75], a[8:11], v[52:55], v[72:75]
    v_mfma_f32_16x16x32_bf16 v[76:79], a[88:91], v[52:55], v[76:79]
    ds_read_b128 v[52:55], v168 offset:26624
    s_waitcnt lgkmcnt(7)
    v_mfma_f32_16x16x32_bf16 v[64:67], a[12:15], v[56:59], v[64:67]
    v_mfma_f32_16x16x32_bf16 v[68:71], a[92:95], v[56:59], v[68:71]
    ds_read_b128 v[56:59], v168 offset:7168
    s_waitcnt lgkmcnt(7)
    v_mfma_f32_16x16x32_bf16 v[72:75], a[12:15], v[60:63], v[72:75]
    v_mfma_f32_16x16x32_bf16 v[76:79], a[92:95], v[60:63], v[76:79]
    ds_read_b128 v[60:63], v168 offset:27648
    s_waitcnt lgkmcnt(7)
    v_mfma_f32_16x16x32_bf16 v[64:67], a[16:19], v[32:35], v[64:67]
    v_mfma_f32_16x16x32_bf16 v[68:71], a[96:99], v[32:35], v[68:71]
    ds_read_b128 v[32:35], v168 offset:8192
    s_waitcnt lgkmcnt(7)
    v_mfma_f32_16x16x32_bf16 v[72:75], a[16:19], v[36:39], v[72:75]
    v_mfma_f32_16x16x32_bf16 v[76:79], a[96:99], v[36:39], v[76:79]
    ds_read_b128 v[36:39], v168 offset:28672
    s_waitcnt lgkmcnt(7)
    v_mfma_f32_16x16x32_bf16 v[64:67], a[20:23], v[40:43], v[64:67]
    v_mfma_f32_16x16x32_bf16 v[68:71], a[100:103], v[40:43], v[68:71]
    ds_read_b128 v[40:43], v168 offset:9216
    s_waitcnt lgkmcnt(7)
    v_mfma_f32_16x16x32_bf16 v[72:75], a[20:23], v[44:47], v[72:75]
    v_mfma_f32_16x16x32_bf16 v[76:79], a[100:103], v[44:47], v[76:79]
    ds_read_b128 v[44:47], v168 offset:29696
    s_waitcnt lgkmcnt(7)
    v_mfma_f32_16x16x32_bf16 v[64:67], a[24:27], v[48:51], v[64:67]
    v_mfma_f32_16x16x32_bf16 v[68:71], a[104:107], v[48:51], v[68:71]
    ds_read_b128 v[48:51], v168 offset:10240
    s_waitcnt lgkmcnt(7)
    v_mfma_f32_16x16x32_bf16 v[72:75], a[24:27], v[52:55], v[72:75]
    v_mfma_f32_16x16x32_bf16 v[76:79], a[104:107], v[52:55], v[76:79]
    ds_read_b128 v[52:55], v168 offset:30720
    s_waitcnt lgkmcnt(7)
    v_mfma_f32_16x16x32_bf16 v[64:67], a[28:31], v[56:59], v[64:67]
    v_mfma_f32_16x16x32_bf16 v[68:71], a[108:111], v[56:59], v[68:71]
    ds_read_b128 v[56:59], v168 offset:11264
    s_waitcnt lgkmcnt(7)
    v_mfma_f32_16x16x32_bf16 v[72:75], a[28:31], v[60:63], v[72:75]
    v_mfma_f32_16x16x32_bf16 v[76:79], a[108:111], v[60:63], v[76:79]
    ds_read_b128 v[60:63], v168 offset:31744
    s_waitcnt lgkmcnt(7)
    v_mfma_f32_16x16x32_bf16 v[64:67], a[32:35], v[32:35], v[64:67]
    v_mfma_f32_16x16x32_bf16 v[68:71], a[112:115], v[32:35], v[68:71]
    ds_read_b128 v[32:35], v168 offset:12288
    s_waitcnt lgkmcnt(7)
    v_mfma_f32_16x16x32_bf16 v[72:75], a[32:35], v[36:39], v[72:75]
    v_mfma_f32_16x16x32_bf16 v[76:79], a[112:115], v[36:39], v[76:79]
    ds_read_b128 v[36:39], v168 offset:32768
    s_waitcnt lgkmcnt(7)
    v_mfma_f32_16x16x32_bf16 v[64:67], a[36:39], v[40:43], v[64:67]
    v_mfma_f32_16x16x32_bf16 v[68:71], a[116:119], v[40:43], v[68:71]
    ds_read_b128 v[40:43], v168 offset:13312
    s_waitcnt lgkmcnt(7)
    v_mfma_f32_16x16x32_bf16 v[72:75], a[36:39], v[44:47], v[72:75]
    v_mfma_f32_16x16x32_bf16 v[76:79], a[116:119], v[44:47], v[76:79]
    ds_read_b128 v[44:47], v168 offset:33792
    s_waitcnt lgkmcnt(7)
    v_mfma_f32_16x16x32_bf16 v[64:67], a[40:43], v[48:51], v[64:67]
    v_mfma_f32_16x16x32_bf16 v[68:71], a[120:123], v[48:51], v[68:71]
    ds_read_b128 v[48:51], v168 offset:14336
    s_waitcnt lgkmcnt(7)
    v_mfma_f32_16x16x32_bf16 v[72:75], a[40:43], v[52:55], v[72:75]
    v_mfma_f32_16x16x32_bf16 v[76:79], a[120:123], v[52:55], v[76:79]
    ds_read_b128 v[52:55], v168 offset:34816
    s_waitcnt lgkmcnt(7)
    v_mfma_f32_16x16x32_bf16 v[64:67], a[44:47], v[56:59], v[64:67]
    v_mfma_f32_16x16x32_bf16 v[68:71], a[124:127], v[56:59], v[68:71]
    ds_read_b128 v[56:59], v168 offset:15360
    s_waitcnt lgkmcnt(7)
    v_mfma_f32_16x16x32_bf16 v[72:75], a[44:47], v[60:63], v[72:75]
    v_mfma_f32_16x16x32_bf16 v[76:79], a[124:127], v[60:63], v[76:79]
    ds_read_b128 v[60:63], v168 offset:35840
    s_waitcnt lgkmcnt(7)
    v_mfma_f32_16x16x32_bf16 v[64:67], a[48:51], v[32:35], v[64:67]
    v_mfma_f32_16x16x32_bf16 v[68:71], a[128:131], v[32:35], v[68:71]
    ds_read_b128 v[32:35], v168 offset:16384
    s_waitcnt lgkmcnt(7)
    v_mfma_f32_16x16x32_bf16 v[72:75], a[48:51], v[36:39], v[72:75]
    v_mfma_f32_16x16x32_bf16 v[76:79], a[128:131], v[36:39], v[76:79]
    ds_read_b128 v[36:39], v168 offset:36864
    s_waitcnt lgkmcnt(7)
    v_mfma_f32_16x16x32_bf16 v[64:67], a[52:55], v[40:43], v[64:67]
    v_mfma_f32_16x16x32_bf16 v[68:71], a[132:135], v[40:43], v[68:71]
    ds_read_b128 v[40:43], v168 offset:17408
    s_waitcnt lgkmcnt(7)
    v_mfma_f32_16x16x32_bf16 v[72:75], a[52:55], v[44:47], v[72:75]
    v_mfma_f32_16x16x32_bf16 v[76:79], a[132:135], v[44:47], v[76:79]
    ds_read_b128 v[44:47], v168 offset:37888
    s_waitcnt lgkmcnt(7)
    v_mfma_f32_16x16x32_bf16 v[64:67], a[56:59], v[48:51], v[64:67]
    v_mfma_f32_16x16x32_bf16 v[68:71], a[136:139], v[48:51], v[68:71]
    ds_read_b128 v[48:51], v168 offset:18432
    s_waitcnt lgkmcnt(7)
    v_mfma_f32_16x16x32_bf16 v[72:75], a[56:59], v[52:55], v[72:75]
    v_mfma_f32_16x16x32_bf16 v[76:79], a[136:139], v[52:55], v[76:79]
    ds_read_b128 v[52:55], v168 offset:38912
    s_waitcnt lgkmcnt(7)
    v_mfma_f32_16x16x32_bf16 v[64:67], a[60:63], v[56:59], v[64:67]
    v_mfma_f32_16x16x32_bf16 v[68:71], a[140:143], v[56:59], v[68:71]
    ds_read_b128 v[56:59], v168 offset:19456
    s_waitcnt lgkmcnt(7)
    v_mfma_f32_16x16x32_bf16 v[72:75], a[60:63], v[60:63], v[72:75]
    v_mfma_f32_16x16x32_bf16 v[76:79], a[140:143], v[60:63], v[76:79]
    ds_read_b128 v[60:63], v168 offset:39936
    s_waitcnt lgkmcnt(7)
    v_mfma_f32_16x16x32_bf16 v[64:67], a[64:67], v[32:35], v[64:67]
    v_mfma_f32_16x16x32_bf16 v[68:71], a[144:147], v[32:35], v[68:71]
    s_waitcnt lgkmcnt(6)
    v_mfma_f32_16x16x32_bf16 v[72:75], a[64:67], v[36:39], v[72:75]
    v_mfma_f32_16x16x32_bf16 v[76:79], a[144:147], v[36:39], v[76:79]
    s_waitcnt lgkmcnt(5)
    v_mfma_f32_16x16x32_bf16 v[64:67], a[68:71], v[40:43], v[64:67]
    v_mfma_f32_16x16x32_bf16 v[68:71], a[148:151], v[40:43], v[68:71]
    s_waitcnt lgkmcnt(4)
    v_mfma_f32_16x16x32_bf16 v[72:75], a[68:71], v[44:47], v[72:75]
    v_mfma_f32_16x16x32_bf16 v[76:79], a[148:151], v[44:47], v[76:79]
    s_waitcnt lgkmcnt(3)
    v_mfma_f32_16x16x32_bf16 v[64:67], a[72:75], v[48:51], v[64:67]
    v_mfma_f32_16x16x32_bf16 v[68:71], a[152:155], v[48:51], v[68:71]
    s_waitcnt lgkmcnt(2)
    v_mfma_f32_16x16x32_bf16 v[72:75], a[72:75], v[52:55], v[72:75]
    v_mfma_f32_16x16x32_bf16 v[76:79], a[152:155], v[52:55], v[76:79]
    s_waitcnt lgkmcnt(1)
    v_mfma_f32_16x16x32_bf16 v[64:67], a[76:79], v[56:59], v[64:67]
    v_mfma_f32_16x16x32_bf16 v[68:71], a[156:159], v[56:59], v[68:71]
    s_waitcnt lgkmcnt(0)
    v_mfma_f32_16x16x32_bf16 v[72:75], a[76:79], v[60:63], v[72:75]
    v_mfma_f32_16x16x32_bf16 v[76:79], a[156:159], v[60:63], v[76:79]
    s_nop 7
    s_lshl_b32 s54, s32, 11
    s_add_u32 s54, s54, 81920
    v_add_u32 v169, s54, v6
    v_cvt_pk_bf16_f32 v32, v64, v65
    v_cvt_pk_bf16_f32 v33, v66, v67
    v_cvt_pk_bf16_f32 v34, v68, v69
    v_cvt_pk_bf16_f32 v35, v70, v71
    ds_write_b128 v169, v[32:35] offset:0
    v_cvt_pk_bf16_f32 v36, v72, v73
    v_cvt_pk_bf16_f32 v37, v74, v75
    v_cvt_pk_bf16_f32 v38, v76, v77
    v_cvt_pk_bf16_f32 v39, v78, v79
    ds_write_b128 v169, v[36:39] offset:1024
    s_waitcnt lgkmcnt(0)
    s_barrier
    v_add_u32 v170, 81920, v6
    ds_read_b128 v[32:35], v170 offset:0
    ds_read_b128 v[36:39], v170 offset:1024
    ds_read_b128 v[40:43], v170 offset:2048
    ds_read_b128 v[44:47], v170 offset:3072
    ds_read_b128 v[48:51], v170 offset:4096
    ds_read_b128 v[52:55], v170 offset:5120
    ds_read_b128 v[56:59], v170 offset:6144
    ds_read_b128 v[60:63], v170 offset:7168
    s_waitcnt lgkmcnt(6)
    v_mfma_f32_16x16x32_bf16 v[64:67], v[32:35], a[160:163], 0
    v_mfma_f32_16x16x32_bf16 v[68:71], v[36:39], a[160:163], 0
    v_mfma_f32_16x16x32_bf16 v[72:75], v[32:35], a[176:179], 0
    v_mfma_f32_16x16x32_bf16 v[76:79], v[36:39], a[176:179], 0
    v_mfma_f32_16x16x32_bf16 v[80:83], v[32:35], a[192:195], 0
    v_mfma_f32_16x16x32_bf16 v[84:87], v[36:39], a[192:195], 0
    v_mfma_f32_16x16x32_bf16 v[88:91], v[32:35], a[208:211], 0
    v_mfma_f32_16x16x32_bf16 v[92:95], v[36:39], a[208:211], 0
    v_mfma_f32_16x16x32_bf16 v[96:99], v[32:35], a[224:227], 0
    v_mfma_f32_16x16x32_bf16 v[100:103], v[36:39], a[224:227], 0
    v_mfma_f32_16x16x32_bf16 v[104:107], v[32:35], a[240:243], 0
    v_mfma_f32_16x16x32_bf16 v[108:111], v[36:39], a[240:243], 0
    v_mfma_f32_16x16x32_bf16 v[112:115], v[32:35], v[192:195], 0
    v_mfma_f32_16x16x32_bf16 v[116:119], v[36:39], v[192:195], 0
    v_mfma_f32_16x16x32_bf16 v[120:123], v[32:35], v[208:211], 0
    v_mfma_f32_16x16x32_bf16 v[124:127], v[36:39], v[208:211], 0
    v_mfma_f32_16x16x32_bf16 v[128:131], v[32:35], v[224:227], 0
    v_mfma_f32_16x16x32_bf16 v[132:135], v[36:39], v[224:227], 0
    v_mfma_f32_16x16x32_bf16 v[136:139], v[32:35], v[240:243], 0
    v_mfma_f32_16x16x32_bf16 v[140:143], v[36:39], v[240:243], 0
    s_waitcnt lgkmcnt(4)
    v_mfma_f32_16x16x32_bf16 v[64:67], v[40:43], a[164:167], v[64:67]
    v_mfma_f32_16x16x32_bf16 v[68:71], v[44:47], a[164:167], v[68:71]
    v_mfma_f32_16x16x32_bf16 v[72:75], v[40:43], a[180:183], v[72:75]
    v_mfma_f32_16x16x32_bf16 v[76:79], v[44:47], a[180:183], v[76:79]
    v_mfma_f32_16x16x32_bf16 v[80:83], v[40:43], a[196:199], v[80:83]
    v_mfma_f32_16x16x32_bf16 v[84:87], v[44:47], a[196:199], v[84:87]
    v_mfma_f32_16x16x32_bf16 v[88:91], v[40:43], a[212:215], v[88:91]
    v_mfma_f32_16x16x32_bf16 v[92:95], v[44:47], a[212:215], v[92:95]
    v_mfma_f32_16x16x32_bf16 v[96:99], v[40:43], a[228:231], v[96:99]
    v_mfma_f32_16x16x32_bf16 v[100:103], v[44:47], a[228:231], v[100:103]
    v_mfma_f32_16x16x32_bf16 v[104:107], v[40:43], a[244:247], v[104:107]
    v_mfma_f32_16x16x32_bf16 v[108:111], v[44:47], a[244:247], v[108:111]
    v_mfma_f32_16x16x32_bf16 v[112:115], v[40:43], v[196:199], v[112:115]
    v_mfma_f32_16x16x32_bf16 v[116:119], v[44:47], v[196:199], v[116:119]
    v_mfma_f32_16x16x32_bf16 v[120:123], v[40:43], v[212:215], v[120:123]
    v_mfma_f32_16x16x32_bf16 v[124:127], v[44:47], v[212:215], v[124:127]
    v_mfma_f32_16x16x32_bf16 v[128:131], v[40:43], v[228:231], v[128:131]
    v_mfma_f32_16x16x32_bf16 v[132:135], v[44:47], v[228:231], v[132:135]
    v_mfma_f32_16x16x32_bf16 v[136:139], v[40:43], v[244:247], v[136:139]
    v_mfma_f32_16x16x32_bf16 v[140:143], v[44:47], v[244:247], v[140:143]
    s_waitcnt lgkmcnt(2)
    v_mfma_f32_16x16x32_bf16 v[64:67], v[48:51], a[168:171], v[64:67]
    v_mfma_f32_16x16x32_bf16 v[68:71], v[52:55], a[168:171], v[68:71]
    v_mfma_f32_16x16x32_bf16 v[72:75], v[48:51], a[184:187], v[72:75]
    v_mfma_f32_16x16x32_bf16 v[76:79], v[52:55], a[184:187], v[76:79]
    v_mfma_f32_16x16x32_bf16 v[80:83], v[48:51], a[200:203], v[80:83]
    v_mfma_f32_16x16x32_bf16 v[84:87], v[52:55], a[200:203], v[84:87]
    v_mfma_f32_16x16x32_bf16 v[88:91], v[48:51], a[216:219], v[88:91]
    v_mfma_f32_16x16x32_bf16 v[92:95], v[52:55], a[216:219], v[92:95]
    v_mfma_f32_16x16x32_bf16 v[96:99], v[48:51], a[232:235], v[96:99]
    v_mfma_f32_16x16x32_bf16 v[100:103], v[52:55], a[232:235], v[100:103]
    v_mfma_f32_16x16x32_bf16 v[104:107], v[48:51], a[248:251], v[104:107]
    v_mfma_f32_16x16x32_bf16 v[108:111], v[52:55], a[248:251], v[108:111]
    v_mfma_f32_16x16x32_bf16 v[112:115], v[48:51], v[200:203], v[112:115]
    v_mfma_f32_16x16x32_bf16 v[116:119], v[52:55], v[200:203], v[116:119]
    v_mfma_f32_16x16x32_bf16 v[120:123], v[48:51], v[216:219], v[120:123]
    v_mfma_f32_16x16x32_bf16 v[124:127], v[52:55], v[216:219], v[124:127]
    v_mfma_f32_16x16x32_bf16 v[128:131], v[48:51], v[232:235], v[128:131]
    v_mfma_f32_16x16x32_bf16 v[132:135], v[52:55], v[232:235], v[132:135]
    v_mfma_f32_16x16x32_bf16 v[136:139], v[48:51], v[248:251], v[136:139]
    v_mfma_f32_16x16x32_bf16 v[140:143], v[52:55], v[248:251], v[140:143]
    s_waitcnt lgkmcnt(0)
    v_mfma_f32_16x16x32_bf16 v[64:67], v[56:59], a[172:175], v[64:67]
    v_mfma_f32_16x16x32_bf16 v[68:71], v[60:63], a[172:175], v[68:71]
    v_mfma_f32_16x16x32_bf16 v[72:75], v[56:59], a[188:191], v[72:75]
    v_mfma_f32_16x16x32_bf16 v[76:79], v[60:63], a[188:191], v[76:79]
    v_mfma_f32_16x16x32_bf16 v[80:83], v[56:59], a[204:207], v[80:83]
    v_mfma_f32_16x16x32_bf16 v[84:87], v[60:63], a[204:207], v[84:87]
    v_mfma_f32_16x16x32_bf16 v[88:91], v[56:59], a[220:223], v[88:91]
    v_mfma_f32_16x16x32_bf16 v[92:95], v[60:63], a[220:223], v[92:95]
    v_mfma_f32_16x16x32_bf16 v[96:99], v[56:59], a[236:239], v[96:99]
    v_mfma_f32_16x16x32_bf16 v[100:103], v[60:63], a[236:239], v[100:103]
    v_mfma_f32_16x16x32_bf16 v[104:107], v[56:59], a[252:255], v[104:107]
    v_mfma_f32_16x16x32_bf16 v[108:111], v[60:63], a[252:255], v[108:111]
    v_mfma_f32_16x16x32_bf16 v[112:115], v[56:59], v[204:207], v[112:115]
    v_mfma_f32_16x16x32_bf16 v[116:119], v[60:63], v[204:207], v[116:119]
    v_mfma_f32_16x16x32_bf16 v[120:123], v[56:59], v[220:223], v[120:123]
    v_mfma_f32_16x16x32_bf16 v[124:127], v[60:63], v[220:223], v[124:127]
    v_mfma_f32_16x16x32_bf16 v[128:131], v[56:59], v[236:239], v[128:131]
    v_mfma_f32_16x16x32_bf16 v[132:135], v[60:63], v[236:239], v[132:135]
    v_mfma_f32_16x16x32_bf16 v[136:139], v[56:59], v[252:255], v[136:139]
    v_mfma_f32_16x16x32_bf16 v[140:143], v[60:63], v[252:255], v[140:143]
    s_nop 7
    s_mul_i32 s54, s33, 1310720
    s_add_u32 s54, s54, 0x2000000
    v_cvt_pk_bf16_f32 v32, v64, v65
    v_cvt_pk_bf16_f32 v33, v66, v67
    v_cvt_pk_bf16_f32 v34, v68, v69
    v_cvt_pk_bf16_f32 v35, v70, v71
    s_add_u32 s55, s54, 0
    buffer_store_dwordx4 v[32:35], v8, s[8:11], s55 offen sc1
    v_cvt_pk_bf16_f32 v36, v72, v73
    v_cvt_pk_bf16_f32 v37, v74, v75
    v_cvt_pk_bf16_f32 v38, v76, v77
    v_cvt_pk_bf16_f32 v39, v78, v79
    s_add_u32 s55, s54, 4096
    buffer_store_dwordx4 v[36:39], v8, s[8:11], s55 offen sc1
    v_cvt_pk_bf16_f32 v40, v80, v81
    v_cvt_pk_bf16_f32 v41, v82, v83
    v_cvt_pk_bf16_f32 v42, v84, v85
    v_cvt_pk_bf16_f32 v43, v86, v87
    s_add_u32 s55, s54, 8192
    buffer_store_dwordx4 v[40:43], v8, s[8:11], s55 offen sc1
    v_cvt_pk_bf16_f32 v44, v88, v89
    v_cvt_pk_bf16_f32 v45, v90, v91
    v_cvt_pk_bf16_f32 v46, v92, v93
    v_cvt_pk_bf16_f32 v47, v94, v95
    s_add_u32 s55, s54, 12288
    buffer_store_dwordx4 v[44:47], v8, s[8:11], s55 offen sc1
    v_cvt_pk_bf16_f32 v48, v96, v97
    v_cvt_pk_bf16_f32 v49, v98, v99
    v_cvt_pk_bf16_f32 v50, v100, v101
    v_cvt_pk_bf16_f32 v51, v102, v103
    s_add_u32 s55, s54, 16384
    buffer_store_dwordx4 v[48:51], v8, s[8:11], s55 offen sc1
    v_cvt_pk_bf16_f32 v52, v104, v105
    v_cvt_pk_bf16_f32 v53, v106, v107
    v_cvt_pk_bf16_f32 v54, v108, v109
    v_cvt_pk_bf16_f32 v55, v110, v111
    s_add_u32 s55, s54, 20480
    buffer_store_dwordx4 v[52:55], v8, s[8:11], s55 offen sc1
    v_cvt_pk_bf16_f32 v56, v112, v113
    v_cvt_pk_bf16_f32 v57, v114, v115
    v_cvt_pk_bf16_f32 v58, v116, v117
    v_cvt_pk_bf16_f32 v59, v118, v119
    s_add_u32 s55, s54, 24576
    buffer_store_dwordx4 v[56:59], v8, s[8:11], s55 offen sc1
    v_cvt_pk_bf16_f32 v60, v120, v121
    v_cvt_pk_bf16_f32 v61, v122, v123
    v_cvt_pk_bf16_f32 v62, v124, v125
    v_cvt_pk_bf16_f32 v63, v126, v127
    s_add_u32 s55, s54, 28672
    buffer_store_dwordx4 v[60:63], v8, s[8:11], s55 offen sc1
    s_nop 1
    v_cvt_pk_bf16_f32 v32, v128, v129
    v_cvt_pk_bf16_f32 v33, v130, v131
    v_cvt_pk_bf16_f32 v34, v132, v133
    v_cvt_pk_bf16_f32 v35, v134, v135
    s_add_u32 s55, s54, 32768
    buffer_store_dwordx4 v[32:35], v8, s[8:11], s55 offen sc1
    v_cvt_pk_bf16_f32 v36, v136, v137
    v_cvt_pk_bf16_f32 v37, v138, v139
    v_cvt_pk_bf16_f32 v38, v140, v141
    v_cvt_pk_bf16_f32 v39, v142, v143
    s_add_u32 s55, s54, 36864
    buffer_store_dwordx4 v[36:39], v8, s[8:11], s55 offen sc1
    s_waitcnt vmcnt(0)
    s_barrier
    s_cmp_eq_u32 s32, 0
    s_cbranch_scc0 ps_130
    v_mov_b32 v170, s37
    v_mov_b32 v171, 0
    s_mov_b64 exec, 1
    buffer_store_dword v170, v171, s[8:11], s41 offen sc1
    s_mov_b64 exec, -1
ps_130:
    s_waitcnt vmcnt(10)
    s_mov_b32 s33, s37
    s_mov_b32 s36, s38
    s_cmp_lt_u32 s33, 64
    s_cbranch_scc1 PB_loop
    s_waitcnt vmcnt(0)
    s_branch f_queue
f_aq:
    s_cmp_eq_u32 s40, 128
    s_cbranch_scc0 zs_131
    v_lshlrev_b32 v4, 3, v0
    v_mov_b32 v6, 0
    v_mov_b32 v7, 0
    s_mov_b32 s54, 0xa600000
    buffer_store_dwordx2 v[6:7], v4, s[8:11], s54 offen sc1
    s_waitcnt vmcnt(0)
    s_barrier
    s_cmp_eq_u32 s32, 0
    s_cbranch_scc0 z2_132
    s_mov_b32 s54, 0x34
    s_mov_b32 s55, 0x1
    v_mov_b32 v4, s55
    v_mov_b32 v5, 0
    s_mov_b64 exec, 1
    buffer_store_dword v4, v5, s[20:23], s54 offen sc1
    s_mov_b64 exec, -1
z2_132:
zs_131:
    s_sub_u32 s30, s40, 129
    s_cmp_ge_u32 s30, 5
    s_cbranch_scc1 wt_133
    s_mov_b32 s12, s80
    s_and_b32 s13, s81, 0xffff
    s_mov_b32 s14, 0xc8000
    s_mov_b32 s15, 0x00020000
    s_lshr_b32 s54, s32, 1
    s_lshl_b32 s54, s54, 3
    v_lshlrev_b32 v13, 1, v3
    v_add_u32 v13, s54, v13
    v_xor_b32 v13, v13, v2
    v_lshlrev_b32 v13, 4, v13
    s_lshl_b32 s54, s32, 2
    v_add_u32 v14, s54, v3
    v_mul_u32_u24 v10, 1280, v14
    v_add_u32 v10, v10, v13
    s_lshl_b32 s54, s32, 2
    s_add_u32 s54, s54, 0
    v_bfe_u32 v13, v1, 1, 1
    v_add_u32 v13, s54, v13
    v_lshrrev_b32 v14, 2, v2
    v_lshlrev_b32 v14, 1, v14
    v_and_b32 v11, 1, v3
    v_lshl_add_u32 v14, v11, 3, v14
    v_xor_b32 v13, v13, v14
    v_lshlrev_b32 v13, 4, v13
    v_and_b32 v14, 1, v1
    v_lshl_add_u32 v13, v14, 3, v13
    v_lshrrev_b32 v14, 2, v2
    v_lshl_add_u32 v14, v3, 3, v14
    v_lshl_add_u32 v11, v14, 8, v13
    s_lshl_b32 s54, s32, 2
    s_add_u32 s54, s54, 2
    v_bfe_u32 v13, v1, 1, 1
    v_add_u32 v13, s54, v13
    v_lshrrev_b32 v14, 2, v2
    v_lshlrev_b32 v14, 1, v14
    v_and_b32 v12, 1, v3
    v_lshl_add_u32 v14, v12, 3, v14
    v_xor_b32 v13, v13, v14
    v_lshlrev_b32 v13, 4, v13
    v_and_b32 v14, 1, v1
    v_lshl_add_u32 v13, v14, 3, v13
    v_lshrrev_b32 v14, 2, v2
    v_lshl_add_u32 v14, v3, 3, v14
    v_lshl_add_u32 v12, v14, 8, v13
    s_lshl_b32 s55, s32, 10
    s_add_u32 m0, s55, 0x0
    s_lshl_b32 s56, s30, 8
    s_add_u32 s56, s56, 0x0
    buffer_load_dwordx4 v10, s[12:15], s56 offen lds
    s_lshl_b32 s55, s32, 10
    s_add_u32 m0, s55, 0x1000
    s_lshl_b32 s56, s30, 8
    s_add_u32 s56, s56, 0x5000
    buffer_load_dwordx4 v10, s[12:15], s56 offen lds
    s_lshl_b32 s55, s32, 10
    s_add_u32 m0, s55, 0x2000
    s_lshl_b32 s56, s30, 8
    s_add_u32 s56, s56, 0xa000
    buffer_load_dwordx4 v10, s[12:15], s56 offen lds
    s_lshl_b32 s55, s32, 10
    s_add_u32 m0, s55, 0x3000
    s_lshl_b32 s56, s30, 8
    s_add_u32 s56, s56, 0xf000
    buffer_load_dwordx4 v10, s[12:15], s56 offen lds
    s_lshl_b32 s55, s32, 10
    s_add_u32 m0, s55, 0x4000
    s_lshl_b32 s56, s30, 8
    s_add_u32 s56, s56, 0x14000
    buffer_load_dwordx4 v10, s[12:15], s56 offen lds
    s_lshl_b32 s55, s32, 10
    s_add_u32 m0, s55, 0x5000
    s_lshl_b32 s56, s30, 8
    s_add_u32 s56, s56, 0x19000
    buffer_load_dwordx4 v10, s[12:15], s56 offen lds
    s_lshl_b32 s55, s32, 10
    s_add_u32 m0, s55, 0x6000
    s_lshl_b32 s56, s30, 8
    s_add_u32 s56, s56, 0x1e000
    buffer_load_dwordx4 v10, s[12:15], s56 offen lds
    s_lshl_b32 s55, s32, 10
    s_add_u32 m0, s55, 0x7000
    s_lshl_b32 s56, s30, 8
    s_add_u32 s56, s56, 0x23000
    buffer_load_dwordx4 v10, s[12:15], s56 offen lds
    s_lshl_b32 s55, s32, 10
    s_add_u32 m0, s55, 0x8000
    s_lshl_b32 s56, s30, 8
    s_add_u32 s56, s56, 0x28000
    buffer_load_dwordx4 v10, s[12:15], s56 offen lds
    s_lshl_b32 s55, s32, 10
    s_add_u32 m0, s55, 0x9000
    s_lshl_b32 s56, s30, 8
    s_add_u32 s56, s56, 0x2d000
    buffer_load_dwordx4 v10, s[12:15], s56 offen lds
    s_lshl_b32 s55, s32, 10
    s_add_u32 m0, s55, 0xa000
    s_lshl_b32 s56, s30, 8
    s_add_u32 s56, s56, 0x32000
    buffer_load_dwordx4 v10, s[12:15], s56 offen lds
    s_lshl_b32 s55, s32, 10
    s_add_u32 m0, s55, 0xb000
    s_lshl_b32 s56, s30, 8
    s_add_u32 s56, s56, 0x37000
    buffer_load_dwordx4 v10, s[12:15], s56 offen lds
    s_lshl_b32 s55, s32, 10
    s_add_u32 m0, s55, 0xc000
    s_lshl_b32 s56, s30, 8
    s_add_u32 s56, s56, 0x3c000
    buffer_load_dwordx4 v10, s[12:15], s56 offen lds
    s_lshl_b32 s55, s32, 10
    s_add_u32 m0, s55, 0xd000
    s_lshl_b32 s56, s30, 8
    s_add_u32 s56, s56, 0x41000
    buffer_load_dwordx4 v10, s[12:15], s56 offen lds
    s_lshl_b32 s55, s32, 10
    s_add_u32 m0, s55, 0xe000
    s_lshl_b32 s56, s30, 8
    s_add_u32 s56, s56, 0x46000
    buffer_load_dwordx4 v10, s[12:15], s56 offen lds
    s_lshl_b32 s55, s32, 10
    s_add_u32 m0, s55, 0xf000
    s_lshl_b32 s56, s30, 8
    s_add_u32 s56, s56, 0x4b000
    buffer_load_dwordx4 v10, s[12:15], s56 offen lds
    s_lshl_b32 s55, s32, 10
    s_add_u32 m0, s55, 0x10000
    s_lshl_b32 s56, s30, 8
    s_add_u32 s56, s56, 0x50000
    buffer_load_dwordx4 v10, s[12:15], s56 offen lds
    s_lshl_b32 s55, s32, 10
    s_add_u32 m0, s55, 0x11000
    s_lshl_b32 s56, s30, 8
    s_add_u32 s56, s56, 0x55000
    buffer_load_dwordx4 v10, s[12:15], s56 offen lds
    s_lshl_b32 s55, s32, 10
    s_add_u32 m0, s55, 0x12000
    s_lshl_b32 s56, s30, 8
    s_add_u32 s56, s56, 0x5a000
    buffer_load_dwordx4 v10, s[12:15], s56 offen lds
    s_lshl_b32 s55, s32, 10
    s_add_u32 m0, s55, 0x13000
    s_lshl_b32 s56, s30, 8
    s_add_u32 s56, s56, 0x5f000
    buffer_load_dwordx4 v10, s[12:15], s56 offen lds
    s_lshl_b32 s55, s32, 10
    s_add_u32 m0, s55, 0x14000
    s_lshl_b32 s56, s30, 8
    s_add_u32 s56, s56, 0x64000
    buffer_load_dwordx4 v10, s[12:15], s56 offen lds
    s_lshl_b32 s55, s32, 10
    s_add_u32 m0, s55, 0x15000
    s_lshl_b32 s56, s30, 8
    s_add_u32 s56, s56, 0x69000
    buffer_load_dwordx4 v10, s[12:15], s56 offen lds
    s_lshl_b32 s55, s32, 10
    s_add_u32 m0, s55, 0x16000
    s_lshl_b32 s56, s30, 8
    s_add_u32 s56, s56, 0x6e000
    buffer_load_dwordx4 v10, s[12:15], s56 offen lds
    s_lshl_b32 s55, s32, 10
    s_add_u32 m0, s55, 0x17000
    s_lshl_b32 s56, s30, 8
    s_add_u32 s56, s56, 0x73000
    buffer_load_dwordx4 v10, s[12:15], s56 offen lds
    s_lshl_b32 s55, s32, 10
    s_add_u32 m0, s55, 0x18000
    s_lshl_b32 s56, s30, 8
    s_add_u32 s56, s56, 0x78000
    buffer_load_dwordx4 v10, s[12:15], s56 offen lds
    s_lshl_b32 s55, s32, 10
    s_add_u32 m0, s55, 0x19000
    s_lshl_b32 s56, s30, 8
    s_add_u32 s56, s56, 0x7d000
    buffer_load_dwordx4 v10, s[12:15], s56 offen lds
    s_lshl_b32 s55, s32, 10
    s_add_u32 m0, s55, 0x1a000
    s_lshl_b32 s56, s30, 8
    s_add_u32 s56, s56, 0x82000
    buffer_load_dwordx4 v10, s[12:15], s56 offen lds
    s_lshl_b32 s55, s32, 10
    s_add_u32 m0, s55, 0x1b000
    s_lshl_b32 s56, s30, 8
    s_add_u32 s56, s56, 0x87000
    buffer_load_dwordx4 v10, s[12:15], s56 offen lds
    s_lshl_b32 s55, s32, 10
    s_add_u32 m0, s55, 0x1c000
    s_lshl_b32 s56, s30, 8
    s_add_u32 s56, s56, 0x8c000
    buffer_load_dwordx4 v10, s[12:15], s56 offen lds
    s_lshl_b32 s55, s32, 10
    s_add_u32 m0, s55, 0x1d000
    s_lshl_b32 s56, s30, 8
    s_add_u32 s56, s56, 0x91000
    buffer_load_dwordx4 v10, s[12:15], s56 offen lds
    s_lshl_b32 s55, s32, 10
    s_add_u32 m0, s55, 0x1e000
    s_lshl_b32 s56, s30, 8
    s_add_u32 s56, s56, 0x96000
    buffer_load_dwordx4 v10, s[12:15], s56 offen lds
    s_lshl_b32 s55, s32, 10
    s_add_u32 m0, s55, 0x1f000
    s_lshl_b32 s56, s30, 8
    s_add_u32 s56, s56, 0x9b000
    buffer_load_dwordx4 v10, s[12:15], s56 offen lds
    s_lshl_b32 s55, s32, 10
    s_add_u32 m0, s55, 0x20000
    s_lshl_b32 s56, s30, 8
    s_add_u32 s56, s56, 0xa0000
    buffer_load_dwordx4 v10, s[12:15], s56 offen lds
    s_lshl_b32 s55, s32, 10
    s_add_u32 m0, s55, 0x21000
    s_lshl_b32 s56, s30, 8
    s_add_u32 s56, s56, 0xa5000
    buffer_load_dwordx4 v10, s[12:15], s56 offen lds
    s_lshl_b32 s55, s32, 10
    s_add_u32 m0, s55, 0x22000
    s_lshl_b32 s56, s30, 8
    s_add_u32 s56, s56, 0xaa000
    buffer_load_dwordx4 v10, s[12:15], s56 offen lds
    s_lshl_b32 s55, s32, 10
    s_add_u32 m0, s55, 0x23000
    s_lshl_b32 s56, s30, 8
    s_add_u32 s56, s56, 0xaf000
    buffer_load_dwordx4 v10, s[12:15], s56 offen lds
    s_lshl_b32 s55, s32, 10
    s_add_u32 m0, s55, 0x24000
    s_lshl_b32 s56, s30, 8
    s_add_u32 s56, s56, 0xb4000
    buffer_load_dwordx4 v10, s[12:15], s56 offen lds
    s_lshl_b32 s55, s32, 10
    s_add_u32 m0, s55, 0x25000
    s_lshl_b32 s56, s30, 8
    s_add_u32 s56, s56, 0xb9000
    buffer_load_dwordx4 v10, s[12:15], s56 offen lds
    s_lshl_b32 s55, s32, 10
    s_add_u32 m0, s55, 0x26000
    s_lshl_b32 s56, s30, 8
    s_add_u32 s56, s56, 0xbe000
    buffer_load_dwordx4 v10, s[12:15], s56 offen lds
    s_lshl_b32 s55, s32, 10
    s_add_u32 m0, s55, 0x27000
    s_lshl_b32 s56, s30, 8
    s_add_u32 s56, s56, 0xc3000
    buffer_load_dwordx4 v10, s[12:15], s56 offen lds
    s_waitcnt vmcnt(0)
    s_barrier
    v_lshlrev_b32 v15, 4, v1
    s_lshl_b32 s54, s30, 3
    s_lshl_b32 s55, s32, 1
    s_add_u32 s54, s54, s55
    s_mul_i32 s54, s54, 20480
    s_add_u32 s54, s54, 0xa000000
    v_add_u32 v13, 0x0, v11
    ds_read_b64_tr_b16 v[32:33], v13 offset:0
    ds_read_b64_tr_b16 v[34:35], v13 offset:1024
    ds_read_b64_tr_b16 v[36:37], v13 offset:8192
    ds_read_b64_tr_b16 v[38:39], v13 offset:9216
    ds_read_b64_tr_b16 v[40:41], v13 offset:16384
    ds_read_b64_tr_b16 v[42:43], v13 offset:17408
    ds_read_b64_tr_b16 v[44:45], v13 offset:24576
    ds_read_b64_tr_b16 v[46:47], v13 offset:25600
    ds_read_b64_tr_b16 v[48:49], v13 offset:32768
    ds_read_b64_tr_b16 v[50:51], v13 offset:33792
    s_waitcnt lgkmcnt(0)
    s_add_u32 s55, s54, 0
    buffer_store_dwordx4 v[32:35], v15, s[8:11], s55 offen sc1
    s_add_u32 s55, s54, 1024
    buffer_store_dwordx4 v[36:39], v15, s[8:11], s55 offen sc1
    s_add_u32 s55, s54, 2048
    buffer_store_dwordx4 v[40:43], v15, s[8:11], s55 offen sc1
    s_add_u32 s55, s54, 3072
    buffer_store_dwordx4 v[44:47], v15, s[8:11], s55 offen sc1
    s_add_u32 s55, s54, 4096
    buffer_store_dwordx4 v[48:51], v15, s[8:11], s55 offen sc1
    s_waitcnt vmcnt(0)
    v_add_u32 v13, 0xa000, v11
    ds_read_b64_tr_b16 v[32:33], v13 offset:0
    ds_read_b64_tr_b16 v[34:35], v13 offset:1024
    ds_read_b64_tr_b16 v[36:37], v13 offset:8192
    ds_read_b64_tr_b16 v[38:39], v13 offset:9216
    ds_read_b64_tr_b16 v[40:41], v13 offset:16384
    ds_read_b64_tr_b16 v[42:43], v13 offset:17408
    ds_read_b64_tr_b16 v[44:45], v13 offset:24576
    ds_read_b64_tr_b16 v[46:47], v13 offset:25600
    ds_read_b64_tr_b16 v[48:49], v13 offset:32768
    ds_read_b64_tr_b16 v[50:51], v13 offset:33792
    s_waitcnt lgkmcnt(0)
    s_add_u32 s55, s54, 5120
    buffer_store_dwordx4 v[32:35], v15, s[8:11], s55 offen sc1
    s_add_u32 s55, s54, 6144
    buffer_store_dwordx4 v[36:39], v15, s[8:11], s55 offen sc1
    s_add_u32 s55, s54, 7168
    buffer_store_dwordx4 v[40:43], v15, s[8:11], s55 offen sc1
    s_add_u32 s55, s54, 8192
    buffer_store_dwordx4 v[44:47], v15, s[8:11], s55 offen sc1
    s_add_u32 s55, s54, 9216
    buffer_store_dwordx4 v[48:51], v15, s[8:11], s55 offen sc1
    s_waitcnt vmcnt(0)
    v_add_u32 v13, 0x14000, v11
    ds_read_b64_tr_b16 v[32:33], v13 offset:0
    ds_read_b64_tr_b16 v[34:35], v13 offset:1024
    ds_read_b64_tr_b16 v[36:37], v13 offset:8192
    ds_read_b64_tr_b16 v[38:39], v13 offset:9216
    ds_read_b64_tr_b16 v[40:41], v13 offset:16384
    ds_read_b64_tr_b16 v[42:43], v13 offset:17408
    ds_read_b64_tr_b16 v[44:45], v13 offset:24576
    ds_read_b64_tr_b16 v[46:47], v13 offset:25600
    ds_read_b64_tr_b16 v[48:49], v13 offset:32768
    ds_read_b64_tr_b16 v[50:51], v13 offset:33792
    s_waitcnt lgkmcnt(0)
    s_add_u32 s55, s54, 10240
    buffer_store_dwordx4 v[32:35], v15, s[8:11], s55 offen sc1
    s_add_u32 s55, s54, 11264
    buffer_store_dwordx4 v[36:39], v15, s[8:11], s55 offen sc1
    s_add_u32 s55, s54, 12288
    buffer_store_dwordx4 v[40:43], v15, s[8:11], s55 offen sc1
    s_add_u32 s55, s54, 13312
    buffer_store_dwordx4 v[44:47], v15, s[8:11], s55 offen sc1
    s_add_u32 s55, s54, 14336
    buffer_store_dwordx4 v[48:51], v15, s[8:11], s55 offen sc1
    s_waitcnt vmcnt(0)
    v_add_u32 v13, 0x1e000, v11
    ds_read_b64_tr_b16 v[32:33], v13 offset:0
    ds_read_b64_tr_b16 v[34:35], v13 offset:1024
    ds_read_b64_tr_b16 v[36:37], v13 offset:8192
    ds_read_b64_tr_b16 v[38:39], v13 offset:9216
    ds_read_b64_tr_b16 v[40:41], v13 offset:16384
    ds_read_b64_tr_b16 v[42:43], v13 offset:17408
    ds_read_b64_tr_b16 v[44:45], v13 offset:24576
    ds_read_b64_tr_b16 v[46:47], v13 offset:25600
    ds_read_b64_tr_b16 v[48:49], v13 offset:32768
    ds_read_b64_tr_b16 v[50:51], v13 offset:33792
    s_waitcnt lgkmcnt(0)
    s_add_u32 s55, s54, 15360
    buffer_store_dwordx4 v[32:35], v15, s[8:11], s55 offen sc1
    s_add_u32 s55, s54, 16384
    buffer_store_dwordx4 v[36:39], v15, s[8:11], s55 offen sc1
    s_add_u32 s55, s54, 17408
    buffer_store_dwordx4 v[40:43], v15, s[8:11], s55 offen sc1
    s_add_u32 s55, s54, 18432
    buffer_store_dwordx4 v[44:47], v15, s[8:11], s55 offen sc1
    s_add_u32 s55, s54, 19456
    buffer_store_dwordx4 v[48:51], v15, s[8:11], s55 offen sc1
    s_waitcnt vmcnt(0)
    v_add_u32 v13, 0x0, v12
    ds_read_b64_tr_b16 v[32:33], v13 offset:0
    ds_read_b64_tr_b16 v[34:35], v13 offset:1024
    ds_read_b64_tr_b16 v[36:37], v13 offset:8192
    ds_read_b64_tr_b16 v[38:39], v13 offset:9216
    ds_read_b64_tr_b16 v[40:41], v13 offset:16384
    ds_read_b64_tr_b16 v[42:43], v13 offset:17408
    ds_read_b64_tr_b16 v[44:45], v13 offset:24576
    ds_read_b64_tr_b16 v[46:47], v13 offset:25600
    ds_read_b64_tr_b16 v[48:49], v13 offset:32768
    ds_read_b64_tr_b16 v[50:51], v13 offset:33792
    s_waitcnt lgkmcnt(0)
    s_add_u32 s55, s54, 20480
    buffer_store_dwordx4 v[32:35], v15, s[8:11], s55 offen sc1
    s_add_u32 s55, s54, 21504
    buffer_store_dwordx4 v[36:39], v15, s[8:11], s55 offen sc1
    s_add_u32 s55, s54, 22528
    buffer_store_dwordx4 v[40:43], v15, s[8:11], s55 offen sc1
    s_add_u32 s55, s54, 23552
    buffer_store_dwordx4 v[44:47], v15, s[8:11], s55 offen sc1
    s_add_u32 s55, s54, 24576
    buffer_store_dwordx4 v[48:51], v15, s[8:11], s55 offen sc1
    s_waitcnt vmcnt(0)
    v_add_u32 v13, 0xa000, v12
    ds_read_b64_tr_b16 v[32:33], v13 offset:0
    ds_read_b64_tr_b16 v[34:35], v13 offset:1024
    ds_read_b64_tr_b16 v[36:37], v13 offset:8192
    ds_read_b64_tr_b16 v[38:39], v13 offset:9216
    ds_read_b64_tr_b16 v[40:41], v13 offset:16384
    ds_read_b64_tr_b16 v[42:43], v13 offset:17408
    ds_read_b64_tr_b16 v[44:45], v13 offset:24576
    ds_read_b64_tr_b16 v[46:47], v13 offset:25600
    ds_read_b64_tr_b16 v[48:49], v13 offset:32768
    ds_read_b64_tr_b16 v[50:51], v13 offset:33792
    s_waitcnt lgkmcnt(0)
    s_add_u32 s55, s54, 25600
    buffer_store_dwordx4 v[32:35], v15, s[8:11], s55 offen sc1
    s_add_u32 s55, s54, 26624
    buffer_store_dwordx4 v[36:39], v15, s[8:11], s55 offen sc1
    s_add_u32 s55, s54, 27648
    buffer_store_dwordx4 v[40:43], v15, s[8:11], s55 offen sc1
    s_add_u32 s55, s54, 28672
    buffer_store_dwordx4 v[44:47], v15, s[8:11], s55 offen sc1
    s_add_u32 s55, s54, 29696
    buffer_store_dwordx4 v[48:51], v15, s[8:11], s55 offen sc1
    s_waitcnt vmcnt(0)
    v_add_u32 v13, 0x14000, v12
    ds_read_b64_tr_b16 v[32:33], v13 offset:0
    ds_read_b64_tr_b16 v[34:35], v13 offset:1024
    ds_read_b64_tr_b16 v[36:37], v13 offset:8192
    ds_read_b64_tr_b16 v[38:39], v13 offset:9216
    ds_read_b64_tr_b16 v[40:41], v13 offset:16384
    ds_read_b64_tr_b16 v[42:43], v13 offset:17408
    ds_read_b64_tr_b16 v[44:45], v13 offset:24576
    ds_read_b64_tr_b16 v[46:47], v13 offset:25600
    ds_read_b64_tr_b16 v[48:49], v13 offset:32768
    ds_read_b64_tr_b16 v[50:51], v13 offset:33792
    s_waitcnt lgkmcnt(0)
    s_add_u32 s55, s54, 30720
    buffer_store_dwordx4 v[32:35], v15, s[8:11], s55 offen sc1
    s_add_u32 s55, s54, 31744
    buffer_store_dwordx4 v[36:39], v15, s[8:11], s55 offen sc1
    s_add_u32 s55, s54, 32768
    buffer_store_dwordx4 v[40:43], v15, s[8:11], s55 offen sc1
    s_add_u32 s55, s54, 33792
    buffer_store_dwordx4 v[44:47], v15, s[8:11], s55 offen sc1
    s_add_u32 s55, s54, 34816
    buffer_store_dwordx4 v[48:51], v15, s[8:11], s55 offen sc1
    s_waitcnt vmcnt(0)
    v_add_u32 v13, 0x1e000, v12
    ds_read_b64_tr_b16 v[32:33], v13 offset:0
    ds_read_b64_tr_b16 v[34:35], v13 offset:1024
    ds_read_b64_tr_b16 v[36:37], v13 offset:8192
    ds_read_b64_tr_b16 v[38:39], v13 offset:9216
    ds_read_b64_tr_b16 v[40:41], v13 offset:16384
    ds_read_b64_tr_b16 v[42:43], v13 offset:17408
    ds_read_b64_tr_b16 v[44:45], v13 offset:24576
    ds_read_b64_tr_b16 v[46:47], v13 offset:25600
    ds_read_b64_tr_b16 v[48:49], v13 offset:32768
    ds_read_b64_tr_b16 v[50:51], v13 offset:33792
    s_waitcnt lgkmcnt(0)
    s_add_u32 s55, s54, 35840
    buffer_store_dwordx4 v[32:35], v15, s[8:11], s55 offen sc1
    s_add_u32 s55, s54, 36864
    buffer_store_dwordx4 v[36:39], v15, s[8:11], s55 offen sc1
    s_add_u32 s55, s54, 37888
    buffer_store_dwordx4 v[40:43], v15, s[8:11], s55 offen sc1
    s_add_u32 s55, s54, 38912
    buffer_store_dwordx4 v[44:47], v15, s[8:11], s55 offen sc1
    s_add_u32 s55, s54, 39936
    buffer_store_dwordx4 v[48:51], v15, s[8:11], s55 offen sc1
    s_waitcnt vmcnt(0)
    s_barrier
    s_mov_b32 s55, 0x30
    s_waitcnt vmcnt(0)
    s_barrier
    s_cmp_eq_u32 s32, 0
    s_cbranch_scc0 WTsg_134
    v_mov_b32 v4, 1
    v_mov_b32 v5, 0
    s_mov_b64 exec, 1
    buffer_atomic_add v4, v5, s[20:23], s55 offen sc1
    s_mov_b64 exec, -1
WTsg_134:
wt_133:
    s_mov_b32 s24, s76
    s_and_b32 s25, s77, 0xffff
    s_mov_b32 s26, 0x280000
    s_mov_b32 s27, 0x00020000
    s_mov_b32 s12, s78
    s_and_b32 s13, s79, 0xffff
    s_mov_b32 s14, 0x258000
    s_mov_b32 s15, 0x00020000
    s_sub_u32 s54, s40, 128
    s_lshr_b32 s30, s54, 2
    s_and_b32 s33, s54, 3
    s_lshl_b32 s33, s33, 4
    s_add_u32 s34, s33, 16
    v_lshlrev_b32 v6, 4, v1
    s_lshr_b32 s54, s32, 1
    s_lshl_b32 s54, s54, 3
    v_lshlrev_b32 v172, 1, v3
    v_add_u32 v172, s54, v172
    v_xor_b32 v172, v172, v2
    v_min_u32 v172, 14, v172
    v_mul_u32_u24 v173, 13, v172
    v_lshrrev_b32 v173, 6, v173
    v_mul_u32_u24 v174, 1200, v173
    v_lshl_add_u32 v174, v172, 4, v174
    s_lshl_b32 s54, s32, 2
    v_add_u32 v173, s54, v3
    v_mul_u32_u24 v168, 3840, v173
    v_add_u32 v168, v168, v174
    s_mul_i32 s54, s30, 80
    v_add_u32 v168, s54, v168
    s_lshr_b32 s54, s32, 1
    s_mul_i32 s54, s54, 40
    s_and_b32 s55, s32, 1
    s_mul_i32 s55, s55, 80
    s_add_u32 s54, s54, s55
    v_and_b32 v172, 3, v1
    v_lshl_add_u32 v172, v172, 3, s54
    v_lshrrev_b32 v173, 4, v172
    v_lshrrev_b32 v174, 2, v2
    v_lshlrev_b32 v174, 1, v174
    v_and_b32 v169, 1, v3
    v_lshl_add_u32 v174, v169, 3, v174
    v_xor_b32 v173, v173, v174
    v_and_b32 v172, 15, v172
    v_lshl_add_u32 v172, v173, 4, v172
    v_lshrrev_b32 v174, 2, v2
    v_lshl_add_u32 v174, v3, 3, v174
    v_lshl_add_u32 v169, v174, 8, v172
    s_lshr_b32 s54, s32, 1
    s_mul_i32 s54, s54, 40
    s_and_b32 s55, s32, 1
    s_mul_i32 s55, s55, 80
    s_add_u32 s54, s54, s55
    s_add_u32 s54, s54, 32
    v_and_b32 v172, 3, v1
    v_lshl_add_u32 v172, v172, 3, s54
    v_lshrrev_b32 v173, 4, v172
    v_lshrrev_b32 v174, 2, v2
    v_lshlrev_b32 v174, 1, v174
    v_and_b32 v170, 1, v3
    v_lshl_add_u32 v174, v170, 3, v174
    v_xor_b32 v173, v173, v174
    v_and_b32 v172, 15, v172
    v_lshl_add_u32 v172, v173, 4, v172
    v_lshrrev_b32 v174, 2, v2
    v_lshl_add_u32 v174, v3, 3, v174
    v_lshl_add_u32 v170, v174, 8, v172
    s_lshr_b32 s54, s32, 1
    s_mul_i32 s54, s54, 40
    s_and_b32 s55, s32, 1
    s_lshl_b32 s55, s55, 5
    s_add_u32 s54, s54, s55
    s_add_u32 s54, s54, 160
    v_and_b32 v172, 3, v1
    v_lshl_add_u32 v172, v172, 3, s54
    v_lshrrev_b32 v173, 4, v172
    v_lshrrev_b32 v174, 2, v2
    v_lshlrev_b32 v174, 1, v174
    v_and_b32 v171, 1, v3
    v_lshl_add_u32 v174, v171, 3, v174
    v_xor_b32 v173, v173, v174
    v_and_b32 v172, 15, v172
    v_lshl_add_u32 v172, v173, 4, v172
    v_lshrrev_b32 v174, 2, v2
    v_lshl_add_u32 v174, v3, 3, v174
    v_lshl_add_u32 v171, v174, 8, v172
    s_lshl_b32 s55, s32, 10
    s_add_u32 m0, s55, 0x0
    s_mov_b32 s56, 0x0
    buffer_load_dwordx4 v168, s[12:15], s56 offen lds
    s_lshl_b32 s55, s32, 10
    s_add_u32 m0, s55, 0x1000
    s_mov_b32 s56, 0xf000
    buffer_load_dwordx4 v168, s[12:15], s56 offen lds
    s_lshl_b32 s55, s32, 10
    s_add_u32 m0, s55, 0x2000
    s_mov_b32 s56, 0x1e000
    buffer_load_dwordx4 v168, s[12:15], s56 offen lds
    s_lshl_b32 s55, s32, 10
    s_add_u32 m0, s55, 0x3000
    s_mov_b32 s56, 0x2d000
    buffer_load_dwordx4 v168, s[12:15], s56 offen lds
    s_lshl_b32 s55, s32, 10
    s_add_u32 m0, s55, 0x4000
    s_mov_b32 s56, 0x3c000
    buffer_load_dwordx4 v168, s[12:15], s56 offen lds
    s_lshl_b32 s55, s32, 10
    s_add_u32 m0, s55, 0x5000
    s_mov_b32 s56, 0x4b000
    buffer_load_dwordx4 v168, s[12:15], s56 offen lds
    s_lshl_b32 s55, s32, 10
    s_add_u32 m0, s55, 0x6000
    s_mov_b32 s56, 0x5a000
    buffer_load_dwordx4 v168, s[12:15], s56 offen lds
    s_lshl_b32 s55, s32, 10
    s_add_u32 m0, s55, 0x7000
    s_mov_b32 s56, 0x69000
    buffer_load_dwordx4 v168, s[12:15], s56 offen lds
    s_lshl_b32 s55, s32, 10
    s_add_u32 m0, s55, 0x8000
    s_mov_b32 s56, 0x78000
    buffer_load_dwordx4 v168, s[12:15], s56 offen lds
    s_lshl_b32 s55, s32, 10
    s_add_u32 m0, s55, 0x9000
    s_mov_b32 s56, 0x87000
    buffer_load_dwordx4 v168, s[12:15], s56 offen lds
    s_lshl_b32 s55, s32, 10
    s_add_u32 m0, s55, 0xa000
    s_mov_b32 s56, 0x96000
    buffer_load_dwordx4 v168, s[12:15], s56 offen lds
    s_lshl_b32 s55, s32, 10
    s_add_u32 m0, s55, 0xb000
    s_mov_b32 s56, 0xa5000
    buffer_load_dwordx4 v168, s[12:15], s56 offen lds
    s_lshl_b32 s55, s32, 10
    s_add_u32 m0, s55, 0xc000
    s_mov_b32 s56, 0xb4000
    buffer_load_dwordx4 v168, s[12:15], s56 offen lds
    s_lshl_b32 s55, s32, 10
    s_add_u32 m0, s55, 0xd000
    s_mov_b32 s56, 0xc3000
    buffer_load_dwordx4 v168, s[12:15], s56 offen lds
    s_lshl_b32 s55, s32, 10
    s_add_u32 m0, s55, 0xe000
    s_mov_b32 s56, 0xd2000
    buffer_load_dwordx4 v168, s[12:15], s56 offen lds
    s_lshl_b32 s55, s32, 10
    s_add_u32 m0, s55, 0xf000
    s_mov_b32 s56, 0xe1000
    buffer_load_dwordx4 v168, s[12:15], s56 offen lds
    s_lshl_b32 s55, s32, 10
    s_add_u32 m0, s55, 0x10000
    s_mov_b32 s56, 0xf0000
    buffer_load_dwordx4 v168, s[12:15], s56 offen lds
    s_lshl_b32 s55, s32, 10
    s_add_u32 m0, s55, 0x11000
    s_mov_b32 s56, 0xff000
    buffer_load_dwordx4 v168, s[12:15], s56 offen lds
    s_lshl_b32 s55, s32, 10
    s_add_u32 m0, s55, 0x12000
    s_mov_b32 s56, 0x10e000
    buffer_load_dwordx4 v168, s[12:15], s56 offen lds
    s_lshl_b32 s55, s32, 10
    s_add_u32 m0, s55, 0x13000
    s_mov_b32 s56, 0x11d000
    buffer_load_dwordx4 v168, s[12:15], s56 offen lds
    s_lshl_b32 s55, s32, 10
    s_add_u32 m0, s55, 0x14000
    s_mov_b32 s56, 0x12c000
    buffer_load_dwordx4 v168, s[12:15], s56 offen lds
    s_lshl_b32 s55, s32, 10
    s_add_u32 m0, s55, 0x15000
    s_mov_b32 s56, 0x13b000
    buffer_load_dwordx4 v168, s[12:15], s56 offen lds
    s_lshl_b32 s55, s32, 10
    s_add_u32 m0, s55, 0x16000
    s_mov_b32 s56, 0x14a000
    buffer_load_dwordx4 v168, s[12:15], s56 offen lds
    s_lshl_b32 s55, s32, 10
    s_add_u32 m0, s55, 0x17000
    s_mov_b32 s56, 0x159000
    buffer_load_dwordx4 v168, s[12:15], s56 offen lds
    s_lshl_b32 s55, s32, 10
    s_add_u32 m0, s55, 0x18000
    s_mov_b32 s56, 0x168000
    buffer_load_dwordx4 v168, s[12:15], s56 offen lds
    s_lshl_b32 s55, s32, 10
    s_add_u32 m0, s55, 0x19000
    s_mov_b32 s56, 0x177000
    buffer_load_dwordx4 v168, s[12:15], s56 offen lds
    s_lshl_b32 s55, s32, 10
    s_add_u32 m0, s55, 0x1a000
    s_mov_b32 s56, 0x186000
    buffer_load_dwordx4 v168, s[12:15], s56 offen lds
    s_lshl_b32 s55, s32, 10
    s_add_u32 m0, s55, 0x1b000
    s_mov_b32 s56, 0x195000
    buffer_load_dwordx4 v168, s[12:15], s56 offen lds
    s_lshl_b32 s55, s32, 10
    s_add_u32 m0, s55, 0x1c000
    s_mov_b32 s56, 0x1a4000
    buffer_load_dwordx4 v168, s[12:15], s56 offen lds
    s_lshl_b32 s55, s32, 10
    s_add_u32 m0, s55, 0x1d000
    s_mov_b32 s56, 0x1b3000
    buffer_load_dwordx4 v168, s[12:15], s56 offen lds
    s_lshl_b32 s55, s32, 10
    s_add_u32 m0, s55, 0x1e000
    s_mov_b32 s56, 0x1c2000
    buffer_load_dwordx4 v168, s[12:15], s56 offen lds
    s_lshl_b32 s55, s32, 10
    s_add_u32 m0, s55, 0x1f000
    s_mov_b32 s56, 0x1d1000
    buffer_load_dwordx4 v168, s[12:15], s56 offen lds
    s_lshl_b32 s55, s32, 10
    s_add_u32 m0, s55, 0x20000
    s_mov_b32 s56, 0x1e0000
    buffer_load_dwordx4 v168, s[12:15], s56 offen lds
    s_lshl_b32 s55, s32, 10
    s_add_u32 m0, s55, 0x21000
    s_mov_b32 s56, 0x1ef000
    buffer_load_dwordx4 v168, s[12:15], s56 offen lds
    s_lshl_b32 s55, s32, 10
    s_add_u32 m0, s55, 0x22000
    s_mov_b32 s56, 0x1fe000
    buffer_load_dwordx4 v168, s[12:15], s56 offen lds
    s_lshl_b32 s55, s32, 10
    s_add_u32 m0, s55, 0x23000
    s_mov_b32 s56, 0x20d000
    buffer_load_dwordx4 v168, s[12:15], s56 offen lds
    s_lshl_b32 s55, s32, 10
    s_add_u32 m0, s55, 0x24000
    s_mov_b32 s56, 0x21c000
    buffer_load_dwordx4 v168, s[12:15], s56 offen lds
    s_lshl_b32 s55, s32, 10
    s_add_u32 m0, s55, 0x25000
    s_mov_b32 s56, 0x22b000
    buffer_load_dwordx4 v168, s[12:15], s56 offen lds
    s_lshl_b32 s55, s32, 10
    s_add_u32 m0, s55, 0x26000
    s_mov_b32 s56, 0x23a000
    buffer_load_dwordx4 v168, s[12:15], s56 offen lds
    s_lshl_b32 s55, s32, 10
    s_add_u32 m0, s55, 0x27000
    s_mov_b32 s56, 0x249000
    buffer_load_dwordx4 v168, s[12:15], s56 offen lds
    s_waitcnt vmcnt(0)
    s_barrier
    v_add_u32 v172, 0x0, v169
    ds_read_b64_tr_b16 a[0:1], v172 offset:0
    ds_read_b64_tr_b16 a[2:3], v172 offset:1024
    ds_read_b64_tr_b16 a[4:5], v172 offset:8192
    ds_read_b64_tr_b16 a[6:7], v172 offset:9216
    ds_read_b64_tr_b16 a[8:9], v172 offset:16384
    ds_read_b64_tr_b16 a[10:11], v172 offset:17408
    ds_read_b64_tr_b16 a[12:13], v172 offset:24576
    ds_read_b64_tr_b16 a[14:15], v172 offset:25600
    ds_read_b64_tr_b16 a[16:17], v172 offset:32768
    ds_read_b64_tr_b16 a[18:19], v172 offset:33792
    s_waitcnt lgkmcnt(0)
    v_add_u32 v172, 0x0, v170
    ds_read_b64_tr_b16 a[80:81], v172 offset:0
    ds_read_b64_tr_b16 a[82:83], v172 offset:1024
    ds_read_b64_tr_b16 a[84:85], v172 offset:8192
    ds_read_b64_tr_b16 a[86:87], v172 offset:9216
    ds_read_b64_tr_b16 a[88:89], v172 offset:16384
    ds_read_b64_tr_b16 a[90:91], v172 offset:17408
    ds_read_b64_tr_b16 a[92:93], v172 offset:24576
    ds_read_b64_tr_b16 a[94:95], v172 offset:25600
    ds_read_b64_tr_b16 a[96:97], v172 offset:32768
    ds_read_b64_tr_b16 a[98:99], v172 offset:33792
    s_waitcnt lgkmcnt(0)
    v_add_u32 v172, 0x0, v171
    ds_read_b64_tr_b16 a[160:161], v172 offset:0
    ds_read_b64_tr_b16 a[162:163], v172 offset:1024
    ds_read_b64_tr_b16 a[164:165], v172 offset:8192
    ds_read_b64_tr_b16 a[166:167], v172 offset:9216
    ds_read_b64_tr_b16 a[168:169], v172 offset:16384
    ds_read_b64_tr_b16 a[170:171], v172 offset:17408
    ds_read_b64_tr_b16 a[172:173], v172 offset:24576
    ds_read_b64_tr_b16 a[174:175], v172 offset:25600
    ds_read_b64_tr_b16 a[176:177], v172 offset:32768
    ds_read_b64_tr_b16 a[178:179], v172 offset:33792
    s_waitcnt lgkmcnt(0)
    v_add_u32 v172, 0xa000, v169
    ds_read_b64_tr_b16 a[20:21], v172 offset:0
    ds_read_b64_tr_b16 a[22:23], v172 offset:1024
    ds_read_b64_tr_b16 a[24:25], v172 offset:8192
    ds_read_b64_tr_b16 a[26:27], v172 offset:9216
    ds_read_b64_tr_b16 a[28:29], v172 offset:16384
    ds_read_b64_tr_b16 a[30:31], v172 offset:17408
    ds_read_b64_tr_b16 a[32:33], v172 offset:24576
    ds_read_b64_tr_b16 a[34:35], v172 offset:25600
    ds_read_b64_tr_b16 a[36:37], v172 offset:32768
    ds_read_b64_tr_b16 a[38:39], v172 offset:33792
    s_waitcnt lgkmcnt(0)
    v_add_u32 v172, 0xa000, v170
    ds_read_b64_tr_b16 a[100:101], v172 offset:0
    ds_read_b64_tr_b16 a[102:103], v172 offset:1024
    ds_read_b64_tr_b16 a[104:105], v172 offset:8192
    ds_read_b64_tr_b16 a[106:107], v172 offset:9216
    ds_read_b64_tr_b16 a[108:109], v172 offset:16384
    ds_read_b64_tr_b16 a[110:111], v172 offset:17408
    ds_read_b64_tr_b16 a[112:113], v172 offset:24576
    ds_read_b64_tr_b16 a[114:115], v172 offset:25600
    ds_read_b64_tr_b16 a[116:117], v172 offset:32768
    ds_read_b64_tr_b16 a[118:119], v172 offset:33792
    s_waitcnt lgkmcnt(0)
    v_add_u32 v172, 0xa000, v171
    ds_read_b64_tr_b16 a[180:181], v172 offset:0
    ds_read_b64_tr_b16 a[182:183], v172 offset:1024
    ds_read_b64_tr_b16 a[184:185], v172 offset:8192
    ds_read_b64_tr_b16 a[186:187], v172 offset:9216
    ds_read_b64_tr_b16 a[188:189], v172 offset:16384
    ds_read_b64_tr_b16 a[190:191], v172 offset:17408
    ds_read_b64_tr_b16 a[192:193], v172 offset:24576
    ds_read_b64_tr_b16 a[194:195], v172 offset:25600
    ds_read_b64_tr_b16 a[196:197], v172 offset:32768
    ds_read_b64_tr_b16 a[198:199], v172 offset:33792
    s_waitcnt lgkmcnt(0)
    v_add_u32 v172, 0x14000, v169
    ds_read_b64_tr_b16 a[40:41], v172 offset:0
    ds_read_b64_tr_b16 a[42:43], v172 offset:1024
    ds_read_b64_tr_b16 a[44:45], v172 offset:8192
    ds_read_b64_tr_b16 a[46:47], v172 offset:9216
    ds_read_b64_tr_b16 a[48:49], v172 offset:16384
    ds_read_b64_tr_b16 a[50:51], v172 offset:17408
    ds_read_b64_tr_b16 a[52:53], v172 offset:24576
    ds_read_b64_tr_b16 a[54:55], v172 offset:25600
    ds_read_b64_tr_b16 a[56:57], v172 offset:32768
    ds_read_b64_tr_b16 a[58:59], v172 offset:33792
    s_waitcnt lgkmcnt(0)
    v_add_u32 v172, 0x14000, v170
    ds_read_b64_tr_b16 a[120:121], v172 offset:0
    ds_read_b64_tr_b16 a[122:123], v172 offset:1024
    ds_read_b64_tr_b16 a[124:125], v172 offset:8192
    ds_read_b64_tr_b16 a[126:127], v172 offset:9216
    ds_read_b64_tr_b16 a[128:129], v172 offset:16384
    ds_read_b64_tr_b16 a[130:131], v172 offset:17408
    ds_read_b64_tr_b16 a[132:133], v172 offset:24576
    ds_read_b64_tr_b16 a[134:135], v172 offset:25600
    ds_read_b64_tr_b16 a[136:137], v172 offset:32768
    ds_read_b64_tr_b16 a[138:139], v172 offset:33792
    s_waitcnt lgkmcnt(0)
    v_add_u32 v172, 0x14000, v171
    ds_read_b64_tr_b16 a[200:201], v172 offset:0
    ds_read_b64_tr_b16 a[202:203], v172 offset:1024
    ds_read_b64_tr_b16 a[204:205], v172 offset:8192
    ds_read_b64_tr_b16 a[206:207], v172 offset:9216
    ds_read_b64_tr_b16 a[208:209], v172 offset:16384
    ds_read_b64_tr_b16 a[210:211], v172 offset:17408
    ds_read_b64_tr_b16 a[212:213], v172 offset:24576
    ds_read_b64_tr_b16 a[214:215], v172 offset:25600
    ds_read_b64_tr_b16 a[216:217], v172 offset:32768
    ds_read_b64_tr_b16 a[218:219], v172 offset:33792
    s_waitcnt lgkmcnt(0)
    v_add_u32 v172, 0x1e000, v169
    ds_read_b64_tr_b16 a[60:61], v172 offset:0
    ds_read_b64_tr_b16 a[62:63], v172 offset:1024
    ds_read_b64_tr_b16 a[64:65], v172 offset:8192
    ds_read_b64_tr_b16 a[66:67], v172 offset:9216
    ds_read_b64_tr_b16 a[68:69], v172 offset:16384
    ds_read_b64_tr_b16 a[70:71], v172 offset:17408
    ds_read_b64_tr_b16 a[72:73], v172 offset:24576
    ds_read_b64_tr_b16 a[74:75], v172 offset:25600
    ds_read_b64_tr_b16 a[76:77], v172 offset:32768
    ds_read_b64_tr_b16 a[78:79], v172 offset:33792
    s_waitcnt lgkmcnt(0)
    v_add_u32 v172, 0x1e000, v170
    ds_read_b64_tr_b16 a[140:141], v172 offset:0
    ds_read_b64_tr_b16 a[142:143], v172 offset:1024
    ds_read_b64_tr_b16 a[144:145], v172 offset:8192
    ds_read_b64_tr_b16 a[146:147], v172 offset:9216
    ds_read_b64_tr_b16 a[148:149], v172 offset:16384
    ds_read_b64_tr_b16 a[150:151], v172 offset:17408
    ds_read_b64_tr_b16 a[152:153], v172 offset:24576
    ds_read_b64_tr_b16 a[154:155], v172 offset:25600
    ds_read_b64_tr_b16 a[156:157], v172 offset:32768
    ds_read_b64_tr_b16 a[158:159], v172 offset:33792
    s_waitcnt lgkmcnt(0)
    v_add_u32 v172, 0x1e000, v171
    ds_read_b64_tr_b16 a[220:221], v172 offset:0
    ds_read_b64_tr_b16 a[222:223], v172 offset:1024
    ds_read_b64_tr_b16 a[224:225], v172 offset:8192
    ds_read_b64_tr_b16 a[226:227], v172 offset:9216
    ds_read_b64_tr_b16 a[228:229], v172 offset:16384
    ds_read_b64_tr_b16 a[230:231], v172 offset:17408
    ds_read_b64_tr_b16 a[232:233], v172 offset:24576
    ds_read_b64_tr_b16 a[234:235], v172 offset:25600
    ds_read_b64_tr_b16 a[236:237], v172 offset:32768
    ds_read_b64_tr_b16 a[238:239], v172 offset:33792
    s_waitcnt lgkmcnt(0)
    s_barrier
    v_mul_u32_u24 v7, 1280, v2
    v_lshl_add_u32 v7, v3, 4, v7
    s_lshr_b32 s54, s32, 1
    s_mul_i32 s54, s54, 20480
    s_and_b32 s55, s32, 1
    s_mul_i32 s55, s55, 640
    s_add_u32 s54, s54, s55
    v_add_u32 v7, s54, v7
    s_lshl_b32 s54, s30, 1
    s_lshr_b32 s55, s32, 1
    s_add_u32 s54, s54, s55
    s_lshl_b32 s56, s54, 17
    s_and_b32 s55, s32, 1
    s_mul_i32 s55, s55, 4194304
    s_add_u32 s55, s55, s56
    s_add_u32 s55, s55, 0x9100000
    v_lshl_add_u32 v8, v2, 6, s55
    v_lshl_add_u32 v8, v3, 4, v8
    s_and_b32 s55, s32, 1
    s_lshl_b32 s55, s55, 16
    s_add_u32 s55, s55, s56
    s_add_u32 s55, s55, 0x9900000
    v_lshl_add_u32 v9, v2, 12, s55
    v_and_b32 v172, 1, v3
    v_lshl_add_u32 v9, v172, 4, v9
    v_lshrrev_b32 v172, 1, v3
    v_lshl_add_u32 v9, v172, 3, v9
    v_cmp_eq_u32 s[44:45], 0, v3
    v_cmp_eq_u32 s[46:47], 4, v2
    s_bitcmp1_b32 s32, 0
    s_cbranch_scc1 AQm_135
    s_mov_b64 s[46:47], 0
AQm_135:
    v_mov_b32 v10, 0
    v_mov_b32 v11, 0x3f803f80
    s_mov_b32 s36, 0x0
    s_mul_i32 s54, s33, 40960
    s_mul_i32 s55, s32, 10240
    s_add_u32 s55, s55, s36
    s_add_u32 m0, s55, 0
    s_add_u32 s56, s54, 0
    buffer_load_dwordx4 v7, s[24:27], s56 offen lds
    s_add_u32 m0, s55, 1024
    s_add_u32 s56, s54, 64
    buffer_load_dwordx4 v7, s[24:27], s56 offen lds
    s_add_u32 m0, s55, 2048
    s_add_u32 s56, s54, 128
    buffer_load_dwordx4 v7, s[24:27], s56 offen lds
    s_add_u32 m0, s55, 3072
    s_add_u32 s56, s54, 192
    buffer_load_dwordx4 v7, s[24:27], s56 offen lds
    s_add_u32 m0, s55, 4096
    s_add_u32 s56, s54, 256
    buffer_load_dwordx4 v7, s[24:27], s56 offen lds
    s_add_u32 m0, s55, 5120
    s_add_u32 s56, s54, 320
    buffer_load_dwordx4 v7, s[24:27], s56 offen lds
    s_add_u32 m0, s55, 6144
    s_add_u32 s56, s54, 384
    buffer_load_dwordx4 v7, s[24:27], s56 offen lds
    s_add_u32 m0, s55, 7168
    s_add_u32 s56, s54, 448
    buffer_load_dwordx4 v7, s[24:27], s56 offen lds
    s_add_u32 m0, s55, 8192
    s_add_u32 s56, s54, 512
    buffer_load_dwordx4 v7, s[24:27], s56 offen lds
    s_add_u32 m0, s55, 9216
    s_add_u32 s56, s54, 576
    buffer_load_dwordx4 v7, s[24:27], s56 offen lds
    s_waitcnt vmcnt(0)
AQ_loop:
    s_barrier
    s_add_u32 s37, s33, 1
    s_xor_b32 s38, s36, 40960
    s_cmp_ge_u32 s37, s34
    s_cbranch_scc1 AQ_nopf
    s_mul_i32 s54, s37, 40960
    s_mul_i32 s55, s32, 10240
    s_add_u32 s55, s55, s38
    s_add_u32 m0, s55, 0
    s_add_u32 s56, s54, 0
    buffer_load_dwordx4 v7, s[24:27], s56 offen lds
    s_add_u32 m0, s55, 1024
    s_add_u32 s56, s54, 64
    buffer_load_dwordx4 v7, s[24:27], s56 offen lds
    s_add_u32 m0, s55, 2048
    s_add_u32 s56, s54, 128
    buffer_load_dwordx4 v7, s[24:27], s56 offen lds
    s_add_u32 m0, s55, 3072
    s_add_u32 s56, s54, 192
    buffer_load_dwordx4 v7, s[24:27], s56 offen lds
    s_add_u32 m0, s55, 4096
    s_add_u32 s56, s54, 256
    buffer_load_dwordx4 v7, s[24:27], s56 offen lds
    s_add_u32 m0, s55, 5120
    s_add_u32 s56, s54, 320
    buffer_load_dwordx4 v7, s[24:27], s56 offen lds
    s_add_u32 m0, s55, 6144
    s_add_u32 s56, s54, 384
    buffer_load_dwordx4 v7, s[24:27], s56 offen lds
    s_add_u32 m0, s55, 7168
    s_add_u32 s56, s54, 448
    buffer_load_dwordx4 v7, s[24:27], s56 offen lds
    s_add_u32 m0, s55, 8192
    s_add_u32 s56, s54, 512
    buffer_load_dwordx4 v7, s[24:27], s56 offen lds
    s_add_u32 m0, s55, 9216
    s_add_u32 s56, s54, 576
    buffer_load_dwordx4 v7, s[24:27], s56 offen lds
AQ_nopf:
    v_add_u32 v168, s36, v6
    ds_read_b128 v[32:35], v168 offset:0
    ds_read_b128 v[36:39], v168 offset:20480
    ds_read_b128 v[40:43], v168 offset:1024
    ds_read_b128 v[44:47], v168 offset:21504
    ds_read_b128 v[48:51], v168 offset:2048
    ds_read_b128 v[52:55], v168 offset:22528
    ds_read_b128 v[56:59], v168 offset:3072
    ds_read_b128 v[60:63], v168 offset:23552
    s_waitcnt lgkmcnt(7)
    v_mfma_f32_16x16x32_bf16 v[64:67], a[0:3], v[32:35], 0
    v_mfma_f32_16x16x32_bf16 v[68:71], a[80:83], v[32:35], 0
    v_mfma_f32_16x16x32_bf16 v[72:75], v[32:35], a[160:163], 0
    ds_read_b128 v[32:35], v168 offset:4096
    s_waitcnt lgkmcnt(7)
    v_mfma_f32_16x16x32_bf16 v[76:79], a[0:3], v[36:39], 0
    v_mfma_f32_16x16x32_bf16 v[80:83], a[80:83], v[36:39], 0
    v_mfma_f32_16x16x32_bf16 v[84:87], v[36:39], a[160:163], 0
    ds_read_b128 v[36:39], v168 offset:24576
    s_waitcnt lgkmcnt(7)
    v_mfma_f32_16x16x32_bf16 v[64:67], a[4:7], v[40:43], v[64:67]
    v_mfma_f32_16x16x32_bf16 v[68:71], a[84:87], v[40:43], v[68:71]
    v_mfma_f32_16x16x32_bf16 v[72:75], v[40:43], a[164:167], v[72:75]
    ds_read_b128 v[40:43], v168 offset:5120
    s_waitcnt lgkmcnt(7)
    v_mfma_f32_16x16x32_bf16 v[76:79], a[4:7], v[44:47], v[76:79]
    v_mfma_f32_16x16x32_bf16 v[80:83], a[84:87], v[44:47], v[80:83]
    v_mfma_f32_16x16x32_bf16 v[84:87], v[44:47], a[164:167], v[84:87]
    ds_read_b128 v[44:47], v168 offset:25600
    s_waitcnt lgkmcnt(7)
    v_mfma_f32_16x16x32_bf16 v[64:67], a[8:11], v[48:51], v[64:67]
    v_mfma_f32_16x16x32_bf16 v[68:71], a[88:91], v[48:51], v[68:71]
    v_mfma_f32_16x16x32_bf16 v[72:75], v[48:51], a[168:171], v[72:75]
    ds_read_b128 v[48:51], v168 offset:6144
    s_waitcnt lgkmcnt(7)
    v_mfma_f32_16x16x32_bf16 v[76:79], a[8:11], v[52:55], v[76:79]
    v_mfma_f32_16x16x32_bf16 v[80:83], a[88:91], v[52:55], v[80:83]
    v_mfma_f32_16x16x32_bf16 v[84:87], v[52:55], a[168:171], v[84:87]
    ds_read_b128 v[52:55], v168 offset:26624
    s_waitcnt lgkmcnt(7)
    v_mfma_f32_16x16x32_bf16 v[64:67], a[12:15], v[56:59], v[64:67]
    v_mfma_f32_16x16x32_bf16 v[68:71], a[92:95], v[56:59], v[68:71]
    v_mfma_f32_16x16x32_bf16 v[72:75], v[56:59], a[172:175], v[72:75]
    ds_read_b128 v[56:59], v168 offset:7168
    s_waitcnt lgkmcnt(7)
    v_mfma_f32_16x16x32_bf16 v[76:79], a[12:15], v[60:63], v[76:79]
    v_mfma_f32_16x16x32_bf16 v[80:83], a[92:95], v[60:63], v[80:83]
    v_mfma_f32_16x16x32_bf16 v[84:87], v[60:63], a[172:175], v[84:87]
    ds_read_b128 v[60:63], v168 offset:27648
    s_waitcnt lgkmcnt(7)
    v_mfma_f32_16x16x32_bf16 v[64:67], a[16:19], v[32:35], v[64:67]
    v_mfma_f32_16x16x32_bf16 v[68:71], a[96:99], v[32:35], v[68:71]
    v_mfma_f32_16x16x32_bf16 v[72:75], v[32:35], a[176:179], v[72:75]
    ds_read_b128 v[32:35], v168 offset:8192
    s_waitcnt lgkmcnt(7)
    v_mfma_f32_16x16x32_bf16 v[76:79], a[16:19], v[36:39], v[76:79]
    v_mfma_f32_16x16x32_bf16 v[80:83], a[96:99], v[36:39], v[80:83]
    v_mfma_f32_16x16x32_bf16 v[84:87], v[36:39], a[176:179], v[84:87]
    ds_read_b128 v[36:39], v168 offset:28672
    s_waitcnt lgkmcnt(7)
    v_mfma_f32_16x16x32_bf16 v[64:67], a[20:23], v[40:43], v[64:67]
    v_mfma_f32_16x16x32_bf16 v[68:71], a[100:103], v[40:43], v[68:71]
    v_mfma_f32_16x16x32_bf16 v[72:75], v[40:43], a[180:183], v[72:75]
    ds_read_b128 v[40:43], v168 offset:9216
    s_waitcnt lgkmcnt(7)
    v_mfma_f32_16x16x32_bf16 v[76:79], a[20:23], v[44:47], v[76:79]
    v_mfma_f32_16x16x32_bf16 v[80:83], a[100:103], v[44:47], v[80:83]
    v_mfma_f32_16x16x32_bf16 v[84:87], v[44:47], a[180:183], v[84:87]
    ds_read_b128 v[44:47], v168 offset:29696
    s_waitcnt lgkmcnt(7)
    v_mfma_f32_16x16x32_bf16 v[64:67], a[24:27], v[48:51], v[64:67]
    v_mfma_f32_16x16x32_bf16 v[68:71], a[104:107], v[48:51], v[68:71]
    v_mfma_f32_16x16x32_bf16 v[72:75], v[48:51], a[184:187], v[72:75]
    ds_read_b128 v[48:51], v168 offset:10240
    s_waitcnt lgkmcnt(7)
    v_mfma_f32_16x16x32_bf16 v[76:79], a[24:27], v[52:55], v[76:79]
    v_mfma_f32_16x16x32_bf16 v[80:83], a[104:107], v[52:55], v[80:83]
    v_mfma_f32_16x16x32_bf16 v[84:87], v[52:55], a[184:187], v[84:87]
    ds_read_b128 v[52:55], v168 offset:30720
    s_waitcnt lgkmcnt(7)
    v_mfma_f32_16x16x32_bf16 v[64:67], a[28:31], v[56:59], v[64:67]
    v_mfma_f32_16x16x32_bf16 v[68:71], a[108:111], v[56:59], v[68:71]
    v_mfma_f32_16x16x32_bf16 v[72:75], v[56:59], a[188:191], v[72:75]
    ds_read_b128 v[56:59], v168 offset:11264
    s_waitcnt lgkmcnt(7)
    v_mfma_f32_16x16x32_bf16 v[76:79], a[28:31], v[60:63], v[76:79]
    v_mfma_f32_16x16x32_bf16 v[80:83], a[108:111], v[60:63], v[80:83]
    v_mfma_f32_16x16x32_bf16 v[84:87], v[60:63], a[188:191], v[84:87]
    ds_read_b128 v[60:63], v168 offset:31744
    s_waitcnt lgkmcnt(7)
    v_mfma_f32_16x16x32_bf16 v[64:67], a[32:35], v[32:35], v[64:67]
    v_mfma_f32_16x16x32_bf16 v[68:71], a[112:115], v[32:35], v[68:71]
    v_mfma_f32_16x16x32_bf16 v[72:75], v[32:35], a[192:195], v[72:75]
    ds_read_b128 v[32:35], v168 offset:12288
    s_waitcnt lgkmcnt(7)
    v_mfma_f32_16x16x32_bf16 v[76:79], a[32:35], v[36:39], v[76:79]
    v_mfma_f32_16x16x32_bf16 v[80:83], a[112:115], v[36:39], v[80:83]
    v_mfma_f32_16x16x32_bf16 v[84:87], v[36:39], a[192:195], v[84:87]
    ds_read_b128 v[36:39], v168 offset:32768
    s_waitcnt lgkmcnt(7)
    v_mfma_f32_16x16x32_bf16 v[64:67], a[36:39], v[40:43], v[64:67]
    v_mfma_f32_16x16x32_bf16 v[68:71], a[116:119], v[40:43], v[68:71]
    v_mfma_f32_16x16x32_bf16 v[72:75], v[40:43], a[196:199], v[72:75]
    ds_read_b128 v[40:43], v168 offset:13312
    s_waitcnt lgkmcnt(7)
    v_mfma_f32_16x16x32_bf16 v[76:79], a[36:39], v[44:47], v[76:79]
    v_mfma_f32_16x16x32_bf16 v[80:83], a[116:119], v[44:47], v[80:83]
    v_mfma_f32_16x16x32_bf16 v[84:87], v[44:47], a[196:199], v[84:87]
    ds_read_b128 v[44:47], v168 offset:33792
    s_waitcnt lgkmcnt(7)
    v_mfma_f32_16x16x32_bf16 v[64:67], a[40:43], v[48:51], v[64:67]
    v_mfma_f32_16x16x32_bf16 v[68:71], a[120:123], v[48:51], v[68:71]
    v_mfma_f32_16x16x32_bf16 v[72:75], v[48:51], a[200:203], v[72:75]
    ds_read_b128 v[48:51], v168 offset:14336
    s_waitcnt lgkmcnt(7)
    v_mfma_f32_16x16x32_bf16 v[76:79], a[40:43], v[52:55], v[76:79]
    v_mfma_f32_16x16x32_bf16 v[80:83], a[120:123], v[52:55], v[80:83]
    v_mfma_f32_16x16x32_bf16 v[84:87], v[52:55], a[200:203], v[84:87]
    ds_read_b128 v[52:55], v168 offset:34816
    s_waitcnt lgkmcnt(7)
    v_mfma_f32_16x16x32_bf16 v[64:67], a[44:47], v[56:59], v[64:67]
    v_mfma_f32_16x16x32_bf16 v[68:71], a[124:127], v[56:59], v[68:71]
    v_mfma_f32_16x16x32_bf16 v[72:75], v[56:59], a[204:207], v[72:75]
    ds_read_b128 v[56:59], v168 offset:15360
    s_waitcnt lgkmcnt(7)
    v_mfma_f32_16x16x32_bf16 v[76:79], a[44:47], v[60:63], v[76:79]
    v_mfma_f32_16x16x32_bf16 v[80:83], a[124:127], v[60:63], v[80:83]
    v_mfma_f32_16x16x32_bf16 v[84:87], v[60:63], a[204:207], v[84:87]
    ds_read_b128 v[60:63], v168 offset:35840
    s_waitcnt lgkmcnt(7)
    v_mfma_f32_16x16x32_bf16 v[64:67], a[48:51], v[32:35], v[64:67]
    v_mfma_f32_16x16x32_bf16 v[68:71], a[128:131], v[32:35], v[68:71]
    v_mfma_f32_16x16x32_bf16 v[72:75], v[32:35], a[208:211], v[72:75]
    ds_read_b128 v[32:35], v168 offset:16384
    s_waitcnt lgkmcnt(7)
    v_mfma_f32_16x16x32_bf16 v[76:79], a[48:51], v[36:39], v[76:79]
    v_mfma_f32_16x16x32_bf16 v[80:83], a[128:131], v[36:39], v[80:83]
    v_mfma_f32_16x16x32_bf16 v[84:87], v[36:39], a[208:211], v[84:87]
    ds_read_b128 v[36:39], v168 offset:36864
    s_waitcnt lgkmcnt(7)
    v_mfma_f32_16x16x32_bf16 v[64:67], a[52:55], v[40:43], v[64:67]
    v_mfma_f32_16x16x32_bf16 v[68:71], a[132:135], v[40:43], v[68:71]
    v_mfma_f32_16x16x32_bf16 v[72:75], v[40:43], a[212:215], v[72:75]
    ds_read_b128 v[40:43], v168 offset:17408
    s_waitcnt lgkmcnt(7)
    v_mfma_f32_16x16x32_bf16 v[76:79], a[52:55], v[44:47], v[76:79]
    v_mfma_f32_16x16x32_bf16 v[80:83], a[132:135], v[44:47], v[80:83]
    v_mfma_f32_16x16x32_bf16 v[84:87], v[44:47], a[212:215], v[84:87]
    ds_read_b128 v[44:47], v168 offset:37888
    s_waitcnt lgkmcnt(7)
    v_mfma_f32_16x16x32_bf16 v[64:67], a[56:59], v[48:51], v[64:67]
    v_mfma_f32_16x16x32_bf16 v[68:71], a[136:139], v[48:51], v[68:71]
    v_mfma_f32_16x16x32_bf16 v[72:75], v[48:51], a[216:219], v[72:75]
    ds_read_b128 v[48:51], v168 offset:18432
    s_waitcnt lgkmcnt(7)
    v_mfma_f32_16x16x32_bf16 v[76:79], a[56:59], v[52:55], v[76:79]
    v_mfma_f32_16x16x32_bf16 v[80:83], a[136:139], v[52:55], v[80:83]
    v_mfma_f32_16x16x32_bf16 v[84:87], v[52:55], a[216:219], v[84:87]
    ds_read_b128 v[52:55], v168 offset:38912
    s_waitcnt lgkmcnt(7)
    v_mfma_f32_16x16x32_bf16 v[64:67], a[60:63], v[56:59], v[64:67]
    v_mfma_f32_16x16x32_bf16 v[68:71], a[140:143], v[56:59], v[68:71]
    v_mfma_f32_16x16x32_bf16 v[72:75], v[56:59], a[220:223], v[72:75]
    ds_read_b128 v[56:59], v168 offset:19456
    s_waitcnt lgkmcnt(7)
    v_mfma_f32_16x16x32_bf16 v[76:79], a[60:63], v[60:63], v[76:79]
    v_mfma_f32_16x16x32_bf16 v[80:83], a[140:143], v[60:63], v[80:83]
    v_mfma_f32_16x16x32_bf16 v[84:87], v[60:63], a[220:223], v[84:87]
    ds_read_b128 v[60:63], v168 offset:39936
    s_waitcnt lgkmcnt(7)
    v_mfma_f32_16x16x32_bf16 v[64:67], a[64:67], v[32:35], v[64:67]
    v_mfma_f32_16x16x32_bf16 v[68:71], a[144:147], v[32:35], v[68:71]
    v_mfma_f32_16x16x32_bf16 v[72:75], v[32:35], a[224:227], v[72:75]
    s_waitcnt lgkmcnt(6)
    v_mfma_f32_16x16x32_bf16 v[76:79], a[64:67], v[36:39], v[76:79]
    v_mfma_f32_16x16x32_bf16 v[80:83], a[144:147], v[36:39], v[80:83]
    v_mfma_f32_16x16x32_bf16 v[84:87], v[36:39], a[224:227], v[84:87]
    s_waitcnt lgkmcnt(5)
    v_mfma_f32_16x16x32_bf16 v[64:67], a[68:71], v[40:43], v[64:67]
    v_mfma_f32_16x16x32_bf16 v[68:71], a[148:151], v[40:43], v[68:71]
    v_mfma_f32_16x16x32_bf16 v[72:75], v[40:43], a[228:231], v[72:75]
    s_waitcnt lgkmcnt(4)
    v_mfma_f32_16x16x32_bf16 v[76:79], a[68:71], v[44:47], v[76:79]
    v_mfma_f32_16x16x32_bf16 v[80:83], a[148:151], v[44:47], v[80:83]
    v_mfma_f32_16x16x32_bf16 v[84:87], v[44:47], a[228:231], v[84:87]
    s_waitcnt lgkmcnt(3)
    v_mfma_f32_16x16x32_bf16 v[64:67], a[72:75], v[48:51], v[64:67]
    v_mfma_f32_16x16x32_bf16 v[68:71], a[152:155], v[48:51], v[68:71]
    v_mfma_f32_16x16x32_bf16 v[72:75], v[48:51], a[232:235], v[72:75]
    s_waitcnt lgkmcnt(2)
    v_mfma_f32_16x16x32_bf16 v[76:79], a[72:75], v[52:55], v[76:79]
    v_mfma_f32_16x16x32_bf16 v[80:83], a[152:155], v[52:55], v[80:83]
    v_mfma_f32_16x16x32_bf16 v[84:87], v[52:55], a[232:235], v[84:87]
    s_waitcnt lgkmcnt(1)
    v_mfma_f32_16x16x32_bf16 v[64:67], a[76:79], v[56:59], v[64:67]
    v_mfma_f32_16x16x32_bf16 v[68:71], a[156:159], v[56:59], v[68:71]
    v_mfma_f32_16x16x32_bf16 v[72:75], v[56:59], a[236:239], v[72:75]
    s_waitcnt lgkmcnt(0)
    v_mfma_f32_16x16x32_bf16 v[76:79], a[76:79], v[60:63], v[76:79]
    v_mfma_f32_16x16x32_bf16 v[80:83], a[156:159], v[60:63], v[80:83]
    v_mfma_f32_16x16x32_bf16 v[84:87], v[60:63], a[236:239], v[84:87]
    s_nop 7
    s_lshl_b32 s54, s33, 11
    s_lshl_b32 s55, s33, 6
    v_cvt_pk_bf16_f32 v32, v64, v65
    v_cvt_pk_bf16_f32 v33, v66, v67
    v_cvt_pk_bf16_f32 v34, v68, v69
    v_cvt_pk_bf16_f32 v35, v70, v71
    v_cndmask_b32 v34, v10, v34, s[44:45]
    v_cndmask_b32 v35, v10, v35, s[44:45]
    buffer_store_dwordx4 v[32:35], v8, s[8:11], s54 offen offset:0 sc1
    v_cvt_pk_bf16_f32 v36, v72, v73
    v_cvt_pk_bf16_f32 v37, v74, v75
    v_cndmask_b32 v36, v36, v11, s[46:47]
    v_cndmask_b32 v37, v37, v11, s[46:47]
    buffer_store_dwordx2 v[36:37], v9, s[8:11], s55 offen offset:0 sc1
    v_cvt_pk_bf16_f32 v40, v76, v77
    v_cvt_pk_bf16_f32 v41, v78, v79
    v_cvt_pk_bf16_f32 v42, v80, v81
    v_cvt_pk_bf16_f32 v43, v82, v83
    v_cndmask_b32 v42, v10, v42, s[44:45]
    v_cndmask_b32 v43, v10, v43, s[44:45]
    buffer_store_dwordx4 v[40:43], v8, s[8:11], s54 offen offset:1024 sc1
    v_cvt_pk_bf16_f32 v44, v84, v85
    v_cvt_pk_bf16_f32 v45, v86, v87
    v_cndmask_b32 v44, v44, v11, s[46:47]
    v_cndmask_b32 v45, v45, v11, s[46:47]
    buffer_store_dwordx2 v[44:45], v9, s[8:11], s55 offen offset:32 sc1
    s_waitcnt vmcnt(4)
    s_mov_b32 s33, s37
    s_mov_b32 s36, s38
    s_cmp_lt_u32 s33, s34
    s_cbranch_scc1 AQ_loop
    s_waitcnt vmcnt(0)
    s_mov_b32 s55, 0x2c
    s_waitcnt vmcnt(0)
    s_barrier
    s_cmp_eq_u32 s32, 0
    s_cbranch_scc0 AQsg_136
    v_mov_b32 v4, 1
    v_mov_b32 v5, 0
    s_mov_b64 exec, 1
    buffer_atomic_add v4, v5, s[20:23], s55 offen sc1
    s_mov_b64 exec, -1
AQsg_136:
f_queue:
    s_cmp_eq_u32 s32, 0
    s_cbranch_scc0 Qtk_137
    s_mov_b32 s54, 0x28
    v_mov_b32 v4, 1
    v_mov_b32 v5, s54
    v_mov_b32 v6, 0
    s_mov_b64 exec, 1
    buffer_atomic_add v4, v5, s[20:23], 0 offen sc0
    s_waitcnt vmcnt(0)
    ds_write_b32 v6, v4
    s_waitcnt lgkmcnt(0)
    s_mov_b64 exec, -1
Qtk_137:
    s_barrier
    v_mov_b32 v6, 0
    ds_read_b32 v4, v6
    s_waitcnt lgkmcnt(0)
    v_readfirstlane_b32 s40, v4
    s_barrier
    s_cmp_ge_u32 s40, 256
    s_cbranch_scc1 f_fin
    s_mov_b32 s55, 0x2c
    s_cmp_eq_u32 s32, 0
    s_cbranch_scc0 AWww_138
    s_mov_b32 s54, 0x40
    v_min_u32 v4, 0, v1
    v_mul_u32_u24 v4, 4, v4
    s_mov_b32 s43, 0x40000
AWwl_139:
    buffer_load_dword v5, v4, s[20:23], s55 offen sc1
    s_waitcnt vmcnt(0)
    v_cmp_gt_u32 vcc, 128, v5
    s_nop 1
    v_cndmask_b32 v5, 0, v5, vcc
    v_cmp_gt_u32 vcc, s54, v5
    s_cbranch_vccz AWwd_140
    s_sleep 4
    s_sub_u32 s43, s43, 1
    s_cbranch_scc0 AWwl_139
AWwd_140:
AWww_138:
    s_barrier
    s_lshr_b32 s30, s40, 3
    s_and_b32 s31, s40, 7
    v_and_b32 v12, 31, v1
    v_lshrrev_b32 v13, 5, v1
    v_lshlrev_b32 v4, 6, v12
    v_lshl_add_u32 v4, v13, 4, v4
    v_lshlrev_b32 v5, 12, v12
    v_lshl_add_u32 v5, v13, 4, v5
    v_lshlrev_b32 v7, 4, v1
    s_lshl_b32 s54, s30, 17
    s_add_u32 s34, s54, 0x9500000
    s_add_u32 s35, s54, 0x9900000
    s_lshl_b32 s55, s31, 8
    s_lshl_b32 s56, s32, 6
    s_add_u32 s55, s55, s56
    s_lshl_b32 s56, s55, 6
    s_add_u32 s56, s56, s54
    s_add_u32 s56, s56, 0x9100000
    buffer_load_dwordx4 v[20:23], v4, s[8:11], s56 offen offset:0 sc1
    buffer_load_dwordx4 v[24:27], v4, s[8:11], s56 offen offset:32 sc1
    buffer_load_dwordx4 v[28:31], v4, s[8:11], s56 offen offset:2048 sc1
    buffer_load_dwordx4 v[32:35], v4, s[8:11], s56 offen offset:2080 sc1
    v_add_u32 v6, s55, v12
    v_mul_u32_u24 v6, 1280, v6
    s_mul_i32 s55, s30, 40
    s_add_u32 s55, s55, 0x9d00000
    v_add_u32 v6, s55, v6
    v_lshl_add_u32 v6, v13, 3, v6
    s_mov_b32 s58, 0x3ea52b5c
    s_mov_b32 s59, 0x3ea52b5c
    v_mov_b32 v8, 0xf149f2ca
    v_mov_b32 v9, 0xf149f2ca
    v_mov_b32 v160, 0
    v_mov_b32 v161, 0
    v_mov_b32 v162, 0
    v_mov_b32 v163, 0
    v_mov_b32 v164, 0
    v_mov_b32 v165, 0
    v_mov_b32 v166, 0
    v_mov_b32 v167, 0
    v_mov_b32 v168, 0
    v_mov_b32 v169, 0
    v_mov_b32 v170, 0
    v_mov_b32 v171, 0
    v_mov_b32 v172, 0
    v_mov_b32 v173, 0
    v_mov_b32 v174, 0
    v_mov_b32 v175, 0
    v_mov_b32 v10, 0xf149f2ca
    v_mov_b32 v11, 0xf149f2ca
    v_mov_b32 v176, 0
    v_mov_b32 v177, 0
    v_mov_b32 v178, 0
    v_mov_b32 v179, 0
    v_mov_b32 v180, 0
    v_mov_b32 v181, 0
    v_mov_b32 v182, 0
    v_mov_b32 v183, 0
    v_mov_b32 v184, 0
    v_mov_b32 v185, 0
    v_mov_b32 v186, 0
    v_mov_b32 v187, 0
    v_mov_b32 v188, 0
    v_mov_b32 v189, 0
    v_mov_b32 v190, 0
    v_mov_b32 v191, 0
    v_mov_b32 v17, 0x41000000
    s_mov_b32 s36, 0x0
    s_lshl_b32 s54, s32, 14
    s_add_u32 s54, s54, s36
    s_lshl_b32 s55, s32, 13
    s_add_u32 s55, s55, s34
    s_lshl_b32 s56, s32, 8
    s_add_u32 s56, s56, s35
    s_add_u32 m0, s54, 0
    s_add_u32 s57, s55, 0
    buffer_load_dwordx4 v4, s[8:11], s57 offen sc1 lds
    s_add_u32 m0, s54, 1024
    s_add_u32 s57, s55, 32
    buffer_load_dwordx4 v4, s[8:11], s57 offen sc1 lds
    s_add_u32 m0, s54, 2048
    s_add_u32 s57, s56, 0
    buffer_load_dwordx4 v5, s[8:11], s57 offen sc1 lds
    s_add_u32 m0, s54, 3072
    s_add_u32 s57, s56, 32
    buffer_load_dwordx4 v5, s[8:11], s57 offen sc1 lds
    s_add_u32 m0, s54, 4096
    s_add_u32 s57, s55, 2048
    buffer_load_dwordx4 v4, s[8:11], s57 offen sc1 lds
    s_add_u32 m0, s54, 5120
    s_add_u32 s57, s55, 2080
    buffer_load_dwordx4 v4, s[8:11], s57 offen sc1 lds
    s_add_u32 m0, s54, 6144
    s_add_u32 s57, s56, 64
    buffer_load_dwordx4 v5, s[8:11], s57 offen sc1 lds
    s_add_u32 m0, s54, 7168
    s_add_u32 s57, s56, 96
    buffer_load_dwordx4 v5, s[8:11], s57 offen sc1 lds
    s_add_u32 m0, s54, 8192
    s_add_u32 s57, s55, 4096
    buffer_load_dwordx4 v4, s[8:11], s57 offen sc1 lds
    s_add_u32 m0, s54, 9216
    s_add_u32 s57, s55, 4128
    buffer_load_dwordx4 v4, s[8:11], s57 offen sc1 lds
    s_add_u32 m0, s54, 10240
    s_add_u32 s57, s56, 128
    buffer_load_dwordx4 v5, s[8:11], s57 offen sc1 lds
    s_add_u32 m0, s54, 11264
    s_add_u32 s57, s56, 160
    buffer_load_dwordx4 v5, s[8:11], s57 offen sc1 lds
    s_add_u32 m0, s54, 12288
    s_add_u32 s57, s55, 6144
    buffer_load_dwordx4 v4, s[8:11], s57 offen sc1 lds
    s_add_u32 m0, s54, 13312
    s_add_u32 s57, s55, 6176
    buffer_load_dwordx4 v4, s[8:11], s57 offen sc1 lds
    s_add_u32 m0, s54, 14336
    s_add_u32 s57, s56, 192
    buffer_load_dwordx4 v5, s[8:11], s57 offen sc1 lds
    s_add_u32 m0, s54, 15360
    s_add_u32 s57, s56, 224
    buffer_load_dwordx4 v5, s[8:11], s57 offen sc1 lds
    s_mov_b32 s33, 0x0
AT_chunk:
    s_waitcnt vmcnt(0)
    s_barrier
    s_add_u32 s34, s34, 32768
    s_add_u32 s35, s35, 1024
    s_xor_b32 s37, s36, 65536
    s_cmp_ge_u32 s33, 3
    s_cbranch_scc1 AT_nopf
    s_lshl_b32 s54, s32, 14
    s_add_u32 s54, s54, s37
    s_lshl_b32 s55, s32, 13
    s_add_u32 s55, s55, s34
    s_lshl_b32 s56, s32, 8
    s_add_u32 s56, s56, s35
    s_add_u32 m0, s54, 0
    s_add_u32 s57, s55, 0
    buffer_load_dwordx4 v4, s[8:11], s57 offen sc1 lds
    s_add_u32 m0, s54, 1024
    s_add_u32 s57, s55, 32
    buffer_load_dwordx4 v4, s[8:11], s57 offen sc1 lds
    s_add_u32 m0, s54, 2048
    s_add_u32 s57, s56, 0
    buffer_load_dwordx4 v5, s[8:11], s57 offen sc1 lds
    s_add_u32 m0, s54, 3072
    s_add_u32 s57, s56, 32
    buffer_load_dwordx4 v5, s[8:11], s57 offen sc1 lds
    s_add_u32 m0, s54, 4096
    s_add_u32 s57, s55, 2048
    buffer_load_dwordx4 v4, s[8:11], s57 offen sc1 lds
    s_add_u32 m0, s54, 5120
    s_add_u32 s57, s55, 2080
    buffer_load_dwordx4 v4, s[8:11], s57 offen sc1 lds
    s_add_u32 m0, s54, 6144
    s_add_u32 s57, s56, 64
    buffer_load_dwordx4 v5, s[8:11], s57 offen sc1 lds
    s_add_u32 m0, s54, 7168
    s_add_u32 s57, s56, 96
    buffer_load_dwordx4 v5, s[8:11], s57 offen sc1 lds
    s_add_u32 m0, s54, 8192
    s_add_u32 s57, s55, 4096
    buffer_load_dwordx4 v4, s[8:11], s57 offen sc1 lds
    s_add_u32 m0, s54, 9216
    s_add_u32 s57, s55, 4128
    buffer_load_dwordx4 v4, s[8:11], s57 offen sc1 lds
    s_add_u32 m0, s54, 10240
    s_add_u32 s57, s56, 128
    buffer_load_dwordx4 v5, s[8:11], s57 offen sc1 lds
    s_add_u32 m0, s54, 11264
    s_add_u32 s57, s56, 160
    buffer_load_dwordx4 v5, s[8:11], s57 offen sc1 lds
    s_add_u32 m0, s54, 12288
    s_add_u32 s57, s55, 6144
    buffer_load_dwordx4 v4, s[8:11], s57 offen sc1 lds
    s_add_u32 m0, s54, 13312
    s_add_u32 s57, s55, 6176
    buffer_load_dwordx4 v4, s[8:11], s57 offen sc1 lds
    s_add_u32 m0, s54, 14336
    s_add_u32 s57, s56, 192
    buffer_load_dwordx4 v5, s[8:11], s57 offen sc1 lds
    s_add_u32 m0, s54, 15360
    s_add_u32 s57, s56, 224
    buffer_load_dwordx4 v5, s[8:11], s57 offen sc1 lds
AT_nopf:
    v_add_u32 v18, s36, v7
    v_add_u32 v19, 32768, v18
    ds_read_b128 v[36:39], v18 offset:0
    ds_read_b128 v[40:43], v18 offset:1024
    ds_read_b128 v[44:47], v18 offset:2048
    ds_read_b128 v[48:51], v18 offset:3072
    ds_read_b128 v[52:55], v18 offset:4096
    ds_read_b128 v[56:59], v18 offset:5120
    s_waitcnt lgkmcnt(4)
    v_mfma_f32_32x32x16_bf16 v[96:111], v[36:39], v[20:23], 0
    v_mfma_f32_32x32x16_bf16 v[96:111], v[40:43], v[24:27], v[96:111]
    v_mfma_f32_32x32x16_bf16 v[112:127], v[36:39], v[28:31], 0
    v_mfma_f32_32x32x16_bf16 v[112:127], v[40:43], v[32:35], v[112:127]
    s_waitcnt lgkmcnt(0)
    v_max3_f32 v12, v96, v97, v98
    v_max3_f32 v13, v99, v100, v101
    v_max3_f32 v12, v12, v102, v103
    v_max3_f32 v13, v13, v104, v105
    v_mfma_f32_32x32x16_bf16 v[128:143], v[52:55], v[20:23], 0
    v_max3_f32 v12, v12, v106, v107
    v_max3_f32 v13, v13, v108, v109
    v_max3_f32 v12, v12, v110, v111
    v_max_f32 v12, v12, v13
    v_mov_b32 v13, v12
    s_nop 1
    v_permlane32_swap_b32 v12, v13
    s_nop 0
    v_max_f32 v12, v12, v13
    v_fma_f32 v13, v12, s58, -v8
    v_cmp_gt_f32 vcc, v13, v17
    s_cbranch_vccnz ATrs_141
ATrb_142:
    v_pk_fma_f32 v[96:97], v[96:97], s[58:59], v[8:9] neg_lo:[0,0,1] neg_hi:[0,0,1]
    v_pk_fma_f32 v[98:99], v[98:99], s[58:59], v[8:9] neg_lo:[0,0,1] neg_hi:[0,0,1]
    v_pk_fma_f32 v[100:101], v[100:101], s[58:59], v[8:9] neg_lo:[0,0,1] neg_hi:[0,0,1]
    v_pk_fma_f32 v[102:103], v[102:103], s[58:59], v[8:9] neg_lo:[0,0,1] neg_hi:[0,0,1]
    v_mfma_f32_32x32x16_bf16 v[128:143], v[56:59], v[24:27], v[128:143]
    v_pk_fma_f32 v[104:105], v[104:105], s[58:59], v[8:9] neg_lo:[0,0,1] neg_hi:[0,0,1]
    v_pk_fma_f32 v[106:107], v[106:107], s[58:59], v[8:9] neg_lo:[0,0,1] neg_hi:[0,0,1]
    v_pk_fma_f32 v[108:109], v[108:109], s[58:59], v[8:9] neg_lo:[0,0,1] neg_hi:[0,0,1]
    v_pk_fma_f32 v[110:111], v[110:111], s[58:59], v[8:9] neg_lo:[0,0,1] neg_hi:[0,0,1]
    v_exp_f32 v96, v96
    v_exp_f32 v97, v97
    v_exp_f32 v98, v98
    v_exp_f32 v99, v99
    v_exp_f32 v100, v100
    v_exp_f32 v101, v101
    v_exp_f32 v102, v102
    v_exp_f32 v103, v103
    v_exp_f32 v104, v104
    v_exp_f32 v105, v105
    v_exp_f32 v106, v106
    v_exp_f32 v107, v107
    v_exp_f32 v108, v108
    v_exp_f32 v109, v109
    v_exp_f32 v110, v110
    v_exp_f32 v111, v111
    s_nop 0
    v_cvt_pk_bf16_f32 v68, v96, v97
    v_cvt_pk_bf16_f32 v69, v98, v99
    v_cvt_pk_bf16_f32 v70, v100, v101
    v_cvt_pk_bf16_f32 v71, v102, v103
    v_cvt_pk_bf16_f32 v72, v104, v105
    v_cvt_pk_bf16_f32 v73, v106, v107
    v_cvt_pk_bf16_f32 v74, v108, v109
    v_cvt_pk_bf16_f32 v75, v110, v111
    ds_read_b128 v[60:63], v18 offset:6144
    ds_read_b128 v[64:67], v18 offset:7168
    s_nop 0
    v_max3_f32 v12, v112, v113, v114
    v_max3_f32 v13, v115, v116, v117
    v_max3_f32 v12, v12, v118, v119
    v_max3_f32 v13, v13, v120, v121
    v_mfma_f32_32x32x16_bf16 v[160:175], v[44:47], v[68:71], v[160:175]
    v_max3_f32 v12, v12, v122, v123
    v_max3_f32 v13, v13, v124, v125
    v_max3_f32 v12, v12, v126, v127
    v_max_f32 v12, v12, v13
    v_mov_b32 v13, v12
    s_nop 1
    v_permlane32_swap_b32 v12, v13
    s_nop 0
    v_max_f32 v12, v12, v13
    v_fma_f32 v13, v12, s58, -v10
    v_cmp_gt_f32 vcc, v13, v17
    s_cbranch_vccnz ATrs_143
ATrb_144:
    v_pk_fma_f32 v[112:113], v[112:113], s[58:59], v[10:11] neg_lo:[0,0,1] neg_hi:[0,0,1]
    v_pk_fma_f32 v[114:115], v[114:115], s[58:59], v[10:11] neg_lo:[0,0,1] neg_hi:[0,0,1]
    v_pk_fma_f32 v[116:117], v[116:117], s[58:59], v[10:11] neg_lo:[0,0,1] neg_hi:[0,0,1]
    v_pk_fma_f32 v[118:119], v[118:119], s[58:59], v[10:11] neg_lo:[0,0,1] neg_hi:[0,0,1]
    v_mfma_f32_32x32x16_bf16 v[160:175], v[48:51], v[72:75], v[160:175]
    v_pk_fma_f32 v[120:121], v[120:121], s[58:59], v[10:11] neg_lo:[0,0,1] neg_hi:[0,0,1]
    v_pk_fma_f32 v[122:123], v[122:123], s[58:59], v[10:11] neg_lo:[0,0,1] neg_hi:[0,0,1]
    v_pk_fma_f32 v[124:125], v[124:125], s[58:59], v[10:11] neg_lo:[0,0,1] neg_hi:[0,0,1]
    v_pk_fma_f32 v[126:127], v[126:127], s[58:59], v[10:11] neg_lo:[0,0,1] neg_hi:[0,0,1]
    v_exp_f32 v112, v112
    v_exp_f32 v113, v113
    v_exp_f32 v114, v114
    v_exp_f32 v115, v115
    v_exp_f32 v116, v116
    v_mfma_f32_32x32x16_bf16 v[144:159], v[52:55], v[28:31], 0
    v_exp_f32 v117, v117
    v_exp_f32 v118, v118
    v_exp_f32 v119, v119
    v_exp_f32 v120, v120
    v_exp_f32 v121, v121
    v_exp_f32 v122, v122
    v_mfma_f32_32x32x16_bf16 v[144:159], v[56:59], v[32:35], v[144:159]
    v_exp_f32 v123, v123
    v_exp_f32 v124, v124
    v_exp_f32 v125, v125
    v_exp_f32 v126, v126
    v_exp_f32 v127, v127
    s_nop 0
    v_cvt_pk_bf16_f32 v76, v112, v113
    v_cvt_pk_bf16_f32 v77, v114, v115
    v_cvt_pk_bf16_f32 v78, v116, v117
    v_cvt_pk_bf16_f32 v79, v118, v119
    v_cvt_pk_bf16_f32 v80, v120, v121
    v_cvt_pk_bf16_f32 v81, v122, v123
    v_cvt_pk_bf16_f32 v82, v124, v125
    v_cvt_pk_bf16_f32 v83, v126, v127
    ds_read_b128 v[36:39], v18 offset:8192
    ds_read_b128 v[40:43], v18 offset:9216
    s_waitcnt lgkmcnt(0)
    v_max3_f32 v12, v128, v129, v130
    v_max3_f32 v13, v131, v132, v133
    v_max3_f32 v12, v12, v134, v135
    v_max3_f32 v13, v13, v136, v137
    v_mfma_f32_32x32x16_bf16 v[176:191], v[44:47], v[76:79], v[176:191]
    v_max3_f32 v12, v12, v138, v139
    v_max3_f32 v13, v13, v140, v141
    v_max3_f32 v12, v12, v142, v143
    v_max_f32 v12, v12, v13
    v_mov_b32 v13, v12
    s_nop 1
    v_permlane32_swap_b32 v12, v13
    s_nop 0
    v_max_f32 v12, v12, v13
    v_fma_f32 v13, v12, s58, -v8
    v_cmp_gt_f32 vcc, v13, v17
    s_cbranch_vccnz ATrs_145
ATrb_146:
    v_pk_fma_f32 v[128:129], v[128:129], s[58:59], v[8:9] neg_lo:[0,0,1] neg_hi:[0,0,1]
    v_pk_fma_f32 v[130:131], v[130:131], s[58:59], v[8:9] neg_lo:[0,0,1] neg_hi:[0,0,1]
    v_pk_fma_f32 v[132:133], v[132:133], s[58:59], v[8:9] neg_lo:[0,0,1] neg_hi:[0,0,1]
    v_pk_fma_f32 v[134:135], v[134:135], s[58:59], v[8:9] neg_lo:[0,0,1] neg_hi:[0,0,1]
    v_mfma_f32_32x32x16_bf16 v[176:191], v[48:51], v[80:83], v[176:191]
    v_pk_fma_f32 v[136:137], v[136:137], s[58:59], v[8:9] neg_lo:[0,0,1] neg_hi:[0,0,1]
    v_pk_fma_f32 v[138:139], v[138:139], s[58:59], v[8:9] neg_lo:[0,0,1] neg_hi:[0,0,1]
    v_pk_fma_f32 v[140:141], v[140:141], s[58:59], v[8:9] neg_lo:[0,0,1] neg_hi:[0,0,1]
    v_pk_fma_f32 v[142:143], v[142:143], s[58:59], v[8:9] neg_lo:[0,0,1] neg_hi:[0,0,1]
    v_exp_f32 v128, v128
    v_exp_f32 v129, v129
    v_exp_f32 v130, v130
    v_exp_f32 v131, v131
    v_exp_f32 v132, v132
    v_mfma_f32_32x32x16_bf16 v[96:111], v[36:39], v[20:23], 0
    v_exp_f32 v133, v133
    v_exp_f32 v134, v134
    v_exp_f32 v135, v135
    v_exp_f32 v136, v136
    v_exp_f32 v137, v137
    v_exp_f32 v138, v138
    v_mfma_f32_32x32x16_bf16 v[96:111], v[40:43], v[24:27], v[96:111]
    v_exp_f32 v139, v139
    v_exp_f32 v140, v140
    v_exp_f32 v141, v141
    v_exp_f32 v142, v142
    v_exp_f32 v143, v143
    s_nop 0
    v_cvt_pk_bf16_f32 v68, v128, v129
    v_cvt_pk_bf16_f32 v69, v130, v131
    v_cvt_pk_bf16_f32 v70, v132, v133
    v_cvt_pk_bf16_f32 v71, v134, v135
    v_cvt_pk_bf16_f32 v72, v136, v137
    v_cvt_pk_bf16_f32 v73, v138, v139
    v_cvt_pk_bf16_f32 v74, v140, v141
    v_cvt_pk_bf16_f32 v75, v142, v143
    ds_read_b128 v[44:47], v18 offset:10240
    ds_read_b128 v[48:51], v18 offset:11264
    s_nop 0
    v_max3_f32 v12, v144, v145, v146
    v_max3_f32 v13, v147, v148, v149
    v_max3_f32 v12, v12, v150, v151
    v_max3_f32 v13, v13, v152, v153
    v_mfma_f32_32x32x16_bf16 v[160:175], v[60:63], v[68:71], v[160:175]
    v_max3_f32 v12, v12, v154, v155
    v_max3_f32 v13, v13, v156, v157
    v_max3_f32 v12, v12, v158, v159
    v_max_f32 v12, v12, v13
    v_mov_b32 v13, v12
    s_nop 1
    v_permlane32_swap_b32 v12, v13
    s_nop 0
    v_max_f32 v12, v12, v13
    v_fma_f32 v13, v12, s58, -v10
    v_cmp_gt_f32 vcc, v13, v17
    s_cbranch_vccnz ATrs_147
ATrb_148:
    v_pk_fma_f32 v[144:145], v[144:145], s[58:59], v[10:11] neg_lo:[0,0,1] neg_hi:[0,0,1]
    v_pk_fma_f32 v[146:147], v[146:147], s[58:59], v[10:11] neg_lo:[0,0,1] neg_hi:[0,0,1]
    v_pk_fma_f32 v[148:149], v[148:149], s[58:59], v[10:11] neg_lo:[0,0,1] neg_hi:[0,0,1]
    v_pk_fma_f32 v[150:151], v[150:151], s[58:59], v[10:11] neg_lo:[0,0,1] neg_hi:[0,0,1]
    v_mfma_f32_32x32x16_bf16 v[160:175], v[64:67], v[72:75], v[160:175]
    v_pk_fma_f32 v[152:153], v[152:153], s[58:59], v[10:11] neg_lo:[0,0,1] neg_hi:[0,0,1]
    v_pk_fma_f32 v[154:155], v[154:155], s[58:59], v[10:11] neg_lo:[0,0,1] neg_hi:[0,0,1]
    v_pk_fma_f32 v[156:157], v[156:157], s[58:59], v[10:11] neg_lo:[0,0,1] neg_hi:[0,0,1]
    v_pk_fma_f32 v[158:159], v[158:159], s[58:59], v[10:11] neg_lo:[0,0,1] neg_hi:[0,0,1]
    v_exp_f32 v144, v144
    v_exp_f32 v145, v145
    v_exp_f32 v146, v146
    v_exp_f32 v147, v147
    v_exp_f32 v148, v148
    v_mfma_f32_32x32x16_bf16 v[112:127], v[36:39], v[28:31], 0
    v_exp_f32 v149, v149
    v_exp_f32 v150, v150
    v_exp_f32 v151, v151
    v_exp_f32 v152, v152
    v_exp_f32 v153, v153
    v_exp_f32 v154, v154
    v_mfma_f32_32x32x16_bf16 v[112:127], v[40:43], v[32:35], v[112:127]
    v_exp_f32 v155, v155
    v_exp_f32 v156, v156
    v_exp_f32 v157, v157
    v_exp_f32 v158, v158
    v_exp_f32 v159, v159
    s_nop 0
    v_cvt_pk_bf16_f32 v76, v144, v145
    v_cvt_pk_bf16_f32 v77, v146, v147
    v_cvt_pk_bf16_f32 v78, v148, v149
    v_cvt_pk_bf16_f32 v79, v150, v151
    v_cvt_pk_bf16_f32 v80, v152, v153
    v_cvt_pk_bf16_f32 v81, v154, v155
    v_cvt_pk_bf16_f32 v82, v156, v157
    v_cvt_pk_bf16_f32 v83, v158, v159
    ds_read_b128 v[52:55], v18 offset:12288
    ds_read_b128 v[56:59], v18 offset:13312
    s_waitcnt lgkmcnt(0)
    v_max3_f32 v12, v96, v97, v98
    v_max3_f32 v13, v99, v100, v101
    v_max3_f32 v12, v12, v102, v103
    v_max3_f32 v13, v13, v104, v105
    v_mfma_f32_32x32x16_bf16 v[176:191], v[60:63], v[76:79], v[176:191]
    v_max3_f32 v12, v12, v106, v107
    v_max3_f32 v13, v13, v108, v109
    v_max3_f32 v12, v12, v110, v111
    v_max_f32 v12, v12, v13
    v_mov_b32 v13, v12
    s_nop 1
    v_permlane32_swap_b32 v12, v13
    s_nop 0
    v_max_f32 v12, v12, v13
    v_fma_f32 v13, v12, s58, -v8
    v_cmp_gt_f32 vcc, v13, v17
    s_cbranch_vccnz ATrs_149
ATrb_150:
    v_pk_fma_f32 v[96:97], v[96:97], s[58:59], v[8:9] neg_lo:[0,0,1] neg_hi:[0,0,1]
    v_pk_fma_f32 v[98:99], v[98:99], s[58:59], v[8:9] neg_lo:[0,0,1] neg_hi:[0,0,1]
    v_pk_fma_f32 v[100:101], v[100:101], s[58:59], v[8:9] neg_lo:[0,0,1] neg_hi:[0,0,1]
    v_pk_fma_f32 v[102:103], v[102:103], s[58:59], v[8:9] neg_lo:[0,0,1] neg_hi:[0,0,1]
    v_mfma_f32_32x32x16_bf16 v[176:191], v[64:67], v[80:83], v[176:191]
    v_pk_fma_f32 v[104:105], v[104:105], s[58:59], v[8:9] neg_lo:[0,0,1] neg_hi:[0,0,1]
    v_pk_fma_f32 v[106:107], v[106:107], s[58:59], v[8:9] neg_lo:[0,0,1] neg_hi:[0,0,1]
    v_pk_fma_f32 v[108:109], v[108:109], s[58:59], v[8:9] neg_lo:[0,0,1] neg_hi:[0,0,1]
    v_pk_fma_f32 v[110:111], v[110:111], s[58:59], v[8:9] neg_lo:[0,0,1] neg_hi:[0,0,1]
    v_exp_f32 v96, v96
    v_exp_f32 v97, v97
    v_exp_f32 v98, v98
    v_exp_f32 v99, v99
    v_exp_f32 v100, v100
    v_mfma_f32_32x32x16_bf16 v[128:143], v[52:55], v[20:23], 0
    v_exp_f32 v101, v101
    v_exp_f32 v102, v102
    v_exp_f32 v103, v103
    v_exp_f32 v104, v104
    v_exp_f32 v105, v105
    v_exp_f32 v106, v106
    v_mfma_f32_32x32x16_bf16 v[128:143], v[56:59], v[24:27], v[128:143]
    v_exp_f32 v107, v107
    v_exp_f32 v108, v108
    v_exp_f32 v109, v109
    v_exp_f32 v110, v110
    v_exp_f32 v111, v111
    s_nop 0
    v_cvt_pk_bf16_f32 v68, v96, v97
    v_cvt_pk_bf16_f32 v69, v98, v99
    v_cvt_pk_bf16_f32 v70, v100, v101
    v_cvt_pk_bf16_f32 v71, v102, v103
    v_cvt_pk_bf16_f32 v72, v104, v105
    v_cvt_pk_bf16_f32 v73, v106, v107
    v_cvt_pk_bf16_f32 v74, v108, v109
    v_cvt_pk_bf16_f32 v75, v110, v111
    ds_read_b128 v[60:63], v18 offset:14336
    ds_read_b128 v[64:67], v18 offset:15360
    s_nop 0
    v_max3_f32 v12, v112, v113, v114
    v_max3_f32 v13, v115, v116, v117
    v_max3_f32 v12, v12, v118, v119
    v_max3_f32 v13, v13, v120, v121
    v_mfma_f32_32x32x16_bf16 v[160:175], v[44:47], v[68:71], v[160:175]
    v_max3_f32 v12, v12, v122, v123
    v_max3_f32 v13, v13, v124, v125
    v_max3_f32 v12, v12, v126, v127
    v_max_f32 v12, v12, v13
    v_mov_b32 v13, v12
    s_nop 1
    v_permlane32_swap_b32 v12, v13
    s_nop 0
    v_max_f32 v12, v12, v13
    v_fma_f32 v13, v12, s58, -v10
    v_cmp_gt_f32 vcc, v13, v17
    s_cbranch_vccnz ATrs_151
ATrb_152:
    v_pk_fma_f32 v[112:113], v[112:113], s[58:59], v[10:11] neg_lo:[0,0,1] neg_hi:[0,0,1]
    v_pk_fma_f32 v[114:115], v[114:115], s[58:59], v[10:11] neg_lo:[0,0,1] neg_hi:[0,0,1]
    v_pk_fma_f32 v[116:117], v[116:117], s[58:59], v[10:11] neg_lo:[0,0,1] neg_hi:[0,0,1]
    v_pk_fma_f32 v[118:119], v[118:119], s[58:59], v[10:11] neg_lo:[0,0,1] neg_hi:[0,0,1]
    v_mfma_f32_32x32x16_bf16 v[160:175], v[48:51], v[72:75], v[160:175]
    v_pk_fma_f32 v[120:121], v[120:121], s[58:59], v[10:11] neg_lo:[0,0,1] neg_hi:[0,0,1]
    v_pk_fma_f32 v[122:123], v[122:123], s[58:59], v[10:11] neg_lo:[0,0,1] neg_hi:[0,0,1]
    v_pk_fma_f32 v[124:125], v[124:125], s[58:59], v[10:11] neg_lo:[0,0,1] neg_hi:[0,0,1]
    v_pk_fma_f32 v[126:127], v[126:127], s[58:59], v[10:11] neg_lo:[0,0,1] neg_hi:[0,0,1]
    v_exp_f32 v112, v112
    v_exp_f32 v113, v113
    v_exp_f32 v114, v114
    v_exp_f32 v115, v115
    v_exp_f32 v116, v116
    v_mfma_f32_32x32x16_bf16 v[144:159], v[52:55], v[28:31], 0
    v_exp_f32 v117, v117
    v_exp_f32 v118, v118
    v_exp_f32 v119, v119
    v_exp_f32 v120, v120
    v_exp_f32 v121, v121
    v_exp_f32 v122, v122
    v_mfma_f32_32x32x16_bf16 v[144:159], v[56:59], v[32:35], v[144:159]
    v_exp_f32 v123, v123
    v_exp_f32 v124, v124
    v_exp_f32 v125, v125
    v_exp_f32 v126, v126
    v_exp_f32 v127, v127
    s_nop 0
    v_cvt_pk_bf16_f32 v76, v112, v113
    v_cvt_pk_bf16_f32 v77, v114, v115
    v_cvt_pk_bf16_f32 v78, v116, v117
    v_cvt_pk_bf16_f32 v79, v118, v119
    v_cvt_pk_bf16_f32 v80, v120, v121
    v_cvt_pk_bf16_f32 v81, v122, v123
    v_cvt_pk_bf16_f32 v82, v124, v125
    v_cvt_pk_bf16_f32 v83, v126, v127
    ds_read_b128 v[36:39], v18 offset:16384
    ds_read_b128 v[40:43], v18 offset:17408
    s_waitcnt lgkmcnt(0)
    v_max3_f32 v12, v128, v129, v130
    v_max3_f32 v13, v131, v132, v133
    v_max3_f32 v12, v12, v134, v135
    v_max3_f32 v13, v13, v136, v137
    v_mfma_f32_32x32x16_bf16 v[176:191], v[44:47], v[76:79], v[176:191]
    v_max3_f32 v12, v12, v138, v139
    v_max3_f32 v13, v13, v140, v141
    v_max3_f32 v12, v12, v142, v143
    v_max_f32 v12, v12, v13
    v_mov_b32 v13, v12
    s_nop 1
    v_permlane32_swap_b32 v12, v13
    s_nop 0
    v_max_f32 v12, v12, v13
    v_fma_f32 v13, v12, s58, -v8
    v_cmp_gt_f32 vcc, v13, v17
    s_cbranch_vccnz ATrs_153
ATrb_154:
    v_pk_fma_f32 v[128:129], v[128:129], s[58:59], v[8:9] neg_lo:[0,0,1] neg_hi:[0,0,1]
    v_pk_fma_f32 v[130:131], v[130:131], s[58:59], v[8:9] neg_lo:[0,0,1] neg_hi:[0,0,1]
    v_pk_fma_f32 v[132:133], v[132:133], s[58:59], v[8:9] neg_lo:[0,0,1] neg_hi:[0,0,1]
    v_pk_fma_f32 v[134:135], v[134:135], s[58:59], v[8:9] neg_lo:[0,0,1] neg_hi:[0,0,1]
    v_mfma_f32_32x32x16_bf16 v[176:191], v[48:51], v[80:83], v[176:191]
    v_pk_fma_f32 v[136:137], v[136:137], s[58:59], v[8:9] neg_lo:[0,0,1] neg_hi:[0,0,1]
    v_pk_fma_f32 v[138:139], v[138:139], s[58:59], v[8:9] neg_lo:[0,0,1] neg_hi:[0,0,1]
    v_pk_fma_f32 v[140:141], v[140:141], s[58:59], v[8:9] neg_lo:[0,0,1] neg_hi:[0,0,1]
    v_pk_fma_f32 v[142:143], v[142:143], s[58:59], v[8:9] neg_lo:[0,0,1] neg_hi:[0,0,1]
    v_exp_f32 v128, v128
    v_exp_f32 v129, v129
    v_exp_f32 v130, v130
    v_exp_f32 v131, v131
    v_exp_f32 v132, v132
    v_mfma_f32_32x32x16_bf16 v[96:111], v[36:39], v[20:23], 0
    v_exp_f32 v133, v133
    v_exp_f32 v134, v134
    v_exp_f32 v135, v135
    v_exp_f32 v136, v136
    v_exp_f32 v137, v137
    v_exp_f32 v138, v138
    v_mfma_f32_32x32x16_bf16 v[96:111], v[40:43], v[24:27], v[96:111]
    v_exp_f32 v139, v139
    v_exp_f32 v140, v140
    v_exp_f32 v141, v141
    v_exp_f32 v142, v142
    v_exp_f32 v143, v143
    s_nop 0
    v_cvt_pk_bf16_f32 v68, v128, v129
    v_cvt_pk_bf16_f32 v69, v130, v131
    v_cvt_pk_bf16_f32 v70, v132, v133
    v_cvt_pk_bf16_f32 v71, v134, v135
    v_cvt_pk_bf16_f32 v72, v136, v137
    v_cvt_pk_bf16_f32 v73, v138, v139
    v_cvt_pk_bf16_f32 v74, v140, v141
    v_cvt_pk_bf16_f32 v75, v142, v143
    ds_read_b128 v[44:47], v18 offset:18432
    ds_read_b128 v[48:51], v18 offset:19456
    s_nop 0
    v_max3_f32 v12, v144, v145, v146
    v_max3_f32 v13, v147, v148, v149
    v_max3_f32 v12, v12, v150, v151
    v_max3_f32 v13, v13, v152, v153
    v_mfma_f32_32x32x16_bf16 v[160:175], v[60:63], v[68:71], v[160:175]
    v_max3_f32 v12, v12, v154, v155
    v_max3_f32 v13, v13, v156, v157
    v_max3_f32 v12, v12, v158, v159
    v_max_f32 v12, v12, v13
    v_mov_b32 v13, v12
    s_nop 1
    v_permlane32_swap_b32 v12, v13
    s_nop 0
    v_max_f32 v12, v12, v13
    v_fma_f32 v13, v12, s58, -v10
    v_cmp_gt_f32 vcc, v13, v17
    s_cbranch_vccnz ATrs_155
ATrb_156:
    v_pk_fma_f32 v[144:145], v[144:145], s[58:59], v[10:11] neg_lo:[0,0,1] neg_hi:[0,0,1]
    v_pk_fma_f32 v[146:147], v[146:147], s[58:59], v[10:11] neg_lo:[0,0,1] neg_hi:[0,0,1]
    v_pk_fma_f32 v[148:149], v[148:149], s[58:59], v[10:11] neg_lo:[0,0,1] neg_hi:[0,0,1]
    v_pk_fma_f32 v[150:151], v[150:151], s[58:59], v[10:11] neg_lo:[0,0,1] neg_hi:[0,0,1]
    v_mfma_f32_32x32x16_bf16 v[160:175], v[64:67], v[72:75], v[160:175]
    v_pk_fma_f32 v[152:153], v[152:153], s[58:59], v[10:11] neg_lo:[0,0,1] neg_hi:[0,0,1]
    v_pk_fma_f32 v[154:155], v[154:155], s[58:59], v[10:11] neg_lo:[0,0,1] neg_hi:[0,0,1]
    v_pk_fma_f32 v[156:157], v[156:157], s[58:59], v[10:11] neg_lo:[0,0,1] neg_hi:[0,0,1]
    v_pk_fma_f32 v[158:159], v[158:159], s[58:59], v[10:11] neg_lo:[0,0,1] neg_hi:[0,0,1]
    v_exp_f32 v144, v144
    v_exp_f32 v145, v145
    v_exp_f32 v146, v146
    v_exp_f32 v147, v147
    v_exp_f32 v148, v148
    v_mfma_f32_32x32x16_bf16 v[112:127], v[36:39], v[28:31], 0
    v_exp_f32 v149, v149
    v_exp_f32 v150, v150
    v_exp_f32 v151, v151
    v_exp_f32 v152, v152
    v_exp_f32 v153, v153
    v_exp_f32 v154, v154
    v_mfma_f32_32x32x16_bf16 v[112:127], v[40:43], v[32:35], v[112:127]
    v_exp_f32 v155, v155
    v_exp_f32 v156, v156
    v_exp_f32 v157, v157
    v_exp_f32 v158, v158
    v_exp_f32 v159, v159
    s_nop 0
    v_cvt_pk_bf16_f32 v76, v144, v145
    v_cvt_pk_bf16_f32 v77, v146, v147
    v_cvt_pk_bf16_f32 v78, v148, v149
    v_cvt_pk_bf16_f32 v79, v150, v151
    v_cvt_pk_bf16_f32 v80, v152, v153
    v_cvt_pk_bf16_f32 v81, v154, v155
    v_cvt_pk_bf16_f32 v82, v156, v157
    v_cvt_pk_bf16_f32 v83, v158, v159
    ds_read_b128 v[52:55], v18 offset:20480
    ds_read_b128 v[56:59], v18 offset:21504
    s_waitcnt lgkmcnt(0)
    v_max3_f32 v12, v96, v97, v98
    v_max3_f32 v13, v99, v100, v101
    v_max3_f32 v12, v12, v102, v103
    v_max3_f32 v13, v13, v104, v105
    v_mfma_f32_32x32x16_bf16 v[176:191], v[60:63], v[76:79], v[176:191]
    v_max3_f32 v12, v12, v106, v107
    v_max3_f32 v13, v13, v108, v109
    v_max3_f32 v12, v12, v110, v111
    v_max_f32 v12, v12, v13
    v_mov_b32 v13, v12
    s_nop 1
    v_permlane32_swap_b32 v12, v13
    s_nop 0
    v_max_f32 v12, v12, v13
    v_fma_f32 v13, v12, s58, -v8
    v_cmp_gt_f32 vcc, v13, v17
    s_cbranch_vccnz ATrs_157
ATrb_158:
    v_pk_fma_f32 v[96:97], v[96:97], s[58:59], v[8:9] neg_lo:[0,0,1] neg_hi:[0,0,1]
    v_pk_fma_f32 v[98:99], v[98:99], s[58:59], v[8:9] neg_lo:[0,0,1] neg_hi:[0,0,1]
    v_pk_fma_f32 v[100:101], v[100:101], s[58:59], v[8:9] neg_lo:[0,0,1] neg_hi:[0,0,1]
    v_pk_fma_f32 v[102:103], v[102:103], s[58:59], v[8:9] neg_lo:[0,0,1] neg_hi:[0,0,1]
    v_mfma_f32_32x32x16_bf16 v[176:191], v[64:67], v[80:83], v[176:191]
    v_pk_fma_f32 v[104:105], v[104:105], s[58:59], v[8:9] neg_lo:[0,0,1] neg_hi:[0,0,1]
    v_pk_fma_f32 v[106:107], v[106:107], s[58:59], v[8:9] neg_lo:[0,0,1] neg_hi:[0,0,1]
    v_pk_fma_f32 v[108:109], v[108:109], s[58:59], v[8:9] neg_lo:[0,0,1] neg_hi:[0,0,1]
    v_pk_fma_f32 v[110:111], v[110:111], s[58:59], v[8:9] neg_lo:[0,0,1] neg_hi:[0,0,1]
    v_exp_f32 v96, v96
    v_exp_f32 v97, v97
    v_exp_f32 v98, v98
    v_exp_f32 v99, v99
    v_exp_f32 v100, v100
    v_mfma_f32_32x32x16_bf16 v[128:143], v[52:55], v[20:23], 0
    v_exp_f32 v101, v101
    v_exp_f32 v102, v102
    v_exp_f32 v103, v103
    v_exp_f32 v104, v104
    v_exp_f32 v105, v105
    v_exp_f32 v106, v106
    v_mfma_f32_32x32x16_bf16 v[128:143], v[56:59], v[24:27], v[128:143]
    v_exp_f32 v107, v107
    v_exp_f32 v108, v108
    v_exp_f32 v109, v109
    v_exp_f32 v110, v110
    v_exp_f32 v111, v111
    s_nop 0
    v_cvt_pk_bf16_f32 v68, v96, v97
    v_cvt_pk_bf16_f32 v69, v98, v99
    v_cvt_pk_bf16_f32 v70, v100, v101
    v_cvt_pk_bf16_f32 v71, v102, v103
    v_cvt_pk_bf16_f32 v72, v104, v105
    v_cvt_pk_bf16_f32 v73, v106, v107
    v_cvt_pk_bf16_f32 v74, v108, v109
    v_cvt_pk_bf16_f32 v75, v110, v111
    ds_read_b128 v[60:63], v18 offset:22528
    ds_read_b128 v[64:67], v18 offset:23552
    s_nop 0
    v_max3_f32 v12, v112, v113, v114
    v_max3_f32 v13, v115, v116, v117
    v_max3_f32 v12, v12, v118, v119
    v_max3_f32 v13, v13, v120, v121
    v_mfma_f32_32x32x16_bf16 v[160:175], v[44:47], v[68:71], v[160:175]
    v_max3_f32 v12, v12, v122, v123
    v_max3_f32 v13, v13, v124, v125
    v_max3_f32 v12, v12, v126, v127
    v_max_f32 v12, v12, v13
    v_mov_b32 v13, v12
    s_nop 1
    v_permlane32_swap_b32 v12, v13
    s_nop 0
    v_max_f32 v12, v12, v13
    v_fma_f32 v13, v12, s58, -v10
    v_cmp_gt_f32 vcc, v13, v17
    s_cbranch_vccnz ATrs_159
ATrb_160:
    v_pk_fma_f32 v[112:113], v[112:113], s[58:59], v[10:11] neg_lo:[0,0,1] neg_hi:[0,0,1]
    v_pk_fma_f32 v[114:115], v[114:115], s[58:59], v[10:11] neg_lo:[0,0,1] neg_hi:[0,0,1]
    v_pk_fma_f32 v[116:117], v[116:117], s[58:59], v[10:11] neg_lo:[0,0,1] neg_hi:[0,0,1]
    v_pk_fma_f32 v[118:119], v[118:119], s[58:59], v[10:11] neg_lo:[0,0,1] neg_hi:[0,0,1]
    v_mfma_f32_32x32x16_bf16 v[160:175], v[48:51], v[72:75], v[160:175]
    v_pk_fma_f32 v[120:121], v[120:121], s[58:59], v[10:11] neg_lo:[0,0,1] neg_hi:[0,0,1]
    v_pk_fma_f32 v[122:123], v[122:123], s[58:59], v[10:11] neg_lo:[0,0,1] neg_hi:[0,0,1]
    v_pk_fma_f32 v[124:125], v[124:125], s[58:59], v[10:11] neg_lo:[0,0,1] neg_hi:[0,0,1]
    v_pk_fma_f32 v[126:127], v[126:127], s[58:59], v[10:11] neg_lo:[0,0,1] neg_hi:[0,0,1]
    v_exp_f32 v112, v112
    v_exp_f32 v113, v113
    v_exp_f32 v114, v114
    v_exp_f32 v115, v115
    v_exp_f32 v116, v116
    v_mfma_f32_32x32x16_bf16 v[144:159], v[52:55], v[28:31], 0
    v_exp_f32 v117, v117
    v_exp_f32 v118, v118
    v_exp_f32 v119, v119
    v_exp_f32 v120, v120
    v_exp_f32 v121, v121
    v_exp_f32 v122, v122
    v_mfma_f32_32x32x16_bf16 v[144:159], v[56:59], v[32:35], v[144:159]
    v_exp_f32 v123, v123
    v_exp_f32 v124, v124
    v_exp_f32 v125, v125
    v_exp_f32 v126, v126
    v_exp_f32 v127, v127
    s_nop 0
    v_cvt_pk_bf16_f32 v76, v112, v113
    v_cvt_pk_bf16_f32 v77, v114, v115
    v_cvt_pk_bf16_f32 v78, v116, v117
    v_cvt_pk_bf16_f32 v79, v118, v119
    v_cvt_pk_bf16_f32 v80, v120, v121
    v_cvt_pk_bf16_f32 v81, v122, v123
    v_cvt_pk_bf16_f32 v82, v124, v125
    v_cvt_pk_bf16_f32 v83, v126, v127
    ds_read_b128 v[36:39], v18 offset:24576
    ds_read_b128 v[40:43], v18 offset:25600
    s_waitcnt lgkmcnt(0)
    v_max3_f32 v12, v128, v129, v130
    v_max3_f32 v13, v131, v132, v133
    v_max3_f32 v12, v12, v134, v135
    v_max3_f32 v13, v13, v136, v137
    v_mfma_f32_32x32x16_bf16 v[176:191], v[44:47], v[76:79], v[176:191]
    v_max3_f32 v12, v12, v138, v139
    v_max3_f32 v13, v13, v140, v141
    v_max3_f32 v12, v12, v142, v143
    v_max_f32 v12, v12, v13
    v_mov_b32 v13, v12
    s_nop 1
    v_permlane32_swap_b32 v12, v13
    s_nop 0
    v_max_f32 v12, v12, v13
    v_fma_f32 v13, v12, s58, -v8
    v_cmp_gt_f32 vcc, v13, v17
    s_cbranch_vccnz ATrs_161
ATrb_162:
    v_pk_fma_f32 v[128:129], v[128:129], s[58:59], v[8:9] neg_lo:[0,0,1] neg_hi:[0,0,1]
    v_pk_fma_f32 v[130:131], v[130:131], s[58:59], v[8:9] neg_lo:[0,0,1] neg_hi:[0,0,1]
    v_pk_fma_f32 v[132:133], v[132:133], s[58:59], v[8:9] neg_lo:[0,0,1] neg_hi:[0,0,1]
    v_pk_fma_f32 v[134:135], v[134:135], s[58:59], v[8:9] neg_lo:[0,0,1] neg_hi:[0,0,1]
    v_mfma_f32_32x32x16_bf16 v[176:191], v[48:51], v[80:83], v[176:191]
    v_pk_fma_f32 v[136:137], v[136:137], s[58:59], v[8:9] neg_lo:[0,0,1] neg_hi:[0,0,1]
    v_pk_fma_f32 v[138:139], v[138:139], s[58:59], v[8:9] neg_lo:[0,0,1] neg_hi:[0,0,1]
    v_pk_fma_f32 v[140:141], v[140:141], s[58:59], v[8:9] neg_lo:[0,0,1] neg_hi:[0,0,1]
    v_pk_fma_f32 v[142:143], v[142:143], s[58:59], v[8:9] neg_lo:[0,0,1] neg_hi:[0,0,1]
    v_exp_f32 v128, v128
    v_exp_f32 v129, v129
    v_exp_f32 v130, v130
    v_exp_f32 v131, v131
    v_exp_f32 v132, v132
    v_mfma_f32_32x32x16_bf16 v[96:111], v[36:39], v[20:23], 0
    v_exp_f32 v133, v133
    v_exp_f32 v134, v134
    v_exp_f32 v135, v135
    v_exp_f32 v136, v136
    v_exp_f32 v137, v137
    v_exp_f32 v138, v138
    v_mfma_f32_32x32x16_bf16 v[96:111], v[40:43], v[24:27], v[96:111]
    v_exp_f32 v139, v139
    v_exp_f32 v140, v140
    v_exp_f32 v141, v141
    v_exp_f32 v142, v142
    v_exp_f32 v143, v143
    s_nop 0
    v_cvt_pk_bf16_f32 v68, v128, v129
    v_cvt_pk_bf16_f32 v69, v130, v131
    v_cvt_pk_bf16_f32 v70, v132, v133
    v_cvt_pk_bf16_f32 v71, v134, v135
    v_cvt_pk_bf16_f32 v72, v136, v137
    v_cvt_pk_bf16_f32 v73, v138, v139
    v_cvt_pk_bf16_f32 v74, v140, v141
    v_cvt_pk_bf16_f32 v75, v142, v143
    ds_read_b128 v[44:47], v18 offset:26624
    ds_read_b128 v[48:51], v18 offset:27648
    s_nop 0
    v_max3_f32 v12, v144, v145, v146
    v_max3_f32 v13, v147, v148, v149
    v_max3_f32 v12, v12, v150, v151
    v_max3_f32 v13, v13, v152, v153
    v_mfma_f32_32x32x16_bf16 v[160:175], v[60:63], v[68:71], v[160:175]
    v_max3_f32 v12, v12, v154, v155
    v_max3_f32 v13, v13, v156, v157
    v_max3_f32 v12, v12, v158, v159
    v_max_f32 v12, v12, v13
    v_mov_b32 v13, v12
    s_nop 1
    v_permlane32_swap_b32 v12, v13
    s_nop 0
    v_max_f32 v12, v12, v13
    v_fma_f32 v13, v12, s58, -v10
    v_cmp_gt_f32 vcc, v13, v17
    s_cbranch_vccnz ATrs_163
ATrb_164:
    v_pk_fma_f32 v[144:145], v[144:145], s[58:59], v[10:11] neg_lo:[0,0,1] neg_hi:[0,0,1]
    v_pk_fma_f32 v[146:147], v[146:147], s[58:59], v[10:11] neg_lo:[0,0,1] neg_hi:[0,0,1]
    v_pk_fma_f32 v[148:149], v[148:149], s[58:59], v[10:11] neg_lo:[0,0,1] neg_hi:[0,0,1]
    v_pk_fma_f32 v[150:151], v[150:151], s[58:59], v[10:11] neg_lo:[0,0,1] neg_hi:[0,0,1]
    v_mfma_f32_32x32x16_bf16 v[160:175], v[64:67], v[72:75], v[160:175]
    v_pk_fma_f32 v[152:153], v[152:153], s[58:59], v[10:11] neg_lo:[0,0,1] neg_hi:[0,0,1]
    v_pk_fma_f32 v[154:155], v[154:155], s[58:59], v[10:11] neg_lo:[0,0,1] neg_hi:[0,0,1]
    v_pk_fma_f32 v[156:157], v[156:157], s[58:59], v[10:11] neg_lo:[0,0,1] neg_hi:[0,0,1]
    v_pk_fma_f32 v[158:159], v[158:159], s[58:59], v[10:11] neg_lo:[0,0,1] neg_hi:[0,0,1]
    v_exp_f32 v144, v144
    v_exp_f32 v145, v145
    v_exp_f32 v146, v146
    v_exp_f32 v147, v147
    v_exp_f32 v148, v148
    v_mfma_f32_32x32x16_bf16 v[112:127], v[36:39], v[28:31], 0
    v_exp_f32 v149, v149
    v_exp_f32 v150, v150
    v_exp_f32 v151, v151
    v_exp_f32 v152, v152
    v_exp_f32 v153, v153
    v_exp_f32 v154, v154
    v_mfma_f32_32x32x16_bf16 v[112:127], v[40:43], v[32:35], v[112:127]
    v_exp_f32 v155, v155
    v_exp_f32 v156, v156
    v_exp_f32 v157, v157
    v_exp_f32 v158, v158
    v_exp_f32 v159, v159
    s_nop 0
    v_cvt_pk_bf16_f32 v76, v144, v145
    v_cvt_pk_bf16_f32 v77, v146, v147
    v_cvt_pk_bf16_f32 v78, v148, v149
    v_cvt_pk_bf16_f32 v79, v150, v151
    v_cvt_pk_bf16_f32 v80, v152, v153
    v_cvt_pk_bf16_f32 v81, v154, v155
    v_cvt_pk_bf16_f32 v82, v156, v157
    v_cvt_pk_bf16_f32 v83, v158, v159
    ds_read_b128 v[52:55], v18 offset:28672
    ds_read_b128 v[56:59], v18 offset:29696
    s_waitcnt lgkmcnt(0)
    v_max3_f32 v12, v96, v97, v98
    v_max3_f32 v13, v99, v100, v101
    v_max3_f32 v12, v12, v102, v103
    v_max3_f32 v13, v13, v104, v105
    v_mfma_f32_32x32x16_bf16 v[176:191], v[60:63], v[76:79], v[176:191]
    v_max3_f32 v12, v12, v106, v107
    v_max3_f32 v13, v13, v108, v109
    v_max3_f32 v12, v12, v110, v111
    v_max_f32 v12, v12, v13
    v_mov_b32 v13, v12
    s_nop 1
    v_permlane32_swap_b32 v12, v13
    s_nop 0
    v_max_f32 v12, v12, v13
    v_fma_f32 v13, v12, s58, -v8
    v_cmp_gt_f32 vcc, v13, v17
    s_cbranch_vccnz ATrs_165
ATrb_166:
    v_pk_fma_f32 v[96:97], v[96:97], s[58:59], v[8:9] neg_lo:[0,0,1] neg_hi:[0,0,1]
    v_pk_fma_f32 v[98:99], v[98:99], s[58:59], v[8:9] neg_lo:[0,0,1] neg_hi:[0,0,1]
    v_pk_fma_f32 v[100:101], v[100:101], s[58:59], v[8:9] neg_lo:[0,0,1] neg_hi:[0,0,1]
    v_pk_fma_f32 v[102:103], v[102:103], s[58:59], v[8:9] neg_lo:[0,0,1] neg_hi:[0,0,1]
    v_mfma_f32_32x32x16_bf16 v[176:191], v[64:67], v[80:83], v[176:191]
    v_pk_fma_f32 v[104:105], v[104:105], s[58:59], v[8:9] neg_lo:[0,0,1] neg_hi:[0,0,1]
    v_pk_fma_f32 v[106:107], v[106:107], s[58:59], v[8:9] neg_lo:[0,0,1] neg_hi:[0,0,1]
    v_pk_fma_f32 v[108:109], v[108:109], s[58:59], v[8:9] neg_lo:[0,0,1] neg_hi:[0,0,1]
    v_pk_fma_f32 v[110:111], v[110:111], s[58:59], v[8:9] neg_lo:[0,0,1] neg_hi:[0,0,1]
    v_exp_f32 v96, v96
    v_exp_f32 v97, v97
    v_exp_f32 v98, v98
    v_exp_f32 v99, v99
    v_exp_f32 v100, v100
    v_mfma_f32_32x32x16_bf16 v[128:143], v[52:55], v[20:23], 0
    v_exp_f32 v101, v101
    v_exp_f32 v102, v102
    v_exp_f32 v103, v103
    v_exp_f32 v104, v104
    v_exp_f32 v105, v105
    v_exp_f32 v106, v106
    v_mfma_f32_32x32x16_bf16 v[128:143], v[56:59], v[24:27], v[128:143]
    v_exp_f32 v107, v107
    v_exp_f32 v108, v108
    v_exp_f32 v109, v109
    v_exp_f32 v110, v110
    v_exp_f32 v111, v111
    s_nop 0
    v_cvt_pk_bf16_f32 v68, v96, v97
    v_cvt_pk_bf16_f32 v69, v98, v99
    v_cvt_pk_bf16_f32 v70, v100, v101
    v_cvt_pk_bf16_f32 v71, v102, v103
    v_cvt_pk_bf16_f32 v72, v104, v105
    v_cvt_pk_bf16_f32 v73, v106, v107
    v_cvt_pk_bf16_f32 v74, v108, v109
    v_cvt_pk_bf16_f32 v75, v110, v111
    ds_read_b128 v[60:63], v18 offset:30720
    ds_read_b128 v[64:67], v18 offset:31744
    s_nop 0
    v_max3_f32 v12, v112, v113, v114
    v_max3_f32 v13, v115, v116, v117
    v_max3_f32 v12, v12, v118, v119
    v_max3_f32 v13, v13, v120, v121
    v_mfma_f32_32x32x16_bf16 v[160:175], v[44:47], v[68:71], v[160:175]
    v_max3_f32 v12, v12, v122, v123
    v_max3_f32 v13, v13, v124, v125
    v_max3_f32 v12, v12, v126, v127
    v_max_f32 v12, v12, v13
    v_mov_b32 v13, v12
    s_nop 1
    v_permlane32_swap_b32 v12, v13
    s_nop 0
    v_max_f32 v12, v12, v13
    v_fma_f32 v13, v12, s58, -v10
    v_cmp_gt_f32 vcc, v13, v17
    s_cbranch_vccnz ATrs_167
ATrb_168:
    v_pk_fma_f32 v[112:113], v[112:113], s[58:59], v[10:11] neg_lo:[0,0,1] neg_hi:[0,0,1]
    v_pk_fma_f32 v[114:115], v[114:115], s[58:59], v[10:11] neg_lo:[0,0,1] neg_hi:[0,0,1]
    v_pk_fma_f32 v[116:117], v[116:117], s[58:59], v[10:11] neg_lo:[0,0,1] neg_hi:[0,0,1]
    v_pk_fma_f32 v[118:119], v[118:119], s[58:59], v[10:11] neg_lo:[0,0,1] neg_hi:[0,0,1]
    v_mfma_f32_32x32x16_bf16 v[160:175], v[48:51], v[72:75], v[160:175]
    v_pk_fma_f32 v[120:121], v[120:121], s[58:59], v[10:11] neg_lo:[0,0,1] neg_hi:[0,0,1]
    v_pk_fma_f32 v[122:123], v[122:123], s[58:59], v[10:11] neg_lo:[0,0,1] neg_hi:[0,0,1]
    v_pk_fma_f32 v[124:125], v[124:125], s[58:59], v[10:11] neg_lo:[0,0,1] neg_hi:[0,0,1]
    v_pk_fma_f32 v[126:127], v[126:127], s[58:59], v[10:11] neg_lo:[0,0,1] neg_hi:[0,0,1]
    v_exp_f32 v112, v112
    v_exp_f32 v113, v113
    v_exp_f32 v114, v114
    v_exp_f32 v115, v115
    v_exp_f32 v116, v116
    v_mfma_f32_32x32x16_bf16 v[144:159], v[52:55], v[28:31], 0
    v_exp_f32 v117, v117
    v_exp_f32 v118, v118
    v_exp_f32 v119, v119
    v_exp_f32 v120, v120
    v_exp_f32 v121, v121
    v_exp_f32 v122, v122
    v_mfma_f32_32x32x16_bf16 v[144:159], v[56:59], v[32:35], v[144:159]
    v_exp_f32 v123, v123
    v_exp_f32 v124, v124
    v_exp_f32 v125, v125
    v_exp_f32 v126, v126
    v_exp_f32 v127, v127
    s_nop 0
    v_cvt_pk_bf16_f32 v76, v112, v113
    v_cvt_pk_bf16_f32 v77, v114, v115
    v_cvt_pk_bf16_f32 v78, v116, v117
    v_cvt_pk_bf16_f32 v79, v118, v119
    v_cvt_pk_bf16_f32 v80, v120, v121
    v_cvt_pk_bf16_f32 v81, v122, v123
    v_cvt_pk_bf16_f32 v82, v124, v125
    v_cvt_pk_bf16_f32 v83, v126, v127
    ds_read_b128 v[36:39], v19 offset:0
    ds_read_b128 v[40:43], v19 offset:1024
    s_waitcnt lgkmcnt(0)
    v_max3_f32 v12, v128, v129, v130
    v_max3_f32 v13, v131, v132, v133
    v_max3_f32 v12, v12, v134, v135
    v_max3_f32 v13, v13, v136, v137
    v_mfma_f32_32x32x16_bf16 v[176:191], v[44:47], v[76:79], v[176:191]
    v_max3_f32 v12, v12, v138, v139
    v_max3_f32 v13, v13, v140, v141
    v_max3_f32 v12, v12, v142, v143
    v_max_f32 v12, v12, v13
    v_mov_b32 v13, v12
    s_nop 1
    v_permlane32_swap_b32 v12, v13
    s_nop 0
    v_max_f32 v12, v12, v13
    v_fma_f32 v13, v12, s58, -v8
    v_cmp_gt_f32 vcc, v13, v17
    s_cbranch_vccnz ATrs_169
ATrb_170:
    v_pk_fma_f32 v[128:129], v[128:129], s[58:59], v[8:9] neg_lo:[0,0,1] neg_hi:[0,0,1]
    v_pk_fma_f32 v[130:131], v[130:131], s[58:59], v[8:9] neg_lo:[0,0,1] neg_hi:[0,0,1]
    v_pk_fma_f32 v[132:133], v[132:133], s[58:59], v[8:9] neg_lo:[0,0,1] neg_hi:[0,0,1]
    v_pk_fma_f32 v[134:135], v[134:135], s[58:59], v[8:9] neg_lo:[0,0,1] neg_hi:[0,0,1]
    v_mfma_f32_32x32x16_bf16 v[176:191], v[48:51], v[80:83], v[176:191]
    v_pk_fma_f32 v[136:137], v[136:137], s[58:59], v[8:9] neg_lo:[0,0,1] neg_hi:[0,0,1]
    v_pk_fma_f32 v[138:139], v[138:139], s[58:59], v[8:9] neg_lo:[0,0,1] neg_hi:[0,0,1]
    v_pk_fma_f32 v[140:141], v[140:141], s[58:59], v[8:9] neg_lo:[0,0,1] neg_hi:[0,0,1]
    v_pk_fma_f32 v[142:143], v[142:143], s[58:59], v[8:9] neg_lo:[0,0,1] neg_hi:[0,0,1]
    v_exp_f32 v128, v128
    v_exp_f32 v129, v129
    v_exp_f32 v130, v130
    v_exp_f32 v131, v131
    v_exp_f32 v132, v132
    v_mfma_f32_32x32x16_bf16 v[96:111], v[36:39], v[20:23], 0
    v_exp_f32 v133, v133
    v_exp_f32 v134, v134
    v_exp_f32 v135, v135
    v_exp_f32 v136, v136
    v_exp_f32 v137, v137
    v_exp_f32 v138, v138
    v_mfma_f32_32x32x16_bf16 v[96:111], v[40:43], v[24:27], v[96:111]
    v_exp_f32 v139, v139
    v_exp_f32 v140, v140
    v_exp_f32 v141, v141
    v_exp_f32 v142, v142
    v_exp_f32 v143, v143
    s_nop 0
    v_cvt_pk_bf16_f32 v68, v128, v129
    v_cvt_pk_bf16_f32 v69, v130, v131
    v_cvt_pk_bf16_f32 v70, v132, v133
    v_cvt_pk_bf16_f32 v71, v134, v135
    v_cvt_pk_bf16_f32 v72, v136, v137
    v_cvt_pk_bf16_f32 v73, v138, v139
    v_cvt_pk_bf16_f32 v74, v140, v141
    v_cvt_pk_bf16_f32 v75, v142, v143
    ds_read_b128 v[44:47], v19 offset:2048
    ds_read_b128 v[48:51], v19 offset:3072
    s_nop 0
    v_max3_f32 v12, v144, v145, v146
    v_max3_f32 v13, v147, v148, v149
    v_max3_f32 v12, v12, v150, v151
    v_max3_f32 v13, v13, v152, v153
    v_mfma_f32_32x32x16_bf16 v[160:175], v[60:63], v[68:71], v[160:175]
    v_max3_f32 v12, v12, v154, v155
    v_max3_f32 v13, v13, v156, v157
    v_max3_f32 v12, v12, v158, v159
    v_max_f32 v12, v12, v13
    v_mov_b32 v13, v12
    s_nop 1
    v_permlane32_swap_b32 v12, v13
    s_nop 0
    v_max_f32 v12, v12, v13
    v_fma_f32 v13, v12, s58, -v10
    v_cmp_gt_f32 vcc, v13, v17
    s_cbranch_vccnz ATrs_171
ATrb_172:
    v_pk_fma_f32 v[144:145], v[144:145], s[58:59], v[10:11] neg_lo:[0,0,1] neg_hi:[0,0,1]
    v_pk_fma_f32 v[146:147], v[146:147], s[58:59], v[10:11] neg_lo:[0,0,1] neg_hi:[0,0,1]
    v_pk_fma_f32 v[148:149], v[148:149], s[58:59], v[10:11] neg_lo:[0,0,1] neg_hi:[0,0,1]
    v_pk_fma_f32 v[150:151], v[150:151], s[58:59], v[10:11] neg_lo:[0,0,1] neg_hi:[0,0,1]
    v_mfma_f32_32x32x16_bf16 v[160:175], v[64:67], v[72:75], v[160:175]
    v_pk_fma_f32 v[152:153], v[152:153], s[58:59], v[10:11] neg_lo:[0,0,1] neg_hi:[0,0,1]
    v_pk_fma_f32 v[154:155], v[154:155], s[58:59], v[10:11] neg_lo:[0,0,1] neg_hi:[0,0,1]
    v_pk_fma_f32 v[156:157], v[156:157], s[58:59], v[10:11] neg_lo:[0,0,1] neg_hi:[0,0,1]
    v_pk_fma_f32 v[158:159], v[158:159], s[58:59], v[10:11] neg_lo:[0,0,1] neg_hi:[0,0,1]
    v_exp_f32 v144, v144
    v_exp_f32 v145, v145
    v_exp_f32 v146, v146
    v_exp_f32 v147, v147
    v_exp_f32 v148, v148
    v_mfma_f32_32x32x16_bf16 v[112:127], v[36:39], v[28:31], 0
    v_exp_f32 v149, v149
    v_exp_f32 v150, v150
    v_exp_f32 v151, v151
    v_exp_f32 v152, v152
    v_exp_f32 v153, v153
    v_exp_f32 v154, v154
    v_mfma_f32_32x32x16_bf16 v[112:127], v[40:43], v[32:35], v[112:127]
    v_exp_f32 v155, v155
    v_exp_f32 v156, v156
    v_exp_f32 v157, v157
    v_exp_f32 v158, v158
    v_exp_f32 v159, v159
    s_nop 0
    v_cvt_pk_bf16_f32 v76, v144, v145
    v_cvt_pk_bf16_f32 v77, v146, v147
    v_cvt_pk_bf16_f32 v78, v148, v149
    v_cvt_pk_bf16_f32 v79, v150, v151
    v_cvt_pk_bf16_f32 v80, v152, v153
    v_cvt_pk_bf16_f32 v81, v154, v155
    v_cvt_pk_bf16_f32 v82, v156, v157
    v_cvt_pk_bf16_f32 v83, v158, v159
    ds_read_b128 v[52:55], v19 offset:4096
    ds_read_b128 v[56:59], v19 offset:5120
    s_waitcnt lgkmcnt(0)
    v_max3_f32 v12, v96, v97, v98
    v_max3_f32 v13, v99, v100, v101
    v_max3_f32 v12, v12, v102, v103
    v_max3_f32 v13, v13, v104, v105
    v_mfma_f32_32x32x16_bf16 v[176:191], v[60:63], v[76:79], v[176:191]
    v_max3_f32 v12, v12, v106, v107
    v_max3_f32 v13, v13, v108, v109
    v_max3_f32 v12, v12, v110, v111
    v_max_f32 v12, v12, v13
    v_mov_b32 v13, v12
    s_nop 1
    v_permlane32_swap_b32 v12, v13
    s_nop 0
    v_max_f32 v12, v12, v13
    v_fma_f32 v13, v12, s58, -v8
    v_cmp_gt_f32 vcc, v13, v17
    s_cbranch_vccnz ATrs_173
ATrb_174:
    v_pk_fma_f32 v[96:97], v[96:97], s[58:59], v[8:9] neg_lo:[0,0,1] neg_hi:[0,0,1]
    v_pk_fma_f32 v[98:99], v[98:99], s[58:59], v[8:9] neg_lo:[0,0,1] neg_hi:[0,0,1]
    v_pk_fma_f32 v[100:101], v[100:101], s[58:59], v[8:9] neg_lo:[0,0,1] neg_hi:[0,0,1]
    v_pk_fma_f32 v[102:103], v[102:103], s[58:59], v[8:9] neg_lo:[0,0,1] neg_hi:[0,0,1]
    v_mfma_f32_32x32x16_bf16 v[176:191], v[64:67], v[80:83], v[176:191]
    v_pk_fma_f32 v[104:105], v[104:105], s[58:59], v[8:9] neg_lo:[0,0,1] neg_hi:[0,0,1]
    v_pk_fma_f32 v[106:107], v[106:107], s[58:59], v[8:9] neg_lo:[0,0,1] neg_hi:[0,0,1]
    v_pk_fma_f32 v[108:109], v[108:109], s[58:59], v[8:9] neg_lo:[0,0,1] neg_hi:[0,0,1]
    v_pk_fma_f32 v[110:111], v[110:111], s[58:59], v[8:9] neg_lo:[0,0,1] neg_hi:[0,0,1]
    v_exp_f32 v96, v96
    v_exp_f32 v97, v97
    v_exp_f32 v98, v98
    v_exp_f32 v99, v99
    v_exp_f32 v100, v100
    v_mfma_f32_32x32x16_bf16 v[128:143], v[52:55], v[20:23], 0
    v_exp_f32 v101, v101
    v_exp_f32 v102, v102
    v_exp_f32 v103, v103
    v_exp_f32 v104, v104
    v_exp_f32 v105, v105
    v_exp_f32 v106, v106
    v_mfma_f32_32x32x16_bf16 v[128:143], v[56:59], v[24:27], v[128:143]
    v_exp_f32 v107, v107
    v_exp_f32 v108, v108
    v_exp_f32 v109, v109
    v_exp_f32 v110, v110
    v_exp_f32 v111, v111
    s_nop 0
    v_cvt_pk_bf16_f32 v68, v96, v97
    v_cvt_pk_bf16_f32 v69, v98, v99
    v_cvt_pk_bf16_f32 v70, v100, v101
    v_cvt_pk_bf16_f32 v71, v102, v103
    v_cvt_pk_bf16_f32 v72, v104, v105
    v_cvt_pk_bf16_f32 v73, v106, v107
    v_cvt_pk_bf16_f32 v74, v108, v109
    v_cvt_pk_bf16_f32 v75, v110, v111
    ds_read_b128 v[60:63], v19 offset:6144
    ds_read_b128 v[64:67], v19 offset:7168
    s_nop 0
    v_max3_f32 v12, v112, v113, v114
    v_max3_f32 v13, v115, v116, v117
    v_max3_f32 v12, v12, v118, v119
    v_max3_f32 v13, v13, v120, v121
    v_mfma_f32_32x32x16_bf16 v[160:175], v[44:47], v[68:71], v[160:175]
    v_max3_f32 v12, v12, v122, v123
    v_max3_f32 v13, v13, v124, v125
    v_max3_f32 v12, v12, v126, v127
    v_max_f32 v12, v12, v13
    v_mov_b32 v13, v12
    s_nop 1
    v_permlane32_swap_b32 v12, v13
    s_nop 0
    v_max_f32 v12, v12, v13
    v_fma_f32 v13, v12, s58, -v10
    v_cmp_gt_f32 vcc, v13, v17
    s_cbranch_vccnz ATrs_175
ATrb_176:
    v_pk_fma_f32 v[112:113], v[112:113], s[58:59], v[10:11] neg_lo:[0,0,1] neg_hi:[0,0,1]
    v_pk_fma_f32 v[114:115], v[114:115], s[58:59], v[10:11] neg_lo:[0,0,1] neg_hi:[0,0,1]
    v_pk_fma_f32 v[116:117], v[116:117], s[58:59], v[10:11] neg_lo:[0,0,1] neg_hi:[0,0,1]
    v_pk_fma_f32 v[118:119], v[118:119], s[58:59], v[10:11] neg_lo:[0,0,1] neg_hi:[0,0,1]
    v_mfma_f32_32x32x16_bf16 v[160:175], v[48:51], v[72:75], v[160:175]
    v_pk_fma_f32 v[120:121], v[120:121], s[58:59], v[10:11] neg_lo:[0,0,1] neg_hi:[0,0,1]
    v_pk_fma_f32 v[122:123], v[122:123], s[58:59], v[10:11] neg_lo:[0,0,1] neg_hi:[0,0,1]
    v_pk_fma_f32 v[124:125], v[124:125], s[58:59], v[10:11] neg_lo:[0,0,1] neg_hi:[0,0,1]
    v_pk_fma_f32 v[126:127], v[126:127], s[58:59], v[10:11] neg_lo:[0,0,1] neg_hi:[0,0,1]
    v_exp_f32 v112, v112
    v_exp_f32 v113, v113
    v_exp_f32 v114, v114
    v_exp_f32 v115, v115
    v_exp_f32 v116, v116
    v_mfma_f32_32x32x16_bf16 v[144:159], v[52:55], v[28:31], 0
    v_exp_f32 v117, v117
    v_exp_f32 v118, v118
    v_exp_f32 v119, v119
    v_exp_f32 v120, v120
    v_exp_f32 v121, v121
    v_exp_f32 v122, v122
    v_mfma_f32_32x32x16_bf16 v[144:159], v[56:59], v[32:35], v[144:159]
    v_exp_f32 v123, v123
    v_exp_f32 v124, v124
    v_exp_f32 v125, v125
    v_exp_f32 v126, v126
    v_exp_f32 v127, v127
    s_nop 0
    v_cvt_pk_bf16_f32 v76, v112, v113
    v_cvt_pk_bf16_f32 v77, v114, v115
    v_cvt_pk_bf16_f32 v78, v116, v117
    v_cvt_pk_bf16_f32 v79, v118, v119
    v_cvt_pk_bf16_f32 v80, v120, v121
    v_cvt_pk_bf16_f32 v81, v122, v123
    v_cvt_pk_bf16_f32 v82, v124, v125
    v_cvt_pk_bf16_f32 v83, v126, v127
    ds_read_b128 v[36:39], v19 offset:8192
    ds_read_b128 v[40:43], v19 offset:9216
    s_waitcnt lgkmcnt(0)
    v_max3_f32 v12, v128, v129, v130
    v_max3_f32 v13, v131, v132, v133
    v_max3_f32 v12, v12, v134, v135
    v_max3_f32 v13, v13, v136, v137
    v_mfma_f32_32x32x16_bf16 v[176:191], v[44:47], v[76:79], v[176:191]
    v_max3_f32 v12, v12, v138, v139
    v_max3_f32 v13, v13, v140, v141
    v_max3_f32 v12, v12, v142, v143
    v_max_f32 v12, v12, v13
    v_mov_b32 v13, v12
    s_nop 1
    v_permlane32_swap_b32 v12, v13
    s_nop 0
    v_max_f32 v12, v12, v13
    v_fma_f32 v13, v12, s58, -v8
    v_cmp_gt_f32 vcc, v13, v17
    s_cbranch_vccnz ATrs_177
ATrb_178:
    v_pk_fma_f32 v[128:129], v[128:129], s[58:59], v[8:9] neg_lo:[0,0,1] neg_hi:[0,0,1]
    v_pk_fma_f32 v[130:131], v[130:131], s[58:59], v[8:9] neg_lo:[0,0,1] neg_hi:[0,0,1]
    v_pk_fma_f32 v[132:133], v[132:133], s[58:59], v[8:9] neg_lo:[0,0,1] neg_hi:[0,0,1]
    v_pk_fma_f32 v[134:135], v[134:135], s[58:59], v[8:9] neg_lo:[0,0,1] neg_hi:[0,0,1]
    v_mfma_f32_32x32x16_bf16 v[176:191], v[48:51], v[80:83], v[176:191]
    v_pk_fma_f32 v[136:137], v[136:137], s[58:59], v[8:9] neg_lo:[0,0,1] neg_hi:[0,0,1]
    v_pk_fma_f32 v[138:139], v[138:139], s[58:59], v[8:9] neg_lo:[0,0,1] neg_hi:[0,0,1]
    v_pk_fma_f32 v[140:141], v[140:141], s[58:59], v[8:9] neg_lo:[0,0,1] neg_hi:[0,0,1]
    v_pk_fma_f32 v[142:143], v[142:143], s[58:59], v[8:9] neg_lo:[0,0,1] neg_hi:[0,0,1]
    v_exp_f32 v128, v128
    v_exp_f32 v129, v129
    v_exp_f32 v130, v130
    v_exp_f32 v131, v131
    v_exp_f32 v132, v132
    v_mfma_f32_32x32x16_bf16 v[96:111], v[36:39], v[20:23], 0
    v_exp_f32 v133, v133
    v_exp_f32 v134, v134
    v_exp_f32 v135, v135
    v_exp_f32 v136, v136
    v_exp_f32 v137, v137
    v_exp_f32 v138, v138
    v_mfma_f32_32x32x16_bf16 v[96:111], v[40:43], v[24:27], v[96:111]
    v_exp_f32 v139, v139
    v_exp_f32 v140, v140
    v_exp_f32 v141, v141
    v_exp_f32 v142, v142
    v_exp_f32 v143, v143
    s_nop 0
    v_cvt_pk_bf16_f32 v68, v128, v129
    v_cvt_pk_bf16_f32 v69, v130, v131
    v_cvt_pk_bf16_f32 v70, v132, v133
    v_cvt_pk_bf16_f32 v71, v134, v135
    v_cvt_pk_bf16_f32 v72, v136, v137
    v_cvt_pk_bf16_f32 v73, v138, v139
    v_cvt_pk_bf16_f32 v74, v140, v141
    v_cvt_pk_bf16_f32 v75, v142, v143
    ds_read_b128 v[44:47], v19 offset:10240
    ds_read_b128 v[48:51], v19 offset:11264
    s_nop 0
    v_max3_f32 v12, v144, v145, v146
    v_max3_f32 v13, v147, v148, v149
    v_max3_f32 v12, v12, v150, v151
    v_max3_f32 v13, v13, v152, v153
    v_mfma_f32_32x32x16_bf16 v[160:175], v[60:63], v[68:71], v[160:175]
    v_max3_f32 v12, v12, v154, v155
    v_max3_f32 v13, v13, v156, v157
    v_max3_f32 v12, v12, v158, v159
    v_max_f32 v12, v12, v13
    v_mov_b32 v13, v12
    s_nop 1
    v_permlane32_swap_b32 v12, v13
    s_nop 0
    v_max_f32 v12, v12, v13
    v_fma_f32 v13, v12, s58, -v10
    v_cmp_gt_f32 vcc, v13, v17
    s_cbranch_vccnz ATrs_179
ATrb_180:
    v_pk_fma_f32 v[144:145], v[144:145], s[58:59], v[10:11] neg_lo:[0,0,1] neg_hi:[0,0,1]
    v_pk_fma_f32 v[146:147], v[146:147], s[58:59], v[10:11] neg_lo:[0,0,1] neg_hi:[0,0,1]
    v_pk_fma_f32 v[148:149], v[148:149], s[58:59], v[10:11] neg_lo:[0,0,1] neg_hi:[0,0,1]
    v_pk_fma_f32 v[150:151], v[150:151], s[58:59], v[10:11] neg_lo:[0,0,1] neg_hi:[0,0,1]
    v_mfma_f32_32x32x16_bf16 v[160:175], v[64:67], v[72:75], v[160:175]
    v_pk_fma_f32 v[152:153], v[152:153], s[58:59], v[10:11] neg_lo:[0,0,1] neg_hi:[0,0,1]
    v_pk_fma_f32 v[154:155], v[154:155], s[58:59], v[10:11] neg_lo:[0,0,1] neg_hi:[0,0,1]
    v_pk_fma_f32 v[156:157], v[156:157], s[58:59], v[10:11] neg_lo:[0,0,1] neg_hi:[0,0,1]
    v_pk_fma_f32 v[158:159], v[158:159], s[58:59], v[10:11] neg_lo:[0,0,1] neg_hi:[0,0,1]
    v_exp_f32 v144, v144
    v_exp_f32 v145, v145
    v_exp_f32 v146, v146
    v_exp_f32 v147, v147
    v_exp_f32 v148, v148
    v_mfma_f32_32x32x16_bf16 v[112:127], v[36:39], v[28:31], 0
    v_exp_f32 v149, v149
    v_exp_f32 v150, v150
    v_exp_f32 v151, v151
    v_exp_f32 v152, v152
    v_exp_f32 v153, v153
    v_exp_f32 v154, v154
    v_mfma_f32_32x32x16_bf16 v[112:127], v[40:43], v[32:35], v[112:127]
    v_exp_f32 v155, v155
    v_exp_f32 v156, v156
    v_exp_f32 v157, v157
    v_exp_f32 v158, v158
    v_exp_f32 v159, v159
    s_nop 0
    v_cvt_pk_bf16_f32 v76, v144, v145
    v_cvt_pk_bf16_f32 v77, v146, v147
    v_cvt_pk_bf16_f32 v78, v148, v149
    v_cvt_pk_bf16_f32 v79, v150, v151
    v_cvt_pk_bf16_f32 v80, v152, v153
    v_cvt_pk_bf16_f32 v81, v154, v155
    v_cvt_pk_bf16_f32 v82, v156, v157
    v_cvt_pk_bf16_f32 v83, v158, v159
    ds_read_b128 v[52:55], v19 offset:12288
    ds_read_b128 v[56:59], v19 offset:13312
    s_waitcnt lgkmcnt(0)
    v_max3_f32 v12, v96, v97, v98
    v_max3_f32 v13, v99, v100, v101
    v_max3_f32 v12, v12, v102, v103
    v_max3_f32 v13, v13, v104, v105
    v_mfma_f32_32x32x16_bf16 v[176:191], v[60:63], v[76:79], v[176:191]
    v_max3_f32 v12, v12, v106, v107
    v_max3_f32 v13, v13, v108, v109
    v_max3_f32 v12, v12, v110, v111
    v_max_f32 v12, v12, v13
    v_mov_b32 v13, v12
    s_nop 1
    v_permlane32_swap_b32 v12, v13
    s_nop 0
    v_max_f32 v12, v12, v13
    v_fma_f32 v13, v12, s58, -v8
    v_cmp_gt_f32 vcc, v13, v17
    s_cbranch_vccnz ATrs_181
ATrb_182:
    v_pk_fma_f32 v[96:97], v[96:97], s[58:59], v[8:9] neg_lo:[0,0,1] neg_hi:[0,0,1]
    v_pk_fma_f32 v[98:99], v[98:99], s[58:59], v[8:9] neg_lo:[0,0,1] neg_hi:[0,0,1]
    v_pk_fma_f32 v[100:101], v[100:101], s[58:59], v[8:9] neg_lo:[0,0,1] neg_hi:[0,0,1]
    v_pk_fma_f32 v[102:103], v[102:103], s[58:59], v[8:9] neg_lo:[0,0,1] neg_hi:[0,0,1]
    v_mfma_f32_32x32x16_bf16 v[176:191], v[64:67], v[80:83], v[176:191]
    v_pk_fma_f32 v[104:105], v[104:105], s[58:59], v[8:9] neg_lo:[0,0,1] neg_hi:[0,0,1]
    v_pk_fma_f32 v[106:107], v[106:107], s[58:59], v[8:9] neg_lo:[0,0,1] neg_hi:[0,0,1]
    v_pk_fma_f32 v[108:109], v[108:109], s[58:59], v[8:9] neg_lo:[0,0,1] neg_hi:[0,0,1]
    v_pk_fma_f32 v[110:111], v[110:111], s[58:59], v[8:9] neg_lo:[0,0,1] neg_hi:[0,0,1]
    v_exp_f32 v96, v96
    v_exp_f32 v97, v97
    v_exp_f32 v98, v98
    v_exp_f32 v99, v99
    v_exp_f32 v100, v100
    v_mfma_f32_32x32x16_bf16 v[128:143], v[52:55], v[20:23], 0
    v_exp_f32 v101, v101
    v_exp_f32 v102, v102
    v_exp_f32 v103, v103
    v_exp_f32 v104, v104
    v_exp_f32 v105, v105
    v_exp_f32 v106, v106
    v_mfma_f32_32x32x16_bf16 v[128:143], v[56:59], v[24:27], v[128:143]
    v_exp_f32 v107, v107
    v_exp_f32 v108, v108
    v_exp_f32 v109, v109
    v_exp_f32 v110, v110
    v_exp_f32 v111, v111
    s_nop 0
    v_cvt_pk_bf16_f32 v68, v96, v97
    v_cvt_pk_bf16_f32 v69, v98, v99
    v_cvt_pk_bf16_f32 v70, v100, v101
    v_cvt_pk_bf16_f32 v71, v102, v103
    v_cvt_pk_bf16_f32 v72, v104, v105
    v_cvt_pk_bf16_f32 v73, v106, v107
    v_cvt_pk_bf16_f32 v74, v108, v109
    v_cvt_pk_bf16_f32 v75, v110, v111
    ds_read_b128 v[60:63], v19 offset:14336
    ds_read_b128 v[64:67], v19 offset:15360
    s_nop 0
    v_max3_f32 v12, v112, v113, v114
    v_max3_f32 v13, v115, v116, v117
    v_max3_f32 v12, v12, v118, v119
    v_max3_f32 v13, v13, v120, v121
    v_mfma_f32_32x32x16_bf16 v[160:175], v[44:47], v[68:71], v[160:175]
    v_max3_f32 v12, v12, v122, v123
    v_max3_f32 v13, v13, v124, v125
    v_max3_f32 v12, v12, v126, v127
    v_max_f32 v12, v12, v13
    v_mov_b32 v13, v12
    s_nop 1
    v_permlane32_swap_b32 v12, v13
    s_nop 0
    v_max_f32 v12, v12, v13
    v_fma_f32 v13, v12, s58, -v10
    v_cmp_gt_f32 vcc, v13, v17
    s_cbranch_vccnz ATrs_183
ATrb_184:
    v_pk_fma_f32 v[112:113], v[112:113], s[58:59], v[10:11] neg_lo:[0,0,1] neg_hi:[0,0,1]
    v_pk_fma_f32 v[114:115], v[114:115], s[58:59], v[10:11] neg_lo:[0,0,1] neg_hi:[0,0,1]
    v_pk_fma_f32 v[116:117], v[116:117], s[58:59], v[10:11] neg_lo:[0,0,1] neg_hi:[0,0,1]
    v_pk_fma_f32 v[118:119], v[118:119], s[58:59], v[10:11] neg_lo:[0,0,1] neg_hi:[0,0,1]
    v_mfma_f32_32x32x16_bf16 v[160:175], v[48:51], v[72:75], v[160:175]
    v_pk_fma_f32 v[120:121], v[120:121], s[58:59], v[10:11] neg_lo:[0,0,1] neg_hi:[0,0,1]
    v_pk_fma_f32 v[122:123], v[122:123], s[58:59], v[10:11] neg_lo:[0,0,1] neg_hi:[0,0,1]
    v_pk_fma_f32 v[124:125], v[124:125], s[58:59], v[10:11] neg_lo:[0,0,1] neg_hi:[0,0,1]
    v_pk_fma_f32 v[126:127], v[126:127], s[58:59], v[10:11] neg_lo:[0,0,1] neg_hi:[0,0,1]
    v_exp_f32 v112, v112
    v_exp_f32 v113, v113
    v_exp_f32 v114, v114
    v_exp_f32 v115, v115
    v_exp_f32 v116, v116
    v_mfma_f32_32x32x16_bf16 v[144:159], v[52:55], v[28:31], 0
    v_exp_f32 v117, v117
    v_exp_f32 v118, v118
    v_exp_f32 v119, v119
    v_exp_f32 v120, v120
    v_exp_f32 v121, v121
    v_exp_f32 v122, v122
    v_mfma_f32_32x32x16_bf16 v[144:159], v[56:59], v[32:35], v[144:159]
    v_exp_f32 v123, v123
    v_exp_f32 v124, v124
    v_exp_f32 v125, v125
    v_exp_f32 v126, v126
    v_exp_f32 v127, v127
    s_nop 0
    v_cvt_pk_bf16_f32 v76, v112, v113
    v_cvt_pk_bf16_f32 v77, v114, v115
    v_cvt_pk_bf16_f32 v78, v116, v117
    v_cvt_pk_bf16_f32 v79, v118, v119
    v_cvt_pk_bf16_f32 v80, v120, v121
    v_cvt_pk_bf16_f32 v81, v122, v123
    v_cvt_pk_bf16_f32 v82, v124, v125
    v_cvt_pk_bf16_f32 v83, v126, v127
    ds_read_b128 v[36:39], v19 offset:16384
    ds_read_b128 v[40:43], v19 offset:17408
    s_waitcnt lgkmcnt(0)
    v_max3_f32 v12, v128, v129, v130
    v_max3_f32 v13, v131, v132, v133
    v_max3_f32 v12, v12, v134, v135
    v_max3_f32 v13, v13, v136, v137
    v_mfma_f32_32x32x16_bf16 v[176:191], v[44:47], v[76:79], v[176:191]
    v_max3_f32 v12, v12, v138, v139
    v_max3_f32 v13, v13, v140, v141
    v_max3_f32 v12, v12, v142, v143
    v_max_f32 v12, v12, v13
    v_mov_b32 v13, v12
    s_nop 1
    v_permlane32_swap_b32 v12, v13
    s_nop 0
    v_max_f32 v12, v12, v13
    v_fma_f32 v13, v12, s58, -v8
    v_cmp_gt_f32 vcc, v13, v17
    s_cbranch_vccnz ATrs_185
ATrb_186:
    v_pk_fma_f32 v[128:129], v[128:129], s[58:59], v[8:9] neg_lo:[0,0,1] neg_hi:[0,0,1]
    v_pk_fma_f32 v[130:131], v[130:131], s[58:59], v[8:9] neg_lo:[0,0,1] neg_hi:[0,0,1]
    v_pk_fma_f32 v[132:133], v[132:133], s[58:59], v[8:9] neg_lo:[0,0,1] neg_hi:[0,0,1]
    v_pk_fma_f32 v[134:135], v[134:135], s[58:59], v[8:9] neg_lo:[0,0,1] neg_hi:[0,0,1]
    v_mfma_f32_32x32x16_bf16 v[176:191], v[48:51], v[80:83], v[176:191]
    v_pk_fma_f32 v[136:137], v[136:137], s[58:59], v[8:9] neg_lo:[0,0,1] neg_hi:[0,0,1]
    v_pk_fma_f32 v[138:139], v[138:139], s[58:59], v[8:9] neg_lo:[0,0,1] neg_hi:[0,0,1]
    v_pk_fma_f32 v[140:141], v[140:141], s[58:59], v[8:9] neg_lo:[0,0,1] neg_hi:[0,0,1]
    v_pk_fma_f32 v[142:143], v[142:143], s[58:59], v[8:9] neg_lo:[0,0,1] neg_hi:[0,0,1]
    v_exp_f32 v128, v128
    v_exp_f32 v129, v129
    v_exp_f32 v130, v130
    v_exp_f32 v131, v131
    v_exp_f32 v132, v132
    v_mfma_f32_32x32x16_bf16 v[96:111], v[36:39], v[20:23], 0
    v_exp_f32 v133, v133
    v_exp_f32 v134, v134
    v_exp_f32 v135, v135
    v_exp_f32 v136, v136
    v_exp_f32 v137, v137
    v_exp_f32 v138, v138
    v_mfma_f32_32x32x16_bf16 v[96:111], v[40:43], v[24:27], v[96:111]
    v_exp_f32 v139, v139
    v_exp_f32 v140, v140
    v_exp_f32 v141, v141
    v_exp_f32 v142, v142
    v_exp_f32 v143, v143
    s_nop 0
    v_cvt_pk_bf16_f32 v68, v128, v129
    v_cvt_pk_bf16_f32 v69, v130, v131
    v_cvt_pk_bf16_f32 v70, v132, v133
    v_cvt_pk_bf16_f32 v71, v134, v135
    v_cvt_pk_bf16_f32 v72, v136, v137
    v_cvt_pk_bf16_f32 v73, v138, v139
    v_cvt_pk_bf16_f32 v74, v140, v141
    v_cvt_pk_bf16_f32 v75, v142, v143
    ds_read_b128 v[44:47], v19 offset:18432
    ds_read_b128 v[48:51], v19 offset:19456
    s_nop 0
    v_max3_f32 v12, v144, v145, v146
    v_max3_f32 v13, v147, v148, v149
    v_max3_f32 v12, v12, v150, v151
    v_max3_f32 v13, v13, v152, v153
    v_mfma_f32_32x32x16_bf16 v[160:175], v[60:63], v[68:71], v[160:175]
    v_max3_f32 v12, v12, v154, v155
    v_max3_f32 v13, v13, v156, v157
    v_max3_f32 v12, v12, v158, v159
    v_max_f32 v12, v12, v13
    v_mov_b32 v13, v12
    s_nop 1
    v_permlane32_swap_b32 v12, v13
    s_nop 0
    v_max_f32 v12, v12, v13
    v_fma_f32 v13, v12, s58, -v10
    v_cmp_gt_f32 vcc, v13, v17
    s_cbranch_vccnz ATrs_187
ATrb_188:
    v_pk_fma_f32 v[144:145], v[144:145], s[58:59], v[10:11] neg_lo:[0,0,1] neg_hi:[0,0,1]
    v_pk_fma_f32 v[146:147], v[146:147], s[58:59], v[10:11] neg_lo:[0,0,1] neg_hi:[0,0,1]
    v_pk_fma_f32 v[148:149], v[148:149], s[58:59], v[10:11] neg_lo:[0,0,1] neg_hi:[0,0,1]
    v_pk_fma_f32 v[150:151], v[150:151], s[58:59], v[10:11] neg_lo:[0,0,1] neg_hi:[0,0,1]
    v_mfma_f32_32x32x16_bf16 v[160:175], v[64:67], v[72:75], v[160:175]
    v_pk_fma_f32 v[152:153], v[152:153], s[58:59], v[10:11] neg_lo:[0,0,1] neg_hi:[0,0,1]
    v_pk_fma_f32 v[154:155], v[154:155], s[58:59], v[10:11] neg_lo:[0,0,1] neg_hi:[0,0,1]
    v_pk_fma_f32 v[156:157], v[156:157], s[58:59], v[10:11] neg_lo:[0,0,1] neg_hi:[0,0,1]
    v_pk_fma_f32 v[158:159], v[158:159], s[58:59], v[10:11] neg_lo:[0,0,1] neg_hi:[0,0,1]
    v_exp_f32 v144, v144
    v_exp_f32 v145, v145
    v_exp_f32 v146, v146
    v_exp_f32 v147, v147
    v_exp_f32 v148, v148
    v_mfma_f32_32x32x16_bf16 v[112:127], v[36:39], v[28:31], 0
    v_exp_f32 v149, v149
    v_exp_f32 v150, v150
    v_exp_f32 v151, v151
    v_exp_f32 v152, v152
    v_exp_f32 v153, v153
    v_exp_f32 v154, v154
    v_mfma_f32_32x32x16_bf16 v[112:127], v[40:43], v[32:35], v[112:127]
    v_exp_f32 v155, v155
    v_exp_f32 v156, v156
    v_exp_f32 v157, v157
    v_exp_f32 v158, v158
    v_exp_f32 v159, v159
    s_nop 0
    v_cvt_pk_bf16_f32 v76, v144, v145
    v_cvt_pk_bf16_f32 v77, v146, v147
    v_cvt_pk_bf16_f32 v78, v148, v149
    v_cvt_pk_bf16_f32 v79, v150, v151
    v_cvt_pk_bf16_f32 v80, v152, v153
    v_cvt_pk_bf16_f32 v81, v154, v155
    v_cvt_pk_bf16_f32 v82, v156, v157
    v_cvt_pk_bf16_f32 v83, v158, v159
    ds_read_b128 v[52:55], v19 offset:20480
    ds_read_b128 v[56:59], v19 offset:21504
    s_waitcnt lgkmcnt(0)
    v_max3_f32 v12, v96, v97, v98
    v_max3_f32 v13, v99, v100, v101
    v_max3_f32 v12, v12, v102, v103
    v_max3_f32 v13, v13, v104, v105
    v_mfma_f32_32x32x16_bf16 v[176:191], v[60:63], v[76:79], v[176:191]
    v_max3_f32 v12, v12, v106, v107
    v_max3_f32 v13, v13, v108, v109
    v_max3_f32 v12, v12, v110, v111
    v_max_f32 v12, v12, v13
    v_mov_b32 v13, v12
    s_nop 1
    v_permlane32_swap_b32 v12, v13
    s_nop 0
    v_max_f32 v12, v12, v13
    v_fma_f32 v13, v12, s58, -v8
    v_cmp_gt_f32 vcc, v13, v17
    s_cbranch_vccnz ATrs_189
ATrb_190:
    v_pk_fma_f32 v[96:97], v[96:97], s[58:59], v[8:9] neg_lo:[0,0,1] neg_hi:[0,0,1]
    v_pk_fma_f32 v[98:99], v[98:99], s[58:59], v[8:9] neg_lo:[0,0,1] neg_hi:[0,0,1]
    v_pk_fma_f32 v[100:101], v[100:101], s[58:59], v[8:9] neg_lo:[0,0,1] neg_hi:[0,0,1]
    v_pk_fma_f32 v[102:103], v[102:103], s[58:59], v[8:9] neg_lo:[0,0,1] neg_hi:[0,0,1]
    v_mfma_f32_32x32x16_bf16 v[176:191], v[64:67], v[80:83], v[176:191]
    v_pk_fma_f32 v[104:105], v[104:105], s[58:59], v[8:9] neg_lo:[0,0,1] neg_hi:[0,0,1]
    v_pk_fma_f32 v[106:107], v[106:107], s[58:59], v[8:9] neg_lo:[0,0,1] neg_hi:[0,0,1]
    v_pk_fma_f32 v[108:109], v[108:109], s[58:59], v[8:9] neg_lo:[0,0,1] neg_hi:[0,0,1]
    v_pk_fma_f32 v[110:111], v[110:111], s[58:59], v[8:9] neg_lo:[0,0,1] neg_hi:[0,0,1]
    v_exp_f32 v96, v96
    v_exp_f32 v97, v97
    v_exp_f32 v98, v98
    v_exp_f32 v99, v99
    v_exp_f32 v100, v100
    v_mfma_f32_32x32x16_bf16 v[128:143], v[52:55], v[20:23], 0
    v_exp_f32 v101, v101
    v_exp_f32 v102, v102
    v_exp_f32 v103, v103
    v_exp_f32 v104, v104
    v_exp_f32 v105, v105
    v_exp_f32 v106, v106
    v_mfma_f32_32x32x16_bf16 v[128:143], v[56:59], v[24:27], v[128:143]
    v_exp_f32 v107, v107
    v_exp_f32 v108, v108
    v_exp_f32 v109, v109
    v_exp_f32 v110, v110
    v_exp_f32 v111, v111
    s_nop 0
    v_cvt_pk_bf16_f32 v68, v96, v97
    v_cvt_pk_bf16_f32 v69, v98, v99
    v_cvt_pk_bf16_f32 v70, v100, v101
    v_cvt_pk_bf16_f32 v71, v102, v103
    v_cvt_pk_bf16_f32 v72, v104, v105
    v_cvt_pk_bf16_f32 v73, v106, v107
    v_cvt_pk_bf16_f32 v74, v108, v109
    v_cvt_pk_bf16_f32 v75, v110, v111
    ds_read_b128 v[60:63], v19 offset:22528
    ds_read_b128 v[64:67], v19 offset:23552
    s_nop 0
    v_max3_f32 v12, v112, v113, v114
    v_max3_f32 v13, v115, v116, v117
    v_max3_f32 v12, v12, v118, v119
    v_max3_f32 v13, v13, v120, v121
    v_mfma_f32_32x32x16_bf16 v[160:175], v[44:47], v[68:71], v[160:175]
    v_max3_f32 v12, v12, v122, v123
    v_max3_f32 v13, v13, v124, v125
    v_max3_f32 v12, v12, v126, v127
    v_max_f32 v12, v12, v13
    v_mov_b32 v13, v12
    s_nop 1
    v_permlane32_swap_b32 v12, v13
    s_nop 0
    v_max_f32 v12, v12, v13
    v_fma_f32 v13, v12, s58, -v10
    v_cmp_gt_f32 vcc, v13, v17
    s_cbranch_vccnz ATrs_191
ATrb_192:
    v_pk_fma_f32 v[112:113], v[112:113], s[58:59], v[10:11] neg_lo:[0,0,1] neg_hi:[0,0,1]
    v_pk_fma_f32 v[114:115], v[114:115], s[58:59], v[10:11] neg_lo:[0,0,1] neg_hi:[0,0,1]
    v_pk_fma_f32 v[116:117], v[116:117], s[58:59], v[10:11] neg_lo:[0,0,1] neg_hi:[0,0,1]
    v_pk_fma_f32 v[118:119], v[118:119], s[58:59], v[10:11] neg_lo:[0,0,1] neg_hi:[0,0,1]
    v_mfma_f32_32x32x16_bf16 v[160:175], v[48:51], v[72:75], v[160:175]
    v_pk_fma_f32 v[120:121], v[120:121], s[58:59], v[10:11] neg_lo:[0,0,1] neg_hi:[0,0,1]
    v_pk_fma_f32 v[122:123], v[122:123], s[58:59], v[10:11] neg_lo:[0,0,1] neg_hi:[0,0,1]
    v_pk_fma_f32 v[124:125], v[124:125], s[58:59], v[10:11] neg_lo:[0,0,1] neg_hi:[0,0,1]
    v_pk_fma_f32 v[126:127], v[126:127], s[58:59], v[10:11] neg_lo:[0,0,1] neg_hi:[0,0,1]
    v_exp_f32 v112, v112
    v_exp_f32 v113, v113
    v_exp_f32 v114, v114
    v_exp_f32 v115, v115
    v_exp_f32 v116, v116
    v_mfma_f32_32x32x16_bf16 v[144:159], v[52:55], v[28:31], 0
    v_exp_f32 v117, v117
    v_exp_f32 v118, v118
    v_exp_f32 v119, v119
    v_exp_f32 v120, v120
    v_exp_f32 v121, v121
    v_exp_f32 v122, v122
    v_mfma_f32_32x32x16_bf16 v[144:159], v[56:59], v[32:35], v[144:159]
    v_exp_f32 v123, v123
    v_exp_f32 v124, v124
    v_exp_f32 v125, v125
    v_exp_f32 v126, v126
    v_exp_f32 v127, v127
    s_nop 0
    v_cvt_pk_bf16_f32 v76, v112, v113
    v_cvt_pk_bf16_f32 v77, v114, v115
    v_cvt_pk_bf16_f32 v78, v116, v117
    v_cvt_pk_bf16_f32 v79, v118, v119
    v_cvt_pk_bf16_f32 v80, v120, v121
    v_cvt_pk_bf16_f32 v81, v122, v123
    v_cvt_pk_bf16_f32 v82, v124, v125
    v_cvt_pk_bf16_f32 v83, v126, v127
    ds_read_b128 v[36:39], v19 offset:24576
    ds_read_b128 v[40:43], v19 offset:25600
    s_waitcnt lgkmcnt(0)
    v_max3_f32 v12, v128, v129, v130
    v_max3_f32 v13, v131, v132, v133
    v_max3_f32 v12, v12, v134, v135
    v_max3_f32 v13, v13, v136, v137
    v_mfma_f32_32x32x16_bf16 v[176:191], v[44:47], v[76:79], v[176:191]
    v_max3_f32 v12, v12, v138, v139
    v_max3_f32 v13, v13, v140, v141
    v_max3_f32 v12, v12, v142, v143
    v_max_f32 v12, v12, v13
    v_mov_b32 v13, v12
    s_nop 1
    v_permlane32_swap_b32 v12, v13
    s_nop 0
    v_max_f32 v12, v12, v13
    v_fma_f32 v13, v12, s58, -v8
    v_cmp_gt_f32 vcc, v13, v17
    s_cbranch_vccnz ATrs_193
ATrb_194:
    v_pk_fma_f32 v[128:129], v[128:129], s[58:59], v[8:9] neg_lo:[0,0,1] neg_hi:[0,0,1]
    v_pk_fma_f32 v[130:131], v[130:131], s[58:59], v[8:9] neg_lo:[0,0,1] neg_hi:[0,0,1]
    v_pk_fma_f32 v[132:133], v[132:133], s[58:59], v[8:9] neg_lo:[0,0,1] neg_hi:[0,0,1]
    v_pk_fma_f32 v[134:135], v[134:135], s[58:59], v[8:9] neg_lo:[0,0,1] neg_hi:[0,0,1]
    v_mfma_f32_32x32x16_bf16 v[176:191], v[48:51], v[80:83], v[176:191]
    v_pk_fma_f32 v[136:137], v[136:137], s[58:59], v[8:9] neg_lo:[0,0,1] neg_hi:[0,0,1]
    v_pk_fma_f32 v[138:139], v[138:139], s[58:59], v[8:9] neg_lo:[0,0,1] neg_hi:[0,0,1]
    v_pk_fma_f32 v[140:141], v[140:141], s[58:59], v[8:9] neg_lo:[0,0,1] neg_hi:[0,0,1]
    v_pk_fma_f32 v[142:143], v[142:143], s[58:59], v[8:9] neg_lo:[0,0,1] neg_hi:[0,0,1]
    v_exp_f32 v128, v128
    v_exp_f32 v129, v129
    v_exp_f32 v130, v130
    v_exp_f32 v131, v131
    v_exp_f32 v132, v132
    v_mfma_f32_32x32x16_bf16 v[96:111], v[36:39], v[20:23], 0
    v_exp_f32 v133, v133
    v_exp_f32 v134, v134
    v_exp_f32 v135, v135
    v_exp_f32 v136, v136
    v_exp_f32 v137, v137
    v_exp_f32 v138, v138
    v_mfma_f32_32x32x16_bf16 v[96:111], v[40:43], v[24:27], v[96:111]
    v_exp_f32 v139, v139
    v_exp_f32 v140, v140
    v_exp_f32 v141, v141
    v_exp_f32 v142, v142
    v_exp_f32 v143, v143
    s_nop 0
    v_cvt_pk_bf16_f32 v68, v128, v129
    v_cvt_pk_bf16_f32 v69, v130, v131
    v_cvt_pk_bf16_f32 v70, v132, v133
    v_cvt_pk_bf16_f32 v71, v134, v135
    v_cvt_pk_bf16_f32 v72, v136, v137
    v_cvt_pk_bf16_f32 v73, v138, v139
    v_cvt_pk_bf16_f32 v74, v140, v141
    v_cvt_pk_bf16_f32 v75, v142, v143
    ds_read_b128 v[44:47], v19 offset:26624
    ds_read_b128 v[48:51], v19 offset:27648
    s_nop 0
    v_max3_f32 v12, v144, v145, v146
    v_max3_f32 v13, v147, v148, v149
    v_max3_f32 v12, v12, v150, v151
    v_max3_f32 v13, v13, v152, v153
    v_mfma_f32_32x32x16_bf16 v[160:175], v[60:63], v[68:71], v[160:175]
    v_max3_f32 v12, v12, v154, v155
    v_max3_f32 v13, v13, v156, v157
    v_max3_f32 v12, v12, v158, v159
    v_max_f32 v12, v12, v13
    v_mov_b32 v13, v12
    s_nop 1
    v_permlane32_swap_b32 v12, v13
    s_nop 0
    v_max_f32 v12, v12, v13
    v_fma_f32 v13, v12, s58, -v10
    v_cmp_gt_f32 vcc, v13, v17
    s_cbranch_vccnz ATrs_195
ATrb_196:
    v_pk_fma_f32 v[144:145], v[144:145], s[58:59], v[10:11] neg_lo:[0,0,1] neg_hi:[0,0,1]
    v_pk_fma_f32 v[146:147], v[146:147], s[58:59], v[10:11] neg_lo:[0,0,1] neg_hi:[0,0,1]
    v_pk_fma_f32 v[148:149], v[148:149], s[58:59], v[10:11] neg_lo:[0,0,1] neg_hi:[0,0,1]
    v_pk_fma_f32 v[150:151], v[150:151], s[58:59], v[10:11] neg_lo:[0,0,1] neg_hi:[0,0,1]
    v_mfma_f32_32x32x16_bf16 v[160:175], v[64:67], v[72:75], v[160:175]
    v_pk_fma_f32 v[152:153], v[152:153], s[58:59], v[10:11] neg_lo:[0,0,1] neg_hi:[0,0,1]
    v_pk_fma_f32 v[154:155], v[154:155], s[58:59], v[10:11] neg_lo:[0,0,1] neg_hi:[0,0,1]
    v_pk_fma_f32 v[156:157], v[156:157], s[58:59], v[10:11] neg_lo:[0,0,1] neg_hi:[0,0,1]
    v_pk_fma_f32 v[158:159], v[158:159], s[58:59], v[10:11] neg_lo:[0,0,1] neg_hi:[0,0,1]
    v_exp_f32 v144, v144
    v_exp_f32 v145, v145
    v_exp_f32 v146, v146
    v_exp_f32 v147, v147
    v_exp_f32 v148, v148
    v_mfma_f32_32x32x16_bf16 v[112:127], v[36:39], v[28:31], 0
    v_exp_f32 v149, v149
    v_exp_f32 v150, v150
    v_exp_f32 v151, v151
    v_exp_f32 v152, v152
    v_exp_f32 v153, v153
    v_exp_f32 v154, v154
    v_mfma_f32_32x32x16_bf16 v[112:127], v[40:43], v[32:35], v[112:127]
    v_exp_f32 v155, v155
    v_exp_f32 v156, v156
    v_exp_f32 v157, v157
    v_exp_f32 v158, v158
    v_exp_f32 v159, v159
    s_nop 0
    v_cvt_pk_bf16_f32 v76, v144, v145
    v_cvt_pk_bf16_f32 v77, v146, v147
    v_cvt_pk_bf16_f32 v78, v148, v149
    v_cvt_pk_bf16_f32 v79, v150, v151
    v_cvt_pk_bf16_f32 v80, v152, v153
    v_cvt_pk_bf16_f32 v81, v154, v155
    v_cvt_pk_bf16_f32 v82, v156, v157
    v_cvt_pk_bf16_f32 v83, v158, v159
    ds_read_b128 v[52:55], v19 offset:28672
    ds_read_b128 v[56:59], v19 offset:29696
    s_waitcnt lgkmcnt(0)
    v_max3_f32 v12, v96, v97, v98
    v_max3_f32 v13, v99, v100, v101
    v_max3_f32 v12, v12, v102, v103
    v_max3_f32 v13, v13, v104, v105
    v_mfma_f32_32x32x16_bf16 v[176:191], v[60:63], v[76:79], v[176:191]
    v_max3_f32 v12, v12, v106, v107
    v_max3_f32 v13, v13, v108, v109
    v_max3_f32 v12, v12, v110, v111
    v_max_f32 v12, v12, v13
    v_mov_b32 v13, v12
    s_nop 1
    v_permlane32_swap_b32 v12, v13
    s_nop 0
    v_max_f32 v12, v12, v13
    v_fma_f32 v13, v12, s58, -v8
    v_cmp_gt_f32 vcc, v13, v17
    s_cbranch_vccnz ATrs_197
ATrb_198:
    v_pk_fma_f32 v[96:97], v[96:97], s[58:59], v[8:9] neg_lo:[0,0,1] neg_hi:[0,0,1]
    v_pk_fma_f32 v[98:99], v[98:99], s[58:59], v[8:9] neg_lo:[0,0,1] neg_hi:[0,0,1]
    v_pk_fma_f32 v[100:101], v[100:101], s[58:59], v[8:9] neg_lo:[0,0,1] neg_hi:[0,0,1]
    v_pk_fma_f32 v[102:103], v[102:103], s[58:59], v[8:9] neg_lo:[0,0,1] neg_hi:[0,0,1]
    v_mfma_f32_32x32x16_bf16 v[176:191], v[64:67], v[80:83], v[176:191]
    v_pk_fma_f32 v[104:105], v[104:105], s[58:59], v[8:9] neg_lo:[0,0,1] neg_hi:[0,0,1]
    v_pk_fma_f32 v[106:107], v[106:107], s[58:59], v[8:9] neg_lo:[0,0,1] neg_hi:[0,0,1]
    v_pk_fma_f32 v[108:109], v[108:109], s[58:59], v[8:9] neg_lo:[0,0,1] neg_hi:[0,0,1]
    v_pk_fma_f32 v[110:111], v[110:111], s[58:59], v[8:9] neg_lo:[0,0,1] neg_hi:[0,0,1]
    v_exp_f32 v96, v96
    v_exp_f32 v97, v97
    v_exp_f32 v98, v98
    v_exp_f32 v99, v99
    v_exp_f32 v100, v100
    v_mfma_f32_32x32x16_bf16 v[128:143], v[52:55], v[20:23], 0
    v_exp_f32 v101, v101
    v_exp_f32 v102, v102
    v_exp_f32 v103, v103
    v_exp_f32 v104, v104
    v_exp_f32 v105, v105
    v_exp_f32 v106, v106
    v_mfma_f32_32x32x16_bf16 v[128:143], v[56:59], v[24:27], v[128:143]
    v_exp_f32 v107, v107
    v_exp_f32 v108, v108
    v_exp_f32 v109, v109
    v_exp_f32 v110, v110
    v_exp_f32 v111, v111
    s_nop 0
    v_cvt_pk_bf16_f32 v68, v96, v97
    v_cvt_pk_bf16_f32 v69, v98, v99
    v_cvt_pk_bf16_f32 v70, v100, v101
    v_cvt_pk_bf16_f32 v71, v102, v103
    v_cvt_pk_bf16_f32 v72, v104, v105
    v_cvt_pk_bf16_f32 v73, v106, v107
    v_cvt_pk_bf16_f32 v74, v108, v109
    v_cvt_pk_bf16_f32 v75, v110, v111
    ds_read_b128 v[60:63], v19 offset:30720
    ds_read_b128 v[64:67], v19 offset:31744
    s_nop 0
    v_max3_f32 v12, v112, v113, v114
    v_max3_f32 v13, v115, v116, v117
    v_max3_f32 v12, v12, v118, v119
    v_max3_f32 v13, v13, v120, v121
    v_mfma_f32_32x32x16_bf16 v[160:175], v[44:47], v[68:71], v[160:175]
    v_max3_f32 v12, v12, v122, v123
    v_max3_f32 v13, v13, v124, v125
    v_max3_f32 v12, v12, v126, v127
    v_max_f32 v12, v12, v13
    v_mov_b32 v13, v12
    s_nop 1
    v_permlane32_swap_b32 v12, v13
    s_nop 0
    v_max_f32 v12, v12, v13
    v_fma_f32 v13, v12, s58, -v10
    v_cmp_gt_f32 vcc, v13, v17
    s_cbranch_vccnz ATrs_199
ATrb_200:
    v_pk_fma_f32 v[112:113], v[112:113], s[58:59], v[10:11] neg_lo:[0,0,1] neg_hi:[0,0,1]
    v_pk_fma_f32 v[114:115], v[114:115], s[58:59], v[10:11] neg_lo:[0,0,1] neg_hi:[0,0,1]
    v_pk_fma_f32 v[116:117], v[116:117], s[58:59], v[10:11] neg_lo:[0,0,1] neg_hi:[0,0,1]
    v_pk_fma_f32 v[118:119], v[118:119], s[58:59], v[10:11] neg_lo:[0,0,1] neg_hi:[0,0,1]
    v_mfma_f32_32x32x16_bf16 v[160:175], v[48:51], v[72:75], v[160:175]
    v_pk_fma_f32 v[120:121], v[120:121], s[58:59], v[10:11] neg_lo:[0,0,1] neg_hi:[0,0,1]
    v_pk_fma_f32 v[122:123], v[122:123], s[58:59], v[10:11] neg_lo:[0,0,1] neg_hi:[0,0,1]
    v_pk_fma_f32 v[124:125], v[124:125], s[58:59], v[10:11] neg_lo:[0,0,1] neg_hi:[0,0,1]
    v_pk_fma_f32 v[126:127], v[126:127], s[58:59], v[10:11] neg_lo:[0,0,1] neg_hi:[0,0,1]
    v_exp_f32 v112, v112
    v_exp_f32 v113, v113
    v_exp_f32 v114, v114
    v_exp_f32 v115, v115
    v_exp_f32 v116, v116
    v_mfma_f32_32x32x16_bf16 v[144:159], v[52:55], v[28:31], 0
    v_exp_f32 v117, v117
    v_exp_f32 v118, v118
    v_exp_f32 v119, v119
    v_exp_f32 v120, v120
    v_exp_f32 v121, v121
    v_exp_f32 v122, v122
    v_mfma_f32_32x32x16_bf16 v[144:159], v[56:59], v[32:35], v[144:159]
    v_exp_f32 v123, v123
    v_exp_f32 v124, v124
    v_exp_f32 v125, v125
    v_exp_f32 v126, v126
    v_exp_f32 v127, v127
    s_nop 0
    v_cvt_pk_bf16_f32 v76, v112, v113
    v_cvt_pk_bf16_f32 v77, v114, v115
    v_cvt_pk_bf16_f32 v78, v116, v117
    v_cvt_pk_bf16_f32 v79, v118, v119
    v_cvt_pk_bf16_f32 v80, v120, v121
    v_cvt_pk_bf16_f32 v81, v122, v123
    v_cvt_pk_bf16_f32 v82, v124, v125
    v_cvt_pk_bf16_f32 v83, v126, v127
    s_waitcnt lgkmcnt(0)
    v_max3_f32 v12, v128, v129, v130
    v_max3_f32 v13, v131, v132, v133
    v_max3_f32 v12, v12, v134, v135
    v_max3_f32 v13, v13, v136, v137
    v_mfma_f32_32x32x16_bf16 v[176:191], v[44:47], v[76:79], v[176:191]
    v_max3_f32 v12, v12, v138, v139
    v_max3_f32 v13, v13, v140, v141
    v_max3_f32 v12, v12, v142, v143
    v_max_f32 v12, v12, v13
    v_mov_b32 v13, v12
    s_nop 1
    v_permlane32_swap_b32 v12, v13
    s_nop 0
    v_max_f32 v12, v12, v13
    v_fma_f32 v13, v12, s58, -v8
    v_cmp_gt_f32 vcc, v13, v17
    s_cbranch_vccnz ATrs_201
ATrb_202:
    v_pk_fma_f32 v[128:129], v[128:129], s[58:59], v[8:9] neg_lo:[0,0,1] neg_hi:[0,0,1]
    v_pk_fma_f32 v[130:131], v[130:131], s[58:59], v[8:9] neg_lo:[0,0,1] neg_hi:[0,0,1]
    v_pk_fma_f32 v[132:133], v[132:133], s[58:59], v[8:9] neg_lo:[0,0,1] neg_hi:[0,0,1]
    v_pk_fma_f32 v[134:135], v[134:135], s[58:59], v[8:9] neg_lo:[0,0,1] neg_hi:[0,0,1]
    v_mfma_f32_32x32x16_bf16 v[176:191], v[48:51], v[80:83], v[176:191]
    v_pk_fma_f32 v[136:137], v[136:137], s[58:59], v[8:9] neg_lo:[0,0,1] neg_hi:[0,0,1]
    v_pk_fma_f32 v[138:139], v[138:139], s[58:59], v[8:9] neg_lo:[0,0,1] neg_hi:[0,0,1]
    v_pk_fma_f32 v[140:141], v[140:141], s[58:59], v[8:9] neg_lo:[0,0,1] neg_hi:[0,0,1]
    v_pk_fma_f32 v[142:143], v[142:143], s[58:59], v[8:9] neg_lo:[0,0,1] neg_hi:[0,0,1]
    v_exp_f32 v128, v128
    v_exp_f32 v129, v129
    v_exp_f32 v130, v130
    v_exp_f32 v131, v131
    v_exp_f32 v132, v132
    v_exp_f32 v133, v133
    v_exp_f32 v134, v134
    v_exp_f32 v135, v135
    v_exp_f32 v136, v136
    v_exp_f32 v137, v137
    v_exp_f32 v138, v138
    v_exp_f32 v139, v139
    v_exp_f32 v140, v140
    v_exp_f32 v141, v141
    v_exp_f32 v142, v142
    v_exp_f32 v143, v143
    s_nop 0
    v_cvt_pk_bf16_f32 v68, v128, v129
    v_cvt_pk_bf16_f32 v69, v130, v131
    v_cvt_pk_bf16_f32 v70, v132, v133
    v_cvt_pk_bf16_f32 v71, v134, v135
    v_cvt_pk_bf16_f32 v72, v136, v137
    v_cvt_pk_bf16_f32 v73, v138, v139
    v_cvt_pk_bf16_f32 v74, v140, v141
    v_cvt_pk_bf16_f32 v75, v142, v143
    s_nop 0
    v_max3_f32 v12, v144, v145, v146
    v_max3_f32 v13, v147, v148, v149
    v_max3_f32 v12, v12, v150, v151
    v_max3_f32 v13, v13, v152, v153
    v_mfma_f32_32x32x16_bf16 v[160:175], v[60:63], v[68:71], v[160:175]
    v_max3_f32 v12, v12, v154, v155
    v_max3_f32 v13, v13, v156, v157
    v_max3_f32 v12, v12, v158, v159
    v_max_f32 v12, v12, v13
    v_mov_b32 v13, v12
    s_nop 1
    v_permlane32_swap_b32 v12, v13
    s_nop 0
    v_max_f32 v12, v12, v13
    v_fma_f32 v13, v12, s58, -v10
    v_cmp_gt_f32 vcc, v13, v17
    s_cbranch_vccnz ATrs_203
ATrb_204:
    v_pk_fma_f32 v[144:145], v[144:145], s[58:59], v[10:11] neg_lo:[0,0,1] neg_hi:[0,0,1]
    v_pk_fma_f32 v[146:147], v[146:147], s[58:59], v[10:11] neg_lo:[0,0,1] neg_hi:[0,0,1]
    v_pk_fma_f32 v[148:149], v[148:149], s[58:59], v[10:11] neg_lo:[0,0,1] neg_hi:[0,0,1]
    v_pk_fma_f32 v[150:151], v[150:151], s[58:59], v[10:11] neg_lo:[0,0,1] neg_hi:[0,0,1]
    v_mfma_f32_32x32x16_bf16 v[160:175], v[64:67], v[72:75], v[160:175]
    v_pk_fma_f32 v[152:153], v[152:153], s[58:59], v[10:11] neg_lo:[0,0,1] neg_hi:[0,0,1]
    v_pk_fma_f32 v[154:155], v[154:155], s[58:59], v[10:11] neg_lo:[0,0,1] neg_hi:[0,0,1]
    v_pk_fma_f32 v[156:157], v[156:157], s[58:59], v[10:11] neg_lo:[0,0,1] neg_hi:[0,0,1]
    v_pk_fma_f32 v[158:159], v[158:159], s[58:59], v[10:11] neg_lo:[0,0,1] neg_hi:[0,0,1]
    v_exp_f32 v144, v144
    v_exp_f32 v145, v145
    v_exp_f32 v146, v146
    v_exp_f32 v147, v147
    v_exp_f32 v148, v148
    v_exp_f32 v149, v149
    v_exp_f32 v150, v150
    v_exp_f32 v151, v151
    v_exp_f32 v152, v152
    v_exp_f32 v153, v153
    v_exp_f32 v154, v154
    v_exp_f32 v155, v155
    v_exp_f32 v156, v156
    v_exp_f32 v157, v157
    v_exp_f32 v158, v158
    v_exp_f32 v159, v159
    s_nop 0
    v_cvt_pk_bf16_f32 v76, v144, v145
    v_cvt_pk_bf16_f32 v77, v146, v147
    v_cvt_pk_bf16_f32 v78, v148, v149
    v_cvt_pk_bf16_f32 v79, v150, v151
    v_cvt_pk_bf16_f32 v80, v152, v153
    v_cvt_pk_bf16_f32 v81, v154, v155
    v_cvt_pk_bf16_f32 v82, v156, v157
    v_cvt_pk_bf16_f32 v83, v158, v159
    s_nop 1
    v_mfma_f32_32x32x16_bf16 v[176:191], v[60:63], v[76:79], v[176:191]
    v_mfma_f32_32x32x16_bf16 v[176:191], v[64:67], v[80:83], v[176:191]
    s_mov_b32 s36, s37
    s_add_u32 s33, s33, 1
    s_cmp_lt_u32 s33, 4
    s_cbranch_scc1 AT_chunk
    s_nop 11
    v_mov_b32 v12, v168
    v_mov_b32 v13, v168
    s_nop 1
    v_permlane32_swap_b32 v12, v13
    s_nop 0
    v_rcp_f32 v13, v13
    s_nop 0
    v_mul_f32 v160, v160, v13
    v_mul_f32 v161, v161, v13
    v_mul_f32 v162, v162, v13
    v_mul_f32 v163, v163, v13
    v_mul_f32 v164, v164, v13
    v_mul_f32 v165, v165, v13
    v_mul_f32 v166, v166, v13
    v_mul_f32 v167, v167, v13
    v_mul_f32 v168, v168, v13
    v_mul_f32 v169, v169, v13
    v_mul_f32 v170, v170, v13
    v_mul_f32 v171, v171, v13
    v_cvt_pk_bf16_f32 v68, v160, v161
    v_cvt_pk_bf16_f32 v69, v162, v163
    v_cvt_pk_bf16_f32 v70, v164, v165
    v_cvt_pk_bf16_f32 v71, v166, v167
    v_cvt_pk_bf16_f32 v72, v168, v169
    v_cvt_pk_bf16_f32 v73, v170, v171
    s_mov_b32 s54, 0x0
    buffer_store_dwordx2 v[68:69], v6, s[8:11], s54 offen sc1
    buffer_store_dwordx2 v[70:71], v6, s[8:11], s54 offen offset:16 sc1
    s_mov_b32 exec_hi, 0
    buffer_store_dwordx2 v[72:73], v6, s[8:11], s54 offen offset:32 sc1
    s_mov_b32 exec_hi, -1
    v_mov_b32 v12, v184
    v_mov_b32 v13, v184
    s_nop 1
    v_permlane32_swap_b32 v12, v13
    s_nop 0
    v_rcp_f32 v13, v13
    s_nop 0
    v_mul_f32 v176, v176, v13
    v_mul_f32 v177, v177, v13
    v_mul_f32 v178, v178, v13
    v_mul_f32 v179, v179, v13
    v_mul_f32 v180, v180, v13
    v_mul_f32 v181, v181, v13
    v_mul_f32 v182, v182, v13
    v_mul_f32 v183, v183, v13
    v_mul_f32 v184, v184, v13
    v_mul_f32 v185, v185, v13
    v_mul_f32 v186, v186, v13
    v_mul_f32 v187, v187, v13
    v_cvt_pk_bf16_f32 v68, v176, v177
    v_cvt_pk_bf16_f32 v69, v178, v179
    v_cvt_pk_bf16_f32 v70, v180, v181
    v_cvt_pk_bf16_f32 v71, v182, v183
    v_cvt_pk_bf16_f32 v72, v184, v185
    v_cvt_pk_bf16_f32 v73, v186, v187
    s_mov_b32 s54, 0xa000
    buffer_store_dwordx2 v[68:69], v6, s[8:11], s54 offen sc1
    buffer_store_dwordx2 v[70:71], v6, s[8:11], s54 offen offset:16 sc1
    s_mov_b32 exec_hi, 0
    buffer_store_dwordx2 v[72:73], v6, s[8:11], s54 offen offset:32 sc1
    s_mov_b32 exec_hi, -1
    s_waitcnt vmcnt(0)
    s_branch AT_end
ATrs_141:
    v_mul_f32 v14, s58, v12
    v_max_f32 v14, v14, v8
    v_sub_f32 v15, v8, v14
    v_exp_f32 v15, v15
    v_mov_b32 v8, v14
    v_mov_b32 v9, v14
    s_nop 7
    v_mul_f32 v160, v160, v15
    v_mul_f32 v161, v161, v15
    v_mul_f32 v162, v162, v15
    v_mul_f32 v163, v163, v15
    v_mul_f32 v164, v164, v15
    v_mul_f32 v165, v165, v15
    v_mul_f32 v166, v166, v15
    v_mul_f32 v167, v167, v15
    v_mul_f32 v168, v168, v15
    v_mul_f32 v169, v169, v15
    v_mul_f32 v170, v170, v15
    v_mul_f32 v171, v171, v15
    v_mul_f32 v172, v172, v15
    v_mul_f32 v173, v173, v15
    v_mul_f32 v174, v174, v15
    v_mul_f32 v175, v175, v15
    s_branch ATrb_142
ATrs_143:
    v_mul_f32 v14, s58, v12
    v_max_f32 v14, v14, v10
    v_sub_f32 v15, v10, v14
    v_exp_f32 v15, v15
    v_mov_b32 v10, v14
    v_mov_b32 v11, v14
    s_nop 7
    v_mul_f32 v176, v176, v15
    v_mul_f32 v177, v177, v15
    v_mul_f32 v178, v178, v15
    v_mul_f32 v179, v179, v15
    v_mul_f32 v180, v180, v15
    v_mul_f32 v181, v181, v15
    v_mul_f32 v182, v182, v15
    v_mul_f32 v183, v183, v15
    v_mul_f32 v184, v184, v15
    v_mul_f32 v185, v185, v15
    v_mul_f32 v186, v186, v15
    v_mul_f32 v187, v187, v15
    v_mul_f32 v188, v188, v15
    v_mul_f32 v189, v189, v15
    v_mul_f32 v190, v190, v15
    v_mul_f32 v191, v191, v15
    s_branch ATrb_144
ATrs_145:
    v_mul_f32 v14, s58, v12
    v_max_f32 v14, v14, v8
    v_sub_f32 v15, v8, v14
    v_exp_f32 v15, v15
    v_mov_b32 v8, v14
    v_mov_b32 v9, v14
    s_nop 7
    v_mul_f32 v160, v160, v15
    v_mul_f32 v161, v161, v15
    v_mul_f32 v162, v162, v15
    v_mul_f32 v163, v163, v15
    v_mul_f32 v164, v164, v15
    v_mul_f32 v165, v165, v15
    v_mul_f32 v166, v166, v15
    v_mul_f32 v167, v167, v15
    v_mul_f32 v168, v168, v15
    v_mul_f32 v169, v169, v15
    v_mul_f32 v170, v170, v15
    v_mul_f32 v171, v171, v15
    v_mul_f32 v172, v172, v15
    v_mul_f32 v173, v173, v15
    v_mul_f32 v174, v174, v15
    v_mul_f32 v175, v175, v15
    s_branch ATrb_146
ATrs_147:
    v_mul_f32 v14, s58, v12
    v_max_f32 v14, v14, v10
    v_sub_f32 v15, v10, v14
    v_exp_f32 v15, v15
    v_mov_b32 v10, v14
    v_mov_b32 v11, v14
    s_nop 7
    v_mul_f32 v176, v176, v15
    v_mul_f32 v177, v177, v15
    v_mul_f32 v178, v178, v15
    v_mul_f32 v179, v179, v15
    v_mul_f32 v180, v180, v15
    v_mul_f32 v181, v181, v15
    v_mul_f32 v182, v182, v15
    v_mul_f32 v183, v183, v15
    v_mul_f32 v184, v184, v15
    v_mul_f32 v185, v185, v15
    v_mul_f32 v186, v186, v15
    v_mul_f32 v187, v187, v15
    v_mul_f32 v188, v188, v15
    v_mul_f32 v189, v189, v15
    v_mul_f32 v190, v190, v15
    v_mul_f32 v191, v191, v15
    s_branch ATrb_148
ATrs_149:
    v_mul_f32 v14, s58, v12
    v_max_f32 v14, v14, v8
    v_sub_f32 v15, v8, v14
    v_exp_f32 v15, v15
    v_mov_b32 v8, v14
    v_mov_b32 v9, v14
    s_nop 7
    v_mul_f32 v160, v160, v15
    v_mul_f32 v161, v161, v15
    v_mul_f32 v162, v162, v15
    v_mul_f32 v163, v163, v15
    v_mul_f32 v164, v164, v15
    v_mul_f32 v165, v165, v15
    v_mul_f32 v166, v166, v15
    v_mul_f32 v167, v167, v15
    v_mul_f32 v168, v168, v15
    v_mul_f32 v169, v169, v15
    v_mul_f32 v170, v170, v15
    v_mul_f32 v171, v171, v15
    v_mul_f32 v172, v172, v15
    v_mul_f32 v173, v173, v15
    v_mul_f32 v174, v174, v15
    v_mul_f32 v175, v175, v15
    s_branch ATrb_150
ATrs_151:
    v_mul_f32 v14, s58, v12
    v_max_f32 v14, v14, v10
    v_sub_f32 v15, v10, v14
    v_exp_f32 v15, v15
    v_mov_b32 v10, v14
    v_mov_b32 v11, v14
    s_nop 7
    v_mul_f32 v176, v176, v15
    v_mul_f32 v177, v177, v15
    v_mul_f32 v178, v178, v15
    v_mul_f32 v179, v179, v15
    v_mul_f32 v180, v180, v15
    v_mul_f32 v181, v181, v15
    v_mul_f32 v182, v182, v15
    v_mul_f32 v183, v183, v15
    v_mul_f32 v184, v184, v15
    v_mul_f32 v185, v185, v15
    v_mul_f32 v186, v186, v15
    v_mul_f32 v187, v187, v15
    v_mul_f32 v188, v188, v15
    v_mul_f32 v189, v189, v15
    v_mul_f32 v190, v190, v15
    v_mul_f32 v191, v191, v15
    s_branch ATrb_152
ATrs_153:
    v_mul_f32 v14, s58, v12
    v_max_f32 v14, v14, v8
    v_sub_f32 v15, v8, v14
    v_exp_f32 v15, v15
    v_mov_b32 v8, v14
    v_mov_b32 v9, v14
    s_nop 7
    v_mul_f32 v160, v160, v15
    v_mul_f32 v161, v161, v15
    v_mul_f32 v162, v162, v15
    v_mul_f32 v163, v163, v15
    v_mul_f32 v164, v164, v15
    v_mul_f32 v165, v165, v15
    v_mul_f32 v166, v166, v15
    v_mul_f32 v167, v167, v15
    v_mul_f32 v168, v168, v15
    v_mul_f32 v169, v169, v15
    v_mul_f32 v170, v170, v15
    v_mul_f32 v171, v171, v15
    v_mul_f32 v172, v172, v15
    v_mul_f32 v173, v173, v15
    v_mul_f32 v174, v174, v15
    v_mul_f32 v175, v175, v15
    s_branch ATrb_154
ATrs_155:
    v_mul_f32 v14, s58, v12
    v_max_f32 v14, v14, v10
    v_sub_f32 v15, v10, v14
    v_exp_f32 v15, v15
    v_mov_b32 v10, v14
    v_mov_b32 v11, v14
    s_nop 7
    v_mul_f32 v176, v176, v15
    v_mul_f32 v177, v177, v15
    v_mul_f32 v178, v178, v15
    v_mul_f32 v179, v179, v15
    v_mul_f32 v180, v180, v15
    v_mul_f32 v181, v181, v15
    v_mul_f32 v182, v182, v15
    v_mul_f32 v183, v183, v15
    v_mul_f32 v184, v184, v15
    v_mul_f32 v185, v185, v15
    v_mul_f32 v186, v186, v15
    v_mul_f32 v187, v187, v15
    v_mul_f32 v188, v188, v15
    v_mul_f32 v189, v189, v15
    v_mul_f32 v190, v190, v15
    v_mul_f32 v191, v191, v15
    s_branch ATrb_156
ATrs_157:
    v_mul_f32 v14, s58, v12
    v_max_f32 v14, v14, v8
    v_sub_f32 v15, v8, v14
    v_exp_f32 v15, v15
    v_mov_b32 v8, v14
    v_mov_b32 v9, v14
    s_nop 7
    v_mul_f32 v160, v160, v15
    v_mul_f32 v161, v161, v15
    v_mul_f32 v162, v162, v15
    v_mul_f32 v163, v163, v15
    v_mul_f32 v164, v164, v15
    v_mul_f32 v165, v165, v15
    v_mul_f32 v166, v166, v15
    v_mul_f32 v167, v167, v15
    v_mul_f32 v168, v168, v15
    v_mul_f32 v169, v169, v15
    v_mul_f32 v170, v170, v15
    v_mul_f32 v171, v171, v15
    v_mul_f32 v172, v172, v15
    v_mul_f32 v173, v173, v15
    v_mul_f32 v174, v174, v15
    v_mul_f32 v175, v175, v15
    s_branch ATrb_158
ATrs_159:
    v_mul_f32 v14, s58, v12
    v_max_f32 v14, v14, v10
    v_sub_f32 v15, v10, v14
    v_exp_f32 v15, v15
    v_mov_b32 v10, v14
    v_mov_b32 v11, v14
    s_nop 7
    v_mul_f32 v176, v176, v15
    v_mul_f32 v177, v177, v15
    v_mul_f32 v178, v178, v15
    v_mul_f32 v179, v179, v15
    v_mul_f32 v180, v180, v15
    v_mul_f32 v181, v181, v15
    v_mul_f32 v182, v182, v15
    v_mul_f32 v183, v183, v15
    v_mul_f32 v184, v184, v15
    v_mul_f32 v185, v185, v15
    v_mul_f32 v186, v186, v15
    v_mul_f32 v187, v187, v15
    v_mul_f32 v188, v188, v15
    v_mul_f32 v189, v189, v15
    v_mul_f32 v190, v190, v15
    v_mul_f32 v191, v191, v15
    s_branch ATrb_160
ATrs_161:
    v_mul_f32 v14, s58, v12
    v_max_f32 v14, v14, v8
    v_sub_f32 v15, v8, v14
    v_exp_f32 v15, v15
    v_mov_b32 v8, v14
    v_mov_b32 v9, v14
    s_nop 7
    v_mul_f32 v160, v160, v15
    v_mul_f32 v161, v161, v15
    v_mul_f32 v162, v162, v15
    v_mul_f32 v163, v163, v15
    v_mul_f32 v164, v164, v15
    v_mul_f32 v165, v165, v15
    v_mul_f32 v166, v166, v15
    v_mul_f32 v167, v167, v15
    v_mul_f32 v168, v168, v15
    v_mul_f32 v169, v169, v15
    v_mul_f32 v170, v170, v15
    v_mul_f32 v171, v171, v15
    v_mul_f32 v172, v172, v15
    v_mul_f32 v173, v173, v15
    v_mul_f32 v174, v174, v15
    v_mul_f32 v175, v175, v15
    s_branch ATrb_162
ATrs_163:
    v_mul_f32 v14, s58, v12
    v_max_f32 v14, v14, v10
    v_sub_f32 v15, v10, v14
    v_exp_f32 v15, v15
    v_mov_b32 v10, v14
    v_mov_b32 v11, v14
    s_nop 7
    v_mul_f32 v176, v176, v15
    v_mul_f32 v177, v177, v15
    v_mul_f32 v178, v178, v15
    v_mul_f32 v179, v179, v15
    v_mul_f32 v180, v180, v15
    v_mul_f32 v181, v181, v15
    v_mul_f32 v182, v182, v15
    v_mul_f32 v183, v183, v15
    v_mul_f32 v184, v184, v15
    v_mul_f32 v185, v185, v15
    v_mul_f32 v186, v186, v15
    v_mul_f32 v187, v187, v15
    v_mul_f32 v188, v188, v15
    v_mul_f32 v189, v189, v15
    v_mul_f32 v190, v190, v15
    v_mul_f32 v191, v191, v15
    s_branch ATrb_164
ATrs_165:
    v_mul_f32 v14, s58, v12
    v_max_f32 v14, v14, v8
    v_sub_f32 v15, v8, v14
    v_exp_f32 v15, v15
    v_mov_b32 v8, v14
    v_mov_b32 v9, v14
    s_nop 7
    v_mul_f32 v160, v160, v15
    v_mul_f32 v161, v161, v15
    v_mul_f32 v162, v162, v15
    v_mul_f32 v163, v163, v15
    v_mul_f32 v164, v164, v15
    v_mul_f32 v165, v165, v15
    v_mul_f32 v166, v166, v15
    v_mul_f32 v167, v167, v15
    v_mul_f32 v168, v168, v15
    v_mul_f32 v169, v169, v15
    v_mul_f32 v170, v170, v15
    v_mul_f32 v171, v171, v15
    v_mul_f32 v172, v172, v15
    v_mul_f32 v173, v173, v15
    v_mul_f32 v174, v174, v15
    v_mul_f32 v175, v175, v15
    s_branch ATrb_166
ATrs_167:
    v_mul_f32 v14, s58, v12
    v_max_f32 v14, v14, v10
    v_sub_f32 v15, v10, v14
    v_exp_f32 v15, v15
    v_mov_b32 v10, v14
    v_mov_b32 v11, v14
    s_nop 7
    v_mul_f32 v176, v176, v15
    v_mul_f32 v177, v177, v15
    v_mul_f32 v178, v178, v15
    v_mul_f32 v179, v179, v15
    v_mul_f32 v180, v180, v15
    v_mul_f32 v181, v181, v15
    v_mul_f32 v182, v182, v15
    v_mul_f32 v183, v183, v15
    v_mul_f32 v184, v184, v15
    v_mul_f32 v185, v185, v15
    v_mul_f32 v186, v186, v15
    v_mul_f32 v187, v187, v15
    v_mul_f32 v188, v188, v15
    v_mul_f32 v189, v189, v15
    v_mul_f32 v190, v190, v15
    v_mul_f32 v191, v191, v15
    s_branch ATrb_168
ATrs_169:
    v_mul_f32 v14, s58, v12
    v_max_f32 v14, v14, v8
    v_sub_f32 v15, v8, v14
    v_exp_f32 v15, v15
    v_mov_b32 v8, v14
    v_mov_b32 v9, v14
    s_nop 7
    v_mul_f32 v160, v160, v15
    v_mul_f32 v161, v161, v15
    v_mul_f32 v162, v162, v15
    v_mul_f32 v163, v163, v15
    v_mul_f32 v164, v164, v15
    v_mul_f32 v165, v165, v15
    v_mul_f32 v166, v166, v15
    v_mul_f32 v167, v167, v15
    v_mul_f32 v168, v168, v15
    v_mul_f32 v169, v169, v15
    v_mul_f32 v170, v170, v15
    v_mul_f32 v171, v171, v15
    v_mul_f32 v172, v172, v15
    v_mul_f32 v173, v173, v15
    v_mul_f32 v174, v174, v15
    v_mul_f32 v175, v175, v15
    s_branch ATrb_170
ATrs_171:
    v_mul_f32 v14, s58, v12
    v_max_f32 v14, v14, v10
    v_sub_f32 v15, v10, v14
    v_exp_f32 v15, v15
    v_mov_b32 v10, v14
    v_mov_b32 v11, v14
    s_nop 7
    v_mul_f32 v176, v176, v15
    v_mul_f32 v177, v177, v15
    v_mul_f32 v178, v178, v15
    v_mul_f32 v179, v179, v15
    v_mul_f32 v180, v180, v15
    v_mul_f32 v181, v181, v15
    v_mul_f32 v182, v182, v15
    v_mul_f32 v183, v183, v15
    v_mul_f32 v184, v184, v15
    v_mul_f32 v185, v185, v15
    v_mul_f32 v186, v186, v15
    v_mul_f32 v187, v187, v15
    v_mul_f32 v188, v188, v15
    v_mul_f32 v189, v189, v15
    v_mul_f32 v190, v190, v15
    v_mul_f32 v191, v191, v15
    s_branch ATrb_172
ATrs_173:
    v_mul_f32 v14, s58, v12
    v_max_f32 v14, v14, v8
    v_sub_f32 v15, v8, v14
    v_exp_f32 v15, v15
    v_mov_b32 v8, v14
    v_mov_b32 v9, v14
    s_nop 7
    v_mul_f32 v160, v160, v15
    v_mul_f32 v161, v161, v15
    v_mul_f32 v162, v162, v15
    v_mul_f32 v163, v163, v15
    v_mul_f32 v164, v164, v15
    v_mul_f32 v165, v165, v15
    v_mul_f32 v166, v166, v15
    v_mul_f32 v167, v167, v15
    v_mul_f32 v168, v168, v15
    v_mul_f32 v169, v169, v15
    v_mul_f32 v170, v170, v15
    v_mul_f32 v171, v171, v15
    v_mul_f32 v172, v172, v15
    v_mul_f32 v173, v173, v15
    v_mul_f32 v174, v174, v15
    v_mul_f32 v175, v175, v15
    s_branch ATrb_174
ATrs_175:
    v_mul_f32 v14, s58, v12
    v_max_f32 v14, v14, v10
    v_sub_f32 v15, v10, v14
    v_exp_f32 v15, v15
    v_mov_b32 v10, v14
    v_mov_b32 v11, v14
    s_nop 7
    v_mul_f32 v176, v176, v15
    v_mul_f32 v177, v177, v15
    v_mul_f32 v178, v178, v15
    v_mul_f32 v179, v179, v15
    v_mul_f32 v180, v180, v15
    v_mul_f32 v181, v181, v15
    v_mul_f32 v182, v182, v15
    v_mul_f32 v183, v183, v15
    v_mul_f32 v184, v184, v15
    v_mul_f32 v185, v185, v15
    v_mul_f32 v186, v186, v15
    v_mul_f32 v187, v187, v15
    v_mul_f32 v188, v188, v15
    v_mul_f32 v189, v189, v15
    v_mul_f32 v190, v190, v15
    v_mul_f32 v191, v191, v15
    s_branch ATrb_176
ATrs_177:
    v_mul_f32 v14, s58, v12
    v_max_f32 v14, v14, v8
    v_sub_f32 v15, v8, v14
    v_exp_f32 v15, v15
    v_mov_b32 v8, v14
    v_mov_b32 v9, v14
    s_nop 7
    v_mul_f32 v160, v160, v15
    v_mul_f32 v161, v161, v15
    v_mul_f32 v162, v162, v15
    v_mul_f32 v163, v163, v15
    v_mul_f32 v164, v164, v15
    v_mul_f32 v165, v165, v15
    v_mul_f32 v166, v166, v15
    v_mul_f32 v167, v167, v15
    v_mul_f32 v168, v168, v15
    v_mul_f32 v169, v169, v15
    v_mul_f32 v170, v170, v15
    v_mul_f32 v171, v171, v15
    v_mul_f32 v172, v172, v15
    v_mul_f32 v173, v173, v15
    v_mul_f32 v174, v174, v15
    v_mul_f32 v175, v175, v15
    s_branch ATrb_178
ATrs_179:
    v_mul_f32 v14, s58, v12
    v_max_f32 v14, v14, v10
    v_sub_f32 v15, v10, v14
    v_exp_f32 v15, v15
    v_mov_b32 v10, v14
    v_mov_b32 v11, v14
    s_nop 7
    v_mul_f32 v176, v176, v15
    v_mul_f32 v177, v177, v15
    v_mul_f32 v178, v178, v15
    v_mul_f32 v179, v179, v15
    v_mul_f32 v180, v180, v15
    v_mul_f32 v181, v181, v15
    v_mul_f32 v182, v182, v15
    v_mul_f32 v183, v183, v15
    v_mul_f32 v184, v184, v15
    v_mul_f32 v185, v185, v15
    v_mul_f32 v186, v186, v15
    v_mul_f32 v187, v187, v15
    v_mul_f32 v188, v188, v15
    v_mul_f32 v189, v189, v15
    v_mul_f32 v190, v190, v15
    v_mul_f32 v191, v191, v15
    s_branch ATrb_180
ATrs_181:
    v_mul_f32 v14, s58, v12
    v_max_f32 v14, v14, v8
    v_sub_f32 v15, v8, v14
    v_exp_f32 v15, v15
    v_mov_b32 v8, v14
    v_mov_b32 v9, v14
    s_nop 7
    v_mul_f32 v160, v160, v15
    v_mul_f32 v161, v161, v15
    v_mul_f32 v162, v162, v15
    v_mul_f32 v163, v163, v15
    v_mul_f32 v164, v164, v15
    v_mul_f32 v165, v165, v15
    v_mul_f32 v166, v166, v15
    v_mul_f32 v167, v167, v15
    v_mul_f32 v168, v168, v15
    v_mul_f32 v169, v169, v15
    v_mul_f32 v170, v170, v15
    v_mul_f32 v171, v171, v15
    v_mul_f32 v172, v172, v15
    v_mul_f32 v173, v173, v15
    v_mul_f32 v174, v174, v15
    v_mul_f32 v175, v175, v15
    s_branch ATrb_182
ATrs_183:
    v_mul_f32 v14, s58, v12
    v_max_f32 v14, v14, v10
    v_sub_f32 v15, v10, v14
    v_exp_f32 v15, v15
    v_mov_b32 v10, v14
    v_mov_b32 v11, v14
    s_nop 7
    v_mul_f32 v176, v176, v15
    v_mul_f32 v177, v177, v15
    v_mul_f32 v178, v178, v15
    v_mul_f32 v179, v179, v15
    v_mul_f32 v180, v180, v15
    v_mul_f32 v181, v181, v15
    v_mul_f32 v182, v182, v15
    v_mul_f32 v183, v183, v15
    v_mul_f32 v184, v184, v15
    v_mul_f32 v185, v185, v15
    v_mul_f32 v186, v186, v15
    v_mul_f32 v187, v187, v15
    v_mul_f32 v188, v188, v15
    v_mul_f32 v189, v189, v15
    v_mul_f32 v190, v190, v15
    v_mul_f32 v191, v191, v15
    s_branch ATrb_184
ATrs_185:
    v_mul_f32 v14, s58, v12
    v_max_f32 v14, v14, v8
    v_sub_f32 v15, v8, v14
    v_exp_f32 v15, v15
    v_mov_b32 v8, v14
    v_mov_b32 v9, v14
    s_nop 7
    v_mul_f32 v160, v160, v15
    v_mul_f32 v161, v161, v15
    v_mul_f32 v162, v162, v15
    v_mul_f32 v163, v163, v15
    v_mul_f32 v164, v164, v15
    v_mul_f32 v165, v165, v15
    v_mul_f32 v166, v166, v15
    v_mul_f32 v167, v167, v15
    v_mul_f32 v168, v168, v15
    v_mul_f32 v169, v169, v15
    v_mul_f32 v170, v170, v15
    v_mul_f32 v171, v171, v15
    v_mul_f32 v172, v172, v15
    v_mul_f32 v173, v173, v15
    v_mul_f32 v174, v174, v15
    v_mul_f32 v175, v175, v15
    s_branch ATrb_186
ATrs_187:
    v_mul_f32 v14, s58, v12
    v_max_f32 v14, v14, v10
    v_sub_f32 v15, v10, v14
    v_exp_f32 v15, v15
    v_mov_b32 v10, v14
    v_mov_b32 v11, v14
    s_nop 7
    v_mul_f32 v176, v176, v15
    v_mul_f32 v177, v177, v15
    v_mul_f32 v178, v178, v15
    v_mul_f32 v179, v179, v15
    v_mul_f32 v180, v180, v15
    v_mul_f32 v181, v181, v15
    v_mul_f32 v182, v182, v15
    v_mul_f32 v183, v183, v15
    v_mul_f32 v184, v184, v15
    v_mul_f32 v185, v185, v15
    v_mul_f32 v186, v186, v15
    v_mul_f32 v187, v187, v15
    v_mul_f32 v188, v188, v15
    v_mul_f32 v189, v189, v15
    v_mul_f32 v190, v190, v15
    v_mul_f32 v191, v191, v15
    s_branch ATrb_188
ATrs_189:
    v_mul_f32 v14, s58, v12
    v_max_f32 v14, v14, v8
    v_sub_f32 v15, v8, v14
    v_exp_f32 v15, v15
    v_mov_b32 v8, v14
    v_mov_b32 v9, v14
    s_nop 7
    v_mul_f32 v160, v160, v15
    v_mul_f32 v161, v161, v15
    v_mul_f32 v162, v162, v15
    v_mul_f32 v163, v163, v15
    v_mul_f32 v164, v164, v15
    v_mul_f32 v165, v165, v15
    v_mul_f32 v166, v166, v15
    v_mul_f32 v167, v167, v15
    v_mul_f32 v168, v168, v15
    v_mul_f32 v169, v169, v15
    v_mul_f32 v170, v170, v15
    v_mul_f32 v171, v171, v15
    v_mul_f32 v172, v172, v15
    v_mul_f32 v173, v173, v15
    v_mul_f32 v174, v174, v15
    v_mul_f32 v175, v175, v15
    s_branch ATrb_190
ATrs_191:
    v_mul_f32 v14, s58, v12
    v_max_f32 v14, v14, v10
    v_sub_f32 v15, v10, v14
    v_exp_f32 v15, v15
    v_mov_b32 v10, v14
    v_mov_b32 v11, v14
    s_nop 7
    v_mul_f32 v176, v176, v15
    v_mul_f32 v177, v177, v15
    v_mul_f32 v178, v178, v15
    v_mul_f32 v179, v179, v15
    v_mul_f32 v180, v180, v15
    v_mul_f32 v181, v181, v15
    v_mul_f32 v182, v182, v15
    v_mul_f32 v183, v183, v15
    v_mul_f32 v184, v184, v15
    v_mul_f32 v185, v185, v15
    v_mul_f32 v186, v186, v15
    v_mul_f32 v187, v187, v15
    v_mul_f32 v188, v188, v15
    v_mul_f32 v189, v189, v15
    v_mul_f32 v190, v190, v15
    v_mul_f32 v191, v191, v15
    s_branch ATrb_192
ATrs_193:
    v_mul_f32 v14, s58, v12
    v_max_f32 v14, v14, v8
    v_sub_f32 v15, v8, v14
    v_exp_f32 v15, v15
    v_mov_b32 v8, v14
    v_mov_b32 v9, v14
    s_nop 7
    v_mul_f32 v160, v160, v15
    v_mul_f32 v161, v161, v15
    v_mul_f32 v162, v162, v15
    v_mul_f32 v163, v163, v15
    v_mul_f32 v164, v164, v15
    v_mul_f32 v165, v165, v15
    v_mul_f32 v166, v166, v15
    v_mul_f32 v167, v167, v15
    v_mul_f32 v168, v168, v15
    v_mul_f32 v169, v169, v15
    v_mul_f32 v170, v170, v15
    v_mul_f32 v171, v171, v15
    v_mul_f32 v172, v172, v15
    v_mul_f32 v173, v173, v15
    v_mul_f32 v174, v174, v15
    v_mul_f32 v175, v175, v15
    s_branch ATrb_194
ATrs_195:
    v_mul_f32 v14, s58, v12
    v_max_f32 v14, v14, v10
    v_sub_f32 v15, v10, v14
    v_exp_f32 v15, v15
    v_mov_b32 v10, v14
    v_mov_b32 v11, v14
    s_nop 7
    v_mul_f32 v176, v176, v15
    v_mul_f32 v177, v177, v15
    v_mul_f32 v178, v178, v15
    v_mul_f32 v179, v179, v15
    v_mul_f32 v180, v180, v15
    v_mul_f32 v181, v181, v15
    v_mul_f32 v182, v182, v15
    v_mul_f32 v183, v183, v15
    v_mul_f32 v184, v184, v15
    v_mul_f32 v185, v185, v15
    v_mul_f32 v186, v186, v15
    v_mul_f32 v187, v187, v15
    v_mul_f32 v188, v188, v15
    v_mul_f32 v189, v189, v15
    v_mul_f32 v190, v190, v15
    v_mul_f32 v191, v191, v15
    s_branch ATrb_196
ATrs_197:
    v_mul_f32 v14, s58, v12
    v_max_f32 v14, v14, v8
    v_sub_f32 v15, v8, v14
    v_exp_f32 v15, v15
    v_mov_b32 v8, v14
    v_mov_b32 v9, v14
    s_nop 7
    v_mul_f32 v160, v160, v15
    v_mul_f32 v161, v161, v15
    v_mul_f32 v162, v162, v15
    v_mul_f32 v163, v163, v15
    v_mul_f32 v164, v164, v15
    v_mul_f32 v165, v165, v15
    v_mul_f32 v166, v166, v15
    v_mul_f32 v167, v167, v15
    v_mul_f32 v168, v168, v15
    v_mul_f32 v169, v169, v15
    v_mul_f32 v170, v170, v15
    v_mul_f32 v171, v171, v15
    v_mul_f32 v172, v172, v15
    v_mul_f32 v173, v173, v15
    v_mul_f32 v174, v174, v15
    v_mul_f32 v175, v175, v15
    s_branch ATrb_198
ATrs_199:
    v_mul_f32 v14, s58, v12
    v_max_f32 v14, v14, v10
    v_sub_f32 v15, v10, v14
    v_exp_f32 v15, v15
    v_mov_b32 v10, v14
    v_mov_b32 v11, v14
    s_nop 7
    v_mul_f32 v176, v176, v15
    v_mul_f32 v177, v177, v15
    v_mul_f32 v178, v178, v15
    v_mul_f32 v179, v179, v15
    v_mul_f32 v180, v180, v15
    v_mul_f32 v181, v181, v15
    v_mul_f32 v182, v182, v15
    v_mul_f32 v183, v183, v15
    v_mul_f32 v184, v184, v15
    v_mul_f32 v185, v185, v15
    v_mul_f32 v186, v186, v15
    v_mul_f32 v187, v187, v15
    v_mul_f32 v188, v188, v15
    v_mul_f32 v189, v189, v15
    v_mul_f32 v190, v190, v15
    v_mul_f32 v191, v191, v15
    s_branch ATrb_200
ATrs_201:
    v_mul_f32 v14, s58, v12
    v_max_f32 v14, v14, v8
    v_sub_f32 v15, v8, v14
    v_exp_f32 v15, v15
    v_mov_b32 v8, v14
    v_mov_b32 v9, v14
    s_nop 7
    v_mul_f32 v160, v160, v15
    v_mul_f32 v161, v161, v15
    v_mul_f32 v162, v162, v15
    v_mul_f32 v163, v163, v15
    v_mul_f32 v164, v164, v15
    v_mul_f32 v165, v165, v15
    v_mul_f32 v166, v166, v15
    v_mul_f32 v167, v167, v15
    v_mul_f32 v168, v168, v15
    v_mul_f32 v169, v169, v15
    v_mul_f32 v170, v170, v15
    v_mul_f32 v171, v171, v15
    v_mul_f32 v172, v172, v15
    v_mul_f32 v173, v173, v15
    v_mul_f32 v174, v174, v15
    v_mul_f32 v175, v175, v15
    s_branch ATrb_202
ATrs_203:
    v_mul_f32 v14, s58, v12
    v_max_f32 v14, v14, v10
    v_sub_f32 v15, v10, v14
    v_exp_f32 v15, v15
    v_mov_b32 v10, v14
    v_mov_b32 v11, v14
    s_nop 7
    v_mul_f32 v176, v176, v15
    v_mul_f32 v177, v177, v15
    v_mul_f32 v178, v178, v15
    v_mul_f32 v179, v179, v15
    v_mul_f32 v180, v180, v15
    v_mul_f32 v181, v181, v15
    v_mul_f32 v182, v182, v15
    v_mul_f32 v183, v183, v15
    v_mul_f32 v184, v184, v15
    v_mul_f32 v185, v185, v15
    v_mul_f32 v186, v186, v15
    v_mul_f32 v187, v187, v15
    v_mul_f32 v188, v188, v15
    v_mul_f32 v189, v189, v15
    v_mul_f32 v190, v190, v15
    v_mul_f32 v191, v191, v15
    s_branch ATrb_204
AT_end:
    s_lshl_b32 s55, s31, 2
    s_add_u32 s55, s55, 0xa600300
    s_waitcnt vmcnt(0)
    s_barrier
    s_cmp_eq_u32 s32, 0
    s_cbranch_scc0 ATsg_205
    v_mov_b32 v4, 1
    v_mov_b32 v5, 0
    s_mov_b64 exec, 1
    buffer_atomic_add v4, v5, s[8:11], s55 offen sc1
    s_mov_b64 exec, -1
ATsg_205:
    s_branch f_queue
f_fin:
    s_sub_u32 s40, s40, 256
    s_cmp_ge_u32 s40, 768
    s_cbranch_scc1 f_end2
    s_mov_b32 s54, 0x15555556
    s_mul_hi_u32 s30, s40, s54
    s_mul_i32 s54, s30, 12
    s_sub_u32 s31, s40, s54
    s_cmp_ge_u32 s31, 4
    s_cbranch_scc1 f_gout
    s_and_b32 s55, s30, 1
    s_lshl_b32 s55, s55, 5
    s_lshl_b32 s56, s31, 3
    s_add_u32 s55, s55, s56
    s_lshl_b32 s55, s55, 2
    s_add_u32 s55, s55, 0xa600000
    s_cmp_eq_u32 s32, 0
    s_cbranch_scc0 PWww_206
    s_add_u32 s54, s30, 1
    v_min_u32 v4, 7, v1
    v_mul_u32_u24 v4, 4, v4
    s_mov_b32 s43, 0x40000
PWwl_207:
    buffer_load_dword v5, v4, s[8:11], s55 offen sc1
    s_waitcnt vmcnt(0)
    v_cmp_gt_u32 vcc, 128, v5
    s_nop 1
    v_cndmask_b32 v5, 0, v5, vcc
    v_cmp_gt_u32 vcc, s54, v5
    s_cbranch_vccz PWwd_208
    s_sleep 8
    s_sub_u32 s43, s43, 1
    s_cbranch_scc0 PWwl_207
PWwd_208:
PWww_206:
    s_barrier
    v_lshlrev_b32 v10, 2, v3
    v_add_u32 v11, 0, v10
    v_cmp_le_u32 s[60:61], v11, v2
    v_add_u32 v11, 1, v10
    v_cmp_le_u32 s[62:63], v11, v2
    v_add_u32 v11, 2, v10
    v_cmp_le_u32 s[64:65], v11, v2
    v_add_u32 v11, 3, v10
    v_cmp_le_u32 s[66:67], v11, v2
    v_cmp_gt_u32 s[68:69], 2, v3
    v_lshlrev_b32 v6, 4, v1
    v_mov_b32 v7, 0xff61b1e6
    s_mov_b32 s57, 0x3e0293ee
    v_lshlrev_b32 v8, 9, v2
    v_lshl_add_u32 v8, v3, 3, v8
    s_lshl_b32 s58, s31, 3
    s_lshl_b32 s54, s32, 1
    s_add_u32 s58, s58, s54
    s_lshl_b32 s44, s30, 5
    s_add_u32 s44, s44, s58
    s_add_u32 s54, s44, 0
    s_lshl_b32 s55, s54, 13
    s_add_u32 s56, s55, 0x1000000
    s_add_u32 s59, s56, 0
    buffer_load_dwordx4 v[32:35], v6, s[8:11], s59 offen offset:0 sc1
    buffer_load_dwordx4 v[36:39], v6, s[8:11], s59 offen offset:1024 sc1
    s_add_u32 s59, s56, 2048
    buffer_load_dwordx4 v[40:43], v6, s[8:11], s59 offen offset:0 sc1
    buffer_load_dwordx4 v[44:47], v6, s[8:11], s59 offen offset:1024 sc1
    s_add_u32 s59, s56, 4096
    buffer_load_dwordx4 v[48:51], v6, s[8:11], s59 offen offset:0 sc1
    buffer_load_dwordx4 v[52:55], v6, s[8:11], s59 offen offset:1024 sc1
    s_add_u32 s59, s56, 6144
    buffer_load_dwordx4 v[56:59], v6, s[8:11], s59 offen offset:0 sc1
    buffer_load_dwordx4 v[60:63], v6, s[8:11], s59 offen offset:1024 sc1
    s_add_u32 s56, s55, 0x0
    s_add_u32 s59, s56, 0
    buffer_load_dwordx4 v[64:67], v6, s[8:11], s59 offen offset:0 sc1
    buffer_load_dwordx4 v[68:71], v6, s[8:11], s59 offen offset:1024 sc1
    s_add_u32 s59, s56, 2048
    buffer_load_dwordx4 v[72:75], v6, s[8:11], s59 offen offset:0 sc1
    buffer_load_dwordx4 v[76:79], v6, s[8:11], s59 offen offset:1024 sc1
    s_add_u32 s59, s56, 4096
    buffer_load_dwordx4 v[80:83], v6, s[8:11], s59 offen offset:0 sc1
    buffer_load_dwordx4 v[84:87], v6, s[8:11], s59 offen offset:1024 sc1
    s_add_u32 s59, s56, 6144
    buffer_load_dwordx4 v[88:91], v6, s[8:11], s59 offen offset:0 sc1
    buffer_load_dwordx4 v[92:95], v6, s[8:11], s59 offen offset:1024 sc1
    s_add_u32 s54, s44, 1
    s_lshl_b32 s55, s54, 13
    s_add_u32 s56, s55, 0x1000000
    s_add_u32 s59, s56, 0
    buffer_load_dwordx4 v[96:99], v6, s[8:11], s59 offen offset:0 sc1
    buffer_load_dwordx4 v[100:103], v6, s[8:11], s59 offen offset:1024 sc1
    s_add_u32 s59, s56, 2048
    buffer_load_dwordx4 v[104:107], v6, s[8:11], s59 offen offset:0 sc1
    buffer_load_dwordx4 v[108:111], v6, s[8:11], s59 offen offset:1024 sc1
    s_add_u32 s59, s56, 4096
    buffer_load_dwordx4 v[112:115], v6, s[8:11], s59 offen offset:0 sc1
    buffer_load_dwordx4 v[116:119], v6, s[8:11], s59 offen offset:1024 sc1
    s_add_u32 s59, s56, 6144
    buffer_load_dwordx4 v[120:123], v6, s[8:11], s59 offen offset:0 sc1
    buffer_load_dwordx4 v[124:127], v6, s[8:11], s59 offen offset:1024 sc1
    s_add_u32 s56, s55, 0x0
    s_add_u32 s59, s56, 0
    buffer_load_dwordx4 v[128:131], v6, s[8:11], s59 offen offset:0 sc1
    buffer_load_dwordx4 v[132:135], v6, s[8:11], s59 offen offset:1024 sc1
    s_add_u32 s59, s56, 2048
    buffer_load_dwordx4 v[136:139], v6, s[8:11], s59 offen offset:0 sc1
    buffer_load_dwordx4 v[140:143], v6, s[8:11], s59 offen offset:1024 sc1
    s_add_u32 s59, s56, 4096
    buffer_load_dwordx4 v[144:147], v6, s[8:11], s59 offen offset:0 sc1
    buffer_load_dwordx4 v[148:151], v6, s[8:11], s59 offen offset:1024 sc1
    s_add_u32 s59, s56, 6144
    buffer_load_dwordx4 v[152:155], v6, s[8:11], s59 offen offset:0 sc1
    buffer_load_dwordx4 v[156:159], v6, s[8:11], s59 offen offset:1024 sc1
    s_waitcnt vmcnt(0)
    v_mfma_f32_16x16x32_bf16 v[196:199], v[64:67], v[32:35], 0
    v_mfma_f32_16x16x32_bf16 v[208:211], v[64:67], v[36:39], 0
    v_mfma_f32_16x16x32_bf16 v[212:215], v[68:71], v[36:39], 0
    v_mfma_f32_16x16x32_bf16 v[196:199], v[72:75], v[40:43], v[196:199]
    v_mfma_f32_16x16x32_bf16 v[208:211], v[72:75], v[44:47], v[208:211]
    v_mfma_f32_16x16x32_bf16 v[212:215], v[76:79], v[44:47], v[212:215]
    v_mfma_f32_16x16x32_bf16 v[196:199], v[80:83], v[48:51], v[196:199]
    v_mfma_f32_16x16x32_bf16 v[208:211], v[80:83], v[52:55], v[208:211]
    v_mfma_f32_16x16x32_bf16 v[212:215], v[84:87], v[52:55], v[212:215]
    v_mfma_f32_16x16x32_bf16 v[196:199], v[88:91], v[56:59], v[196:199]
    v_mfma_f32_16x16x32_bf16 v[208:211], v[88:91], v[60:63], v[208:211]
    v_mfma_f32_16x16x32_bf16 v[212:215], v[92:95], v[60:63], v[212:215]
    v_mfma_f32_16x16x32_bf16 v[220:223], v[128:131], v[96:99], 0
    v_mfma_f32_16x16x32_bf16 v[232:235], v[128:131], v[100:103], 0
    v_mfma_f32_16x16x32_bf16 v[236:239], v[132:135], v[100:103], 0
    v_mfma_f32_16x16x32_bf16 v[220:223], v[136:139], v[104:107], v[220:223]
    v_mfma_f32_16x16x32_bf16 v[232:235], v[136:139], v[108:111], v[232:235]
    v_mfma_f32_16x16x32_bf16 v[236:239], v[140:143], v[108:111], v[236:239]
    v_mfma_f32_16x16x32_bf16 v[220:223], v[144:147], v[112:115], v[220:223]
    v_mfma_f32_16x16x32_bf16 v[232:235], v[144:147], v[116:119], v[232:235]
    v_mfma_f32_16x16x32_bf16 v[236:239], v[148:151], v[116:119], v[236:239]
    v_mfma_f32_16x16x32_bf16 v[220:223], v[152:155], v[120:123], v[220:223]
    v_mfma_f32_16x16x32_bf16 v[232:235], v[152:155], v[124:127], v[232:235]
    v_mfma_f32_16x16x32_bf16 v[236:239], v[156:159], v[124:127], v[236:239]
    s_lshl_b32 s55, s31, 5
    s_add_u32 s55, s55, 0xa600200
    s_cmp_eq_u32 s32, 0
    s_cbranch_scc0 PKww_209
    s_add_u32 s54, s30, 1
    v_min_u32 v12, 7, v1
    v_mul_u32_u24 v12, 4, v12
    s_mov_b32 s43, 0x40000
PKwl_210:
    buffer_load_dword v13, v12, s[8:11], s55 offen sc1
    s_waitcnt vmcnt(0)
    v_cmp_gt_u32 vcc, 128, v13
    s_nop 1
    v_cndmask_b32 v13, 0, v13, vcc
    v_cmp_gt_u32 vcc, s54, v13
    s_cbranch_vccz PKwd_211
    s_sleep 2
    s_sub_u32 s43, s43, 1
    s_cbranch_scc0 PKwl_210
PKwd_211:
PKww_209:
    s_barrier
    s_add_u32 s54, s44, 0
    s_lshl_b32 s56, s54, 12
    s_add_u32 s56, s56, 0x8400000
    buffer_load_dwordx4 v[160:163], v6, s[8:11], s56 offen offset:0 sc1
    buffer_load_dwordx4 v[164:167], v6, s[8:11], s56 offen offset:1024 sc1
    buffer_load_dwordx4 v[168:171], v6, s[8:11], s56 offen offset:2048 sc1
    buffer_load_dwordx4 v[172:175], v6, s[8:11], s56 offen offset:3072 sc1
    s_add_u32 s54, s44, 1
    s_lshl_b32 s56, s54, 12
    s_add_u32 s56, s56, 0x8400000
    buffer_load_dwordx4 v[176:179], v6, s[8:11], s56 offen offset:0 sc1
    buffer_load_dwordx4 v[180:183], v6, s[8:11], s56 offen offset:1024 sc1
    buffer_load_dwordx4 v[184:187], v6, s[8:11], s56 offen offset:2048 sc1
    buffer_load_dwordx4 v[188:191], v6, s[8:11], s56 offen offset:3072 sc1
    s_waitcnt vmcnt(4)
    v_mfma_f32_16x16x32_bf16 v[192:195], v[160:163], v[32:35], 0
    v_mfma_f32_16x16x32_bf16 v[204:207], v[160:163], v[36:39], 0
    v_mfma_f32_16x16x32_bf16 v[192:195], v[164:167], v[40:43], v[192:195]
    v_mfma_f32_16x16x32_bf16 v[204:207], v[164:167], v[44:47], v[204:207]
    v_mfma_f32_16x16x32_bf16 v[192:195], v[168:171], v[48:51], v[192:195]
    v_mfma_f32_16x16x32_bf16 v[204:207], v[168:171], v[52:55], v[204:207]
    v_mfma_f32_16x16x32_bf16 v[192:195], v[172:175], v[56:59], v[192:195]
    v_mfma_f32_16x16x32_bf16 v[204:207], v[172:175], v[60:63], v[204:207]
    s_waitcnt vmcnt(0)
    v_mfma_f32_16x16x32_bf16 v[216:219], v[176:179], v[96:99], 0
    v_mfma_f32_16x16x32_bf16 v[228:231], v[176:179], v[100:103], 0
    v_mfma_f32_16x16x32_bf16 v[216:219], v[180:183], v[104:107], v[216:219]
    v_mfma_f32_16x16x32_bf16 v[228:231], v[180:183], v[108:111], v[228:231]
    v_mfma_f32_16x16x32_bf16 v[216:219], v[184:187], v[112:115], v[216:219]
    v_mfma_f32_16x16x32_bf16 v[228:231], v[184:187], v[116:119], v[228:231]
    v_mfma_f32_16x16x32_bf16 v[216:219], v[188:191], v[120:123], v[216:219]
    v_mfma_f32_16x16x32_bf16 v[228:231], v[188:191], v[124:127], v[228:231]
    s_nop 7
    v_cndmask_b32 v192, v7, v192, s[68:69]
    v_cndmask_b32 v196, v7, v196, s[60:61]
    v_cndmask_b32 v193, v7, v193, s[68:69]
    v_cndmask_b32 v197, v7, v197, s[62:63]
    v_cndmask_b32 v194, v7, v194, s[68:69]
    v_cndmask_b32 v198, v7, v198, s[64:65]
    v_cndmask_b32 v195, v7, v195, s[68:69]
    v_cndmask_b32 v199, v7, v199, s[66:67]
    v_max3_f32 v240, v192, v193, v194
    v_max3_f32 v240, v240, v195, v196
    v_max3_f32 v240, v240, v197, v198
    v_max_f32 v240, v240, v199
    v_mov_b32 v241, v240
    s_nop 1
    v_permlane32_swap_b32 v240, v241
    s_nop 0
    v_max_f32 v240, v240, v241
    v_mov_b32 v241, v240
    s_nop 1
    v_permlane16_swap_b32 v240, v241
    s_nop 0
    v_max_f32 v240, v240, v241
    v_mul_f32 v240, s57, v240
    v_fma_f32 v192, v192, s57, -v240
    v_fma_f32 v193, v193, s57, -v240
    v_fma_f32 v194, v194, s57, -v240
    v_fma_f32 v195, v195, s57, -v240
    v_fma_f32 v196, v196, s57, -v240
    v_fma_f32 v197, v197, s57, -v240
    v_fma_f32 v198, v198, s57, -v240
    v_fma_f32 v199, v199, s57, -v240
    v_exp_f32 v192, v192
    v_exp_f32 v193, v193
    v_exp_f32 v194, v194
    v_exp_f32 v195, v195
    v_exp_f32 v196, v196
    v_exp_f32 v197, v197
    v_exp_f32 v198, v198
    v_exp_f32 v199, v199
    s_nop 0
    v_add_f32 v242, v192, v193
    v_add_f32 v242, v242, v194
    v_add_f32 v242, v242, v195
    v_add_f32 v242, v242, v196
    v_add_f32 v242, v242, v197
    v_add_f32 v242, v242, v198
    v_add_f32 v242, v242, v199
    v_mov_b32 v241, v242
    s_nop 1
    v_permlane32_swap_b32 v242, v241
    s_nop 0
    v_add_f32 v242, v242, v241
    v_mov_b32 v241, v242
    s_nop 1
    v_permlane16_swap_b32 v242, v241
    s_nop 0
    v_add_f32 v242, v242, v241
    v_rcp_f32 v242, v242
    s_nop 0
    v_mul_f32 v192, v192, v242
    v_mul_f32 v193, v193, v242
    v_mul_f32 v194, v194, v242
    v_mul_f32 v195, v195, v242
    v_mul_f32 v196, v196, v242
    v_mul_f32 v197, v197, v242
    v_mul_f32 v198, v198, v242
    v_mul_f32 v199, v199, v242
    v_cvt_pk_bf16_f32 v244, v196, v197
    v_cvt_pk_bf16_f32 v245, v198, v199
    v_mov_b32 v246, 0
    v_mov_b32 v247, 0
    v_cvt_pk_bf16_f32 v252, v192, v193
    v_cvt_pk_bf16_f32 v253, v194, v195
    s_add_u32 s54, s44, 0
    s_lshl_b32 s56, s54, 11
    s_add_u32 s56, s56, 0xa100000
    buffer_store_dwordx4 v[244:247], v6, s[8:11], s56 offen sc1
    s_lshl_b32 s56, s30, 14
    s_add_u32 s59, s58, 0
    s_lshl_b32 s59, s59, 4
    s_add_u32 s56, s56, s59
    s_add_u32 s56, s56, 0xa500000
    s_mov_b64 exec, s[68:69]
    buffer_store_dwordx2 v[252:253], v8, s[8:11], s56 offen sc1
    s_mov_b64 exec, -1
    s_nop 1
    v_cndmask_b32 v204, v7, v204, s[68:69]
    v_cndmask_b32 v212, v7, v212, s[60:61]
    v_cndmask_b32 v205, v7, v205, s[68:69]
    v_cndmask_b32 v213, v7, v213, s[62:63]
    v_cndmask_b32 v206, v7, v206, s[68:69]
    v_cndmask_b32 v214, v7, v214, s[64:65]
    v_cndmask_b32 v207, v7, v207, s[68:69]
    v_cndmask_b32 v215, v7, v215, s[66:67]
    v_max3_f32 v240, v204, v205, v206
    v_max3_f32 v240, v240, v207, v208
    v_max3_f32 v240, v240, v209, v210
    v_max3_f32 v240, v240, v211, v212
    v_max3_f32 v240, v240, v213, v214
    v_max_f32 v240, v240, v215
    v_mov_b32 v241, v240
    s_nop 1
    v_permlane32_swap_b32 v240, v241
    s_nop 0
    v_max_f32 v240, v240, v241
    v_mov_b32 v241, v240
    s_nop 1
    v_permlane16_swap_b32 v240, v241
    s_nop 0
    v_max_f32 v240, v240, v241
    v_mul_f32 v240, s57, v240
    v_fma_f32 v204, v204, s57, -v240
    v_fma_f32 v205, v205, s57, -v240
    v_fma_f32 v206, v206, s57, -v240
    v_fma_f32 v207, v207, s57, -v240
    v_fma_f32 v208, v208, s57, -v240
    v_fma_f32 v209, v209, s57, -v240
    v_fma_f32 v210, v210, s57, -v240
    v_fma_f32 v211, v211, s57, -v240
    v_fma_f32 v212, v212, s57, -v240
    v_fma_f32 v213, v213, s57, -v240
    v_fma_f32 v214, v214, s57, -v240
    v_fma_f32 v215, v215, s57, -v240
    v_exp_f32 v204, v204
    v_exp_f32 v205, v205
    v_exp_f32 v206, v206
    v_exp_f32 v207, v207
    v_exp_f32 v208, v208
    v_exp_f32 v209, v209
    v_exp_f32 v210, v210
    v_exp_f32 v211, v211
    v_exp_f32 v212, v212
    v_exp_f32 v213, v213
    v_exp_f32 v214, v214
    v_exp_f32 v215, v215
    s_nop 0
    v_add_f32 v242, v204, v205
    v_add_f32 v242, v242, v206
    v_add_f32 v242, v242, v207
    v_add_f32 v242, v242, v208
    v_add_f32 v242, v242, v209
    v_add_f32 v242, v242, v210
    v_add_f32 v242, v242, v211
    v_add_f32 v242, v242, v212
    v_add_f32 v242, v242, v213
    v_add_f32 v242, v242, v214
    v_add_f32 v242, v242, v215
    v_mov_b32 v241, v242
    s_nop 1
    v_permlane32_swap_b32 v242, v241
    s_nop 0
    v_add_f32 v242, v242, v241
    v_mov_b32 v241, v242
    s_nop 1
    v_permlane16_swap_b32 v242, v241
    s_nop 0
    v_add_f32 v242, v242, v241
    v_rcp_f32 v242, v242
    s_nop 0
    v_mul_f32 v204, v204, v242
    v_mul_f32 v205, v205, v242
    v_mul_f32 v206, v206, v242
    v_mul_f32 v207, v207, v242
    v_mul_f32 v208, v208, v242
    v_mul_f32 v209, v209, v242
    v_mul_f32 v210, v210, v242
    v_mul_f32 v211, v211, v242
    v_mul_f32 v212, v212, v242
    v_mul_f32 v213, v213, v242
    v_mul_f32 v214, v214, v242
    v_mul_f32 v215, v215, v242
    v_cvt_pk_bf16_f32 v248, v208, v209
    v_cvt_pk_bf16_f32 v249, v210, v211
    v_cvt_pk_bf16_f32 v250, v212, v213
    v_cvt_pk_bf16_f32 v251, v214, v215
    v_cvt_pk_bf16_f32 v254, v204, v205
    v_cvt_pk_bf16_f32 v255, v206, v207
    s_add_u32 s54, s44, 0
    s_lshl_b32 s56, s54, 11
    s_add_u32 s56, s56, 0xa100400
    buffer_store_dwordx4 v[248:251], v6, s[8:11], s56 offen sc1
    s_lshl_b32 s56, s30, 14
    s_add_u32 s59, s58, 0
    s_lshl_b32 s59, s59, 4
    s_add_u32 s56, s56, s59
    s_add_u32 s56, s56, 0xa502000
    s_mov_b64 exec, s[68:69]
    buffer_store_dwordx2 v[254:255], v8, s[8:11], s56 offen sc1
    s_mov_b64 exec, -1
    s_nop 1
    v_cndmask_b32 v216, v7, v216, s[68:69]
    v_cndmask_b32 v220, v7, v220, s[60:61]
    v_cndmask_b32 v217, v7, v217, s[68:69]
    v_cndmask_b32 v221, v7, v221, s[62:63]
    v_cndmask_b32 v218, v7, v218, s[68:69]
    v_cndmask_b32 v222, v7, v222, s[64:65]
    v_cndmask_b32 v219, v7, v219, s[68:69]
    v_cndmask_b32 v223, v7, v223, s[66:67]
    v_max3_f32 v240, v216, v217, v218
    v_max3_f32 v240, v240, v219, v220
    v_max3_f32 v240, v240, v221, v222
    v_max_f32 v240, v240, v223
    v_mov_b32 v241, v240
    s_nop 1
    v_permlane32_swap_b32 v240, v241
    s_nop 0
    v_max_f32 v240, v240, v241
    v_mov_b32 v241, v240
    s_nop 1
    v_permlane16_swap_b32 v240, v241
    s_nop 0
    v_max_f32 v240, v240, v241
    v_mul_f32 v240, s57, v240
    v_fma_f32 v216, v216, s57, -v240
    v_fma_f32 v217, v217, s57, -v240
    v_fma_f32 v218, v218, s57, -v240
    v_fma_f32 v219, v219, s57, -v240
    v_fma_f32 v220, v220, s57, -v240
    v_fma_f32 v221, v221, s57, -v240
    v_fma_f32 v222, v222, s57, -v240
    v_fma_f32 v223, v223, s57, -v240
    v_exp_f32 v216, v216
    v_exp_f32 v217, v217
    v_exp_f32 v218, v218
    v_exp_f32 v219, v219
    v_exp_f32 v220, v220
    v_exp_f32 v221, v221
    v_exp_f32 v222, v222
    v_exp_f32 v223, v223
    s_nop 0
    v_add_f32 v242, v216, v217
    v_add_f32 v242, v242, v218
    v_add_f32 v242, v242, v219
    v_add_f32 v242, v242, v220
    v_add_f32 v242, v242, v221
    v_add_f32 v242, v242, v222
    v_add_f32 v242, v242, v223
    v_mov_b32 v241, v242
    s_nop 1
    v_permlane32_swap_b32 v242, v241
    s_nop 0
    v_add_f32 v242, v242, v241
    v_mov_b32 v241, v242
    s_nop 1
    v_permlane16_swap_b32 v242, v241
    s_nop 0
    v_add_f32 v242, v242, v241
    v_rcp_f32 v242, v242
    s_nop 0
    v_mul_f32 v216, v216, v242
    v_mul_f32 v217, v217, v242
    v_mul_f32 v218, v218, v242
    v_mul_f32 v219, v219, v242
    v_mul_f32 v220, v220, v242
    v_mul_f32 v221, v221, v242
    v_mul_f32 v222, v222, v242
    v_mul_f32 v223, v223, v242
    v_cvt_pk_bf16_f32 v244, v220, v221
    v_cvt_pk_bf16_f32 v245, v222, v223
    v_mov_b32 v246, 0
    v_mov_b32 v247, 0
    v_cvt_pk_bf16_f32 v252, v216, v217
    v_cvt_pk_bf16_f32 v253, v218, v219
    s_add_u32 s54, s44, 1
    s_lshl_b32 s56, s54, 11
    s_add_u32 s56, s56, 0xa100000
    buffer_store_dwordx4 v[244:247], v6, s[8:11], s56 offen sc1
    s_lshl_b32 s56, s30, 14
    s_add_u32 s59, s58, 1
    s_lshl_b32 s59, s59, 4
    s_add_u32 s56, s56, s59
    s_add_u32 s56, s56, 0xa500000
    s_mov_b64 exec, s[68:69]
    buffer_store_dwordx2 v[252:253], v8, s[8:11], s56 offen sc1
    s_mov_b64 exec, -1
    s_nop 1
    v_cndmask_b32 v228, v7, v228, s[68:69]
    v_cndmask_b32 v236, v7, v236, s[60:61]
    v_cndmask_b32 v229, v7, v229, s[68:69]
    v_cndmask_b32 v237, v7, v237, s[62:63]
    v_cndmask_b32 v230, v7, v230, s[68:69]
    v_cndmask_b32 v238, v7, v238, s[64:65]
    v_cndmask_b32 v231, v7, v231, s[68:69]
    v_cndmask_b32 v239, v7, v239, s[66:67]
    v_max3_f32 v240, v228, v229, v230
    v_max3_f32 v240, v240, v231, v232
    v_max3_f32 v240, v240, v233, v234
    v_max3_f32 v240, v240, v235, v236
    v_max3_f32 v240, v240, v237, v238
    v_max_f32 v240, v240, v239
    v_mov_b32 v241, v240
    s_nop 1
    v_permlane32_swap_b32 v240, v241
    s_nop 0
    v_max_f32 v240, v240, v241
    v_mov_b32 v241, v240
    s_nop 1
    v_permlane16_swap_b32 v240, v241
    s_nop 0
    v_max_f32 v240, v240, v241
    v_mul_f32 v240, s57, v240
    v_fma_f32 v228, v228, s57, -v240
    v_fma_f32 v229, v229, s57, -v240
    v_fma_f32 v230, v230, s57, -v240
    v_fma_f32 v231, v231, s57, -v240
    v_fma_f32 v232, v232, s57, -v240
    v_fma_f32 v233, v233, s57, -v240
    v_fma_f32 v234, v234, s57, -v240
    v_fma_f32 v235, v235, s57, -v240
    v_fma_f32 v236, v236, s57, -v240
    v_fma_f32 v237, v237, s57, -v240
    v_fma_f32 v238, v238, s57, -v240
    v_fma_f32 v239, v239, s57, -v240
    v_exp_f32 v228, v228
    v_exp_f32 v229, v229
    v_exp_f32 v230, v230
    v_exp_f32 v231, v231
    v_exp_f32 v232, v232
    v_exp_f32 v233, v233
    v_exp_f32 v234, v234
    v_exp_f32 v235, v235
    v_exp_f32 v236, v236
    v_exp_f32 v237, v237
    v_exp_f32 v238, v238
    v_exp_f32 v239, v239
    s_nop 0
    v_add_f32 v242, v228, v229
    v_add_f32 v242, v242, v230
    v_add_f32 v242, v242, v231
    v_add_f32 v242, v242, v232
    v_add_f32 v242, v242, v233
    v_add_f32 v242, v242, v234
    v_add_f32 v242, v242, v235
    v_add_f32 v242, v242, v236
    v_add_f32 v242, v242, v237
    v_add_f32 v242, v242, v238
    v_add_f32 v242, v242, v239
    v_mov_b32 v241, v242
    s_nop 1
    v_permlane32_swap_b32 v242, v241
    s_nop 0
    v_add_f32 v242, v242, v241
    v_mov_b32 v241, v242
    s_nop 1
    v_permlane16_swap_b32 v242, v241
    s_nop 0
    v_add_f32 v242, v242, v241
    v_rcp_f32 v242, v242
    s_nop 0
    v_mul_f32 v228, v228, v242
    v_mul_f32 v229, v229, v242
    v_mul_f32 v230, v230, v242
    v_mul_f32 v231, v231, v242
    v_mul_f32 v232, v232, v242
    v_mul_f32 v233, v233, v242
    v_mul_f32 v234, v234, v242
    v_mul_f32 v235, v235, v242
    v_mul_f32 v236, v236, v242
    v_mul_f32 v237, v237, v242
    v_mul_f32 v238, v238, v242
    v_mul_f32 v239, v239, v242
    v_cvt_pk_bf16_f32 v248, v232, v233
    v_cvt_pk_bf16_f32 v249, v234, v235
    v_cvt_pk_bf16_f32 v250, v236, v237
    v_cvt_pk_bf16_f32 v251, v238, v239
    v_cvt_pk_bf16_f32 v254, v228, v229
    v_cvt_pk_bf16_f32 v255, v230, v231
    s_add_u32 s54, s44, 1
    s_lshl_b32 s56, s54, 11
    s_add_u32 s56, s56, 0xa100400
    buffer_store_dwordx4 v[248:251], v6, s[8:11], s56 offen sc1
    s_lshl_b32 s56, s30, 14
    s_add_u32 s59, s58, 1
    s_lshl_b32 s59, s59, 4
    s_add_u32 s56, s56, s59
    s_add_u32 s56, s56, 0xa502000
    s_mov_b64 exec, s[68:69]
    buffer_store_dwordx2 v[254:255], v8, s[8:11], s56 offen sc1
    s_mov_b64 exec, -1
    s_nop 1
    s_waitcnt vmcnt(0)
    s_lshl_b32 s55, s30, 2
    s_add_u32 s55, s55, 0xa600400
    s_waitcnt vmcnt(0)
    s_barrier
    s_cmp_eq_u32 s32, 0
    s_cbranch_scc0 PTsg_212
    v_mov_b32 v4, 1
    v_mov_b32 v5, 0
    s_mov_b64 exec, 1
    buffer_atomic_add v4, v5, s[8:11], s55 offen sc1
    s_mov_b64 exec, -1
PTsg_212:
    s_cmp_eq_u32 s32, 0
    s_cbranch_scc0 PTdn_213
    v_mov_b32 v4, 1
    v_mov_b32 v5, 56
    s_mov_b64 exec, 1
    buffer_atomic_add v4, v5, s[20:23], 0 offen sc0
    s_waitcnt vmcnt(0)
    s_mov_b64 exec, -1
    v_readfirstlane_b32 s54, v4
    s_nop 3
    s_cmp_eq_u32 s54, 767
    s_cbranch_scc0 PTdn_213
    v_lshlrev_b32 v4, 5, v1
    v_mov_b32 v8, 0
    v_mov_b32 v9, 0
    v_mov_b32 v10, 0
    v_mov_b32 v11, 0
    s_mov_b32 s54, 0xa600000
    buffer_store_dwordx4 v[8:11], v4, s[8:11], s54 offen sc1
    buffer_store_dwordx4 v[8:11], v4, s[8:11], s54 offen offset:16 sc1
    s_waitcnt vmcnt(0)
PTdn_213:
    s_branch f_queue
f_gout:
    s_sub_u32 s31, s31, 4
    s_mov_b32 s24, s76
    s_and_b32 s25, s77, 0xffff
    s_mov_b32 s26, 0x280000
    s_mov_b32 s27, 0x00020000
    s_mov_b32 s12, s92
    s_and_b32 s13, s93, 0xffff
    s_mov_b32 s14, 0x500
    s_mov_b32 s15, 0x00020000
    s_mov_b32 s16, s94
    s_and_b32 s17, s95, 0xffff
    s_mov_b32 s18, 0x280000
    s_mov_b32 s19, 0x00020000
    v_lshlrev_b32 v6, 4, v1
    v_mul_u32_u24 v7, 1280, v2
    v_lshl_add_u32 v7, v3, 4, v7
    v_lshlrev_b32 v10, 4, v3
    v_lshlrev_b32 v8, 9, v2
    v_lshl_add_u32 v8, v3, 4, v8
    v_mul_u32_u24 v9, 10240, v3
    v_lshl_add_u32 v9, v2, 4, v9
    s_mov_b32 s55, 0x30
    s_cmp_eq_u32 s32, 0
    s_cbranch_scc0 GWww_214
    s_mov_b32 s54, 0x5
    v_min_u32 v12, 0, v1
    v_mul_u32_u24 v12, 4, v12
    s_mov_b32 s43, 0x40000
GWwl_215:
    buffer_load_dword v13, v12, s[20:23], s55 offen sc1
    s_waitcnt vmcnt(0)
    v_cmp_gt_u32 vcc, 128, v13
    s_nop 1
    v_cndmask_b32 v13, 0, v13, vcc
    v_cmp_gt_u32 vcc, s54, v13
    s_cbranch_vccz GWwd_216
    s_sleep 4
    s_sub_u32 s43, s43, 1
    s_cbranch_scc0 GWwl_215
GWwd_216:
GWww_214:
    s_barrier
    s_lshr_b32 s55, s30, 3
    s_lshl_b32 s55, s55, 2
    s_add_u32 s55, s55, 0xa600300
    s_cmp_eq_u32 s32, 0
    s_cbranch_scc0 GAww_217
    s_mov_b32 s54, 0x20
    v_min_u32 v12, 0, v1
    v_mul_u32_u24 v12, 4, v12
    s_mov_b32 s43, 0x40000
GAwl_218:
    buffer_load_dword v13, v12, s[8:11], s55 offen sc1
    s_waitcnt vmcnt(0)
    v_cmp_gt_u32 vcc, 128, v13
    s_nop 1
    v_cndmask_b32 v13, 0, v13, vcc
    v_cmp_gt_u32 vcc, s54, v13
    s_cbranch_vccz GAwd_219
    s_sleep 8
    s_sub_u32 s43, s43, 1
    s_cbranch_scc0 GAwl_218
GAwd_219:
GAww_217:
    s_barrier
    s_mul_i32 s58, s30, 40960
    s_mul_i32 s54, s32, 320
    s_add_u32 s58, s58, s54
    s_mul_i32 s59, s31, 102400
    s_mul_i32 s54, s32, 5120
    s_add_u32 s59, s59, s54
    s_add_u32 s59, s59, 0xa000000
    s_mul_i32 s60, s32, 320
    s_add_u32 s54, s58, 0
    s_add_u32 s55, s54, 0x9d00000
    buffer_load_dwordx4 v[128:131], v7, s[8:11], s55 offen sc1
    buffer_load_dwordx4 v[136:139], v7, s[24:27], s54 offen
    s_add_u32 s54, s58, 20480
    s_add_u32 s55, s54, 0x9d00000
    buffer_load_dwordx4 v[132:135], v7, s[8:11], s55 offen sc1
    buffer_load_dwordx4 v[140:143], v7, s[24:27], s54 offen
    buffer_load_dwordx4 v[144:147], v10, s[12:15], s60 offen offset:0
    s_add_u32 s54, s59, 0
    buffer_load_dwordx4 v[148:151], v6, s[8:11], s54 offen sc1
    s_add_u32 s54, s59, 20480
    buffer_load_dwordx4 v[152:155], v6, s[8:11], s54 offen sc1
    s_add_u32 s54, s59, 40960
    buffer_load_dwordx4 v[156:159], v6, s[8:11], s54 offen sc1
    s_add_u32 s54, s59, 61440
    buffer_load_dwordx4 v[160:163], v6, s[8:11], s54 offen sc1
    s_add_u32 s54, s59, 81920
    buffer_load_dwordx4 v[164:167], v6, s[8:11], s54 offen sc1
    s_waitcnt vmcnt(0)
    v_mfma_f32_16x16x32_bf16 v[112:115], v[144:147], v[136:139], 0
    v_mfma_f32_16x16x32_bf16 v[72:75], v[148:151], v[128:131], 0
    v_mfma_f32_16x16x32_bf16 v[80:83], v[152:155], v[128:131], 0
    v_mfma_f32_16x16x32_bf16 v[88:91], v[156:159], v[128:131], 0
    v_mfma_f32_16x16x32_bf16 v[96:99], v[160:163], v[128:131], 0
    v_mfma_f32_16x16x32_bf16 v[104:107], v[164:167], v[128:131], 0
    v_mfma_f32_16x16x32_bf16 v[116:119], v[144:147], v[140:143], 0
    v_mfma_f32_16x16x32_bf16 v[76:79], v[148:151], v[132:135], 0
    v_mfma_f32_16x16x32_bf16 v[84:87], v[152:155], v[132:135], 0
    v_mfma_f32_16x16x32_bf16 v[92:95], v[156:159], v[132:135], 0
    v_mfma_f32_16x16x32_bf16 v[100:103], v[160:163], v[132:135], 0
    v_mfma_f32_16x16x32_bf16 v[108:111], v[164:167], v[132:135], 0
    s_add_u32 s54, s58, 64
    s_add_u32 s55, s54, 0x9d00000
    buffer_load_dwordx4 v[168:171], v7, s[8:11], s55 offen sc1
    buffer_load_dwordx4 v[176:179], v7, s[24:27], s54 offen
    s_add_u32 s54, s58, 20544
    s_add_u32 s55, s54, 0x9d00000
    buffer_load_dwordx4 v[172:175], v7, s[8:11], s55 offen sc1
    buffer_load_dwordx4 v[180:183], v7, s[24:27], s54 offen
    buffer_load_dwordx4 v[184:187], v10, s[12:15], s60 offen offset:64
    s_add_u32 s54, s59, 1024
    buffer_load_dwordx4 v[188:191], v6, s[8:11], s54 offen sc1
    s_add_u32 s54, s59, 21504
    buffer_load_dwordx4 v[192:195], v6, s[8:11], s54 offen sc1
    s_add_u32 s54, s59, 41984
    buffer_load_dwordx4 v[196:199], v6, s[8:11], s54 offen sc1
    s_add_u32 s54, s59, 62464
    buffer_load_dwordx4 v[200:203], v6, s[8:11], s54 offen sc1
    s_add_u32 s54, s59, 82944
    buffer_load_dwordx4 v[204:207], v6, s[8:11], s54 offen sc1
    s_waitcnt vmcnt(0)
    v_mfma_f32_16x16x32_bf16 v[112:115], v[184:187], v[176:179], v[112:115]
    v_mfma_f32_16x16x32_bf16 v[72:75], v[188:191], v[168:171], v[72:75]
    v_mfma_f32_16x16x32_bf16 v[80:83], v[192:195], v[168:171], v[80:83]
    v_mfma_f32_16x16x32_bf16 v[88:91], v[196:199], v[168:171], v[88:91]
    v_mfma_f32_16x16x32_bf16 v[96:99], v[200:203], v[168:171], v[96:99]
    v_mfma_f32_16x16x32_bf16 v[104:107], v[204:207], v[168:171], v[104:107]
    v_mfma_f32_16x16x32_bf16 v[116:119], v[184:187], v[180:183], v[116:119]
    v_mfma_f32_16x16x32_bf16 v[76:79], v[188:191], v[172:175], v[76:79]
    v_mfma_f32_16x16x32_bf16 v[84:87], v[192:195], v[172:175], v[84:87]
    v_mfma_f32_16x16x32_bf16 v[92:95], v[196:199], v[172:175], v[92:95]
    v_mfma_f32_16x16x32_bf16 v[100:103], v[200:203], v[172:175], v[100:103]
    v_mfma_f32_16x16x32_bf16 v[108:111], v[204:207], v[172:175], v[108:111]
    s_add_u32 s54, s58, 128
    s_add_u32 s55, s54, 0x9d00000
    buffer_load_dwordx4 v[128:131], v7, s[8:11], s55 offen sc1
    buffer_load_dwordx4 v[136:139], v7, s[24:27], s54 offen
    s_add_u32 s54, s58, 20608
    s_add_u32 s55, s54, 0x9d00000
    buffer_load_dwordx4 v[132:135], v7, s[8:11], s55 offen sc1
    buffer_load_dwordx4 v[140:143], v7, s[24:27], s54 offen
    buffer_load_dwordx4 v[144:147], v10, s[12:15], s60 offen offset:128
    s_add_u32 s54, s59, 2048
    buffer_load_dwordx4 v[148:151], v6, s[8:11], s54 offen sc1
    s_add_u32 s54, s59, 22528
    buffer_load_dwordx4 v[152:155], v6, s[8:11], s54 offen sc1
    s_add_u32 s54, s59, 43008
    buffer_load_dwordx4 v[156:159], v6, s[8:11], s54 offen sc1
    s_add_u32 s54, s59, 63488
    buffer_load_dwordx4 v[160:163], v6, s[8:11], s54 offen sc1
    s_add_u32 s54, s59, 83968
    buffer_load_dwordx4 v[164:167], v6, s[8:11], s54 offen sc1
    s_waitcnt vmcnt(0)
    v_mfma_f32_16x16x32_bf16 v[112:115], v[144:147], v[136:139], v[112:115]
    v_mfma_f32_16x16x32_bf16 v[72:75], v[148:151], v[128:131], v[72:75]
    v_mfma_f32_16x16x32_bf16 v[80:83], v[152:155], v[128:131], v[80:83]
    v_mfma_f32_16x16x32_bf16 v[88:91], v[156:159], v[128:131], v[88:91]
    v_mfma_f32_16x16x32_bf16 v[96:99], v[160:163], v[128:131], v[96:99]
    v_mfma_f32_16x16x32_bf16 v[104:107], v[164:167], v[128:131], v[104:107]
    v_mfma_f32_16x16x32_bf16 v[116:119], v[144:147], v[140:143], v[116:119]
    v_mfma_f32_16x16x32_bf16 v[76:79], v[148:151], v[132:135], v[76:79]
    v_mfma_f32_16x16x32_bf16 v[84:87], v[152:155], v[132:135], v[84:87]
    v_mfma_f32_16x16x32_bf16 v[92:95], v[156:159], v[132:135], v[92:95]
    v_mfma_f32_16x16x32_bf16 v[100:103], v[160:163], v[132:135], v[100:103]
    v_mfma_f32_16x16x32_bf16 v[108:111], v[164:167], v[132:135], v[108:111]
    s_add_u32 s54, s58, 192
    s_add_u32 s55, s54, 0x9d00000
    buffer_load_dwordx4 v[168:171], v7, s[8:11], s55 offen sc1
    buffer_load_dwordx4 v[176:179], v7, s[24:27], s54 offen
    s_add_u32 s54, s58, 20672
    s_add_u32 s55, s54, 0x9d00000
    buffer_load_dwordx4 v[172:175], v7, s[8:11], s55 offen sc1
    buffer_load_dwordx4 v[180:183], v7, s[24:27], s54 offen
    buffer_load_dwordx4 v[184:187], v10, s[12:15], s60 offen offset:192
    s_add_u32 s54, s59, 3072
    buffer_load_dwordx4 v[188:191], v6, s[8:11], s54 offen sc1
    s_add_u32 s54, s59, 23552
    buffer_load_dwordx4 v[192:195], v6, s[8:11], s54 offen sc1
    s_add_u32 s54, s59, 44032
    buffer_load_dwordx4 v[196:199], v6, s[8:11], s54 offen sc1
    s_add_u32 s54, s59, 64512
    buffer_load_dwordx4 v[200:203], v6, s[8:11], s54 offen sc1
    s_add_u32 s54, s59, 84992
    buffer_load_dwordx4 v[204:207], v6, s[8:11], s54 offen sc1
    s_waitcnt vmcnt(0)
    v_mfma_f32_16x16x32_bf16 v[112:115], v[184:187], v[176:179], v[112:115]
    v_mfma_f32_16x16x32_bf16 v[72:75], v[188:191], v[168:171], v[72:75]
    v_mfma_f32_16x16x32_bf16 v[80:83], v[192:195], v[168:171], v[80:83]
    v_mfma_f32_16x16x32_bf16 v[88:91], v[196:199], v[168:171], v[88:91]
    v_mfma_f32_16x16x32_bf16 v[96:99], v[200:203], v[168:171], v[96:99]
    v_mfma_f32_16x16x32_bf16 v[104:107], v[204:207], v[168:171], v[104:107]
    v_mfma_f32_16x16x32_bf16 v[116:119], v[184:187], v[180:183], v[116:119]
    v_mfma_f32_16x16x32_bf16 v[76:79], v[188:191], v[172:175], v[76:79]
    v_mfma_f32_16x16x32_bf16 v[84:87], v[192:195], v[172:175], v[84:87]
    v_mfma_f32_16x16x32_bf16 v[92:95], v[196:199], v[172:175], v[92:95]
    v_mfma_f32_16x16x32_bf16 v[100:103], v[200:203], v[172:175], v[100:103]
    v_mfma_f32_16x16x32_bf16 v[108:111], v[204:207], v[172:175], v[108:111]
    s_add_u32 s54, s58, 256
    s_add_u32 s55, s54, 0x9d00000
    buffer_load_dwordx4 v[128:131], v7, s[8:11], s55 offen sc1
    buffer_load_dwordx4 v[136:139], v7, s[24:27], s54 offen
    s_add_u32 s54, s58, 20736
    s_add_u32 s55, s54, 0x9d00000
    buffer_load_dwordx4 v[132:135], v7, s[8:11], s55 offen sc1
    buffer_load_dwordx4 v[140:143], v7, s[24:27], s54 offen
    buffer_load_dwordx4 v[144:147], v10, s[12:15], s60 offen offset:256
    s_add_u32 s54, s59, 4096
    buffer_load_dwordx4 v[148:151], v6, s[8:11], s54 offen sc1
    s_add_u32 s54, s59, 24576
    buffer_load_dwordx4 v[152:155], v6, s[8:11], s54 offen sc1
    s_add_u32 s54, s59, 45056
    buffer_load_dwordx4 v[156:159], v6, s[8:11], s54 offen sc1
    s_add_u32 s54, s59, 65536
    buffer_load_dwordx4 v[160:163], v6, s[8:11], s54 offen sc1
    s_add_u32 s54, s59, 86016
    buffer_load_dwordx4 v[164:167], v6, s[8:11], s54 offen sc1
    s_waitcnt vmcnt(0)
    v_mfma_f32_16x16x32_bf16 v[112:115], v[144:147], v[136:139], v[112:115]
    v_mfma_f32_16x16x32_bf16 v[72:75], v[148:151], v[128:131], v[72:75]
    v_mfma_f32_16x16x32_bf16 v[80:83], v[152:155], v[128:131], v[80:83]
    v_mfma_f32_16x16x32_bf16 v[88:91], v[156:159], v[128:131], v[88:91]
    v_mfma_f32_16x16x32_bf16 v[96:99], v[160:163], v[128:131], v[96:99]
    v_mfma_f32_16x16x32_bf16 v[104:107], v[164:167], v[128:131], v[104:107]
    v_mfma_f32_16x16x32_bf16 v[116:119], v[144:147], v[140:143], v[116:119]
    v_mfma_f32_16x16x32_bf16 v[76:79], v[148:151], v[132:135], v[76:79]
    v_mfma_f32_16x16x32_bf16 v[84:87], v[152:155], v[132:135], v[84:87]
    v_mfma_f32_16x16x32_bf16 v[92:95], v[156:159], v[132:135], v[92:95]
    v_mfma_f32_16x16x32_bf16 v[100:103], v[160:163], v[132:135], v[100:103]
    v_mfma_f32_16x16x32_bf16 v[108:111], v[164:167], v[132:135], v[108:111]
    s_and_b32 s55, s30, 1
    s_lshl_b32 s55, s55, 7
    s_add_u32 s55, s55, 0xa600100
    s_cmp_eq_u32 s32, 0
    s_cbranch_scc0 GBww_220
    s_add_u32 s54, s30, 1
    v_min_u32 v12, 31, v1
    v_mul_u32_u24 v12, 4, v12
    s_mov_b32 s43, 0x40000
GBwl_221:
    buffer_load_dword v13, v12, s[8:11], s55 offen sc1
    s_waitcnt vmcnt(0)
    v_cmp_gt_u32 vcc, 128, v13
    s_nop 1
    v_cndmask_b32 v13, 0, v13, vcc
    v_cmp_gt_u32 vcc, s54, v13
    s_cbranch_vccz GBwd_222
    s_sleep 8
    s_sub_u32 s43, s43, 1
    s_cbranch_scc0 GBwl_221
GBwd_222:
GBww_220:
    s_barrier
    s_lshl_b32 s58, s30, 5
    s_lshl_b32 s54, s32, 3
    s_add_u32 s58, s58, s54
    s_mul_i32 s59, s58, 40960
    s_mul_i32 s54, s31, 5120
    s_add_u32 s59, s59, s54
    s_add_u32 s59, s59, 0x2000000
    s_add_u32 s54, s59, 0
    buffer_load_dwordx4 a[0:3], v6, s[8:11], s54 offen sc1
    s_add_u32 s54, s59, 1024
    buffer_load_dwordx4 a[4:7], v6, s[8:11], s54 offen sc1
    s_add_u32 s54, s59, 2048
    buffer_load_dwordx4 a[8:11], v6, s[8:11], s54 offen sc1
    s_add_u32 s54, s59, 3072
    buffer_load_dwordx4 a[12:15], v6, s[8:11], s54 offen sc1
    s_add_u32 s54, s59, 4096
    buffer_load_dwordx4 a[16:19], v6, s[8:11], s54 offen sc1
    s_add_u32 s54, s59, 40960
    buffer_load_dwordx4 a[20:23], v6, s[8:11], s54 offen sc1
    s_add_u32 s54, s59, 41984
    buffer_load_dwordx4 a[24:27], v6, s[8:11], s54 offen sc1
    s_add_u32 s54, s59, 43008
    buffer_load_dwordx4 a[28:31], v6, s[8:11], s54 offen sc1
    s_add_u32 s54, s59, 44032
    buffer_load_dwordx4 a[32:35], v6, s[8:11], s54 offen sc1
    s_add_u32 s54, s59, 45056
    buffer_load_dwordx4 a[36:39], v6, s[8:11], s54 offen sc1
    s_add_u32 s54, s59, 81920
    buffer_load_dwordx4 a[40:43], v6, s[8:11], s54 offen sc1
    s_add_u32 s54, s59, 82944
    buffer_load_dwordx4 a[44:47], v6, s[8:11], s54 offen sc1
    s_add_u32 s54, s59, 83968
    buffer_load_dwordx4 a[48:51], v6, s[8:11], s54 offen sc1
    s_add_u32 s54, s59, 84992
    buffer_load_dwordx4 a[52:55], v6, s[8:11], s54 offen sc1
    s_add_u32 s54, s59, 86016
    buffer_load_dwordx4 a[56:59], v6, s[8:11], s54 offen sc1
    s_add_u32 s54, s59, 122880
    buffer_load_dwordx4 a[60:63], v6, s[8:11], s54 offen sc1
    s_add_u32 s54, s59, 123904
    buffer_load_dwordx4 a[64:67], v6, s[8:11], s54 offen sc1
    s_add_u32 s54, s59, 124928
    buffer_load_dwordx4 a[68:71], v6, s[8:11], s54 offen sc1
    s_add_u32 s54, s59, 125952
    buffer_load_dwordx4 a[72:75], v6, s[8:11], s54 offen sc1
    s_add_u32 s54, s59, 126976
    buffer_load_dwordx4 a[76:79], v6, s[8:11], s54 offen sc1
    s_add_u32 s54, s59, 163840
    buffer_load_dwordx4 a[80:83], v6, s[8:11], s54 offen sc1
    s_add_u32 s54, s59, 164864
    buffer_load_dwordx4 a[84:87], v6, s[8:11], s54 offen sc1
    s_add_u32 s54, s59, 165888
    buffer_load_dwordx4 a[88:91], v6, s[8:11], s54 offen sc1
    s_add_u32 s54, s59, 166912
    buffer_load_dwordx4 a[92:95], v6, s[8:11], s54 offen sc1
    s_add_u32 s54, s59, 167936
    buffer_load_dwordx4 a[96:99], v6, s[8:11], s54 offen sc1
    s_add_u32 s54, s59, 204800
    buffer_load_dwordx4 a[100:103], v6, s[8:11], s54 offen sc1
    s_add_u32 s54, s59, 205824
    buffer_load_dwordx4 a[104:107], v6, s[8:11], s54 offen sc1
    s_add_u32 s54, s59, 206848
    buffer_load_dwordx4 a[108:111], v6, s[8:11], s54 offen sc1
    s_add_u32 s54, s59, 207872
    buffer_load_dwordx4 a[112:115], v6, s[8:11], s54 offen sc1
    s_add_u32 s54, s59, 208896
    buffer_load_dwordx4 a[116:119], v6, s[8:11], s54 offen sc1
    s_add_u32 s54, s59, 245760
    buffer_load_dwordx4 a[120:123], v6, s[8:11], s54 offen sc1
    s_add_u32 s54, s59, 246784
    buffer_load_dwordx4 a[124:127], v6, s[8:11], s54 offen sc1
    s_add_u32 s54, s59, 247808
    buffer_load_dwordx4 a[128:131], v6, s[8:11], s54 offen sc1
    s_add_u32 s54, s59, 248832
    buffer_load_dwordx4 a[132:135], v6, s[8:11], s54 offen sc1
    s_add_u32 s54, s59, 249856
    buffer_load_dwordx4 a[136:139], v6, s[8:11], s54 offen sc1
    s_add_u32 s54, s59, 286720
    buffer_load_dwordx4 a[140:143], v6, s[8:11], s54 offen sc1
    s_add_u32 s54, s59, 287744
    buffer_load_dwordx4 a[144:147], v6, s[8:11], s54 offen sc1
    s_add_u32 s54, s59, 288768
    buffer_load_dwordx4 a[148:151], v6, s[8:11], s54 offen sc1
    s_add_u32 s54, s59, 289792
    buffer_load_dwordx4 a[152:155], v6, s[8:11], s54 offen sc1
    s_add_u32 s54, s59, 290816
    buffer_load_dwordx4 a[156:159], v6, s[8:11], s54 offen sc1
    s_mov_b32 s55, 0xa600200
    s_cmp_eq_u32 s32, 0
    s_cbranch_scc0 GYww_223
    s_add_u32 s54, s30, 1
    v_min_u32 v12, 31, v1
    v_mul_u32_u24 v12, 4, v12
    s_mov_b32 s43, 0x40000
GYwl_224:
    buffer_load_dword v13, v12, s[8:11], s55 offen sc1
    s_waitcnt vmcnt(0)
    v_cmp_gt_u32 vcc, 128, v13
    s_nop 1
    v_cndmask_b32 v13, 0, v13, vcc
    v_cmp_gt_u32 vcc, s54, v13
    s_cbranch_vccz GYwd_225
    s_sleep 4
    s_sub_u32 s43, s43, 1
    s_cbranch_scc0 GYwl_224
GYwd_225:
GYww_223:
    s_barrier
    s_cmp_eq_u32 s30, 63
    s_cbranch_scc0 l63_226
    s_mov_b32 s55, 0xa600280
    s_cmp_eq_u32 s32, 0
    s_cbranch_scc0 GZww_227
    s_mov_b32 s54, 0x40
    v_min_u32 v12, 31, v1
    v_mul_u32_u24 v12, 4, v12
    s_mov_b32 s43, 0x40000
GZwl_228:
    buffer_load_dword v13, v12, s[8:11], s55 offen sc1
    s_waitcnt vmcnt(0)
    v_cmp_gt_u32 vcc, 128, v13
    s_nop 1
    v_cndmask_b32 v13, 0, v13, vcc
    v_cmp_gt_u32 vcc, s54, v13
    s_cbranch_vccz GZwd_229
    s_sleep 1
    s_sub_u32 s43, s43, 1
    s_cbranch_scc0 GZwl_228
GZwd_229:
GZww_227:
    s_barrier
l63_226:
    s_lshl_b32 s55, s30, 2
    s_add_u32 s55, s55, 0xa600400
    s_cmp_eq_u32 s32, 0
    s_cbranch_scc0 GPww_230
    s_mov_b32 s54, 0x4
    v_min_u32 v12, 0, v1
    v_mul_u32_u24 v12, 4, v12
    s_mov_b32 s43, 0x40000
GPwl_231:
    buffer_load_dword v13, v12, s[8:11], s55 offen sc1
    s_waitcnt vmcnt(0)
    v_cmp_gt_u32 vcc, 128, v13
    s_nop 1
    v_cndmask_b32 v13, 0, v13, vcc
    v_cmp_gt_u32 vcc, s54, v13
    s_cbranch_vccz GPwd_232
    s_sleep 1
    s_sub_u32 s43, s43, 1
    s_cbranch_scc0 GPwl_231
GPwd_232:
GPww_230:
    s_barrier
    s_lshl_b32 s58, s30, 14
    s_lshl_b32 s54, s32, 7
    s_add_u32 s58, s58, s54
    s_add_u32 s58, s58, 0xa500000
    s_mul_i32 s59, s30, 327680
    s_mul_i32 s54, s32, 81920
    s_add_u32 s59, s59, s54
    s_mul_i32 s54, s31, 1280
    s_add_u32 s59, s59, s54
    s_add_u32 s59, s59, 0x7000000
    s_add_u32 s54, s58, 0
    buffer_load_dwordx4 v[128:131], v8, s[8:11], s54 offen sc1
    s_add_u32 s54, s58, 8192
    buffer_load_dwordx4 v[132:135], v8, s[8:11], s54 offen sc1
    s_add_u32 s54, s59, 0
    buffer_load_dwordx4 v[136:139], v9, s[8:11], s54 offen offset:0 sc1
    buffer_load_dwordx4 v[140:143], v9, s[8:11], s54 offen offset:256 sc1
    buffer_load_dwordx4 v[144:147], v9, s[8:11], s54 offen offset:512 sc1
    buffer_load_dwordx4 v[148:151], v9, s[8:11], s54 offen offset:768 sc1
    buffer_load_dwordx4 v[152:155], v9, s[8:11], s54 offen offset:1024 sc1
    s_add_u32 s54, s58, 64
    buffer_load_dwordx4 v[156:159], v8, s[8:11], s54 offen sc1
    s_add_u32 s54, s58, 8256
    buffer_load_dwordx4 v[160:163], v8, s[8:11], s54 offen sc1
    s_add_u32 s54, s59, 40960
    buffer_load_dwordx4 v[164:167], v9, s[8:11], s54 offen offset:0 sc1
    buffer_load_dwordx4 v[168:171], v9, s[8:11], s54 offen offset:256 sc1
    buffer_load_dwordx4 v[172:175], v9, s[8:11], s54 offen offset:512 sc1
    buffer_load_dwordx4 v[176:179], v9, s[8:11], s54 offen offset:768 sc1
    buffer_load_dwordx4 v[180:183], v9, s[8:11], s54 offen offset:1024 sc1
    s_lshl_b32 s58, s30, 5
    s_lshl_b32 s54, s32, 3
    s_add_u32 s58, s58, s54
    s_lshl_b32 s58, s58, 11
    s_add_u32 s58, s58, 0xa100000
    s_add_u32 s54, s58, 0
    buffer_load_dwordx4 v[184:187], v6, s[8:11], s54 offen offset:0 sc1
    buffer_load_dwordx4 v[188:191], v6, s[8:11], s54 offen offset:1024 sc1
    s_add_u32 s54, s58, 2048
    buffer_load_dwordx4 v[192:195], v6, s[8:11], s54 offen offset:0 sc1
    buffer_load_dwordx4 v[196:199], v6, s[8:11], s54 offen offset:1024 sc1
    s_add_u32 s54, s58, 4096
    buffer_load_dwordx4 v[200:203], v6, s[8:11], s54 offen offset:0 sc1
    buffer_load_dwordx4 v[204:207], v6, s[8:11], s54 offen offset:1024 sc1
    s_add_u32 s54, s58, 6144
    buffer_load_dwordx4 v[208:211], v6, s[8:11], s54 offen offset:0 sc1
    buffer_load_dwordx4 v[212:215], v6, s[8:11], s54 offen offset:1024 sc1
    s_add_u32 s54, s58, 8192
    buffer_load_dwordx4 v[216:219], v6, s[8:11], s54 offen offset:0 sc1
    buffer_load_dwordx4 v[220:223], v6, s[8:11], s54 offen offset:1024 sc1
    s_add_u32 s54, s58, 10240
    buffer_load_dwordx4 v[224:227], v6, s[8:11], s54 offen offset:0 sc1
    buffer_load_dwordx4 v[228:231], v6, s[8:11], s54 offen offset:1024 sc1
    s_add_u32 s54, s58, 12288
    buffer_load_dwordx4 v[232:235], v6, s[8:11], s54 offen offset:0 sc1
    buffer_load_dwordx4 v[236:239], v6, s[8:11], s54 offen offset:1024 sc1
    s_add_u32 s54, s58, 14336
    buffer_load_dwordx4 v[240:243], v6, s[8:11], s54 offen offset:0 sc1
    buffer_load_dwordx4 v[244:247], v6, s[8:11], s54 offen offset:1024 sc1
    s_waitcnt vmcnt(16)
    v_mfma_f32_16x16x32_bf16 v[32:35], v[136:139], v[128:131], 0
    v_mfma_f32_16x16x32_bf16 v[36:39], v[136:139], v[132:135], 0
    v_mfma_f32_16x16x32_bf16 v[40:43], v[140:143], v[128:131], 0
    v_mfma_f32_16x16x32_bf16 v[44:47], v[140:143], v[132:135], 0
    v_mfma_f32_16x16x32_bf16 v[48:51], v[144:147], v[128:131], 0
    v_mfma_f32_16x16x32_bf16 v[52:55], v[144:147], v[132:135], 0
    v_mfma_f32_16x16x32_bf16 v[56:59], v[148:151], v[128:131], 0
    v_mfma_f32_16x16x32_bf16 v[60:63], v[148:151], v[132:135], 0
    v_mfma_f32_16x16x32_bf16 v[64:67], v[152:155], v[128:131], 0
    v_mfma_f32_16x16x32_bf16 v[68:71], v[152:155], v[132:135], 0
    v_mfma_f32_16x16x32_bf16 v[32:35], v[164:167], v[156:159], v[32:35]
    v_mfma_f32_16x16x32_bf16 v[36:39], v[164:167], v[160:163], v[36:39]
    v_mfma_f32_16x16x32_bf16 v[40:43], v[168:171], v[156:159], v[40:43]
    v_mfma_f32_16x16x32_bf16 v[44:47], v[168:171], v[160:163], v[44:47]
    v_mfma_f32_16x16x32_bf16 v[48:51], v[172:175], v[156:159], v[48:51]
    v_mfma_f32_16x16x32_bf16 v[52:55], v[172:175], v[160:163], v[52:55]
    v_mfma_f32_16x16x32_bf16 v[56:59], v[176:179], v[156:159], v[56:59]
    v_mfma_f32_16x16x32_bf16 v[60:63], v[176:179], v[160:163], v[60:63]
    v_mfma_f32_16x16x32_bf16 v[64:67], v[180:183], v[156:159], v[64:67]
    v_mfma_f32_16x16x32_bf16 v[68:71], v[180:183], v[160:163], v[68:71]
    s_waitcnt vmcnt(14)
    v_mfma_f32_16x16x32_bf16 v[32:35], a[0:3], v[184:187], v[32:35]
    v_mfma_f32_16x16x32_bf16 v[36:39], a[0:3], v[188:191], v[36:39]
    v_mfma_f32_16x16x32_bf16 v[40:43], a[4:7], v[184:187], v[40:43]
    v_mfma_f32_16x16x32_bf16 v[44:47], a[4:7], v[188:191], v[44:47]
    v_mfma_f32_16x16x32_bf16 v[48:51], a[8:11], v[184:187], v[48:51]
    v_mfma_f32_16x16x32_bf16 v[52:55], a[8:11], v[188:191], v[52:55]
    v_mfma_f32_16x16x32_bf16 v[56:59], a[12:15], v[184:187], v[56:59]
    v_mfma_f32_16x16x32_bf16 v[60:63], a[12:15], v[188:191], v[60:63]
    v_mfma_f32_16x16x32_bf16 v[64:67], a[16:19], v[184:187], v[64:67]
    v_mfma_f32_16x16x32_bf16 v[68:71], a[16:19], v[188:191], v[68:71]
    s_waitcnt vmcnt(12)
    v_mfma_f32_16x16x32_bf16 v[32:35], a[20:23], v[192:195], v[32:35]
    v_mfma_f32_16x16x32_bf16 v[36:39], a[20:23], v[196:199], v[36:39]
    v_mfma_f32_16x16x32_bf16 v[40:43], a[24:27], v[192:195], v[40:43]
    v_mfma_f32_16x16x32_bf16 v[44:47], a[24:27], v[196:199], v[44:47]
    v_mfma_f32_16x16x32_bf16 v[48:51], a[28:31], v[192:195], v[48:51]
    v_mfma_f32_16x16x32_bf16 v[52:55], a[28:31], v[196:199], v[52:55]
    v_mfma_f32_16x16x32_bf16 v[56:59], a[32:35], v[192:195], v[56:59]
    v_mfma_f32_16x16x32_bf16 v[60:63], a[32:35], v[196:199], v[60:63]
    v_mfma_f32_16x16x32_bf16 v[64:67], a[36:39], v[192:195], v[64:67]
    v_mfma_f32_16x16x32_bf16 v[68:71], a[36:39], v[196:199], v[68:71]
    s_waitcnt vmcnt(10)
    v_mfma_f32_16x16x32_bf16 v[32:35], a[40:43], v[200:203], v[32:35]
    v_mfma_f32_16x16x32_bf16 v[36:39], a[40:43], v[204:207], v[36:39]
    v_mfma_f32_16x16x32_bf16 v[40:43], a[44:47], v[200:203], v[40:43]
    v_mfma_f32_16x16x32_bf16 v[44:47], a[44:47], v[204:207], v[44:47]
    v_mfma_f32_16x16x32_bf16 v[48:51], a[48:51], v[200:203], v[48:51]
    v_mfma_f32_16x16x32_bf16 v[52:55], a[48:51], v[204:207], v[52:55]
    v_mfma_f32_16x16x32_bf16 v[56:59], a[52:55], v[200:203], v[56:59]
    v_mfma_f32_16x16x32_bf16 v[60:63], a[52:55], v[204:207], v[60:63]
    v_mfma_f32_16x16x32_bf16 v[64:67], a[56:59], v[200:203], v[64:67]
    v_mfma_f32_16x16x32_bf16 v[68:71], a[56:59], v[204:207], v[68:71]
    s_waitcnt vmcnt(8)
    v_mfma_f32_16x16x32_bf16 v[32:35], a[60:63], v[208:211], v[32:35]
    v_mfma_f32_16x16x32_bf16 v[36:39], a[60:63], v[212:215], v[36:39]
    v_mfma_f32_16x16x32_bf16 v[40:43], a[64:67], v[208:211], v[40:43]
    v_mfma_f32_16x16x32_bf16 v[44:47], a[64:67], v[212:215], v[44:47]
    v_mfma_f32_16x16x32_bf16 v[48:51], a[68:71], v[208:211], v[48:51]
    v_mfma_f32_16x16x32_bf16 v[52:55], a[68:71], v[212:215], v[52:55]
    v_mfma_f32_16x16x32_bf16 v[56:59], a[72:75], v[208:211], v[56:59]
    v_mfma_f32_16x16x32_bf16 v[60:63], a[72:75], v[212:215], v[60:63]
    v_mfma_f32_16x16x32_bf16 v[64:67], a[76:79], v[208:211], v[64:67]
    v_mfma_f32_16x16x32_bf16 v[68:71], a[76:79], v[212:215], v[68:71]
    s_waitcnt vmcnt(6)
    v_mfma_f32_16x16x32_bf16 v[32:35], a[80:83], v[216:219], v[32:35]
    v_mfma_f32_16x16x32_bf16 v[36:39], a[80:83], v[220:223], v[36:39]
    v_mfma_f32_16x16x32_bf16 v[40:43], a[84:87], v[216:219], v[40:43]
    v_mfma_f32_16x16x32_bf16 v[44:47], a[84:87], v[220:223], v[44:47]
    v_mfma_f32_16x16x32_bf16 v[48:51], a[88:91], v[216:219], v[48:51]
    v_mfma_f32_16x16x32_bf16 v[52:55], a[88:91], v[220:223], v[52:55]
    v_mfma_f32_16x16x32_bf16 v[56:59], a[92:95], v[216:219], v[56:59]
    v_mfma_f32_16x16x32_bf16 v[60:63], a[92:95], v[220:223], v[60:63]
    v_mfma_f32_16x16x32_bf16 v[64:67], a[96:99], v[216:219], v[64:67]
    v_mfma_f32_16x16x32_bf16 v[68:71], a[96:99], v[220:223], v[68:71]
    s_waitcnt vmcnt(4)
    v_mfma_f32_16x16x32_bf16 v[32:35], a[100:103], v[224:227], v[32:35]
    v_mfma_f32_16x16x32_bf16 v[36:39], a[100:103], v[228:231], v[36:39]
    v_mfma_f32_16x16x32_bf16 v[40:43], a[104:107], v[224:227], v[40:43]
    v_mfma_f32_16x16x32_bf16 v[44:47], a[104:107], v[228:231], v[44:47]
    v_mfma_f32_16x16x32_bf16 v[48:51], a[108:111], v[224:227], v[48:51]
    v_mfma_f32_16x16x32_bf16 v[52:55], a[108:111], v[228:231], v[52:55]
    v_mfma_f32_16x16x32_bf16 v[56:59], a[112:115], v[224:227], v[56:59]
    v_mfma_f32_16x16x32_bf16 v[60:63], a[112:115], v[228:231], v[60:63]
    v_mfma_f32_16x16x32_bf16 v[64:67], a[116:119], v[224:227], v[64:67]
    v_mfma_f32_16x16x32_bf16 v[68:71], a[116:119], v[228:231], v[68:71]
    s_waitcnt vmcnt(2)
    v_mfma_f32_16x16x32_bf16 v[32:35], a[120:123], v[232:235], v[32:35]
    v_mfma_f32_16x16x32_bf16 v[36:39], a[120:123], v[236:239], v[36:39]
    v_mfma_f32_16x16x32_bf16 v[40:43], a[124:127], v[232:235], v[40:43]
    v_mfma_f32_16x16x32_bf16 v[44:47], a[124:127], v[236:239], v[44:47]
    v_mfma_f32_16x16x32_bf16 v[48:51], a[128:131], v[232:235], v[48:51]
    v_mfma_f32_16x16x32_bf16 v[52:55], a[128:131], v[236:239], v[52:55]
    v_mfma_f32_16x16x32_bf16 v[56:59], a[132:135], v[232:235], v[56:59]
    v_mfma_f32_16x16x32_bf16 v[60:63], a[132:135], v[236:239], v[60:63]
    v_mfma_f32_16x16x32_bf16 v[64:67], a[136:139], v[232:235], v[64:67]
    v_mfma_f32_16x16x32_bf16 v[68:71], a[136:139], v[236:239], v[68:71]
    s_waitcnt vmcnt(0)
    v_mfma_f32_16x16x32_bf16 v[32:35], a[140:143], v[240:243], v[32:35]
    v_mfma_f32_16x16x32_bf16 v[36:39], a[140:143], v[244:247], v[36:39]
    v_mfma_f32_16x16x32_bf16 v[40:43], a[144:147], v[240:243], v[40:43]
    v_mfma_f32_16x16x32_bf16 v[44:47], a[144:147], v[244:247], v[44:47]
    v_mfma_f32_16x16x32_bf16 v[48:51], a[148:151], v[240:243], v[48:51]
    v_mfma_f32_16x16x32_bf16 v[52:55], a[148:151], v[244:247], v[52:55]
    v_mfma_f32_16x16x32_bf16 v[56:59], a[152:155], v[240:243], v[56:59]
    v_mfma_f32_16x16x32_bf16 v[60:63], a[152:155], v[244:247], v[60:63]
    v_mfma_f32_16x16x32_bf16 v[64:67], a[156:159], v[240:243], v[64:67]
    v_mfma_f32_16x16x32_bf16 v[68:71], a[156:159], v[244:247], v[68:71]
    s_nop 7
    s_mul_i32 s54, s32, 22528
    v_add_u32 v12, s54, v6
    ds_write_b128 v12, v[32:35] offset:0
    ds_write_b128 v12, v[72:75] offset:10240
    ds_write_b128 v12, v[36:39] offset:1024
    ds_write_b128 v12, v[76:79] offset:11264
    ds_write_b128 v12, v[40:43] offset:2048
    ds_write_b128 v12, v[80:83] offset:12288
    ds_write_b128 v12, v[44:47] offset:3072
    ds_write_b128 v12, v[84:87] offset:13312
    ds_write_b128 v12, v[48:51] offset:4096
    ds_write_b128 v12, v[88:91] offset:14336
    ds_write_b128 v12, v[52:55] offset:5120
    ds_write_b128 v12, v[92:95] offset:15360
    ds_write_b128 v12, v[56:59] offset:6144
    ds_write_b128 v12, v[96:99] offset:16384
    ds_write_b128 v12, v[60:63] offset:7168
    ds_write_b128 v12, v[100:103] offset:17408
    ds_write_b128 v12, v[64:67] offset:8192
    ds_write_b128 v12, v[104:107] offset:18432
    ds_write_b128 v12, v[68:71] offset:9216
    ds_write_b128 v12, v[108:111] offset:19456
    ds_write_b128 v12, v[112:115] offset:20480
    ds_write_b128 v12, v[116:119] offset:21504
    s_waitcnt lgkmcnt(0)
    s_barrier
    v_mul_u32_u24 v11, 1280, v2
    v_lshl_add_u32 v11, v3, 3, v11
    s_add_u32 s58, s32, 0
    s_lshl_b32 s59, s58, 10
    v_add_u32 v12, s59, v6
    s_and_b32 s60, s58, 1
    s_lshl_b32 s61, s60, 10
    v_add_u32 v13, s61, v6
    v_add_u32 v14, 0, v12
    ds_read_b128 v[128:131], v14
    ds_read_b128 v[144:147], v14 offset:10240
    v_add_u32 v15, 20480, v13
    ds_read_b32 v160, v15
    v_add_u32 v14, 22528, v12
    ds_read_b128 v[132:135], v14
    ds_read_b128 v[148:151], v14 offset:10240
    v_add_u32 v15, 43008, v13
    ds_read_b32 v161, v15
    v_add_u32 v14, 45056, v12
    ds_read_b128 v[136:139], v14
    ds_read_b128 v[152:155], v14 offset:10240
    v_add_u32 v15, 65536, v13
    ds_read_b32 v162, v15
    v_add_u32 v14, 67584, v12
    ds_read_b128 v[140:143], v14
    ds_read_b128 v[156:159], v14 offset:10240
    v_add_u32 v15, 88064, v13
    ds_read_b32 v163, v15
    s_waitcnt lgkmcnt(0)
    v_add_f32 v128, v128, v132
    v_add_f32 v136, v136, v140
    v_add_f32 v129, v129, v133
    v_add_f32 v137, v137, v141
    v_add_f32 v130, v130, v134
    v_add_f32 v138, v138, v142
    v_add_f32 v131, v131, v135
    v_add_f32 v139, v139, v143
    v_add_f32 v128, v128, v136
    v_add_f32 v129, v129, v137
    v_add_f32 v130, v130, v138
    v_add_f32 v131, v131, v139
    v_add_f32 v144, v144, v148
    v_add_f32 v152, v152, v156
    v_add_f32 v145, v145, v149
    v_add_f32 v153, v153, v157
    v_add_f32 v146, v146, v150
    v_add_f32 v154, v154, v158
    v_add_f32 v147, v147, v151
    v_add_f32 v155, v155, v159
    v_add_f32 v144, v144, v152
    v_add_f32 v145, v145, v153
    v_add_f32 v146, v146, v154
    v_add_f32 v147, v147, v155
    v_add_f32 v160, v160, v161
    v_add_f32 v162, v162, v163
    v_add_f32 v160, v160, v162
    v_mul_f32 v160, 0xbfb8aa3b, v160
    v_exp_f32 v160, v160
    s_nop 0
    v_add_f32 v160, 1.0, v160
    v_rcp_f32 v160, v160
    s_nop 0
    v_sub_f32 v144, v144, v128
    v_fma_f32 v128, v144, v160, v128
    v_sub_f32 v145, v145, v129
    v_fma_f32 v129, v145, v160, v129
    v_sub_f32 v146, v146, v130
    v_fma_f32 v130, v146, v160, v130
    v_sub_f32 v147, v147, v131
    v_fma_f32 v131, v147, v160, v131
    v_cvt_pk_bf16_f32 v132, v128, v129
    v_cvt_pk_bf16_f32 v133, v130, v131
    s_lshl_b32 s61, s30, 1
    s_add_u32 s61, s61, s60
    s_mul_i32 s61, s61, 20480
    s_mul_i32 s59, s31, 5
    s_lshr_b32 s60, s58, 1
    s_add_u32 s59, s59, s60
    s_lshl_b32 s59, s59, 5
    s_add_u32 s61, s61, s59
    buffer_store_dwordx2 v[132:133], v11, s[16:19], s61 offen
GOsk_233:
    s_add_u32 s58, s32, 4
    s_lshl_b32 s59, s58, 10
    v_add_u32 v12, s59, v6
    s_and_b32 s60, s58, 1
    s_lshl_b32 s61, s60, 10
    v_add_u32 v13, s61, v6
    v_add_u32 v14, 0, v12
    ds_read_b128 v[128:131], v14
    ds_read_b128 v[144:147], v14 offset:10240
    v_add_u32 v15, 20480, v13
    ds_read_b32 v160, v15
    v_add_u32 v14, 22528, v12
    ds_read_b128 v[132:135], v14
    ds_read_b128 v[148:151], v14 offset:10240
    v_add_u32 v15, 43008, v13
    ds_read_b32 v161, v15
    v_add_u32 v14, 45056, v12
    ds_read_b128 v[136:139], v14
    ds_read_b128 v[152:155], v14 offset:10240
    v_add_u32 v15, 65536, v13
    ds_read_b32 v162, v15
    v_add_u32 v14, 67584, v12
    ds_read_b128 v[140:143], v14
    ds_read_b128 v[156:159], v14 offset:10240
    v_add_u32 v15, 88064, v13
    ds_read_b32 v163, v15
    s_waitcnt lgkmcnt(0)
    v_add_f32 v128, v128, v132
    v_add_f32 v136, v136, v140
    v_add_f32 v129, v129, v133
    v_add_f32 v137, v137, v141
    v_add_f32 v130, v130, v134
    v_add_f32 v138, v138, v142
    v_add_f32 v131, v131, v135
    v_add_f32 v139, v139, v143
    v_add_f32 v128, v128, v136
    v_add_f32 v129, v129, v137
    v_add_f32 v130, v130, v138
    v_add_f32 v131, v131, v139
    v_add_f32 v144, v144, v148
    v_add_f32 v152, v152, v156
    v_add_f32 v145, v145, v149
    v_add_f32 v153, v153, v157
    v_add_f32 v146, v146, v150
    v_add_f32 v154, v154, v158
    v_add_f32 v147, v147, v151
    v_add_f32 v155, v155, v159
    v_add_f32 v144, v144, v152
    v_add_f32 v145, v145, v153
    v_add_f32 v146, v146, v154
    v_add_f32 v147, v147, v155
    v_add_f32 v160, v160, v161
    v_add_f32 v162, v162, v163
    v_add_f32 v160, v160, v162
    v_mul_f32 v160, 0xbfb8aa3b, v160
    v_exp_f32 v160, v160
    s_nop 0
    v_add_f32 v160, 1.0, v160
    v_rcp_f32 v160, v160
    s_nop 0
    v_sub_f32 v144, v144, v128
    v_fma_f32 v128, v144, v160, v128
    v_sub_f32 v145, v145, v129
    v_fma_f32 v129, v145, v160, v129
    v_sub_f32 v146, v146, v130
    v_fma_f32 v130, v146, v160, v130
    v_sub_f32 v147, v147, v131
    v_fma_f32 v131, v147, v160, v131
    v_cvt_pk_bf16_f32 v132, v128, v129
    v_cvt_pk_bf16_f32 v133, v130, v131
    s_lshl_b32 s61, s30, 1
    s_add_u32 s61, s61, s60
    s_mul_i32 s61, s61, 20480
    s_mul_i32 s59, s31, 5
    s_lshr_b32 s60, s58, 1
    s_add_u32 s59, s59, s60
    s_lshl_b32 s59, s59, 5
    s_add_u32 s61, s61, s59
    buffer_store_dwordx2 v[132:133], v11, s[16:19], s61 offen
GOsk_234:
    s_add_u32 s58, s32, 8
    s_cmp_ge_u32 s58, 10
    s_cbranch_scc1 GOsk_235
    s_lshl_b32 s59, s58, 10
    v_add_u32 v12, s59, v6
    s_and_b32 s60, s58, 1
    s_lshl_b32 s61, s60, 10
    v_add_u32 v13, s61, v6
    v_add_u32 v14, 0, v12
    ds_read_b128 v[128:131], v14
    ds_read_b128 v[144:147], v14 offset:10240
    v_add_u32 v15, 20480, v13
    ds_read_b32 v160, v15
    v_add_u32 v14, 22528, v12
    ds_read_b128 v[132:135], v14
    ds_read_b128 v[148:151], v14 offset:10240
    v_add_u32 v15, 43008, v13
    ds_read_b32 v161, v15
    v_add_u32 v14, 45056, v12
    ds_read_b128 v[136:139], v14
    ds_read_b128 v[152:155], v14 offset:10240
    v_add_u32 v15, 65536, v13
    ds_read_b32 v162, v15
    v_add_u32 v14, 67584, v12
    ds_read_b128 v[140:143], v14
    ds_read_b128 v[156:159], v14 offset:10240
    v_add_u32 v15, 88064, v13
    ds_read_b32 v163, v15
    s_waitcnt lgkmcnt(0)
    v_add_f32 v128, v128, v132
    v_add_f32 v136, v136, v140
    v_add_f32 v129, v129, v133
    v_add_f32 v137, v137, v141
    v_add_f32 v130, v130, v134
    v_add_f32 v138, v138, v142
    v_add_f32 v131, v131, v135
    v_add_f32 v139, v139, v143
    v_add_f32 v128, v128, v136
    v_add_f32 v129, v129, v137
    v_add_f32 v130, v130, v138
    v_add_f32 v131, v131, v139
    v_add_f32 v144, v144, v148
    v_add_f32 v152, v152, v156
    v_add_f32 v145, v145, v149
    v_add_f32 v153, v153, v157
    v_add_f32 v146, v146, v150
    v_add_f32 v154, v154, v158
    v_add_f32 v147, v147, v151
    v_add_f32 v155, v155, v159
    v_add_f32 v144, v144, v152
    v_add_f32 v145, v145, v153
    v_add_f32 v146, v146, v154
    v_add_f32 v147, v147, v155
    v_add_f32 v160, v160, v161
    v_add_f32 v162, v162, v163
    v_add_f32 v160, v160, v162
    v_mul_f32 v160, 0xbfb8aa3b, v160
    v_exp_f32 v160, v160
    s_nop 0
    v_add_f32 v160, 1.0, v160
    v_rcp_f32 v160, v160
    s_nop 0
    v_sub_f32 v144, v144, v128
    v_fma_f32 v128, v144, v160, v128
    v_sub_f32 v145, v145, v129
    v_fma_f32 v129, v145, v160, v129
    v_sub_f32 v146, v146, v130
    v_fma_f32 v130, v146, v160, v130
    v_sub_f32 v147, v147, v131
    v_fma_f32 v131, v147, v160, v131
    v_cvt_pk_bf16_f32 v132, v128, v129
    v_cvt_pk_bf16_f32 v133, v130, v131
    s_lshl_b32 s61, s30, 1
    s_add_u32 s61, s61, s60
    s_mul_i32 s61, s61, 20480
    s_mul_i32 s59, s31, 5
    s_lshr_b32 s60, s58, 1
    s_add_u32 s59, s59, s60
    s_lshl_b32 s59, s59, 5
    s_add_u32 s61, s61, s59
    buffer_store_dwordx2 v[132:133], v11, s[16:19], s61 offen
GOsk_235:
    s_waitcnt vmcnt(0)
    s_barrier
    s_cmp_eq_u32 s32, 0
    s_cbranch_scc0 GOdn_236
    v_mov_b32 v4, 1
    v_mov_b32 v5, 56
    s_mov_b64 exec, 1
    buffer_atomic_add v4, v5, s[20:23], 0 offen sc0
    s_waitcnt vmcnt(0)
    s_mov_b64 exec, -1
    v_readfirstlane_b32 s54, v4
    s_nop 3
    s_cmp_eq_u32 s54, 767
    s_cbranch_scc0 GOdn_236
    v_lshlrev_b32 v4, 5, v1
    v_mov_b32 v8, 0
    v_mov_b32 v9, 0
    v_mov_b32 v10, 0
    v_mov_b32 v11, 0
    s_mov_b32 s54, 0xa600000
    buffer_store_dwordx4 v[8:11], v4, s[8:11], s54 offen sc1
    buffer_store_dwordx4 v[8:11], v4, s[8:11], s54 offen offset:16 sc1
    s_waitcnt vmcnt(0)
GOdn_236:
    s_branch f_queue
    s_branch f_end
f_spare:
    v_lshlrev_b32 v4, 2, v2
    v_and_b32 v4, 28, v4
    s_mov_b32 s43, 0x40000
sp_237:
    buffer_load_dword v5, v4, s[20:23], 0 offen sc1
    s_waitcnt vmcnt(0)
    v_mov_b32 v6, v5
    s_nop 1
    v_add_u32_dpp v6, v6, v6 row_ror:1 row_mask:0xf bank_mask:0xf
    s_nop 1
    v_add_u32_dpp v6, v6, v6 row_ror:2 row_mask:0xf bank_mask:0xf
    s_nop 1
    v_add_u32_dpp v6, v6, v6 row_ror:4 row_mask:0xf bank_mask:0xf
    s_nop 1
    v_readfirstlane_b32 s54, v6
    v_readlane_b32 s55, v5, 0
    v_readlane_b32 s56, v5, 1
    s_nop 3
    s_cmp_ge_u32 s54, 256
    s_cbranch_scc1 sdn_238
    s_sleep 1
    s_sub_u32 s43, s43, 1
    s_cbranch_scc0 sp_237
sdn_238:
    s_min_u32 s55, s55, 32
    s_min_u32 s56, s56, 32
    s_sub_u32 s40, s40, 192
    s_sub_u32 s54, 32, s55
    s_mov_b32 s28, 0x0
    s_add_u32 s29, s55, s40
    s_cmp_lt_u32 s40, s54
    s_cbranch_scc1 f_chain
    s_sub_u32 s40, s40, s54
    s_mov_b32 s28, 0x1
    s_add_u32 s29, s56, s40
    s_cmp_lt_u32 s29, 32
    s_cbranch_scc1 f_chain
    s_branch f_end
f_end2:
f_end:
    s_endpgm
.section .rodata,"a"
.p2align 6
.amdhsa_kernel gated_mix__mha_block__memory_aug_recurrent_mem_tr__prompt_kernel
  .amdhsa_next_free_vgpr 512
  .amdhsa_next_free_sgpr 102
  .amdhsa_accum_offset 256
  .amdhsa_group_segment_fixed_size 0
  .amdhsa_kernarg_size 112
  .amdhsa_user_sgpr_count 2
  .amdhsa_user_sgpr_kernarg_segment_ptr 1
  .amdhsa_system_sgpr_workgroup_id_x 1
.end_amdhsa_kernel
```
